```python
import torch

def _softmax(x, axis=-1):
    return torch.softmax(x, dim=axis)
def _gelu(x):
    return torch.nn.functional.gelu(x, approximate="tanh")
def _silu(x):
    return torch.nn.functional.silu(x)
def _sigmoid(x):
    return torch.sigmoid(x)
def _layernorm(x, axis=-1, eps=1e-5):
    m = x.mean(dim=axis, keepdim=True)
    v = x.var(dim=axis, keepdim=True, unbiased=False)
    return (x - m) / torch.sqrt(v + eps)
def _scatter_add(tgt, idx, src, axis=0):
    return tgt.clone().index_add_(axis, idx, src)
def _segment_sum(src, seg, n):
    out = torch.zeros((n,) + src.shape[1:], dtype=src.dtype)
    return out.index_add_(0, seg, src)
def _pad(x, pw):
    flat = tuple(v for pair in reversed(pw) for v in pair)
    return torch.nn.functional.pad(x, flat)

kernel_name = 'concat_heads__compressed_kv_cla__linear_kernel_hedgehog__prompt'

def setup_inputs():

    _w = (lambda a: (lambda t: t.to(torch.bfloat16) if t.is_floating_point() else t)(torch.as_tensor(a)))
    def _A_setup():
        B, H, Sq, Sk, D, M = 1, 32, 2048, 2048, 128, 640
        Dc = 4 * D
        return {
            "x": _w((lambda *s: torch.randn(*s, dtype=torch.bfloat16) * 0.8)(B, Sq, M)),
            "c_kv": _w((lambda *s: torch.randn(*s, dtype=torch.bfloat16) * 0.4)(B, Sk, Dc)),
            "w_q": _w((lambda *s: torch.randn(*s, dtype=torch.bfloat16) * 6.4)(M, H, D) * (M ** -0.5)),
            "w_uk": _w((lambda *s: torch.randn(*s, dtype=torch.bfloat16) * 6.4)(Dc, H, D) * (Dc ** -0.5)),
            "w_uv": _w((lambda *s: torch.randn(*s, dtype=torch.bfloat16) * 0.4)(Dc, H, D) * (Dc ** -0.5)),
            "w_o": _w((lambda *s: torch.randn(*s, dtype=torch.bfloat16) * 0.4)(H, D, M) * ((H * D) ** -0.5)),
        }
    _A_in = _A_setup()

    def _B_setup():
        B, S, D, H = 1, 2048, 640, 32
        Dh = D // H
        return {
            "x": _w((lambda *s: torch.randn(*s, dtype=torch.bfloat16) * 0.4)(B, S, D)),
            "wqkv": _w((lambda *s: torch.randn(*s, dtype=torch.bfloat16) * 0.4)(D, 3 * D)),
            "w_phi": _w((lambda *s: torch.randn(*s, dtype=torch.bfloat16) * 0.4)(H, Dh, Dh) * (Dh ** -0.5)),
            "wo": _w((lambda *s: torch.randn(*s, dtype=torch.bfloat16) * 0.05)(D, D)),
        }
    _B_in = _B_setup()

    return {
        "A_x": _A_in["x"],
        "A_c_kv": _A_in["c_kv"],
        "A_w_q": _A_in["w_q"],
        "A_w_uk": _A_in["w_uk"],
        "A_w_uv": _A_in["w_uv"],
        "A_w_o": _A_in["w_o"],
        "B_x": _B_in["x"],
        "B_wqkv": _B_in["wqkv"],
        "B_w_phi": _B_in["w_phi"],
        "B_wo": _B_in["wo"],
    }

def reference(A_x, A_c_kv, A_w_q, A_w_uk, A_w_uv, A_w_o, B_x, B_wqkv, B_w_phi, B_wo):
    def _A_ref(x, c_kv, w_q, w_uk, w_uv, w_o):
        B, Sq, M = x.shape[0], x.shape[1], x.shape[2]
        Sk = c_kv.shape[1]
        H, D = w_q.shape[1], w_q.shape[2]
        q = torch.einsum("bqm,mhd->bhqd", x, w_q)
        k = torch.einsum("bkc,chd->bhkd", c_kv, w_uk)
        v = torch.einsum("bkc,chd->bhkd", c_kv, w_uv)
        scores = torch.einsum("bhqd,bhkd->bhqk", q, k) * (D ** -0.5)
        off = Sk - Sq
        qi = torch.arange(Sq)[:, None]
        kj = torch.arange(Sk)[None, :]
        cmask = kj <= (qi + off)
        scores = torch.where(cmask[None, None], scores, -1e9)
        p = _softmax(scores, axis=-1)
        ctx = torch.einsum("bhqk,bhkd->bhqd", p, v)
        return torch.einsum("bhqd,hdm->bqm", ctx, w_o)

    def _B_ref(x, wqkv, w_phi, wo):
        B, S, D = x.shape
        H = 32; Dh = D // H
        qkv = (lambda x, *d: x.permute(*d))((x @ wqkv).reshape(B, S, 3, H, Dh), 2, 0, 3, 1, 4)
        q, k, v = qkv[0], qkv[1], qkv[2]
        pq = torch.einsum("bhsd,hdf->bhsf", q, w_phi)
        pk = torch.einsum("bhsd,hdf->bhsf", k, w_phi)
        phi_q = torch.concatenate([_softmax(pq, axis=-1), _softmax(-pq, axis=-1)], axis=-1)
        phi_k = torch.concatenate([_softmax(pk, axis=-1), _softmax(-pk, axis=-1)], axis=-1)
        kv = torch.einsum("bhsf,bhsd->bhfd", phi_k, v)
        z  = torch.einsum("bhsf->bhf", phi_k)
        num = torch.einsum("bhqf,bhfd->bhqd", phi_q, kv)
        den = torch.einsum("bhqf,bhf->bhq", phi_q, z)[..., None] + 1e-6
        o = num / den
        return (lambda x, *d: x.permute(*d))(o, 0, 2, 1, 3).reshape(B, S, D) @ wo

    a = _A_ref(A_x, A_c_kv, A_w_q, A_w_uk, A_w_uv, A_w_o)
    b = _B_ref(B_x, B_wqkv, B_w_phi, B_wo)
    return torch.concatenate([a, b], axis=-1)
```

```asm
; @launch grid=(256,1,1) block=(256,1,1) lds=163840
.amdgcn_target "amdgcn-amd-amdhsa--gfx950"
.text
.globl concat_heads__compressed_kv_cla__linear_kernel_hedgehog__prompt_kernel
.p2align 8
.type concat_heads__compressed_kv_cla__linear_kernel_hedgehog__prompt_kernel,@function
concat_heads__compressed_kv_cla__linear_kernel_hedgehog__prompt_kernel:
s_cmp_ge_u32 s2, 256
s_cbranch_scc1 L_end
s_getpc_b64 s[84:85]
L_pc0:
s_lshr_b32 s32, s2, 3
s_lshl_b32 s32, s32, 12
v_lshrrev_b32 v18, 3, v0
v_lshlrev_b32 v18, 7, v18
v_add_u32 v18, s32, v18
v_min_u32 v18, L_code_end-L_pc0-4, v18
v_mov_b32 v19, s85
v_add_co_u32 v18, vcc, s84, v18
s_nop 1
v_addc_co_u32 v19, vcc, 0, v19, vcc
global_load_dword v28, v[18:19], off
v_accvgpr_write_b32 a220, v18
v_accvgpr_write_b32 a221, v19
s_load_dwordx2 s[8:9], s[0:1], 8
s_load_dwordx4 s[44:47], s[0:1], 24
s_load_dwordx2 s[48:49], s[0:1], 56
s_load_dwordx2 s[50:51], s[0:1], 72
s_load_dwordx2 s[16:17], s[0:1], 96
s_load_dwordx2 s[20:21], s[0:1], 80
s_load_dwordx2 s[24:25], s[0:1], 88
s_load_dwordx2 s[64:65], s[0:1], 0
s_load_dwordx2 s[68:69], s[0:1], 16
s_load_dwordx2 s[72:73], s[0:1], 48
s_load_dwordx2 s[76:77], s[0:1], 64
s_load_dwordx2 s[80:81], s[0:1], 40
s_and_b32 s32, s2, 7
s_lshr_b32 s33, s2, 3
s_lshl_b32 s4, s32, 2
s_and_b32 s32, s33, 3
s_add_u32 s4, s4, s32
s_lshr_b32 s5, s33, 2
v_lshrrev_b32 v17, 6, v0
v_and_b32 v1, 63, v0
v_readfirstlane_b32 s3, v17
v_lshlrev_b32 v16, 4, v1
v_lshrrev_b32 v17, 3, v1
v_mul_u32_u24 v17, 1024, v17
v_and_b32 v18, 7, v1
v_lshrrev_b32 v19, 4, v1
v_xor_b32 v18, v18, v19
v_lshl_add_u32 v2, v18, 4, v17
v_xor_b32 v18, 4, v18
v_lshl_add_u32 v3, v18, 4, v17
v_add_u32 v4, 14336, v2
v_add_u32 v5, 21504, v3
v_add_u32 v3, 7168, v3
v_bfe_u32 v17, v1, 3, 2
v_mul_u32_u24 v19, 8192, v17
v_lshrrev_b32 v17, 1, v17
v_lshlrev_b32 v17, 2, v17
v_and_b32 v18, 7, v1
v_xor_b32 v18, v18, v17
v_lshl_add_u32 v19, v18, 4, v19
v_lshrrev_b32 v17, 5, v1
v_lshl_add_u32 v6, v17, 7, v19
v_xor_b32 v19, 32, v6
v_add_u32 v7, 31744, v6
v_add_u32 v8, 63488, v19
v_add_u32 v9, 95232, v19
s_lshl_b32 s28, s5, 16
s_lshr_b32 s32, s3, 1
s_lshl_b32 s32, s32, 15
s_add_u32 s28, s28, s32
s_and_b32 s32, s3, 1
s_lshl_b32 s32, s32, 20
s_add_u32 s28, s28, s32
s_and_b32 s32, s3, 1
s_lshl_b32 s29, s32, 18
s_lshl_b32 s32, s4, 8
s_add_u32 s29, s29, s32
s_lshl_b32 s30, s3, 13
s_mov_b32 s10, 0x200000
s_mov_b32 s11, 0x00020000
s_mov_b32 s14, 0x400000
s_mov_b32 s15, 0x00020000
s_waitcnt lgkmcnt(0)
s_cmp_lt_u32 s3, 2
s_cselect_b32 s12, s44, s46
s_cselect_b32 s13, s45, s47
s_mov_b32 m0, s30
s_nop 0
buffer_load_dwordx4 v2, s[8:11], s28 offen offset:0 lds
buffer_load_dwordx4 v3, s[8:11], s28 offen offset:1024 lds
buffer_load_dwordx4 v4, s[8:11], s28 offen offset:2048 lds
buffer_load_dwordx4 v5, s[8:11], s28 offen offset:3072 lds
s_add_u32 m0, m0, 4096
s_nop 0
s_mov_b32 s18, 0x10000000
s_mov_b32 s19, 0x00020000
s_mov_b32 s22, 0x500000
s_mov_b32 s23, 0x00020000
s_mov_b32 s26, 0x100
s_mov_b32 s27, 0x00020000
s_mov_b32 s66, 0x280000
s_mov_b32 s67, 0x00020000
s_mov_b32 s70, 0x500000
s_mov_b32 s71, 0x00020000
s_mov_b32 s74, 0x280000
s_mov_b32 s75, 0x00020000
s_mov_b32 s78, 0x6400
s_mov_b32 s79, 0x00020000
s_mov_b32 s82, 0x500000
s_mov_b32 s83, 0x00020000
s_cmp_lg_u32 s2, 0
s_cbranch_scc1 L_nz
v_lshlrev_b32 v17, 8, v0
v_mov_b32 v18, 0
s_mov_b32 s33, 64159744
buffer_store_dword v18, v17, s[16:19], s33 offen sc1
L_nz:
s_add_u32 s32, s28, 524288
buffer_load_dwordx4 v2, s[8:11], s32 offen offset:0 lds
buffer_load_dwordx4 v3, s[8:11], s32 offen offset:1024 lds
buffer_load_dwordx4 v4, s[8:11], s32 offen offset:2048 lds
buffer_load_dwordx4 v5, s[8:11], s32 offen offset:3072 lds
s_add_u32 m0, s30, 32768
s_nop 0
buffer_load_dwordx4 v6, s[12:15], s29 offen offset:0 lds
buffer_load_dwordx4 v7, s[12:15], s29 offen offset:1024 lds
buffer_load_dwordx4 v8, s[12:15], s29 offen offset:2048 lds
buffer_load_dwordx4 v9, s[12:15], s29 offen offset:3072 lds
s_add_u32 m0, m0, 4096
s_nop 0
s_add_u32 s32, s29, 131072
buffer_load_dwordx4 v6, s[12:15], s32 offen offset:0 lds
buffer_load_dwordx4 v7, s[12:15], s32 offen offset:1024 lds
buffer_load_dwordx4 v8, s[12:15], s32 offen offset:2048 lds
buffer_load_dwordx4 v9, s[12:15], s32 offen offset:3072 lds
s_add_u32 s28, s28, 128
s_add_u32 s29, s29, 524288
s_xor_b32 s30, s30, 0x10000
s_lshl_b32 s35, s3, 12
s_lshl_b32 s36, s3, 13
s_lshr_b32 s32, s2, 3
s_lshl_b32 s33, s32, 8
v_add_u32 v30, s33, v0
s_and_b32 s44, s2, 7
s_lshl_b32 s44, s44, 10
s_lshl_b32 s33, s32, 7
v_and_b32 v27, 127, v0
v_add_u32 v27, s33, v27
v_accvgpr_write_b32 a249, v30
v_lshrrev_b32 v19, 2, v30
v_mul_u32_u24 v19, 1024, v19
buffer_load_dword v28, v19, s[8:11], 0 offen offset:128
s_add_u32 s33, s44, 524288
v_lshrrev_b32 v19, 5, v27
v_mul_u32_u24 v19, 8192, v19
v_and_b32 v18, 7, v27
v_lshl_add_u32 v19, v18, 7, v19
buffer_load_dword v28, v19, s[12:15], s33 offen
s_lshl_b32 s33, s2, 6
v_lshrrev_b32 v30, 2, v0
v_add_u32 v30, s33, v30
v_lshlrev_b32 v30, 7, v30
buffer_load_dword v28, v30, s[8:11], 0 offen
s_sub_u32 s52, 255, s2
s_lshl_b32 s52, s52, 2
s_add_u32 s52, s52, s3
s_add_u32 s31, s36, 131072
s_mov_b32 s87, 0x00020000
s_cmp_ge_u32 s52, 800
s_cbranch_scc1 RL_i_none
s_cmp_ge_u32 s52, 640
s_cbranch_scc1 RL_i_bwo
s_mov_b32 s84, s48
s_mov_b32 s85, s49
s_mov_b32 s86, 0x258000
s_cmp_ge_u32 s52, 320
s_cselect_b32 s34, 320, 0
s_sub_u32 s32, s52, s34
s_mul_i32 s33, s32, 3277
s_lshr_b32 s33, s33, 16
s_mul_i32 s34, s33, 20
s_sub_u32 s32, s32, s34
s_lshl_b32 s62, s33, 8
s_add_u32 s62, s62, 64210944
s_mul_i32 s63, s33, 12
s_add_u32 s63, s63, s32
s_lshl_b32 s63, s63, 10
s_add_u32 s63, s63, 63963136
s_cmp_lt_u32 s32, 12
s_cselect_b32 s63, s63, 0x7ff00000
s_mul_i32 s53, s32, 122880
s_mul_i32 s34, s33, 80
s_add_u32 s53, s53, s34
s_mul_i32 s54, s33, 20
s_add_u32 s54, s54, s32
s_lshl_b32 s54, s54, 13
s_add_u32 s54, s54, 57671680
s_cmp_ge_u32 s52, 320
s_cselect_b32 s34, 1280, 0
s_add_u32 s53, s53, s34
s_mov_b32 s55, 15360
s_mov_b32 s56, 61440
s_mov_b32 s57, 30720
s_mov_b32 s58, 7680
s_mov_b32 s59, 3840
s_mov_b32 s41, 1200
s_branch RL_i_done
RL_i_bwo:
s_mov_b32 s62, 64215040
s_mov_b32 s84, s50
s_mov_b32 s85, s51
s_mov_b32 s86, 0xc8000
s_sub_u32 s32, s52, 640
s_lshr_b32 s32, s32, 3
s_and_b32 s33, s52, 7
s_lshr_b32 s34, s32, 2
s_add_u32 s34, s34, s32
s_mul_i32 s54, s32, 5
s_sub_u32 s54, s54, 76
s_cmp_lt_u32 s32, 16
s_cselect_b32 s34, s34, s54
s_mul_i32 s54, s33, 20
s_add_u32 s54, s54, s34
s_mul_i32 s54, s54, 5120
s_add_u32 s54, s54, 56623104
s_mul_i32 s34, s33, 160
s_cmp_ge_u32 s52, 768
s_cbranch_scc1 RL_i_rem
s_mul_i32 s53, s32, 51200
s_add_u32 s53, s53, s34
s_mov_b32 s55, 5120
s_mov_b32 s56, 25600
s_mov_b32 s57, 10240
s_mov_b32 s58, 2560
s_mov_b32 s59, 1280
s_mov_b32 s41, 0
s_branch RL_i_done
RL_i_rem:
s_sub_u32 s32, s32, 16
s_mul_i32 s53, s32, 204800
s_add_u32 s53, s53, s34
s_add_u32 s53, s53, 20480
s_mov_b32 s55, 102400
s_mov_b32 s56, 25600
s_mov_b32 s57, 2560
s_mov_b32 s58, 51200
s_mov_b32 s59, 1280
s_mov_b32 s41, 0
s_branch RL_i_done
RL_i_none:
s_mov_b32 s84, s50
s_mov_b32 s85, s51
s_mov_b32 s86, 0
s_mov_b32 s53, 0
s_mov_b32 s55, 0
s_mov_b32 s56, 0
s_mov_b32 s57, 0
s_mov_b32 s58, 0
s_mov_b32 s59, 0
s_mov_b32 s41, 0
RL_i_done:
v_lshrrev_b32 v17, 4, v1
v_bfe_u32 v19, v1, 1, 3
v_xor_b32 v19, v19, v17
v_and_b32 v18, 15, v1
v_lshlrev_b32 v18, 7, v18
v_lshl_add_u32 v10, v19, 4, v18
v_xor_b32 v11, 64, v10
v_bfe_u32 v18, v1, 2, 2
v_lshlrev_b32 v19, 7, v18
v_lshl_add_u32 v19, v17, 11, v19
v_and_b32 v20, 1, v1
v_lshl_add_u32 v19, v20, 3, v19
v_lshrrev_b32 v18, 1, v18
v_lshlrev_b32 v18, 2, v18
v_and_b32 v20, 1, v17
v_lshl_or_b32 v18, v20, 1, v18
v_bfe_u32 v20, v1, 1, 1
v_or_b32 v18, v18, v20
v_lshl_add_u32 v12, v18, 4, v19
v_xor_b32 v13, 32, v12
v_xor_b32 v14, 64, v12
v_xor_b32 v15, 96, v12
v_mov_b32 v22, v10
v_mov_b32 v23, v12
s_and_b32 s32, s3, 1
s_lshl_b32 s32, s32, 14
v_add_u32 v10, s32, v10
v_add_u32 v11, s32, v11
s_lshr_b32 s32, s3, 1
s_lshl_b32 s32, s32, 9
s_add_u32 s32, s32, 32768
v_add_u32 v12, s32, v12
v_add_u32 v13, s32, v13
v_add_u32 v14, s32, v14
v_add_u32 v15, s32, v15
s_waitcnt vmcnt(3)
s_barrier
s_cmp_lg_u32 s52, 1020
s_cbranch_scc1 L_nz2
v_mov_b32 v31, 0
v_mov_b32 v29, 1
s_mov_b64 exec, 1
buffer_store_dword v29, v31, s[24:27], 0 offen sc1
s_mov_b64 exec, -1
L_nz2:
ds_read_b64_tr_b16 a[128:129], v12 offset:16384
ds_read_b64_tr_b16 a[130:131], v12 offset:17408
ds_read_b64_tr_b16 a[132:133], v12 offset:24576
ds_read_b64_tr_b16 a[134:135], v12 offset:25600
ds_read_b128 a[0:3], v10 offset:0
ds_read_b128 a[4:7], v11 offset:0
ds_read_b128 a[8:11], v10 offset:2048
ds_read_b128 a[12:15], v11 offset:2048
ds_read_b128 a[16:19], v10 offset:4096
ds_read_b128 a[20:23], v11 offset:4096
ds_read_b128 a[24:27], v10 offset:6144
ds_read_b128 a[28:31], v11 offset:6144
ds_read_b128 a[32:35], v10 offset:8192
ds_read_b128 a[36:39], v11 offset:8192
ds_read_b128 a[40:43], v10 offset:10240
ds_read_b128 a[44:47], v11 offset:10240
ds_read_b128 a[48:51], v10 offset:12288
ds_read_b128 a[52:55], v11 offset:12288
ds_read_b128 a[56:59], v10 offset:14336
ds_read_b128 a[60:63], v11 offset:14336
ds_read_b64_tr_b16 a[136:137], v13 offset:16384
ds_read_b64_tr_b16 a[138:139], v13 offset:17408
ds_read_b64_tr_b16 a[140:141], v13 offset:24576
ds_read_b64_tr_b16 a[142:143], v13 offset:25600
s_waitcnt lgkmcnt(0)
v_mfma_f32_16x16x32_bf16 a[160:163], a[0:3], a[128:131], 0
s_mov_b32 m0, s30
ds_read_b64_tr_b16 a[144:145], v14 offset:16384
v_mfma_f32_16x16x32_bf16 a[160:163], a[4:7], a[132:135], a[160:163]
ds_read_b64_tr_b16 a[146:147], v14 offset:17408
v_add_u32 v24, 0, v1
v_mfma_f32_16x16x32_bf16 a[164:167], a[8:11], a[128:131], 0
ds_read_b64_tr_b16 a[148:149], v14 offset:24576
v_mul_u32_u24 v25, 6554, v24
v_mfma_f32_16x16x32_bf16 a[164:167], a[12:15], a[132:135], a[164:167]
ds_read_b64_tr_b16 a[150:151], v14 offset:25600
v_lshrrev_b32 v25, 16, v25
v_mfma_f32_16x16x32_bf16 a[168:171], a[16:19], a[128:131], 0
buffer_load_dwordx4 v2, s[8:11], s28 offen offset:0 lds
v_mfma_f32_16x16x32_bf16 a[168:171], a[20:23], a[132:135], a[168:171]
v_mul_u32_u24 v26, 10, v25
v_sub_u32 v24, v24, v26
v_mfma_f32_16x16x32_bf16 a[172:175], a[24:27], a[128:131], 0
buffer_load_dwordx4 v3, s[8:11], s28 offen offset:1024 lds
v_mfma_f32_16x16x32_bf16 a[172:175], a[28:31], a[132:135], a[172:175]
v_lshlrev_b32 v26, 4, v24
v_bfe_u32 v20, v25, 4, 1
v_mfma_f32_16x16x32_bf16 a[176:179], a[32:35], a[128:131], 0
buffer_load_dwordx4 v4, s[8:11], s28 offen offset:2048 lds
v_mfma_f32_16x16x32_bf16 a[176:179], a[36:39], a[132:135], a[176:179]
v_mad_u32_u24 v26, v20, s55, v26
v_bfe_u32 v20, v25, 3, 1
v_mfma_f32_16x16x32_bf16 a[180:183], a[40:43], a[128:131], 0
buffer_load_dwordx4 v5, s[8:11], s28 offen offset:3072 lds
v_mfma_f32_16x16x32_bf16 a[180:183], a[44:47], a[132:135], a[180:183]
s_add_u32 m0, m0, 4096
s_add_u32 s32, s28, 524288
v_mad_u32_u24 v26, v20, s56, v26
v_mfma_f32_16x16x32_bf16 a[184:187], a[48:51], a[128:131], 0
buffer_load_dwordx4 v2, s[8:11], s32 offen offset:0 lds
v_mfma_f32_16x16x32_bf16 a[184:187], a[52:55], a[132:135], a[184:187]
v_bfe_u32 v20, v25, 2, 1
v_mad_u32_u24 v26, v20, s57, v26
v_mfma_f32_16x16x32_bf16 a[188:191], a[56:59], a[128:131], 0
buffer_load_dwordx4 v3, s[8:11], s32 offen offset:1024 lds
v_mfma_f32_16x16x32_bf16 a[188:191], a[60:63], a[132:135], a[188:191]
s_waitcnt lgkmcnt(0)
v_bfe_u32 v20, v25, 1, 1
v_mad_u32_u24 v26, v20, s58, v26
v_mfma_f32_16x16x32_bf16 v[160:163], a[0:3], a[136:139], 0
ds_read_b64_tr_b16 a[152:153], v15 offset:16384
v_bfe_u32 v20, v25, 0, 1
v_mfma_f32_16x16x32_bf16 v[160:163], a[4:7], a[140:143], v[160:163]
ds_read_b64_tr_b16 a[154:155], v15 offset:17408
v_mad_u32_u24 v26, v20, s59, v26
v_mfma_f32_16x16x32_bf16 v[164:167], a[8:11], a[136:139], 0
ds_read_b64_tr_b16 a[156:157], v15 offset:24576
v_add_u32 v24, 3, v24
v_mfma_f32_16x16x32_bf16 v[164:167], a[12:15], a[140:143], v[164:167]
ds_read_b64_tr_b16 a[158:159], v15 offset:25600
v_bfe_u32 v20, v24, 3, 1
v_mfma_f32_16x16x32_bf16 v[192:195], a[16:19], a[136:139], 0
buffer_load_dwordx4 v4, s[8:11], s32 offen offset:2048 lds
v_mfma_f32_16x16x32_bf16 v[192:195], a[20:23], a[140:143], v[192:195]
v_mad_u32_u24 v26, v20, s41, v26
v_accvgpr_write_b32 a250, v26
v_mfma_f32_16x16x32_bf16 v[196:199], a[24:27], a[136:139], 0
buffer_load_dwordx4 v5, s[8:11], s32 offen offset:3072 lds
v_mfma_f32_16x16x32_bf16 v[196:199], a[28:31], a[140:143], v[196:199]
s_add_u32 m0, s30, 32768
v_add_u32 v24, 64, v1
v_mul_u32_u24 v25, 6554, v24
v_mfma_f32_16x16x32_bf16 v[224:227], a[32:35], a[136:139], 0
buffer_load_dwordx4 v6, s[12:15], s29 offen offset:0 lds
v_mfma_f32_16x16x32_bf16 v[224:227], a[36:39], a[140:143], v[224:227]
v_lshrrev_b32 v25, 16, v25
v_mul_u32_u24 v26, 10, v25
v_mfma_f32_16x16x32_bf16 v[228:231], a[40:43], a[136:139], 0
buffer_load_dwordx4 v7, s[12:15], s29 offen offset:1024 lds
v_mfma_f32_16x16x32_bf16 v[228:231], a[44:47], a[140:143], v[228:231]
v_sub_u32 v24, v24, v26
v_lshlrev_b32 v26, 4, v24
v_mfma_f32_16x16x32_bf16 v[184:187], a[48:51], a[136:139], 0
buffer_load_dwordx4 v8, s[12:15], s29 offen offset:2048 lds
v_mfma_f32_16x16x32_bf16 v[184:187], a[52:55], a[140:143], v[184:187]
v_bfe_u32 v20, v25, 4, 1
v_mad_u32_u24 v26, v20, s55, v26
v_mfma_f32_16x16x32_bf16 v[188:191], a[56:59], a[136:139], 0
buffer_load_dwordx4 v9, s[12:15], s29 offen offset:3072 lds
v_mfma_f32_16x16x32_bf16 v[188:191], a[60:63], a[140:143], v[188:191]
s_waitcnt lgkmcnt(0)
s_add_u32 m0, m0, 4096
s_add_u32 s32, s29, 131072
v_mfma_f32_16x16x32_bf16 v[168:171], a[0:3], a[144:147], 0
ds_read_b64_tr_b16 a[128:129], v12 offset:0
v_bfe_u32 v20, v25, 3, 1
v_mfma_f32_16x16x32_bf16 v[168:171], a[4:7], a[148:151], v[168:171]
ds_read_b64_tr_b16 a[130:131], v12 offset:1024
v_mad_u32_u24 v26, v20, s56, v26
v_mfma_f32_16x16x32_bf16 v[172:175], a[8:11], a[144:147], 0
ds_read_b64_tr_b16 a[132:133], v12 offset:8192
v_bfe_u32 v20, v25, 2, 1
v_mfma_f32_16x16x32_bf16 v[172:175], a[12:15], a[148:151], v[172:175]
ds_read_b64_tr_b16 a[134:135], v12 offset:9216
v_mad_u32_u24 v26, v20, s57, v26
v_mfma_f32_16x16x32_bf16 v[200:203], a[16:19], a[144:147], 0
buffer_load_dwordx4 v6, s[12:15], s32 offen offset:0 lds
v_mfma_f32_16x16x32_bf16 v[200:203], a[20:23], a[148:151], v[200:203]
v_bfe_u32 v20, v25, 1, 1
v_mad_u32_u24 v26, v20, s58, v26
v_mfma_f32_16x16x32_bf16 v[204:207], a[24:27], a[144:147], 0
buffer_load_dwordx4 v7, s[12:15], s32 offen offset:1024 lds
v_mfma_f32_16x16x32_bf16 v[204:207], a[28:31], a[148:151], v[204:207]
v_bfe_u32 v20, v25, 0, 1
v_mad_u32_u24 v26, v20, s59, v26
v_mfma_f32_16x16x32_bf16 v[232:235], a[32:35], a[144:147], 0
buffer_load_dwordx4 v8, s[12:15], s32 offen offset:2048 lds
v_mfma_f32_16x16x32_bf16 v[232:235], a[36:39], a[148:151], v[232:235]
v_add_u32 v24, 3, v24
v_bfe_u32 v20, v24, 3, 1
v_mfma_f32_16x16x32_bf16 v[236:239], a[40:43], a[144:147], 0
buffer_load_dwordx4 v9, s[12:15], s32 offen offset:3072 lds
v_mfma_f32_16x16x32_bf16 v[236:239], a[44:47], a[148:151], v[236:239]
s_add_u32 s28, s28, 128
s_add_u32 s29, s29, 524288
s_xor_b32 s30, s30, 0x10000
v_mfma_f32_16x16x32_bf16 v[216:219], a[48:51], a[144:147], 0
s_add_u32 s33, s44, 1572864
v_lshrrev_b32 v19, 5, v27
v_mul_u32_u24 v19, 8192, v19
v_mfma_f32_16x16x32_bf16 v[216:219], a[52:55], a[148:151], v[216:219]
v_and_b32 v18, 7, v27
v_lshl_add_u32 v19, v18, 7, v19
v_mfma_f32_16x16x32_bf16 v[220:223], a[56:59], a[144:147], 0
buffer_load_dword v28, v19, s[12:15], s33 offen
v_mfma_f32_16x16x32_bf16 v[220:223], a[60:63], a[148:151], v[220:223]
s_waitcnt lgkmcnt(0)
v_mad_u32_u24 v26, v20, s41, v26
v_accvgpr_write_b32 a251, v26
v_mfma_f32_16x16x32_bf16 v[176:179], a[0:3], a[152:155], 0
ds_read_b64_tr_b16 a[136:137], v13 offset:0
v_add_u32 v24, 128, v1
v_mfma_f32_16x16x32_bf16 v[176:179], a[4:7], a[156:159], v[176:179]
ds_read_b64_tr_b16 a[138:139], v13 offset:1024
v_mul_u32_u24 v25, 6554, v24
v_mfma_f32_16x16x32_bf16 v[180:183], a[8:11], a[152:155], 0
ds_read_b64_tr_b16 a[140:141], v13 offset:8192
v_lshrrev_b32 v25, 16, v25
v_mfma_f32_16x16x32_bf16 v[180:183], a[12:15], a[156:159], v[180:183]
ds_read_b64_tr_b16 a[142:143], v13 offset:9216
v_mul_u32_u24 v26, 10, v25
v_mfma_f32_16x16x32_bf16 v[208:211], a[16:19], a[152:155], 0
v_sub_u32 v24, v24, v26
v_lshlrev_b32 v26, 4, v24
v_mfma_f32_16x16x32_bf16 v[208:211], a[20:23], a[156:159], v[208:211]
v_bfe_u32 v20, v25, 4, 1
v_mad_u32_u24 v26, v20, s55, v26
v_mfma_f32_16x16x32_bf16 v[212:215], a[24:27], a[152:155], 0
v_bfe_u32 v20, v25, 3, 1
v_mad_u32_u24 v26, v20, s56, v26
v_mfma_f32_16x16x32_bf16 v[212:215], a[28:31], a[156:159], v[212:215]
v_bfe_u32 v20, v25, 2, 1
v_mad_u32_u24 v26, v20, s57, v26
v_mfma_f32_16x16x32_bf16 v[240:243], a[32:35], a[152:155], 0
v_bfe_u32 v20, v25, 1, 1
v_mad_u32_u24 v26, v20, s58, v26
v_mfma_f32_16x16x32_bf16 v[240:243], a[36:39], a[156:159], v[240:243]
v_bfe_u32 v20, v25, 0, 1
v_mad_u32_u24 v26, v20, s59, v26
v_mfma_f32_16x16x32_bf16 v[244:247], a[40:43], a[152:155], 0
v_add_u32 v24, 3, v24
v_bfe_u32 v20, v24, 3, 1
v_mfma_f32_16x16x32_bf16 v[244:247], a[44:47], a[156:159], v[244:247]
v_mad_u32_u24 v26, v20, s41, v26
v_accvgpr_write_b32 a252, v26
v_mfma_f32_16x16x32_bf16 v[248:251], a[48:51], a[152:155], 0
v_add_u32 v24, 192, v1
v_mul_u32_u24 v25, 6554, v24
v_mfma_f32_16x16x32_bf16 v[248:251], a[52:55], a[156:159], v[248:251]
v_lshrrev_b32 v25, 16, v25
v_mul_u32_u24 v26, 10, v25
v_mfma_f32_16x16x32_bf16 v[252:255], a[56:59], a[152:155], 0
v_sub_u32 v24, v24, v26
v_lshlrev_b32 v26, 4, v24
v_mfma_f32_16x16x32_bf16 v[252:255], a[60:63], a[156:159], v[252:255]
s_waitcnt lgkmcnt(0)
v_bfe_u32 v20, v25, 4, 1
v_mad_u32_u24 v26, v20, s55, v26
v_mfma_f32_16x16x32_bf16 v[96:99], a[128:131], a[0:3], 0
ds_read_b64_tr_b16 a[144:145], v14 offset:0
v_bfe_u32 v20, v25, 3, 1
v_mfma_f32_16x16x32_bf16 v[96:99], a[132:135], a[4:7], v[96:99]
ds_read_b64_tr_b16 a[146:147], v14 offset:1024
v_mad_u32_u24 v26, v20, s56, v26
v_mfma_f32_16x16x32_bf16 v[100:103], a[128:131], a[8:11], 0
ds_read_b64_tr_b16 a[148:149], v14 offset:8192
v_bfe_u32 v20, v25, 2, 1
v_mfma_f32_16x16x32_bf16 v[100:103], a[132:135], a[12:15], v[100:103]
ds_read_b64_tr_b16 a[150:151], v14 offset:9216
v_mad_u32_u24 v26, v20, s57, v26
v_mfma_f32_16x16x32_bf16 v[104:107], a[128:131], a[16:19], 0
ds_read_b64_tr_b16 a[152:153], v15 offset:0
v_bfe_u32 v20, v25, 1, 1
v_mfma_f32_16x16x32_bf16 v[104:107], a[132:135], a[20:23], v[104:107]
ds_read_b64_tr_b16 a[154:155], v15 offset:1024
v_mad_u32_u24 v26, v20, s58, v26
v_mfma_f32_16x16x32_bf16 v[108:111], a[128:131], a[24:27], 0
ds_read_b64_tr_b16 a[156:157], v15 offset:8192
v_bfe_u32 v20, v25, 0, 1
v_mfma_f32_16x16x32_bf16 v[108:111], a[132:135], a[28:31], v[108:111]
ds_read_b64_tr_b16 a[158:159], v15 offset:9216
v_mad_u32_u24 v26, v20, s59, v26
v_mfma_f32_16x16x32_bf16 v[32:35], a[128:131], a[32:35], 0
v_add_u32 v24, 3, v24
v_bfe_u32 v20, v24, 3, 1
v_mfma_f32_16x16x32_bf16 v[32:35], a[132:135], a[36:39], v[32:35]
v_mad_u32_u24 v26, v20, s41, v26
v_accvgpr_write_b32 a253, v26
v_mfma_f32_16x16x32_bf16 v[36:39], a[128:131], a[40:43], 0
v_add_u32 v24, 256, v1
v_mul_u32_u24 v25, 6554, v24
v_mfma_f32_16x16x32_bf16 v[36:39], a[132:135], a[44:47], v[36:39]
v_lshrrev_b32 v25, 16, v25
v_mul_u32_u24 v26, 10, v25
v_mfma_f32_16x16x32_bf16 v[40:43], a[128:131], a[48:51], 0
v_xor_b32 v10, 0x10000, v10
v_xor_b32 v11, 0x10000, v11
v_mfma_f32_16x16x32_bf16 v[40:43], a[132:135], a[52:55], v[40:43]
v_xor_b32 v12, 0x10000, v12
v_xor_b32 v13, 0x10000, v13
v_mfma_f32_16x16x32_bf16 v[44:47], a[128:131], a[56:59], 0
v_xor_b32 v14, 0x10000, v14
v_xor_b32 v15, 0x10000, v15
v_mfma_f32_16x16x32_bf16 v[44:47], a[132:135], a[60:63], v[44:47]
s_waitcnt lgkmcnt(0)
v_sub_u32 v24, v24, v26
v_lshlrev_b32 v26, 4, v24
v_mfma_f32_16x16x32_bf16 v[112:115], a[136:139], a[0:3], 0
s_waitcnt vmcnt(1)
s_barrier
v_mfma_f32_16x16x32_bf16 v[112:115], a[140:143], a[4:7], v[112:115]
s_mov_b32 m0, s30
ds_read_b128 a[64:67], v10 offset:0
v_mfma_f32_16x16x32_bf16 v[116:119], a[136:139], a[8:11], 0
buffer_load_dwordx4 v2, s[8:11], s28 offen offset:0 lds
v_mfma_f32_16x16x32_bf16 v[116:119], a[140:143], a[12:15], v[116:119]
ds_read_b128 a[68:71], v11 offset:0
v_bfe_u32 v20, v25, 4, 1
v_mfma_f32_16x16x32_bf16 v[120:123], a[136:139], a[16:19], 0
v_mad_u32_u24 v26, v20, s55, v26
v_bfe_u32 v20, v25, 3, 1
v_mfma_f32_16x16x32_bf16 v[120:123], a[140:143], a[20:23], v[120:123]
ds_read_b128 a[72:75], v10 offset:2048
v_mad_u32_u24 v26, v20, s56, v26
v_mfma_f32_16x16x32_bf16 v[124:127], a[136:139], a[24:27], 0
v_bfe_u32 v20, v25, 2, 1
v_mad_u32_u24 v26, v20, s57, v26
v_mfma_f32_16x16x32_bf16 v[124:127], a[140:143], a[28:31], v[124:127]
ds_read_b128 a[76:79], v11 offset:2048
v_bfe_u32 v20, v25, 1, 1
v_mfma_f32_16x16x32_bf16 v[48:51], a[136:139], a[32:35], 0
buffer_load_dwordx4 v3, s[8:11], s28 offen offset:1024 lds
v_mfma_f32_16x16x32_bf16 v[48:51], a[140:143], a[36:39], v[48:51]
ds_read_b128 a[80:83], v10 offset:4096
v_mad_u32_u24 v26, v20, s58, v26
v_mfma_f32_16x16x32_bf16 v[52:55], a[136:139], a[40:43], 0
v_bfe_u32 v20, v25, 0, 1
v_mad_u32_u24 v26, v20, s59, v26
v_mfma_f32_16x16x32_bf16 v[52:55], a[140:143], a[44:47], v[52:55]
ds_read_b128 a[84:87], v11 offset:4096
v_add_u32 v24, 3, v24
v_mfma_f32_16x16x32_bf16 v[56:59], a[136:139], a[48:51], 0
v_bfe_u32 v20, v24, 3, 1
v_mad_u32_u24 v26, v20, s41, v26
v_mfma_f32_16x16x32_bf16 v[56:59], a[140:143], a[52:55], v[56:59]
ds_read_b128 a[88:91], v10 offset:6144
v_accvgpr_write_b32 a254, v26
v_mfma_f32_16x16x32_bf16 v[60:63], a[136:139], a[56:59], 0
buffer_load_dwordx4 v4, s[8:11], s28 offen offset:2048 lds
v_mfma_f32_16x16x32_bf16 v[60:63], a[140:143], a[60:63], v[60:63]
ds_read_b128 a[92:95], v11 offset:6144
v_mfma_f32_16x16x32_bf16 v[128:131], a[144:147], a[0:3], 0
v_mfma_f32_16x16x32_bf16 v[128:131], a[148:151], a[4:7], v[128:131]
ds_read_b128 a[96:99], v10 offset:8192
v_mfma_f32_16x16x32_bf16 v[132:135], a[144:147], a[8:11], 0
v_mfma_f32_16x16x32_bf16 v[132:135], a[148:151], a[12:15], v[132:135]
ds_read_b128 a[100:103], v11 offset:8192
v_mfma_f32_16x16x32_bf16 v[136:139], a[144:147], a[16:19], 0
buffer_load_dwordx4 v5, s[8:11], s28 offen offset:3072 lds
v_mfma_f32_16x16x32_bf16 v[136:139], a[148:151], a[20:23], v[136:139]
s_add_u32 m0, m0, 4096
ds_read_b128 a[104:107], v10 offset:10240
v_mfma_f32_16x16x32_bf16 v[140:143], a[144:147], a[24:27], 0
s_add_u32 s32, s28, 524288
v_mfma_f32_16x16x32_bf16 v[140:143], a[148:151], a[28:31], v[140:143]
ds_read_b128 a[108:111], v11 offset:10240
v_mfma_f32_16x16x32_bf16 v[64:67], a[144:147], a[32:35], 0
v_mfma_f32_16x16x32_bf16 v[64:67], a[148:151], a[36:39], v[64:67]
ds_read_b128 a[112:115], v10 offset:12288
v_mfma_f32_16x16x32_bf16 v[68:71], a[144:147], a[40:43], 0
buffer_load_dwordx4 v2, s[8:11], s32 offen offset:0 lds
v_mfma_f32_16x16x32_bf16 v[68:71], a[148:151], a[44:47], v[68:71]
ds_read_b128 a[116:119], v11 offset:12288
v_mfma_f32_16x16x32_bf16 v[72:75], a[144:147], a[48:51], 0
v_mfma_f32_16x16x32_bf16 v[72:75], a[148:151], a[52:55], v[72:75]
ds_read_b128 a[120:123], v10 offset:14336
v_mfma_f32_16x16x32_bf16 v[76:79], a[144:147], a[56:59], 0
v_mfma_f32_16x16x32_bf16 v[76:79], a[148:151], a[60:63], v[76:79]
ds_read_b128 a[124:127], v11 offset:14336
v_mfma_f32_16x16x32_bf16 v[144:147], a[152:155], a[0:3], 0
buffer_load_dwordx4 v3, s[8:11], s32 offen offset:1024 lds
v_mfma_f32_16x16x32_bf16 v[144:147], a[156:159], a[4:7], v[144:147]
ds_read_b64_tr_b16 a[128:129], v12 offset:16384
v_mfma_f32_16x16x32_bf16 v[148:151], a[152:155], a[8:11], 0
ds_read_b64_tr_b16 a[130:131], v12 offset:17408
v_mfma_f32_16x16x32_bf16 v[148:151], a[156:159], a[12:15], v[148:151]
ds_read_b64_tr_b16 a[132:133], v12 offset:24576
v_mfma_f32_16x16x32_bf16 v[152:155], a[152:155], a[16:19], 0
ds_read_b64_tr_b16 a[134:135], v12 offset:25600
v_mfma_f32_16x16x32_bf16 v[152:155], a[156:159], a[20:23], v[152:155]
ds_read_b64_tr_b16 a[136:137], v13 offset:16384
v_mfma_f32_16x16x32_bf16 v[156:159], a[152:155], a[24:27], 0
ds_read_b64_tr_b16 a[138:139], v13 offset:17408
v_mfma_f32_16x16x32_bf16 v[156:159], a[156:159], a[28:31], v[156:159]
ds_read_b64_tr_b16 a[140:141], v13 offset:24576
v_mfma_f32_16x16x32_bf16 v[80:83], a[152:155], a[32:35], 0
ds_read_b64_tr_b16 a[142:143], v13 offset:25600
v_mfma_f32_16x16x32_bf16 v[80:83], a[156:159], a[36:39], v[80:83]
buffer_load_dwordx4 v4, s[8:11], s32 offen offset:2048 lds
v_mfma_f32_16x16x32_bf16 v[84:87], a[152:155], a[40:43], 0
v_mfma_f32_16x16x32_bf16 v[84:87], a[156:159], a[44:47], v[84:87]
v_mfma_f32_16x16x32_bf16 v[88:91], a[152:155], a[48:51], 0
v_mfma_f32_16x16x32_bf16 v[88:91], a[156:159], a[52:55], v[88:91]
v_mfma_f32_16x16x32_bf16 v[92:95], a[152:155], a[56:59], 0
buffer_load_dwordx4 v5, s[8:11], s32 offen offset:3072 lds
v_mfma_f32_16x16x32_bf16 v[92:95], a[156:159], a[60:63], v[92:95]
s_waitcnt lgkmcnt(0)
v_mfma_f32_16x16x32_bf16 a[160:163], a[64:67], a[128:131], a[160:163]
s_add_u32 m0, s30, 32768
ds_read_b64_tr_b16 a[144:145], v14 offset:16384
v_mfma_f32_16x16x32_bf16 a[160:163], a[68:71], a[132:135], a[160:163]
ds_read_b64_tr_b16 a[146:147], v14 offset:17408
v_mfma_f32_16x16x32_bf16 a[164:167], a[72:75], a[128:131], a[164:167]
ds_read_b64_tr_b16 a[148:149], v14 offset:24576
v_mfma_f32_16x16x32_bf16 a[164:167], a[76:79], a[132:135], a[164:167]
ds_read_b64_tr_b16 a[150:151], v14 offset:25600
v_mfma_f32_16x16x32_bf16 a[168:171], a[80:83], a[128:131], a[168:171]
buffer_load_dwordx4 v6, s[12:15], s29 offen offset:0 lds
v_mfma_f32_16x16x32_bf16 a[168:171], a[84:87], a[132:135], a[168:171]
v_mfma_f32_16x16x32_bf16 a[172:175], a[88:91], a[128:131], a[172:175]
v_mfma_f32_16x16x32_bf16 a[172:175], a[92:95], a[132:135], a[172:175]
v_mfma_f32_16x16x32_bf16 a[176:179], a[96:99], a[128:131], a[176:179]
v_mfma_f32_16x16x32_bf16 a[176:179], a[100:103], a[132:135], a[176:179]
buffer_load_dwordx4 v7, s[12:15], s29 offen offset:1024 lds
v_mfma_f32_16x16x32_bf16 a[180:183], a[104:107], a[128:131], a[180:183]
v_mfma_f32_16x16x32_bf16 a[180:183], a[108:111], a[132:135], a[180:183]
v_mfma_f32_16x16x32_bf16 a[184:187], a[112:115], a[128:131], a[184:187]
v_mfma_f32_16x16x32_bf16 a[184:187], a[116:119], a[132:135], a[184:187]
v_mfma_f32_16x16x32_bf16 a[188:191], a[120:123], a[128:131], a[188:191]
buffer_load_dwordx4 v8, s[12:15], s29 offen offset:2048 lds
v_mfma_f32_16x16x32_bf16 a[188:191], a[124:127], a[132:135], a[188:191]
s_waitcnt lgkmcnt(0)
v_mfma_f32_16x16x32_bf16 v[160:163], a[64:67], a[136:139], v[160:163]
ds_read_b64_tr_b16 a[152:153], v15 offset:16384
v_mfma_f32_16x16x32_bf16 v[160:163], a[68:71], a[140:143], v[160:163]
ds_read_b64_tr_b16 a[154:155], v15 offset:17408
v_mfma_f32_16x16x32_bf16 v[164:167], a[72:75], a[136:139], v[164:167]
ds_read_b64_tr_b16 a[156:157], v15 offset:24576
v_mfma_f32_16x16x32_bf16 v[164:167], a[76:79], a[140:143], v[164:167]
ds_read_b64_tr_b16 a[158:159], v15 offset:25600
v_mfma_f32_16x16x32_bf16 v[192:195], a[80:83], a[136:139], v[192:195]
buffer_load_dwordx4 v9, s[12:15], s29 offen offset:3072 lds
v_mfma_f32_16x16x32_bf16 v[192:195], a[84:87], a[140:143], v[192:195]
s_add_u32 m0, m0, 4096
s_add_u32 s32, s29, 131072
v_mfma_f32_16x16x32_bf16 v[196:199], a[88:91], a[136:139], v[196:199]
v_mfma_f32_16x16x32_bf16 v[196:199], a[92:95], a[140:143], v[196:199]
v_mfma_f32_16x16x32_bf16 v[224:227], a[96:99], a[136:139], v[224:227]
v_mfma_f32_16x16x32_bf16 v[224:227], a[100:103], a[140:143], v[224:227]
buffer_load_dwordx4 v6, s[12:15], s32 offen offset:0 lds
v_mfma_f32_16x16x32_bf16 v[228:231], a[104:107], a[136:139], v[228:231]
v_mfma_f32_16x16x32_bf16 v[228:231], a[108:111], a[140:143], v[228:231]
v_mfma_f32_16x16x32_bf16 v[184:187], a[112:115], a[136:139], v[184:187]
v_mfma_f32_16x16x32_bf16 v[184:187], a[116:119], a[140:143], v[184:187]
v_mfma_f32_16x16x32_bf16 v[188:191], a[120:123], a[136:139], v[188:191]
buffer_load_dwordx4 v7, s[12:15], s32 offen offset:1024 lds
v_mfma_f32_16x16x32_bf16 v[188:191], a[124:127], a[140:143], v[188:191]
s_waitcnt lgkmcnt(0)
v_mfma_f32_16x16x32_bf16 v[168:171], a[64:67], a[144:147], v[168:171]
ds_read_b64_tr_b16 a[128:129], v12 offset:0
v_mfma_f32_16x16x32_bf16 v[168:171], a[68:71], a[148:151], v[168:171]
ds_read_b64_tr_b16 a[130:131], v12 offset:1024
v_mfma_f32_16x16x32_bf16 v[172:175], a[72:75], a[144:147], v[172:175]
ds_read_b64_tr_b16 a[132:133], v12 offset:8192
v_mfma_f32_16x16x32_bf16 v[172:175], a[76:79], a[148:151], v[172:175]
ds_read_b64_tr_b16 a[134:135], v12 offset:9216
v_mfma_f32_16x16x32_bf16 v[200:203], a[80:83], a[144:147], v[200:203]
buffer_load_dwordx4 v8, s[12:15], s32 offen offset:2048 lds
v_mfma_f32_16x16x32_bf16 v[200:203], a[84:87], a[148:151], v[200:203]
v_mfma_f32_16x16x32_bf16 v[204:207], a[88:91], a[144:147], v[204:207]
v_mfma_f32_16x16x32_bf16 v[204:207], a[92:95], a[148:151], v[204:207]
v_mfma_f32_16x16x32_bf16 v[232:235], a[96:99], a[144:147], v[232:235]
v_mfma_f32_16x16x32_bf16 v[232:235], a[100:103], a[148:151], v[232:235]
buffer_load_dwordx4 v9, s[12:15], s32 offen offset:3072 lds
v_mfma_f32_16x16x32_bf16 v[236:239], a[104:107], a[144:147], v[236:239]
s_add_u32 s28, s28, 128
s_add_u32 s29, s29, 524288
s_xor_b32 s30, s30, 0x10000
v_mfma_f32_16x16x32_bf16 v[236:239], a[108:111], a[148:151], v[236:239]
s_add_u32 s33, s44, 2621440
v_lshrrev_b32 v19, 5, v27
v_mul_u32_u24 v19, 8192, v19
v_mfma_f32_16x16x32_bf16 v[216:219], a[112:115], a[144:147], v[216:219]
v_and_b32 v18, 7, v27
v_lshl_add_u32 v19, v18, 7, v19
v_mfma_f32_16x16x32_bf16 v[216:219], a[116:119], a[148:151], v[216:219]
buffer_load_dword v28, v19, s[12:15], s33 offen
v_mfma_f32_16x16x32_bf16 v[220:223], a[120:123], a[144:147], v[220:223]
s_add_u32 m0, s31, 0
v_accvgpr_read_b32 v17, a250
v_mfma_f32_16x16x32_bf16 v[220:223], a[124:127], a[148:151], v[220:223]
s_waitcnt lgkmcnt(0)
v_mfma_f32_16x16x32_bf16 v[176:179], a[64:67], a[152:155], v[176:179]
ds_read_b64_tr_b16 a[136:137], v13 offset:0
v_mfma_f32_16x16x32_bf16 v[176:179], a[68:71], a[156:159], v[176:179]
ds_read_b64_tr_b16 a[138:139], v13 offset:1024
v_mfma_f32_16x16x32_bf16 v[180:183], a[72:75], a[152:155], v[180:183]
ds_read_b64_tr_b16 a[140:141], v13 offset:8192
v_mfma_f32_16x16x32_bf16 v[180:183], a[76:79], a[156:159], v[180:183]
ds_read_b64_tr_b16 a[142:143], v13 offset:9216
v_mfma_f32_16x16x32_bf16 v[208:211], a[80:83], a[152:155], v[208:211]
buffer_load_dwordx4 v17, s[84:87], s53 offen lds
v_mfma_f32_16x16x32_bf16 v[208:211], a[84:87], a[156:159], v[208:211]
v_mfma_f32_16x16x32_bf16 v[212:215], a[88:91], a[152:155], v[212:215]
v_mfma_f32_16x16x32_bf16 v[212:215], a[92:95], a[156:159], v[212:215]
v_mfma_f32_16x16x32_bf16 v[240:243], a[96:99], a[152:155], v[240:243]
v_mfma_f32_16x16x32_bf16 v[240:243], a[100:103], a[156:159], v[240:243]
v_mfma_f32_16x16x32_bf16 v[244:247], a[104:107], a[152:155], v[244:247]
v_mfma_f32_16x16x32_bf16 v[244:247], a[108:111], a[156:159], v[244:247]
v_mfma_f32_16x16x32_bf16 v[248:251], a[112:115], a[152:155], v[248:251]
v_mfma_f32_16x16x32_bf16 v[248:251], a[116:119], a[156:159], v[248:251]
v_mfma_f32_16x16x32_bf16 v[252:255], a[120:123], a[152:155], v[252:255]
v_mfma_f32_16x16x32_bf16 v[252:255], a[124:127], a[156:159], v[252:255]
s_waitcnt lgkmcnt(0)
v_mfma_f32_16x16x32_bf16 v[96:99], a[128:131], a[64:67], v[96:99]
ds_read_b64_tr_b16 a[144:145], v14 offset:0
v_mfma_f32_16x16x32_bf16 v[96:99], a[132:135], a[68:71], v[96:99]
ds_read_b64_tr_b16 a[146:147], v14 offset:1024
v_mfma_f32_16x16x32_bf16 v[100:103], a[128:131], a[72:75], v[100:103]
ds_read_b64_tr_b16 a[148:149], v14 offset:8192
v_mfma_f32_16x16x32_bf16 v[100:103], a[132:135], a[76:79], v[100:103]
ds_read_b64_tr_b16 a[150:151], v14 offset:9216
v_mfma_f32_16x16x32_bf16 v[104:107], a[128:131], a[80:83], v[104:107]
ds_read_b64_tr_b16 a[152:153], v15 offset:0
v_mfma_f32_16x16x32_bf16 v[104:107], a[132:135], a[84:87], v[104:107]
ds_read_b64_tr_b16 a[154:155], v15 offset:1024
v_mfma_f32_16x16x32_bf16 v[108:111], a[128:131], a[88:91], v[108:111]
ds_read_b64_tr_b16 a[156:157], v15 offset:8192
v_mfma_f32_16x16x32_bf16 v[108:111], a[132:135], a[92:95], v[108:111]
ds_read_b64_tr_b16 a[158:159], v15 offset:9216
v_mfma_f32_16x16x32_bf16 v[32:35], a[128:131], a[96:99], v[32:35]
v_mfma_f32_16x16x32_bf16 v[32:35], a[132:135], a[100:103], v[32:35]
v_mfma_f32_16x16x32_bf16 v[36:39], a[128:131], a[104:107], v[36:39]
v_mfma_f32_16x16x32_bf16 v[36:39], a[132:135], a[108:111], v[36:39]
v_mfma_f32_16x16x32_bf16 v[40:43], a[128:131], a[112:115], v[40:43]
v_xor_b32 v10, 0x10000, v10
v_xor_b32 v11, 0x10000, v11
v_mfma_f32_16x16x32_bf16 v[40:43], a[132:135], a[116:119], v[40:43]
v_xor_b32 v12, 0x10000, v12
v_xor_b32 v13, 0x10000, v13
v_mfma_f32_16x16x32_bf16 v[44:47], a[128:131], a[120:123], v[44:47]
v_xor_b32 v14, 0x10000, v14
v_xor_b32 v15, 0x10000, v15
v_mfma_f32_16x16x32_bf16 v[44:47], a[132:135], a[124:127], v[44:47]
s_waitcnt lgkmcnt(0)
v_mfma_f32_16x16x32_bf16 v[112:115], a[136:139], a[64:67], v[112:115]
s_waitcnt vmcnt(2)
s_barrier
v_mfma_f32_16x16x32_bf16 v[112:115], a[140:143], a[68:71], v[112:115]
s_mov_b32 m0, s30
ds_read_b128 a[0:3], v10 offset:0
v_mfma_f32_16x16x32_bf16 v[116:119], a[136:139], a[72:75], v[116:119]
buffer_load_dwordx4 v2, s[8:11], s28 offen offset:0 lds
v_mfma_f32_16x16x32_bf16 v[116:119], a[140:143], a[76:79], v[116:119]
ds_read_b128 a[4:7], v11 offset:0
v_mfma_f32_16x16x32_bf16 v[120:123], a[136:139], a[80:83], v[120:123]
v_lshrrev_b32 v24, 2, v1
v_mul_u32_u24 v24, 160, v24
v_mfma_f32_16x16x32_bf16 v[120:123], a[140:143], a[84:87], v[120:123]
ds_read_b128 a[8:11], v10 offset:2048
v_add_u32 v24, s31, v24
v_mfma_f32_16x16x32_bf16 v[124:127], a[136:139], a[88:91], v[124:127]
v_and_b32 v26, 3, v1
v_lshl_add_u32 v25, v26, 3, v24
v_mfma_f32_16x16x32_bf16 v[124:127], a[140:143], a[92:95], v[124:127]
ds_read_b128 a[12:15], v11 offset:2048
v_mfma_f32_16x16x32_bf16 v[48:51], a[136:139], a[96:99], v[48:51]
buffer_load_dwordx4 v3, s[8:11], s28 offen offset:1024 lds
v_mfma_f32_16x16x32_bf16 v[48:51], a[140:143], a[100:103], v[48:51]
ds_read_b128 a[16:19], v10 offset:4096
v_mfma_f32_16x16x32_bf16 v[52:55], a[136:139], a[104:107], v[52:55]
v_mfma_f32_16x16x32_bf16 v[52:55], a[140:143], a[108:111], v[52:55]
ds_read_b128 a[20:23], v11 offset:4096
v_mfma_f32_16x16x32_bf16 v[56:59], a[136:139], a[112:115], v[56:59]
v_mfma_f32_16x16x32_bf16 v[56:59], a[140:143], a[116:119], v[56:59]
ds_read_b128 a[24:27], v10 offset:6144
v_mfma_f32_16x16x32_bf16 v[60:63], a[136:139], a[120:123], v[60:63]
buffer_load_dwordx4 v4, s[8:11], s28 offen offset:2048 lds
v_mfma_f32_16x16x32_bf16 v[60:63], a[140:143], a[124:127], v[60:63]
ds_read_b128 a[28:31], v11 offset:6144
v_mfma_f32_16x16x32_bf16 v[128:131], a[144:147], a[64:67], v[128:131]
v_mfma_f32_16x16x32_bf16 v[128:131], a[148:151], a[68:71], v[128:131]
ds_read_b128 a[32:35], v10 offset:8192
v_mfma_f32_16x16x32_bf16 v[132:135], a[144:147], a[72:75], v[132:135]
v_mfma_f32_16x16x32_bf16 v[132:135], a[148:151], a[76:79], v[132:135]
ds_read_b128 a[36:39], v11 offset:8192
v_mfma_f32_16x16x32_bf16 v[136:139], a[144:147], a[80:83], v[136:139]
buffer_load_dwordx4 v5, s[8:11], s28 offen offset:3072 lds
v_mfma_f32_16x16x32_bf16 v[136:139], a[148:151], a[84:87], v[136:139]
s_add_u32 m0, m0, 4096
ds_read_b128 a[40:43], v10 offset:10240
v_mfma_f32_16x16x32_bf16 v[140:143], a[144:147], a[88:91], v[140:143]
s_add_u32 s32, s28, 524288
v_mfma_f32_16x16x32_bf16 v[140:143], a[148:151], a[92:95], v[140:143]
ds_read_b128 a[44:47], v11 offset:10240
v_mfma_f32_16x16x32_bf16 v[64:67], a[144:147], a[96:99], v[64:67]
v_mfma_f32_16x16x32_bf16 v[64:67], a[148:151], a[100:103], v[64:67]
ds_read_b128 a[48:51], v10 offset:12288
v_mfma_f32_16x16x32_bf16 v[68:71], a[144:147], a[104:107], v[68:71]
buffer_load_dwordx4 v2, s[8:11], s32 offen offset:0 lds
v_mfma_f32_16x16x32_bf16 v[68:71], a[148:151], a[108:111], v[68:71]
ds_read_b128 a[52:55], v11 offset:12288
v_mfma_f32_16x16x32_bf16 v[72:75], a[144:147], a[112:115], v[72:75]
v_mfma_f32_16x16x32_bf16 v[72:75], a[148:151], a[116:119], v[72:75]
ds_read_b128 a[56:59], v10 offset:14336
v_mfma_f32_16x16x32_bf16 v[76:79], a[144:147], a[120:123], v[76:79]
v_mfma_f32_16x16x32_bf16 v[76:79], a[148:151], a[124:127], v[76:79]
ds_read_b128 a[60:63], v11 offset:14336
v_mfma_f32_16x16x32_bf16 v[144:147], a[152:155], a[64:67], v[144:147]
buffer_load_dwordx4 v3, s[8:11], s32 offen offset:1024 lds
v_mfma_f32_16x16x32_bf16 v[144:147], a[156:159], a[68:71], v[144:147]
ds_read_b64_tr_b16 a[128:129], v12 offset:16384
v_mfma_f32_16x16x32_bf16 v[148:151], a[152:155], a[72:75], v[148:151]
ds_read_b64_tr_b16 a[130:131], v12 offset:17408
v_mfma_f32_16x16x32_bf16 v[148:151], a[156:159], a[76:79], v[148:151]
ds_read_b64_tr_b16 a[132:133], v12 offset:24576
v_mfma_f32_16x16x32_bf16 v[152:155], a[152:155], a[80:83], v[152:155]
ds_read_b64_tr_b16 a[134:135], v12 offset:25600
v_mfma_f32_16x16x32_bf16 v[152:155], a[156:159], a[84:87], v[152:155]
ds_read_b64_tr_b16 a[136:137], v13 offset:16384
v_mfma_f32_16x16x32_bf16 v[156:159], a[152:155], a[88:91], v[156:159]
ds_read_b64_tr_b16 a[138:139], v13 offset:17408
v_mfma_f32_16x16x32_bf16 v[156:159], a[156:159], a[92:95], v[156:159]
ds_read_b64_tr_b16 a[140:141], v13 offset:24576
v_mfma_f32_16x16x32_bf16 v[80:83], a[152:155], a[96:99], v[80:83]
ds_read_b64_tr_b16 a[142:143], v13 offset:25600
v_mfma_f32_16x16x32_bf16 v[80:83], a[156:159], a[100:103], v[80:83]
buffer_load_dwordx4 v4, s[8:11], s32 offen offset:2048 lds
v_mfma_f32_16x16x32_bf16 v[84:87], a[152:155], a[104:107], v[84:87]
v_mfma_f32_16x16x32_bf16 v[84:87], a[156:159], a[108:111], v[84:87]
v_mfma_f32_16x16x32_bf16 v[88:91], a[152:155], a[112:115], v[88:91]
v_mfma_f32_16x16x32_bf16 v[88:91], a[156:159], a[116:119], v[88:91]
v_mfma_f32_16x16x32_bf16 v[92:95], a[152:155], a[120:123], v[92:95]
buffer_load_dwordx4 v5, s[8:11], s32 offen offset:3072 lds
v_mfma_f32_16x16x32_bf16 v[92:95], a[156:159], a[124:127], v[92:95]
s_waitcnt lgkmcnt(0)
v_mfma_f32_16x16x32_bf16 a[160:163], a[0:3], a[128:131], a[160:163]
s_add_u32 m0, s30, 32768
ds_read_b64_tr_b16 a[144:145], v14 offset:16384
v_mfma_f32_16x16x32_bf16 a[160:163], a[4:7], a[132:135], a[160:163]
s_and_b32 s60, s2, 3
ds_read_b64_tr_b16 a[146:147], v14 offset:17408
v_mfma_f32_16x16x32_bf16 a[164:167], a[8:11], a[128:131], a[164:167]
s_lshl_b32 s88, s60, 2
ds_read_b64_tr_b16 a[148:149], v14 offset:24576
v_mfma_f32_16x16x32_bf16 a[164:167], a[12:15], a[132:135], a[164:167]
s_bfe_u32 s60, s2, 0x20003
ds_read_b64_tr_b16 a[150:151], v14 offset:25600
v_mfma_f32_16x16x32_bf16 a[168:171], a[16:19], a[128:131], a[168:171]
buffer_load_dwordx4 v6, s[12:15], s29 offen offset:0 lds
v_mfma_f32_16x16x32_bf16 a[168:171], a[20:23], a[132:135], a[168:171]
s_add_u32 s88, s88, s60
s_bfe_u32 s60, s2, 0x10002
s_lshl_b32 s89, s60, 3
v_mfma_f32_16x16x32_bf16 a[172:175], a[24:27], a[128:131], a[172:175]
s_lshr_b32 s60, s2, 5
s_add_u32 s89, s89, s60
s_and_b32 s60, s2, 3
v_mfma_f32_16x16x32_bf16 a[172:175], a[28:31], a[132:135], a[172:175]
s_lshl_b32 s6, s60, 3
s_bfe_u32 s60, s2, 0x30003
s_add_u32 s6, s6, s60
v_mfma_f32_16x16x32_bf16 a[176:179], a[32:35], a[128:131], a[176:179]
s_bfe_u32 s60, s2, 0x10002
s_lshl_b32 s7, s60, 2
s_lshr_b32 s60, s2, 6
v_mfma_f32_16x16x32_bf16 a[176:179], a[36:39], a[132:135], a[176:179]
buffer_load_dwordx4 v7, s[12:15], s29 offen offset:1024 lds
v_mfma_f32_16x16x32_bf16 a[180:183], a[40:43], a[128:131], a[180:183]
s_add_u32 s7, s7, s60
s_lshl_b32 s60, s89, 7
s_lshl_b32 s61, s3, 5
v_mfma_f32_16x16x32_bf16 a[180:183], a[44:47], a[132:135], a[180:183]
s_add_u32 s37, s60, s61
s_mul_i32 s37, s37, 1280
s_mul_i32 s40, s88, 163840
v_mfma_f32_16x16x32_bf16 a[184:187], a[48:51], a[128:131], a[184:187]
s_add_u32 s40, s40, s35
s_add_u32 s40, s40, 57671680
s_lshl_b32 s60, s5, 7
v_mfma_f32_16x16x32_bf16 a[184:187], a[52:55], a[132:135], a[184:187]
s_add_u32 s41, s60, s61
s_sub_u32 s57, 1920, s60
s_add_u32 s57, s57, s61
v_mfma_f32_16x16x32_bf16 a[188:191], a[56:59], a[128:131], a[188:191]
buffer_load_dwordx4 v8, s[12:15], s29 offen offset:2048 lds
v_mfma_f32_16x16x32_bf16 a[188:191], a[60:63], a[132:135], a[188:191]
s_waitcnt lgkmcnt(0)
s_mul_i32 s41, s41, 1280
s_mul_i32 s57, s57, 1280
v_mfma_f32_16x16x32_bf16 v[160:163], a[0:3], a[136:139], v[160:163]
s_lshl_b32 s58, s3, 17
ds_read_b64_tr_b16 a[152:153], v15 offset:16384
v_mfma_f32_16x16x32_bf16 v[160:163], a[4:7], a[140:143], v[160:163]
s_lshl_b32 s60, s4, 8
ds_read_b64_tr_b16 a[154:155], v15 offset:17408
v_mfma_f32_16x16x32_bf16 v[164:167], a[8:11], a[136:139], v[164:167]
s_add_u32 s58, s58, s60
ds_read_b64_tr_b16 a[156:157], v15 offset:24576
v_mfma_f32_16x16x32_bf16 v[164:167], a[12:15], a[140:143], v[164:167]
s_lshl_b32 s38, s4, 19
ds_read_b64_tr_b16 a[158:159], v15 offset:25600
v_mfma_f32_16x16x32_bf16 v[192:195], a[16:19], a[136:139], v[192:195]
buffer_load_dwordx4 v9, s[12:15], s29 offen offset:3072 lds
v_mfma_f32_16x16x32_bf16 v[192:195], a[20:23], a[140:143], v[192:195]
s_add_u32 m0, m0, 4096
s_add_u32 s32, s29, 131072
s_add_u32 s59, s38, s35
v_mfma_f32_16x16x32_bf16 v[196:199], a[24:27], a[136:139], v[196:199]
s_mov_b32 s39, s36
s_add_u32 s38, s38, s36
s_lshr_b32 s60, s3, 1
v_mfma_f32_16x16x32_bf16 v[196:199], a[28:31], a[140:143], v[196:199]
s_mul_i32 s60, s60, 16736256
s_add_u32 s38, s38, s60
s_add_u32 s38, s38, 16384
v_mfma_f32_16x16x32_bf16 v[224:227], a[32:35], a[136:139], v[224:227]
s_lshl_b32 s60, s4, 19
s_lshl_b32 s61, s5, 14
s_add_u32 s60, s60, s61
v_mfma_f32_16x16x32_bf16 v[224:227], a[36:39], a[140:143], v[224:227]
buffer_load_dwordx4 v6, s[12:15], s32 offen offset:0 lds
v_mfma_f32_16x16x32_bf16 v[228:231], a[40:43], a[136:139], v[228:231]
s_and_b32 s61, s3, 1
s_lshl_b32 s61, s61, 13
s_add_u32 s60, s60, s61
v_mfma_f32_16x16x32_bf16 v[228:231], a[44:47], a[140:143], v[228:231]
s_lshr_b32 s61, s3, 1
s_lshl_b32 s55, s61, 11
s_add_u32 s55, s55, s60
v_mfma_f32_16x16x32_bf16 v[184:187], a[48:51], a[136:139], v[184:187]
s_lshl_b32 s56, s61, 12
s_add_u32 s56, s56, s60
s_add_u32 s56, s56, 16777216
v_mfma_f32_16x16x32_bf16 v[184:187], a[52:55], a[140:143], v[184:187]
v_mfma_f32_16x16x32_bf16 v[188:191], a[56:59], a[136:139], v[188:191]
buffer_load_dwordx4 v7, s[12:15], s32 offen offset:1024 lds
v_mfma_f32_16x16x32_bf16 v[188:191], a[60:63], a[140:143], v[188:191]
s_waitcnt lgkmcnt(0)
v_mfma_f32_16x16x32_bf16 v[168:171], a[0:3], a[144:147], v[168:171]
ds_read_b64_tr_b16 a[128:129], v12 offset:0
v_mfma_f32_16x16x32_bf16 v[168:171], a[4:7], a[148:151], v[168:171]
ds_read_b64_tr_b16 a[130:131], v12 offset:1024
v_mfma_f32_16x16x32_bf16 v[172:175], a[8:11], a[144:147], v[172:175]
ds_read_b64_tr_b16 a[132:133], v12 offset:8192
v_mfma_f32_16x16x32_bf16 v[172:175], a[12:15], a[148:151], v[172:175]
ds_read_b64_tr_b16 a[134:135], v12 offset:9216
v_mfma_f32_16x16x32_bf16 v[200:203], a[16:19], a[144:147], v[200:203]
buffer_load_dwordx4 v8, s[12:15], s32 offen offset:2048 lds
v_mfma_f32_16x16x32_bf16 v[200:203], a[20:23], a[148:151], v[200:203]
v_mfma_f32_16x16x32_bf16 v[204:207], a[24:27], a[144:147], v[204:207]
v_mfma_f32_16x16x32_bf16 v[204:207], a[28:31], a[148:151], v[204:207]
v_mfma_f32_16x16x32_bf16 v[232:235], a[32:35], a[144:147], v[232:235]
v_mfma_f32_16x16x32_bf16 v[232:235], a[36:39], a[148:151], v[232:235]
buffer_load_dwordx4 v9, s[12:15], s32 offen offset:3072 lds
v_mfma_f32_16x16x32_bf16 v[236:239], a[40:43], a[144:147], v[236:239]
s_add_u32 s28, s28, 128
s_add_u32 s29, s29, 524288
s_xor_b32 s30, s30, 0x10000
v_mfma_f32_16x16x32_bf16 v[236:239], a[44:47], a[148:151], v[236:239]
s_add_u32 s33, s44, 3670016
v_lshrrev_b32 v19, 5, v27
v_mul_u32_u24 v19, 8192, v19
v_mfma_f32_16x16x32_bf16 v[216:219], a[48:51], a[144:147], v[216:219]
v_and_b32 v18, 7, v27
v_lshl_add_u32 v19, v18, 7, v19
v_mfma_f32_16x16x32_bf16 v[216:219], a[52:55], a[148:151], v[216:219]
buffer_load_dword v28, v19, s[12:15], s33 offen
v_mfma_f32_16x16x32_bf16 v[220:223], a[56:59], a[144:147], v[220:223]
s_mov_b32 s33, 2097152
v_mfma_f32_16x16x32_bf16 v[220:223], a[60:63], a[148:151], v[220:223]
s_waitcnt lgkmcnt(0)
v_mfma_f32_16x16x32_bf16 v[176:179], a[0:3], a[152:155], v[176:179]
ds_read_b64_tr_b16 a[136:137], v13 offset:0
v_mfma_f32_16x16x32_bf16 v[176:179], a[4:7], a[156:159], v[176:179]
ds_read_b64_tr_b16 a[138:139], v13 offset:1024
v_mfma_f32_16x16x32_bf16 v[180:183], a[8:11], a[152:155], v[180:183]
ds_read_b64_tr_b16 a[140:141], v13 offset:8192
v_mfma_f32_16x16x32_bf16 v[180:183], a[12:15], a[156:159], v[180:183]
ds_read_b64_tr_b16 a[142:143], v13 offset:9216
v_mfma_f32_16x16x32_bf16 v[208:211], a[16:19], a[152:155], v[208:211]
buffer_load_dword v28, v30, s[64:67], s33 offen
v_mfma_f32_16x16x32_bf16 v[208:211], a[20:23], a[156:159], v[208:211]
s_add_u32 m0, s31, 1024
v_accvgpr_read_b32 v17, a251
v_mfma_f32_16x16x32_bf16 v[212:215], a[24:27], a[152:155], v[212:215]
buffer_load_dwordx4 v17, s[84:87], s53 offen lds
v_mfma_f32_16x16x32_bf16 v[212:215], a[28:31], a[156:159], v[212:215]
v_mfma_f32_16x16x32_bf16 v[240:243], a[32:35], a[152:155], v[240:243]
v_mfma_f32_16x16x32_bf16 v[240:243], a[36:39], a[156:159], v[240:243]
v_mfma_f32_16x16x32_bf16 v[244:247], a[40:43], a[152:155], v[244:247]
v_mfma_f32_16x16x32_bf16 v[244:247], a[44:47], a[156:159], v[244:247]
v_mfma_f32_16x16x32_bf16 v[248:251], a[48:51], a[152:155], v[248:251]
v_mfma_f32_16x16x32_bf16 v[248:251], a[52:55], a[156:159], v[248:251]
v_mfma_f32_16x16x32_bf16 v[252:255], a[56:59], a[152:155], v[252:255]
v_mfma_f32_16x16x32_bf16 v[252:255], a[60:63], a[156:159], v[252:255]
s_waitcnt lgkmcnt(0)
v_mfma_f32_16x16x32_bf16 v[96:99], a[128:131], a[0:3], v[96:99]
ds_read_b64_tr_b16 a[144:145], v14 offset:0
v_mfma_f32_16x16x32_bf16 v[96:99], a[132:135], a[4:7], v[96:99]
ds_read_b64_tr_b16 a[146:147], v14 offset:1024
v_mfma_f32_16x16x32_bf16 v[100:103], a[128:131], a[8:11], v[100:103]
ds_read_b64_tr_b16 a[148:149], v14 offset:8192
v_mfma_f32_16x16x32_bf16 v[100:103], a[132:135], a[12:15], v[100:103]
ds_read_b64_tr_b16 a[150:151], v14 offset:9216
v_mfma_f32_16x16x32_bf16 v[104:107], a[128:131], a[16:19], v[104:107]
ds_read_b64_tr_b16 a[152:153], v15 offset:0
v_mfma_f32_16x16x32_bf16 v[104:107], a[132:135], a[20:23], v[104:107]
ds_read_b64_tr_b16 a[154:155], v15 offset:1024
v_mfma_f32_16x16x32_bf16 v[108:111], a[128:131], a[24:27], v[108:111]
ds_read_b64_tr_b16 a[156:157], v15 offset:8192
v_mfma_f32_16x16x32_bf16 v[108:111], a[132:135], a[28:31], v[108:111]
ds_read_b64_tr_b16 a[158:159], v15 offset:9216
v_mfma_f32_16x16x32_bf16 v[32:35], a[128:131], a[32:35], v[32:35]
v_mfma_f32_16x16x32_bf16 v[32:35], a[132:135], a[36:39], v[32:35]
v_mfma_f32_16x16x32_bf16 v[36:39], a[128:131], a[40:43], v[36:39]
v_mfma_f32_16x16x32_bf16 v[36:39], a[132:135], a[44:47], v[36:39]
v_mfma_f32_16x16x32_bf16 v[40:43], a[128:131], a[48:51], v[40:43]
v_xor_b32 v10, 0x10000, v10
v_xor_b32 v11, 0x10000, v11
v_mfma_f32_16x16x32_bf16 v[40:43], a[132:135], a[52:55], v[40:43]
v_xor_b32 v12, 0x10000, v12
v_xor_b32 v13, 0x10000, v13
v_mfma_f32_16x16x32_bf16 v[44:47], a[128:131], a[56:59], v[44:47]
v_xor_b32 v14, 0x10000, v14
v_xor_b32 v15, 0x10000, v15
v_mfma_f32_16x16x32_bf16 v[44:47], a[132:135], a[60:63], v[44:47]
s_waitcnt lgkmcnt(0)
v_mfma_f32_16x16x32_bf16 v[112:115], a[136:139], a[0:3], v[112:115]
s_waitcnt vmcnt(3)
s_barrier
v_mfma_f32_16x16x32_bf16 v[112:115], a[140:143], a[4:7], v[112:115]
s_mov_b32 m0, s30
ds_read_b128 a[64:67], v10 offset:0
v_mfma_f32_16x16x32_bf16 v[116:119], a[136:139], a[8:11], v[116:119]
buffer_load_dwordx4 v2, s[8:11], s28 offen offset:0 lds
v_mfma_f32_16x16x32_bf16 v[116:119], a[140:143], a[12:15], v[116:119]
ds_read_b128 a[68:71], v11 offset:0
v_mfma_f32_16x16x32_bf16 v[120:123], a[136:139], a[16:19], v[120:123]
v_mfma_f32_16x16x32_bf16 v[120:123], a[140:143], a[20:23], v[120:123]
ds_read_b128 a[72:75], v10 offset:2048
v_mfma_f32_16x16x32_bf16 v[124:127], a[136:139], a[24:27], v[124:127]
v_mfma_f32_16x16x32_bf16 v[124:127], a[140:143], a[28:31], v[124:127]
ds_read_b128 a[76:79], v11 offset:2048
v_mfma_f32_16x16x32_bf16 v[48:51], a[136:139], a[32:35], v[48:51]
buffer_load_dwordx4 v3, s[8:11], s28 offen offset:1024 lds
v_mfma_f32_16x16x32_bf16 v[48:51], a[140:143], a[36:39], v[48:51]
ds_read_b128 a[80:83], v10 offset:4096
v_mfma_f32_16x16x32_bf16 v[52:55], a[136:139], a[40:43], v[52:55]
v_mfma_f32_16x16x32_bf16 v[52:55], a[140:143], a[44:47], v[52:55]
ds_read_b128 a[84:87], v11 offset:4096
v_mfma_f32_16x16x32_bf16 v[56:59], a[136:139], a[48:51], v[56:59]
v_mfma_f32_16x16x32_bf16 v[56:59], a[140:143], a[52:55], v[56:59]
ds_read_b128 a[88:91], v10 offset:6144
v_mfma_f32_16x16x32_bf16 v[60:63], a[136:139], a[56:59], v[60:63]
buffer_load_dwordx4 v4, s[8:11], s28 offen offset:2048 lds
v_mfma_f32_16x16x32_bf16 v[60:63], a[140:143], a[60:63], v[60:63]
ds_read_b128 a[92:95], v11 offset:6144
v_mfma_f32_16x16x32_bf16 v[128:131], a[144:147], a[0:3], v[128:131]
v_mfma_f32_16x16x32_bf16 v[128:131], a[148:151], a[4:7], v[128:131]
ds_read_b128 a[96:99], v10 offset:8192
v_mfma_f32_16x16x32_bf16 v[132:135], a[144:147], a[8:11], v[132:135]
v_mfma_f32_16x16x32_bf16 v[132:135], a[148:151], a[12:15], v[132:135]
ds_read_b128 a[100:103], v11 offset:8192
v_mfma_f32_16x16x32_bf16 v[136:139], a[144:147], a[16:19], v[136:139]
buffer_load_dwordx4 v5, s[8:11], s28 offen offset:3072 lds
v_mfma_f32_16x16x32_bf16 v[136:139], a[148:151], a[20:23], v[136:139]
s_add_u32 m0, m0, 4096
ds_read_b128 a[104:107], v10 offset:10240
v_mfma_f32_16x16x32_bf16 v[140:143], a[144:147], a[24:27], v[140:143]
s_add_u32 s32, s28, 524288
v_mfma_f32_16x16x32_bf16 v[140:143], a[148:151], a[28:31], v[140:143]
ds_read_b128 a[108:111], v11 offset:10240
v_mfma_f32_16x16x32_bf16 v[64:67], a[144:147], a[32:35], v[64:67]
v_mfma_f32_16x16x32_bf16 v[64:67], a[148:151], a[36:39], v[64:67]
ds_read_b128 a[112:115], v10 offset:12288
v_mfma_f32_16x16x32_bf16 v[68:71], a[144:147], a[40:43], v[68:71]
buffer_load_dwordx4 v2, s[8:11], s32 offen offset:0 lds
v_mfma_f32_16x16x32_bf16 v[68:71], a[148:151], a[44:47], v[68:71]
ds_read_b128 a[116:119], v11 offset:12288
v_mfma_f32_16x16x32_bf16 v[72:75], a[144:147], a[48:51], v[72:75]
v_mfma_f32_16x16x32_bf16 v[72:75], a[148:151], a[52:55], v[72:75]
ds_read_b128 a[120:123], v10 offset:14336
v_mfma_f32_16x16x32_bf16 v[76:79], a[144:147], a[56:59], v[76:79]
v_mfma_f32_16x16x32_bf16 v[76:79], a[148:151], a[60:63], v[76:79]
ds_read_b128 a[124:127], v11 offset:14336
v_mfma_f32_16x16x32_bf16 v[144:147], a[152:155], a[0:3], v[144:147]
buffer_load_dwordx4 v3, s[8:11], s32 offen offset:1024 lds
v_mfma_f32_16x16x32_bf16 v[144:147], a[156:159], a[4:7], v[144:147]
ds_read_b64_tr_b16 a[128:129], v12 offset:16384
v_mfma_f32_16x16x32_bf16 v[148:151], a[152:155], a[8:11], v[148:151]
ds_read_b64_tr_b16 a[130:131], v12 offset:17408
v_mfma_f32_16x16x32_bf16 v[148:151], a[156:159], a[12:15], v[148:151]
ds_read_b64_tr_b16 a[132:133], v12 offset:24576
v_mfma_f32_16x16x32_bf16 v[152:155], a[152:155], a[16:19], v[152:155]
ds_read_b64_tr_b16 a[134:135], v12 offset:25600
v_mfma_f32_16x16x32_bf16 v[152:155], a[156:159], a[20:23], v[152:155]
ds_read_b64_tr_b16 a[136:137], v13 offset:16384
v_mfma_f32_16x16x32_bf16 v[156:159], a[152:155], a[24:27], v[156:159]
ds_read_b64_tr_b16 a[138:139], v13 offset:17408
v_mfma_f32_16x16x32_bf16 v[156:159], a[156:159], a[28:31], v[156:159]
ds_read_b64_tr_b16 a[140:141], v13 offset:24576
v_mfma_f32_16x16x32_bf16 v[80:83], a[152:155], a[32:35], v[80:83]
ds_read_b64_tr_b16 a[142:143], v13 offset:25600
v_mfma_f32_16x16x32_bf16 v[80:83], a[156:159], a[36:39], v[80:83]
buffer_load_dwordx4 v4, s[8:11], s32 offen offset:2048 lds
v_mfma_f32_16x16x32_bf16 v[84:87], a[152:155], a[40:43], v[84:87]
v_mfma_f32_16x16x32_bf16 v[84:87], a[156:159], a[44:47], v[84:87]
v_mfma_f32_16x16x32_bf16 v[88:91], a[152:155], a[48:51], v[88:91]
v_mfma_f32_16x16x32_bf16 v[88:91], a[156:159], a[52:55], v[88:91]
v_mfma_f32_16x16x32_bf16 v[92:95], a[152:155], a[56:59], v[92:95]
buffer_load_dwordx4 v5, s[8:11], s32 offen offset:3072 lds
v_mfma_f32_16x16x32_bf16 v[92:95], a[156:159], a[60:63], v[92:95]
s_waitcnt lgkmcnt(0)
v_mfma_f32_16x16x32_bf16 a[160:163], a[64:67], a[128:131], a[160:163]
s_add_u32 m0, s30, 32768
ds_read_b64_tr_b16 a[144:145], v14 offset:16384
v_mfma_f32_16x16x32_bf16 a[160:163], a[68:71], a[132:135], a[160:163]
ds_read_b64_tr_b16 a[146:147], v14 offset:17408
v_mfma_f32_16x16x32_bf16 a[164:167], a[72:75], a[128:131], a[164:167]
ds_read_b64_tr_b16 a[148:149], v14 offset:24576
v_mfma_f32_16x16x32_bf16 a[164:167], a[76:79], a[132:135], a[164:167]
ds_read_b64_tr_b16 a[150:151], v14 offset:25600
v_mfma_f32_16x16x32_bf16 a[168:171], a[80:83], a[128:131], a[168:171]
buffer_load_dwordx4 v6, s[12:15], s29 offen offset:0 lds
s_cmp_lg_u32 s3, 0
s_cbranch_scc1 w0_concat_1
v_mov_b32 v31, 0
buffer_load_dword v21, v31, s[24:27], 0 offen sc1
w0_concat_1:
v_mfma_f32_16x16x32_bf16 a[168:171], a[84:87], a[132:135], a[168:171]
v_mfma_f32_16x16x32_bf16 a[172:175], a[88:91], a[128:131], a[172:175]
v_mfma_f32_16x16x32_bf16 a[172:175], a[92:95], a[132:135], a[172:175]
v_mfma_f32_16x16x32_bf16 a[176:179], a[96:99], a[128:131], a[176:179]
v_mfma_f32_16x16x32_bf16 a[176:179], a[100:103], a[132:135], a[176:179]
buffer_load_dwordx4 v7, s[12:15], s29 offen offset:1024 lds
v_mfma_f32_16x16x32_bf16 a[180:183], a[104:107], a[128:131], a[180:183]
v_mfma_f32_16x16x32_bf16 a[180:183], a[108:111], a[132:135], a[180:183]
v_mfma_f32_16x16x32_bf16 a[184:187], a[112:115], a[128:131], a[184:187]
v_mfma_f32_16x16x32_bf16 a[184:187], a[116:119], a[132:135], a[184:187]
v_mfma_f32_16x16x32_bf16 a[188:191], a[120:123], a[128:131], a[188:191]
buffer_load_dwordx4 v8, s[12:15], s29 offen offset:2048 lds
v_mfma_f32_16x16x32_bf16 a[188:191], a[124:127], a[132:135], a[188:191]
s_waitcnt lgkmcnt(0)
v_mfma_f32_16x16x32_bf16 v[160:163], a[64:67], a[136:139], v[160:163]
ds_read_b64_tr_b16 a[152:153], v15 offset:16384
v_mfma_f32_16x16x32_bf16 v[160:163], a[68:71], a[140:143], v[160:163]
ds_read_b64_tr_b16 a[154:155], v15 offset:17408
v_mfma_f32_16x16x32_bf16 v[164:167], a[72:75], a[136:139], v[164:167]
ds_read_b64_tr_b16 a[156:157], v15 offset:24576
v_mfma_f32_16x16x32_bf16 v[164:167], a[76:79], a[140:143], v[164:167]
ds_read_b64_tr_b16 a[158:159], v15 offset:25600
v_mfma_f32_16x16x32_bf16 v[192:195], a[80:83], a[136:139], v[192:195]
buffer_load_dwordx4 v9, s[12:15], s29 offen offset:3072 lds
v_mfma_f32_16x16x32_bf16 v[192:195], a[84:87], a[140:143], v[192:195]
s_add_u32 m0, m0, 4096
s_add_u32 s32, s29, 131072
v_mfma_f32_16x16x32_bf16 v[196:199], a[88:91], a[136:139], v[196:199]
v_mfma_f32_16x16x32_bf16 v[196:199], a[92:95], a[140:143], v[196:199]
v_mfma_f32_16x16x32_bf16 v[224:227], a[96:99], a[136:139], v[224:227]
v_mfma_f32_16x16x32_bf16 v[224:227], a[100:103], a[140:143], v[224:227]
buffer_load_dwordx4 v6, s[12:15], s32 offen offset:0 lds
v_mfma_f32_16x16x32_bf16 v[228:231], a[104:107], a[136:139], v[228:231]
v_mfma_f32_16x16x32_bf16 v[228:231], a[108:111], a[140:143], v[228:231]
v_mfma_f32_16x16x32_bf16 v[184:187], a[112:115], a[136:139], v[184:187]
v_mfma_f32_16x16x32_bf16 v[184:187], a[116:119], a[140:143], v[184:187]
v_mfma_f32_16x16x32_bf16 v[188:191], a[120:123], a[136:139], v[188:191]
buffer_load_dwordx4 v7, s[12:15], s32 offen offset:1024 lds
v_mfma_f32_16x16x32_bf16 v[188:191], a[124:127], a[140:143], v[188:191]
s_waitcnt lgkmcnt(0)
v_mfma_f32_16x16x32_bf16 v[168:171], a[64:67], a[144:147], v[168:171]
ds_read_b64_tr_b16 a[128:129], v12 offset:0
v_mfma_f32_16x16x32_bf16 v[168:171], a[68:71], a[148:151], v[168:171]
ds_read_b64_tr_b16 a[130:131], v12 offset:1024
v_mfma_f32_16x16x32_bf16 v[172:175], a[72:75], a[144:147], v[172:175]
ds_read_b64_tr_b16 a[132:133], v12 offset:8192
v_mfma_f32_16x16x32_bf16 v[172:175], a[76:79], a[148:151], v[172:175]
ds_read_b64_tr_b16 a[134:135], v12 offset:9216
v_mfma_f32_16x16x32_bf16 v[200:203], a[80:83], a[144:147], v[200:203]
buffer_load_dwordx4 v8, s[12:15], s32 offen offset:2048 lds
v_mfma_f32_16x16x32_bf16 v[200:203], a[84:87], a[148:151], v[200:203]
v_mfma_f32_16x16x32_bf16 v[204:207], a[88:91], a[144:147], v[204:207]
v_mfma_f32_16x16x32_bf16 v[204:207], a[92:95], a[148:151], v[204:207]
v_mfma_f32_16x16x32_bf16 v[232:235], a[96:99], a[144:147], v[232:235]
v_mfma_f32_16x16x32_bf16 v[232:235], a[100:103], a[148:151], v[232:235]
buffer_load_dwordx4 v9, s[12:15], s32 offen offset:3072 lds
v_mfma_f32_16x16x32_bf16 v[236:239], a[104:107], a[144:147], v[236:239]
s_add_u32 s28, s28, 128
s_add_u32 s29, s29, 524288
s_xor_b32 s30, s30, 0x10000
v_mfma_f32_16x16x32_bf16 v[236:239], a[108:111], a[148:151], v[236:239]
s_mov_b32 s33, 0
v_mfma_f32_16x16x32_bf16 v[216:219], a[112:115], a[144:147], v[216:219]
buffer_load_dword v28, v30, s[64:67], s33 offen
v_mfma_f32_16x16x32_bf16 v[216:219], a[116:119], a[148:151], v[216:219]
s_add_u32 m0, s31, 2048
v_accvgpr_read_b32 v17, a252
v_mfma_f32_16x16x32_bf16 v[220:223], a[120:123], a[144:147], v[220:223]
buffer_load_dwordx4 v17, s[84:87], s53 offen lds
v_mfma_f32_16x16x32_bf16 v[220:223], a[124:127], a[148:151], v[220:223]
s_waitcnt lgkmcnt(0)
v_mfma_f32_16x16x32_bf16 v[176:179], a[64:67], a[152:155], v[176:179]
ds_read_b64_tr_b16 a[136:137], v13 offset:0
v_mfma_f32_16x16x32_bf16 v[176:179], a[68:71], a[156:159], v[176:179]
ds_read_b64_tr_b16 a[138:139], v13 offset:1024
v_mfma_f32_16x16x32_bf16 v[180:183], a[72:75], a[152:155], v[180:183]
ds_read_b64_tr_b16 a[140:141], v13 offset:8192
v_mfma_f32_16x16x32_bf16 v[180:183], a[76:79], a[156:159], v[180:183]
ds_read_b64_tr_b16 a[142:143], v13 offset:9216
v_mfma_f32_16x16x32_bf16 v[208:211], a[80:83], a[152:155], v[208:211]
v_mfma_f32_16x16x32_bf16 v[208:211], a[84:87], a[156:159], v[208:211]
v_mfma_f32_16x16x32_bf16 v[212:215], a[88:91], a[152:155], v[212:215]
v_mfma_f32_16x16x32_bf16 v[212:215], a[92:95], a[156:159], v[212:215]
v_mfma_f32_16x16x32_bf16 v[240:243], a[96:99], a[152:155], v[240:243]
v_mfma_f32_16x16x32_bf16 v[240:243], a[100:103], a[156:159], v[240:243]
v_mfma_f32_16x16x32_bf16 v[244:247], a[104:107], a[152:155], v[244:247]
v_mfma_f32_16x16x32_bf16 v[244:247], a[108:111], a[156:159], v[244:247]
v_mfma_f32_16x16x32_bf16 v[248:251], a[112:115], a[152:155], v[248:251]
v_mfma_f32_16x16x32_bf16 v[248:251], a[116:119], a[156:159], v[248:251]
v_mfma_f32_16x16x32_bf16 v[252:255], a[120:123], a[152:155], v[252:255]
v_mfma_f32_16x16x32_bf16 v[252:255], a[124:127], a[156:159], v[252:255]
s_waitcnt lgkmcnt(0)
v_mfma_f32_16x16x32_bf16 v[96:99], a[128:131], a[64:67], v[96:99]
ds_read_b64_tr_b16 a[144:145], v14 offset:0
v_mfma_f32_16x16x32_bf16 v[96:99], a[132:135], a[68:71], v[96:99]
ds_read_b64_tr_b16 a[146:147], v14 offset:1024
v_mfma_f32_16x16x32_bf16 v[100:103], a[128:131], a[72:75], v[100:103]
ds_read_b64_tr_b16 a[148:149], v14 offset:8192
v_mfma_f32_16x16x32_bf16 v[100:103], a[132:135], a[76:79], v[100:103]
ds_read_b64_tr_b16 a[150:151], v14 offset:9216
v_mfma_f32_16x16x32_bf16 v[104:107], a[128:131], a[80:83], v[104:107]
ds_read_b64_tr_b16 a[152:153], v15 offset:0
v_mfma_f32_16x16x32_bf16 v[104:107], a[132:135], a[84:87], v[104:107]
ds_read_b64_tr_b16 a[154:155], v15 offset:1024
v_mfma_f32_16x16x32_bf16 v[108:111], a[128:131], a[88:91], v[108:111]
ds_read_b64_tr_b16 a[156:157], v15 offset:8192
v_mfma_f32_16x16x32_bf16 v[108:111], a[132:135], a[92:95], v[108:111]
ds_read_b64_tr_b16 a[158:159], v15 offset:9216
v_mfma_f32_16x16x32_bf16 v[32:35], a[128:131], a[96:99], v[32:35]
v_mfma_f32_16x16x32_bf16 v[32:35], a[132:135], a[100:103], v[32:35]
v_mfma_f32_16x16x32_bf16 v[36:39], a[128:131], a[104:107], v[36:39]
v_mfma_f32_16x16x32_bf16 v[36:39], a[132:135], a[108:111], v[36:39]
v_mfma_f32_16x16x32_bf16 v[40:43], a[128:131], a[112:115], v[40:43]
v_xor_b32 v10, 0x10000, v10
v_xor_b32 v11, 0x10000, v11
v_mfma_f32_16x16x32_bf16 v[40:43], a[132:135], a[116:119], v[40:43]
v_xor_b32 v12, 0x10000, v12
v_xor_b32 v13, 0x10000, v13
v_mfma_f32_16x16x32_bf16 v[44:47], a[128:131], a[120:123], v[44:47]
v_xor_b32 v14, 0x10000, v14
v_xor_b32 v15, 0x10000, v15
v_mfma_f32_16x16x32_bf16 v[44:47], a[132:135], a[124:127], v[44:47]
s_waitcnt lgkmcnt(0)
v_mfma_f32_16x16x32_bf16 v[112:115], a[136:139], a[64:67], v[112:115]
s_waitcnt vmcnt(2)
s_cmp_lg_u32 s3, 0
s_cbranch_scc1 spinret_concat_3
v_readfirstlane_b32 s60, v21
s_cmp_lt_u32 s60, 1
s_cbranch_scc1 spin_concat_2
spinret_concat_3:
s_barrier
v_mfma_f32_16x16x32_bf16 v[112:115], a[140:143], a[68:71], v[112:115]
s_mov_b32 m0, s30
ds_read_b128 a[0:3], v10 offset:0
v_mfma_f32_16x16x32_bf16 v[116:119], a[136:139], a[72:75], v[116:119]
buffer_load_dwordx4 v2, s[8:11], s28 offen offset:0 lds
v_mfma_f32_16x16x32_bf16 v[116:119], a[140:143], a[76:79], v[116:119]
ds_read_b128 a[4:7], v11 offset:0
v_mfma_f32_16x16x32_bf16 v[120:123], a[136:139], a[80:83], v[120:123]
v_mfma_f32_16x16x32_bf16 v[120:123], a[140:143], a[84:87], v[120:123]
ds_read_b128 a[8:11], v10 offset:2048
v_mfma_f32_16x16x32_bf16 v[124:127], a[136:139], a[88:91], v[124:127]
v_mfma_f32_16x16x32_bf16 v[124:127], a[140:143], a[92:95], v[124:127]
ds_read_b128 a[12:15], v11 offset:2048
v_mfma_f32_16x16x32_bf16 v[48:51], a[136:139], a[96:99], v[48:51]
buffer_load_dwordx4 v3, s[8:11], s28 offen offset:1024 lds
v_mfma_f32_16x16x32_bf16 v[48:51], a[140:143], a[100:103], v[48:51]
ds_read_b128 a[16:19], v10 offset:4096
v_mfma_f32_16x16x32_bf16 v[52:55], a[136:139], a[104:107], v[52:55]
v_mfma_f32_16x16x32_bf16 v[52:55], a[140:143], a[108:111], v[52:55]
ds_read_b128 a[20:23], v11 offset:4096
v_mfma_f32_16x16x32_bf16 v[56:59], a[136:139], a[112:115], v[56:59]
v_mfma_f32_16x16x32_bf16 v[56:59], a[140:143], a[116:119], v[56:59]
ds_read_b128 a[24:27], v10 offset:6144
v_mfma_f32_16x16x32_bf16 v[60:63], a[136:139], a[120:123], v[60:63]
buffer_load_dwordx4 v4, s[8:11], s28 offen offset:2048 lds
v_mfma_f32_16x16x32_bf16 v[60:63], a[140:143], a[124:127], v[60:63]
ds_read_b128 a[28:31], v11 offset:6144
v_mfma_f32_16x16x32_bf16 v[128:131], a[144:147], a[64:67], v[128:131]
v_mfma_f32_16x16x32_bf16 v[128:131], a[148:151], a[68:71], v[128:131]
ds_read_b128 a[32:35], v10 offset:8192
v_mfma_f32_16x16x32_bf16 v[132:135], a[144:147], a[72:75], v[132:135]
v_mfma_f32_16x16x32_bf16 v[132:135], a[148:151], a[76:79], v[132:135]
ds_read_b128 a[36:39], v11 offset:8192
v_mfma_f32_16x16x32_bf16 v[136:139], a[144:147], a[80:83], v[136:139]
buffer_load_dwordx4 v5, s[8:11], s28 offen offset:3072 lds
v_mfma_f32_16x16x32_bf16 v[136:139], a[148:151], a[84:87], v[136:139]
s_add_u32 m0, m0, 4096
ds_read_b128 a[40:43], v10 offset:10240
v_mfma_f32_16x16x32_bf16 v[140:143], a[144:147], a[88:91], v[140:143]
s_add_u32 s32, s28, 524288
v_mfma_f32_16x16x32_bf16 v[140:143], a[148:151], a[92:95], v[140:143]
ds_read_b128 a[44:47], v11 offset:10240
v_mfma_f32_16x16x32_bf16 v[64:67], a[144:147], a[96:99], v[64:67]
v_mfma_f32_16x16x32_bf16 v[64:67], a[148:151], a[100:103], v[64:67]
ds_read_b128 a[48:51], v10 offset:12288
v_mfma_f32_16x16x32_bf16 v[68:71], a[144:147], a[104:107], v[68:71]
buffer_load_dwordx4 v2, s[8:11], s32 offen offset:0 lds
v_mfma_f32_16x16x32_bf16 v[68:71], a[148:151], a[108:111], v[68:71]
ds_read_b128 a[52:55], v11 offset:12288
v_mfma_f32_16x16x32_bf16 v[72:75], a[144:147], a[112:115], v[72:75]
v_mfma_f32_16x16x32_bf16 v[72:75], a[148:151], a[116:119], v[72:75]
ds_read_b128 a[56:59], v10 offset:14336
v_mfma_f32_16x16x32_bf16 v[76:79], a[144:147], a[120:123], v[76:79]
v_mfma_f32_16x16x32_bf16 v[76:79], a[148:151], a[124:127], v[76:79]
ds_read_b128 a[60:63], v11 offset:14336
v_mfma_f32_16x16x32_bf16 v[144:147], a[152:155], a[64:67], v[144:147]
buffer_load_dwordx4 v3, s[8:11], s32 offen offset:1024 lds
v_mfma_f32_16x16x32_bf16 v[144:147], a[156:159], a[68:71], v[144:147]
ds_read_b64_tr_b16 a[128:129], v12 offset:16384
v_mfma_f32_16x16x32_bf16 v[148:151], a[152:155], a[72:75], v[148:151]
ds_read_b64_tr_b16 a[130:131], v12 offset:17408
v_mfma_f32_16x16x32_bf16 v[148:151], a[156:159], a[76:79], v[148:151]
ds_read_b64_tr_b16 a[132:133], v12 offset:24576
v_mfma_f32_16x16x32_bf16 v[152:155], a[152:155], a[80:83], v[152:155]
ds_read_b64_tr_b16 a[134:135], v12 offset:25600
v_mfma_f32_16x16x32_bf16 v[152:155], a[156:159], a[84:87], v[152:155]
ds_read_b64_tr_b16 a[136:137], v13 offset:16384
v_mfma_f32_16x16x32_bf16 v[156:159], a[152:155], a[88:91], v[156:159]
ds_read_b64_tr_b16 a[138:139], v13 offset:17408
v_mfma_f32_16x16x32_bf16 v[156:159], a[156:159], a[92:95], v[156:159]
ds_read_b64_tr_b16 a[140:141], v13 offset:24576
v_mfma_f32_16x16x32_bf16 v[80:83], a[152:155], a[96:99], v[80:83]
ds_read_b64_tr_b16 a[142:143], v13 offset:25600
v_mfma_f32_16x16x32_bf16 v[80:83], a[156:159], a[100:103], v[80:83]
buffer_load_dwordx4 v4, s[8:11], s32 offen offset:2048 lds
v_mfma_f32_16x16x32_bf16 v[84:87], a[152:155], a[104:107], v[84:87]
v_mfma_f32_16x16x32_bf16 v[84:87], a[156:159], a[108:111], v[84:87]
v_mfma_f32_16x16x32_bf16 v[88:91], a[152:155], a[112:115], v[88:91]
v_mfma_f32_16x16x32_bf16 v[88:91], a[156:159], a[116:119], v[88:91]
v_mfma_f32_16x16x32_bf16 v[92:95], a[152:155], a[120:123], v[92:95]
buffer_load_dwordx4 v5, s[8:11], s32 offen offset:3072 lds
v_mfma_f32_16x16x32_bf16 v[92:95], a[156:159], a[124:127], v[92:95]
s_waitcnt lgkmcnt(0)
v_mfma_f32_16x16x32_bf16 a[160:163], a[0:3], a[128:131], a[160:163]
s_add_u32 m0, s30, 32768
ds_read_b64_tr_b16 a[144:145], v14 offset:16384
v_mfma_f32_16x16x32_bf16 a[160:163], a[4:7], a[132:135], a[160:163]
ds_read_b64_tr_b16 a[146:147], v14 offset:17408
v_mfma_f32_16x16x32_bf16 a[164:167], a[8:11], a[128:131], a[164:167]
ds_read_b64_tr_b16 a[148:149], v14 offset:24576
v_mfma_f32_16x16x32_bf16 a[164:167], a[12:15], a[132:135], a[164:167]
ds_read_b64_tr_b16 a[150:151], v14 offset:25600
v_mfma_f32_16x16x32_bf16 a[168:171], a[16:19], a[128:131], a[168:171]
buffer_load_dwordx4 v6, s[12:15], s29 offen offset:0 lds
v_mfma_f32_16x16x32_bf16 a[168:171], a[20:23], a[132:135], a[168:171]
v_mfma_f32_16x16x32_bf16 a[172:175], a[24:27], a[128:131], a[172:175]
v_mfma_f32_16x16x32_bf16 a[172:175], a[28:31], a[132:135], a[172:175]
v_mfma_f32_16x16x32_bf16 a[176:179], a[32:35], a[128:131], a[176:179]
v_mfma_f32_16x16x32_bf16 a[176:179], a[36:39], a[132:135], a[176:179]
buffer_load_dwordx4 v7, s[12:15], s29 offen offset:1024 lds
v_mfma_f32_16x16x32_bf16 a[180:183], a[40:43], a[128:131], a[180:183]
v_mfma_f32_16x16x32_bf16 a[180:183], a[44:47], a[132:135], a[180:183]
v_mfma_f32_16x16x32_bf16 a[184:187], a[48:51], a[128:131], a[184:187]
v_mfma_f32_16x16x32_bf16 a[184:187], a[52:55], a[132:135], a[184:187]
v_mfma_f32_16x16x32_bf16 a[188:191], a[56:59], a[128:131], a[188:191]
buffer_load_dwordx4 v8, s[12:15], s29 offen offset:2048 lds
v_mfma_f32_16x16x32_bf16 a[188:191], a[60:63], a[132:135], a[188:191]
s_waitcnt lgkmcnt(0)
v_mfma_f32_16x16x32_bf16 v[160:163], a[0:3], a[136:139], v[160:163]
ds_read_b64_tr_b16 a[152:153], v15 offset:16384
v_mfma_f32_16x16x32_bf16 v[160:163], a[4:7], a[140:143], v[160:163]
ds_read_b64_tr_b16 a[154:155], v15 offset:17408
v_mfma_f32_16x16x32_bf16 v[164:167], a[8:11], a[136:139], v[164:167]
ds_read_b64_tr_b16 a[156:157], v15 offset:24576
v_mfma_f32_16x16x32_bf16 v[164:167], a[12:15], a[140:143], v[164:167]
ds_read_b64_tr_b16 a[158:159], v15 offset:25600
v_mfma_f32_16x16x32_bf16 v[192:195], a[16:19], a[136:139], v[192:195]
buffer_load_dwordx4 v9, s[12:15], s29 offen offset:3072 lds
v_mfma_f32_16x16x32_bf16 v[192:195], a[20:23], a[140:143], v[192:195]
s_add_u32 m0, m0, 4096
s_add_u32 s32, s29, 131072
v_mfma_f32_16x16x32_bf16 v[196:199], a[24:27], a[136:139], v[196:199]
v_mfma_f32_16x16x32_bf16 v[196:199], a[28:31], a[140:143], v[196:199]
v_mfma_f32_16x16x32_bf16 v[224:227], a[32:35], a[136:139], v[224:227]
v_mfma_f32_16x16x32_bf16 v[224:227], a[36:39], a[140:143], v[224:227]
buffer_load_dwordx4 v6, s[12:15], s32 offen offset:0 lds
v_mfma_f32_16x16x32_bf16 v[228:231], a[40:43], a[136:139], v[228:231]
v_mfma_f32_16x16x32_bf16 v[228:231], a[44:47], a[140:143], v[228:231]
v_mfma_f32_16x16x32_bf16 v[184:187], a[48:51], a[136:139], v[184:187]
v_mfma_f32_16x16x32_bf16 v[184:187], a[52:55], a[140:143], v[184:187]
v_mfma_f32_16x16x32_bf16 v[188:191], a[56:59], a[136:139], v[188:191]
buffer_load_dwordx4 v7, s[12:15], s32 offen offset:1024 lds
v_mfma_f32_16x16x32_bf16 v[188:191], a[60:63], a[140:143], v[188:191]
s_waitcnt lgkmcnt(0)
v_mfma_f32_16x16x32_bf16 v[168:171], a[0:3], a[144:147], v[168:171]
ds_read_b64_tr_b16 a[128:129], v12 offset:0
v_mfma_f32_16x16x32_bf16 v[168:171], a[4:7], a[148:151], v[168:171]
ds_read_b64_tr_b16 a[130:131], v12 offset:1024
v_mfma_f32_16x16x32_bf16 v[172:175], a[8:11], a[144:147], v[172:175]
ds_read_b64_tr_b16 a[132:133], v12 offset:8192
v_mfma_f32_16x16x32_bf16 v[172:175], a[12:15], a[148:151], v[172:175]
ds_read_b64_tr_b16 a[134:135], v12 offset:9216
v_mfma_f32_16x16x32_bf16 v[200:203], a[16:19], a[144:147], v[200:203]
buffer_load_dwordx4 v8, s[12:15], s32 offen offset:2048 lds
v_mfma_f32_16x16x32_bf16 v[200:203], a[20:23], a[148:151], v[200:203]
v_mfma_f32_16x16x32_bf16 v[204:207], a[24:27], a[144:147], v[204:207]
v_mfma_f32_16x16x32_bf16 v[204:207], a[28:31], a[148:151], v[204:207]
v_mfma_f32_16x16x32_bf16 v[232:235], a[32:35], a[144:147], v[232:235]
v_mfma_f32_16x16x32_bf16 v[232:235], a[36:39], a[148:151], v[232:235]
buffer_load_dwordx4 v9, s[12:15], s32 offen offset:3072 lds
v_mfma_f32_16x16x32_bf16 v[236:239], a[40:43], a[144:147], v[236:239]
s_add_u32 s28, s28, 128
s_add_u32 s29, s29, 524288
s_xor_b32 s30, s30, 0x10000
v_mfma_f32_16x16x32_bf16 v[236:239], a[44:47], a[148:151], v[236:239]
s_mov_b32 s33, 0
v_mfma_f32_16x16x32_bf16 v[216:219], a[48:51], a[144:147], v[216:219]
buffer_load_dword v28, v30, s[68:71], s33 offen
v_mfma_f32_16x16x32_bf16 v[216:219], a[52:55], a[148:151], v[216:219]
s_add_u32 m0, s31, 3072
v_accvgpr_read_b32 v17, a253
v_mfma_f32_16x16x32_bf16 v[220:223], a[56:59], a[144:147], v[220:223]
buffer_load_dwordx4 v17, s[84:87], s53 offen lds
v_mfma_f32_16x16x32_bf16 v[220:223], a[60:63], a[148:151], v[220:223]
s_waitcnt lgkmcnt(0)
v_mfma_f32_16x16x32_bf16 v[176:179], a[0:3], a[152:155], v[176:179]
ds_read_b64_tr_b16 a[136:137], v13 offset:0
v_mfma_f32_16x16x32_bf16 v[176:179], a[4:7], a[156:159], v[176:179]
ds_read_b64_tr_b16 a[138:139], v13 offset:1024
v_mfma_f32_16x16x32_bf16 v[180:183], a[8:11], a[152:155], v[180:183]
ds_read_b64_tr_b16 a[140:141], v13 offset:8192
v_mfma_f32_16x16x32_bf16 v[180:183], a[12:15], a[156:159], v[180:183]
ds_read_b64_tr_b16 a[142:143], v13 offset:9216
v_mfma_f32_16x16x32_bf16 v[208:211], a[16:19], a[152:155], v[208:211]
v_mfma_f32_16x16x32_bf16 v[208:211], a[20:23], a[156:159], v[208:211]
v_mfma_f32_16x16x32_bf16 v[212:215], a[24:27], a[152:155], v[212:215]
v_mfma_f32_16x16x32_bf16 v[212:215], a[28:31], a[156:159], v[212:215]
v_mfma_f32_16x16x32_bf16 v[240:243], a[32:35], a[152:155], v[240:243]
v_mfma_f32_16x16x32_bf16 v[240:243], a[36:39], a[156:159], v[240:243]
v_mfma_f32_16x16x32_bf16 v[244:247], a[40:43], a[152:155], v[244:247]
v_mfma_f32_16x16x32_bf16 v[244:247], a[44:47], a[156:159], v[244:247]
v_mfma_f32_16x16x32_bf16 v[248:251], a[48:51], a[152:155], v[248:251]
v_mfma_f32_16x16x32_bf16 v[248:251], a[52:55], a[156:159], v[248:251]
v_mfma_f32_16x16x32_bf16 v[252:255], a[56:59], a[152:155], v[252:255]
v_mfma_f32_16x16x32_bf16 v[252:255], a[60:63], a[156:159], v[252:255]
s_waitcnt lgkmcnt(0)
v_mfma_f32_16x16x32_bf16 v[96:99], a[128:131], a[0:3], v[96:99]
ds_read_b64_tr_b16 a[144:145], v14 offset:0
v_mfma_f32_16x16x32_bf16 v[96:99], a[132:135], a[4:7], v[96:99]
ds_read_b64_tr_b16 a[146:147], v14 offset:1024
v_mfma_f32_16x16x32_bf16 v[100:103], a[128:131], a[8:11], v[100:103]
ds_read_b64_tr_b16 a[148:149], v14 offset:8192
v_mfma_f32_16x16x32_bf16 v[100:103], a[132:135], a[12:15], v[100:103]
ds_read_b64_tr_b16 a[150:151], v14 offset:9216
v_mfma_f32_16x16x32_bf16 v[104:107], a[128:131], a[16:19], v[104:107]
ds_read_b64_tr_b16 a[152:153], v15 offset:0
v_mfma_f32_16x16x32_bf16 v[104:107], a[132:135], a[20:23], v[104:107]
ds_read_b64_tr_b16 a[154:155], v15 offset:1024
v_mfma_f32_16x16x32_bf16 v[108:111], a[128:131], a[24:27], v[108:111]
ds_read_b64_tr_b16 a[156:157], v15 offset:8192
v_mfma_f32_16x16x32_bf16 v[108:111], a[132:135], a[28:31], v[108:111]
ds_read_b64_tr_b16 a[158:159], v15 offset:9216
v_mfma_f32_16x16x32_bf16 v[32:35], a[128:131], a[32:35], v[32:35]
v_mfma_f32_16x16x32_bf16 v[32:35], a[132:135], a[36:39], v[32:35]
v_mfma_f32_16x16x32_bf16 v[36:39], a[128:131], a[40:43], v[36:39]
v_mfma_f32_16x16x32_bf16 v[36:39], a[132:135], a[44:47], v[36:39]
v_mfma_f32_16x16x32_bf16 v[40:43], a[128:131], a[48:51], v[40:43]
v_xor_b32 v10, 0x10000, v10
v_xor_b32 v11, 0x10000, v11
v_mfma_f32_16x16x32_bf16 v[40:43], a[132:135], a[52:55], v[40:43]
v_xor_b32 v12, 0x10000, v12
v_xor_b32 v13, 0x10000, v13
v_mfma_f32_16x16x32_bf16 v[44:47], a[128:131], a[56:59], v[44:47]
v_xor_b32 v14, 0x10000, v14
v_xor_b32 v15, 0x10000, v15
v_mfma_f32_16x16x32_bf16 v[44:47], a[132:135], a[60:63], v[44:47]
s_waitcnt lgkmcnt(0)
v_mfma_f32_16x16x32_bf16 v[112:115], a[136:139], a[0:3], v[112:115]
s_waitcnt vmcnt(2)
s_barrier
v_mfma_f32_16x16x32_bf16 v[112:115], a[140:143], a[4:7], v[112:115]
s_mov_b32 m0, s30
ds_read_b128 a[64:67], v10 offset:0
v_mfma_f32_16x16x32_bf16 v[116:119], a[136:139], a[8:11], v[116:119]
buffer_load_dwordx4 v2, s[8:11], s28 offen offset:0 lds
v_mfma_f32_16x16x32_bf16 v[116:119], a[140:143], a[12:15], v[116:119]
ds_read_b128 a[68:71], v11 offset:0
v_mfma_f32_16x16x32_bf16 v[120:123], a[136:139], a[16:19], v[120:123]
v_mfma_f32_16x16x32_bf16 v[120:123], a[140:143], a[20:23], v[120:123]
ds_read_b128 a[72:75], v10 offset:2048
v_mfma_f32_16x16x32_bf16 v[124:127], a[136:139], a[24:27], v[124:127]
v_mfma_f32_16x16x32_bf16 v[124:127], a[140:143], a[28:31], v[124:127]
ds_read_b128 a[76:79], v11 offset:2048
v_mfma_f32_16x16x32_bf16 v[48:51], a[136:139], a[32:35], v[48:51]
buffer_load_dwordx4 v3, s[8:11], s28 offen offset:1024 lds
v_mfma_f32_16x16x32_bf16 v[48:51], a[140:143], a[36:39], v[48:51]
ds_read_b128 a[80:83], v10 offset:4096
v_mfma_f32_16x16x32_bf16 v[52:55], a[136:139], a[40:43], v[52:55]
v_mfma_f32_16x16x32_bf16 v[52:55], a[140:143], a[44:47], v[52:55]
ds_read_b128 a[84:87], v11 offset:4096
v_mfma_f32_16x16x32_bf16 v[56:59], a[136:139], a[48:51], v[56:59]
v_mfma_f32_16x16x32_bf16 v[56:59], a[140:143], a[52:55], v[56:59]
ds_read_b128 a[88:91], v10 offset:6144
v_mfma_f32_16x16x32_bf16 v[60:63], a[136:139], a[56:59], v[60:63]
buffer_load_dwordx4 v4, s[8:11], s28 offen offset:2048 lds
v_mfma_f32_16x16x32_bf16 v[60:63], a[140:143], a[60:63], v[60:63]
ds_read_b128 a[92:95], v11 offset:6144
v_mfma_f32_16x16x32_bf16 v[128:131], a[144:147], a[0:3], v[128:131]
v_mfma_f32_16x16x32_bf16 v[128:131], a[148:151], a[4:7], v[128:131]
ds_read_b128 a[96:99], v10 offset:8192
v_mfma_f32_16x16x32_bf16 v[132:135], a[144:147], a[8:11], v[132:135]
v_mfma_f32_16x16x32_bf16 v[132:135], a[148:151], a[12:15], v[132:135]
ds_read_b128 a[100:103], v11 offset:8192
v_mfma_f32_16x16x32_bf16 v[136:139], a[144:147], a[16:19], v[136:139]
buffer_load_dwordx4 v5, s[8:11], s28 offen offset:3072 lds
v_mfma_f32_16x16x32_bf16 v[136:139], a[148:151], a[20:23], v[136:139]
s_add_u32 m0, m0, 4096
ds_read_b128 a[104:107], v10 offset:10240
v_mfma_f32_16x16x32_bf16 v[140:143], a[144:147], a[24:27], v[140:143]
s_add_u32 s32, s28, 524288
v_mfma_f32_16x16x32_bf16 v[140:143], a[148:151], a[28:31], v[140:143]
ds_read_b128 a[108:111], v11 offset:10240
v_mfma_f32_16x16x32_bf16 v[64:67], a[144:147], a[32:35], v[64:67]
v_mfma_f32_16x16x32_bf16 v[64:67], a[148:151], a[36:39], v[64:67]
ds_read_b128 a[112:115], v10 offset:12288
v_mfma_f32_16x16x32_bf16 v[68:71], a[144:147], a[40:43], v[68:71]
buffer_load_dwordx4 v2, s[8:11], s32 offen offset:0 lds
v_mfma_f32_16x16x32_bf16 v[68:71], a[148:151], a[44:47], v[68:71]
ds_read_b128 a[116:119], v11 offset:12288
v_mfma_f32_16x16x32_bf16 v[72:75], a[144:147], a[48:51], v[72:75]
v_mfma_f32_16x16x32_bf16 v[72:75], a[148:151], a[52:55], v[72:75]
ds_read_b128 a[120:123], v10 offset:14336
v_mfma_f32_16x16x32_bf16 v[76:79], a[144:147], a[56:59], v[76:79]
v_mfma_f32_16x16x32_bf16 v[76:79], a[148:151], a[60:63], v[76:79]
ds_read_b128 a[124:127], v11 offset:14336
v_mfma_f32_16x16x32_bf16 v[144:147], a[152:155], a[0:3], v[144:147]
buffer_load_dwordx4 v3, s[8:11], s32 offen offset:1024 lds
v_mfma_f32_16x16x32_bf16 v[144:147], a[156:159], a[4:7], v[144:147]
ds_read_b64_tr_b16 a[128:129], v12 offset:16384
v_mfma_f32_16x16x32_bf16 v[148:151], a[152:155], a[8:11], v[148:151]
ds_read_b64_tr_b16 a[130:131], v12 offset:17408
v_mfma_f32_16x16x32_bf16 v[148:151], a[156:159], a[12:15], v[148:151]
ds_read_b64_tr_b16 a[132:133], v12 offset:24576
v_mfma_f32_16x16x32_bf16 v[152:155], a[152:155], a[16:19], v[152:155]
ds_read_b64_tr_b16 a[134:135], v12 offset:25600
v_mfma_f32_16x16x32_bf16 v[152:155], a[156:159], a[20:23], v[152:155]
ds_read_b64_tr_b16 a[136:137], v13 offset:16384
v_mfma_f32_16x16x32_bf16 v[156:159], a[152:155], a[24:27], v[156:159]
ds_read_b64_tr_b16 a[138:139], v13 offset:17408
v_mfma_f32_16x16x32_bf16 v[156:159], a[156:159], a[28:31], v[156:159]
ds_read_b64_tr_b16 a[140:141], v13 offset:24576
v_mfma_f32_16x16x32_bf16 v[80:83], a[152:155], a[32:35], v[80:83]
ds_read_b64_tr_b16 a[142:143], v13 offset:25600
v_mfma_f32_16x16x32_bf16 v[80:83], a[156:159], a[36:39], v[80:83]
buffer_load_dwordx4 v4, s[8:11], s32 offen offset:2048 lds
v_mfma_f32_16x16x32_bf16 v[84:87], a[152:155], a[40:43], v[84:87]
v_mfma_f32_16x16x32_bf16 v[84:87], a[156:159], a[44:47], v[84:87]
v_mfma_f32_16x16x32_bf16 v[88:91], a[152:155], a[48:51], v[88:91]
v_mfma_f32_16x16x32_bf16 v[88:91], a[156:159], a[52:55], v[88:91]
v_mfma_f32_16x16x32_bf16 v[92:95], a[152:155], a[56:59], v[92:95]
buffer_load_dwordx4 v5, s[8:11], s32 offen offset:3072 lds
v_mfma_f32_16x16x32_bf16 v[92:95], a[156:159], a[60:63], v[92:95]
s_waitcnt lgkmcnt(0)
v_mfma_f32_16x16x32_bf16 a[160:163], a[64:67], a[128:131], a[160:163]
s_add_u32 m0, s30, 32768
ds_read_b64_tr_b16 a[144:145], v14 offset:16384
v_mfma_f32_16x16x32_bf16 a[160:163], a[68:71], a[132:135], a[160:163]
ds_read_b64_tr_b16 a[146:147], v14 offset:17408
v_mfma_f32_16x16x32_bf16 a[164:167], a[72:75], a[128:131], a[164:167]
ds_read_b64_tr_b16 a[148:149], v14 offset:24576
v_mfma_f32_16x16x32_bf16 a[164:167], a[76:79], a[132:135], a[164:167]
ds_read_b64_tr_b16 a[150:151], v14 offset:25600
v_mfma_f32_16x16x32_bf16 a[168:171], a[80:83], a[128:131], a[168:171]
buffer_load_dwordx4 v6, s[12:15], s29 offen offset:0 lds
v_mfma_f32_16x16x32_bf16 a[168:171], a[84:87], a[132:135], a[168:171]
v_mfma_f32_16x16x32_bf16 a[172:175], a[88:91], a[128:131], a[172:175]
v_mfma_f32_16x16x32_bf16 a[172:175], a[92:95], a[132:135], a[172:175]
v_mfma_f32_16x16x32_bf16 a[176:179], a[96:99], a[128:131], a[176:179]
v_mfma_f32_16x16x32_bf16 a[176:179], a[100:103], a[132:135], a[176:179]
buffer_load_dwordx4 v7, s[12:15], s29 offen offset:1024 lds
v_mfma_f32_16x16x32_bf16 a[180:183], a[104:107], a[128:131], a[180:183]
v_mfma_f32_16x16x32_bf16 a[180:183], a[108:111], a[132:135], a[180:183]
v_mfma_f32_16x16x32_bf16 a[184:187], a[112:115], a[128:131], a[184:187]
v_mfma_f32_16x16x32_bf16 a[184:187], a[116:119], a[132:135], a[184:187]
v_mfma_f32_16x16x32_bf16 a[188:191], a[120:123], a[128:131], a[188:191]
buffer_load_dwordx4 v8, s[12:15], s29 offen offset:2048 lds
v_mfma_f32_16x16x32_bf16 a[188:191], a[124:127], a[132:135], a[188:191]
s_waitcnt lgkmcnt(0)
v_mfma_f32_16x16x32_bf16 v[160:163], a[64:67], a[136:139], v[160:163]
ds_read_b64_tr_b16 a[152:153], v15 offset:16384
v_mfma_f32_16x16x32_bf16 v[160:163], a[68:71], a[140:143], v[160:163]
ds_read_b64_tr_b16 a[154:155], v15 offset:17408
v_mfma_f32_16x16x32_bf16 v[164:167], a[72:75], a[136:139], v[164:167]
ds_read_b64_tr_b16 a[156:157], v15 offset:24576
v_mfma_f32_16x16x32_bf16 v[164:167], a[76:79], a[140:143], v[164:167]
ds_read_b64_tr_b16 a[158:159], v15 offset:25600
v_mfma_f32_16x16x32_bf16 v[192:195], a[80:83], a[136:139], v[192:195]
buffer_load_dwordx4 v9, s[12:15], s29 offen offset:3072 lds
v_mfma_f32_16x16x32_bf16 v[192:195], a[84:87], a[140:143], v[192:195]
s_add_u32 m0, m0, 4096
s_add_u32 s32, s29, 131072
v_mfma_f32_16x16x32_bf16 v[196:199], a[88:91], a[136:139], v[196:199]
v_mfma_f32_16x16x32_bf16 v[196:199], a[92:95], a[140:143], v[196:199]
v_mfma_f32_16x16x32_bf16 v[224:227], a[96:99], a[136:139], v[224:227]
v_mfma_f32_16x16x32_bf16 v[224:227], a[100:103], a[140:143], v[224:227]
buffer_load_dwordx4 v6, s[12:15], s32 offen offset:0 lds
v_mfma_f32_16x16x32_bf16 v[228:231], a[104:107], a[136:139], v[228:231]
v_mfma_f32_16x16x32_bf16 v[228:231], a[108:111], a[140:143], v[228:231]
v_mfma_f32_16x16x32_bf16 v[184:187], a[112:115], a[136:139], v[184:187]
v_mfma_f32_16x16x32_bf16 v[184:187], a[116:119], a[140:143], v[184:187]
v_mfma_f32_16x16x32_bf16 v[188:191], a[120:123], a[136:139], v[188:191]
buffer_load_dwordx4 v7, s[12:15], s32 offen offset:1024 lds
v_mfma_f32_16x16x32_bf16 v[188:191], a[124:127], a[140:143], v[188:191]
s_waitcnt lgkmcnt(0)
v_mfma_f32_16x16x32_bf16 v[168:171], a[64:67], a[144:147], v[168:171]
ds_read_b64_tr_b16 a[128:129], v12 offset:0
v_mfma_f32_16x16x32_bf16 v[168:171], a[68:71], a[148:151], v[168:171]
ds_read_b64_tr_b16 a[130:131], v12 offset:1024
v_mfma_f32_16x16x32_bf16 v[172:175], a[72:75], a[144:147], v[172:175]
ds_read_b64_tr_b16 a[132:133], v12 offset:8192
v_mfma_f32_16x16x32_bf16 v[172:175], a[76:79], a[148:151], v[172:175]
ds_read_b64_tr_b16 a[134:135], v12 offset:9216
v_mfma_f32_16x16x32_bf16 v[200:203], a[80:83], a[144:147], v[200:203]
buffer_load_dwordx4 v8, s[12:15], s32 offen offset:2048 lds
v_mfma_f32_16x16x32_bf16 v[200:203], a[84:87], a[148:151], v[200:203]
v_mfma_f32_16x16x32_bf16 v[204:207], a[88:91], a[144:147], v[204:207]
v_mfma_f32_16x16x32_bf16 v[204:207], a[92:95], a[148:151], v[204:207]
v_mfma_f32_16x16x32_bf16 v[232:235], a[96:99], a[144:147], v[232:235]
v_mfma_f32_16x16x32_bf16 v[232:235], a[100:103], a[148:151], v[232:235]
buffer_load_dwordx4 v9, s[12:15], s32 offen offset:3072 lds
v_mfma_f32_16x16x32_bf16 v[236:239], a[104:107], a[144:147], v[236:239]
s_add_u32 s28, s28, 128
s_add_u32 s29, s29, 524288
s_xor_b32 s30, s30, 0x10000
v_mfma_f32_16x16x32_bf16 v[236:239], a[108:111], a[148:151], v[236:239]
s_mov_b32 s33, 2097152
v_mfma_f32_16x16x32_bf16 v[216:219], a[112:115], a[144:147], v[216:219]
buffer_load_dword v28, v30, s[68:71], s33 offen
v_mfma_f32_16x16x32_bf16 v[216:219], a[116:119], a[148:151], v[216:219]
s_add_u32 m0, s31, 4096
v_accvgpr_read_b32 v17, a254
v_mfma_f32_16x16x32_bf16 v[220:223], a[120:123], a[144:147], v[220:223]
buffer_load_dwordx4 v17, s[84:87], s53 offen lds
v_mfma_f32_16x16x32_bf16 v[220:223], a[124:127], a[148:151], v[220:223]
s_waitcnt lgkmcnt(0)
v_mfma_f32_16x16x32_bf16 v[176:179], a[64:67], a[152:155], v[176:179]
ds_read_b64_tr_b16 a[136:137], v13 offset:0
v_mfma_f32_16x16x32_bf16 v[176:179], a[68:71], a[156:159], v[176:179]
ds_read_b64_tr_b16 a[138:139], v13 offset:1024
v_mfma_f32_16x16x32_bf16 v[180:183], a[72:75], a[152:155], v[180:183]
ds_read_b64_tr_b16 a[140:141], v13 offset:8192
v_mfma_f32_16x16x32_bf16 v[180:183], a[76:79], a[156:159], v[180:183]
ds_read_b64_tr_b16 a[142:143], v13 offset:9216
v_mfma_f32_16x16x32_bf16 v[208:211], a[80:83], a[152:155], v[208:211]
v_mfma_f32_16x16x32_bf16 v[208:211], a[84:87], a[156:159], v[208:211]
v_mfma_f32_16x16x32_bf16 v[212:215], a[88:91], a[152:155], v[212:215]
v_mfma_f32_16x16x32_bf16 v[212:215], a[92:95], a[156:159], v[212:215]
v_mfma_f32_16x16x32_bf16 v[240:243], a[96:99], a[152:155], v[240:243]
v_mfma_f32_16x16x32_bf16 v[240:243], a[100:103], a[156:159], v[240:243]
v_mfma_f32_16x16x32_bf16 v[244:247], a[104:107], a[152:155], v[244:247]
v_mfma_f32_16x16x32_bf16 v[244:247], a[108:111], a[156:159], v[244:247]
v_mfma_f32_16x16x32_bf16 v[248:251], a[112:115], a[152:155], v[248:251]
v_mfma_f32_16x16x32_bf16 v[248:251], a[116:119], a[156:159], v[248:251]
v_mfma_f32_16x16x32_bf16 v[252:255], a[120:123], a[152:155], v[252:255]
v_mfma_f32_16x16x32_bf16 v[252:255], a[124:127], a[156:159], v[252:255]
s_waitcnt lgkmcnt(0)
v_mfma_f32_16x16x32_bf16 v[96:99], a[128:131], a[64:67], v[96:99]
ds_read_b64_tr_b16 a[144:145], v14 offset:0
v_mfma_f32_16x16x32_bf16 v[96:99], a[132:135], a[68:71], v[96:99]
ds_read_b64_tr_b16 a[146:147], v14 offset:1024
v_mfma_f32_16x16x32_bf16 v[100:103], a[128:131], a[72:75], v[100:103]
ds_read_b64_tr_b16 a[148:149], v14 offset:8192
v_mfma_f32_16x16x32_bf16 v[100:103], a[132:135], a[76:79], v[100:103]
ds_read_b64_tr_b16 a[150:151], v14 offset:9216
v_mfma_f32_16x16x32_bf16 v[104:107], a[128:131], a[80:83], v[104:107]
ds_read_b64_tr_b16 a[152:153], v15 offset:0
v_mfma_f32_16x16x32_bf16 v[104:107], a[132:135], a[84:87], v[104:107]
ds_read_b64_tr_b16 a[154:155], v15 offset:1024
v_mfma_f32_16x16x32_bf16 v[108:111], a[128:131], a[88:91], v[108:111]
ds_read_b64_tr_b16 a[156:157], v15 offset:8192
v_mfma_f32_16x16x32_bf16 v[108:111], a[132:135], a[92:95], v[108:111]
ds_read_b64_tr_b16 a[158:159], v15 offset:9216
v_mfma_f32_16x16x32_bf16 v[32:35], a[128:131], a[96:99], v[32:35]
v_mfma_f32_16x16x32_bf16 v[32:35], a[132:135], a[100:103], v[32:35]
v_mfma_f32_16x16x32_bf16 v[36:39], a[128:131], a[104:107], v[36:39]
v_mfma_f32_16x16x32_bf16 v[36:39], a[132:135], a[108:111], v[36:39]
v_mfma_f32_16x16x32_bf16 v[40:43], a[128:131], a[112:115], v[40:43]
v_xor_b32 v10, 0x10000, v10
v_xor_b32 v11, 0x10000, v11
v_mfma_f32_16x16x32_bf16 v[40:43], a[132:135], a[116:119], v[40:43]
v_xor_b32 v12, 0x10000, v12
v_xor_b32 v13, 0x10000, v13
v_mfma_f32_16x16x32_bf16 v[44:47], a[128:131], a[120:123], v[44:47]
v_xor_b32 v14, 0x10000, v14
v_xor_b32 v15, 0x10000, v15
v_mfma_f32_16x16x32_bf16 v[44:47], a[132:135], a[124:127], v[44:47]
s_waitcnt lgkmcnt(0)
v_mfma_f32_16x16x32_bf16 v[112:115], a[136:139], a[64:67], v[112:115]
s_waitcnt vmcnt(2)
s_barrier
v_mfma_f32_16x16x32_bf16 v[112:115], a[140:143], a[68:71], v[112:115]
s_mov_b32 m0, s30
ds_read_b128 a[0:3], v10 offset:0
v_mfma_f32_16x16x32_bf16 v[116:119], a[136:139], a[72:75], v[116:119]
buffer_load_dwordx4 v2, s[8:11], s28 offen offset:0 lds
v_mfma_f32_16x16x32_bf16 v[116:119], a[140:143], a[76:79], v[116:119]
ds_read_b128 a[4:7], v11 offset:0
v_mfma_f32_16x16x32_bf16 v[120:123], a[136:139], a[80:83], v[120:123]
v_mfma_f32_16x16x32_bf16 v[120:123], a[140:143], a[84:87], v[120:123]
ds_read_b128 a[8:11], v10 offset:2048
v_mfma_f32_16x16x32_bf16 v[124:127], a[136:139], a[88:91], v[124:127]
v_mfma_f32_16x16x32_bf16 v[124:127], a[140:143], a[92:95], v[124:127]
ds_read_b128 a[12:15], v11 offset:2048
v_mfma_f32_16x16x32_bf16 v[48:51], a[136:139], a[96:99], v[48:51]
buffer_load_dwordx4 v3, s[8:11], s28 offen offset:1024 lds
v_mfma_f32_16x16x32_bf16 v[48:51], a[140:143], a[100:103], v[48:51]
ds_read_b128 a[16:19], v10 offset:4096
v_mfma_f32_16x16x32_bf16 v[52:55], a[136:139], a[104:107], v[52:55]
v_mfma_f32_16x16x32_bf16 v[52:55], a[140:143], a[108:111], v[52:55]
ds_read_b128 a[20:23], v11 offset:4096
v_mfma_f32_16x16x32_bf16 v[56:59], a[136:139], a[112:115], v[56:59]
v_mfma_f32_16x16x32_bf16 v[56:59], a[140:143], a[116:119], v[56:59]
ds_read_b128 a[24:27], v10 offset:6144
v_mfma_f32_16x16x32_bf16 v[60:63], a[136:139], a[120:123], v[60:63]
buffer_load_dwordx4 v4, s[8:11], s28 offen offset:2048 lds
v_mfma_f32_16x16x32_bf16 v[60:63], a[140:143], a[124:127], v[60:63]
ds_read_b128 a[28:31], v11 offset:6144
v_mfma_f32_16x16x32_bf16 v[128:131], a[144:147], a[64:67], v[128:131]
v_mfma_f32_16x16x32_bf16 v[128:131], a[148:151], a[68:71], v[128:131]
ds_read_b128 a[32:35], v10 offset:8192
v_mfma_f32_16x16x32_bf16 v[132:135], a[144:147], a[72:75], v[132:135]
v_mfma_f32_16x16x32_bf16 v[132:135], a[148:151], a[76:79], v[132:135]
ds_read_b128 a[36:39], v11 offset:8192
v_mfma_f32_16x16x32_bf16 v[136:139], a[144:147], a[80:83], v[136:139]
buffer_load_dwordx4 v5, s[8:11], s28 offen offset:3072 lds
v_mfma_f32_16x16x32_bf16 v[136:139], a[148:151], a[84:87], v[136:139]
s_add_u32 m0, m0, 4096
ds_read_b128 a[40:43], v10 offset:10240
v_mfma_f32_16x16x32_bf16 v[140:143], a[144:147], a[88:91], v[140:143]
s_add_u32 s32, s28, 524288
v_mfma_f32_16x16x32_bf16 v[140:143], a[148:151], a[92:95], v[140:143]
ds_read_b128 a[44:47], v11 offset:10240
v_mfma_f32_16x16x32_bf16 v[64:67], a[144:147], a[96:99], v[64:67]
v_mfma_f32_16x16x32_bf16 v[64:67], a[148:151], a[100:103], v[64:67]
ds_read_b128 a[48:51], v10 offset:12288
v_mfma_f32_16x16x32_bf16 v[68:71], a[144:147], a[104:107], v[68:71]
buffer_load_dwordx4 v2, s[8:11], s32 offen offset:0 lds
v_mfma_f32_16x16x32_bf16 v[68:71], a[148:151], a[108:111], v[68:71]
ds_read_b128 a[52:55], v11 offset:12288
v_mfma_f32_16x16x32_bf16 v[72:75], a[144:147], a[112:115], v[72:75]
v_mfma_f32_16x16x32_bf16 v[72:75], a[148:151], a[116:119], v[72:75]
ds_read_b128 a[56:59], v10 offset:14336
v_mfma_f32_16x16x32_bf16 v[76:79], a[144:147], a[120:123], v[76:79]
v_mfma_f32_16x16x32_bf16 v[76:79], a[148:151], a[124:127], v[76:79]
ds_read_b128 a[60:63], v11 offset:14336
v_mfma_f32_16x16x32_bf16 v[144:147], a[152:155], a[64:67], v[144:147]
buffer_load_dwordx4 v3, s[8:11], s32 offen offset:1024 lds
v_mfma_f32_16x16x32_bf16 v[144:147], a[156:159], a[68:71], v[144:147]
ds_read_b64_tr_b16 a[128:129], v12 offset:16384
v_mfma_f32_16x16x32_bf16 v[148:151], a[152:155], a[72:75], v[148:151]
ds_read_b64_tr_b16 a[130:131], v12 offset:17408
v_mfma_f32_16x16x32_bf16 v[148:151], a[156:159], a[76:79], v[148:151]
ds_read_b64_tr_b16 a[132:133], v12 offset:24576
v_mfma_f32_16x16x32_bf16 v[152:155], a[152:155], a[80:83], v[152:155]
ds_read_b64_tr_b16 a[134:135], v12 offset:25600
v_mfma_f32_16x16x32_bf16 v[152:155], a[156:159], a[84:87], v[152:155]
ds_read_b64_tr_b16 a[136:137], v13 offset:16384
v_mfma_f32_16x16x32_bf16 v[156:159], a[152:155], a[88:91], v[156:159]
ds_read_b64_tr_b16 a[138:139], v13 offset:17408
v_mfma_f32_16x16x32_bf16 v[156:159], a[156:159], a[92:95], v[156:159]
ds_read_b64_tr_b16 a[140:141], v13 offset:24576
v_mfma_f32_16x16x32_bf16 v[80:83], a[152:155], a[96:99], v[80:83]
ds_read_b64_tr_b16 a[142:143], v13 offset:25600
v_mfma_f32_16x16x32_bf16 v[80:83], a[156:159], a[100:103], v[80:83]
buffer_load_dwordx4 v4, s[8:11], s32 offen offset:2048 lds
v_mfma_f32_16x16x32_bf16 v[84:87], a[152:155], a[104:107], v[84:87]
v_mfma_f32_16x16x32_bf16 v[84:87], a[156:159], a[108:111], v[84:87]
v_mfma_f32_16x16x32_bf16 v[88:91], a[152:155], a[112:115], v[88:91]
v_mfma_f32_16x16x32_bf16 v[88:91], a[156:159], a[116:119], v[88:91]
v_mfma_f32_16x16x32_bf16 v[92:95], a[152:155], a[120:123], v[92:95]
buffer_load_dwordx4 v5, s[8:11], s32 offen offset:3072 lds
v_mfma_f32_16x16x32_bf16 v[92:95], a[156:159], a[124:127], v[92:95]
s_waitcnt lgkmcnt(0)
v_mfma_f32_16x16x32_bf16 a[160:163], a[0:3], a[128:131], a[160:163]
s_add_u32 m0, s30, 32768
ds_read_b64_tr_b16 a[144:145], v14 offset:16384
v_mfma_f32_16x16x32_bf16 a[160:163], a[4:7], a[132:135], a[160:163]
ds_read_b64_tr_b16 a[146:147], v14 offset:17408
v_mfma_f32_16x16x32_bf16 a[164:167], a[8:11], a[128:131], a[164:167]
ds_read_b64_tr_b16 a[148:149], v14 offset:24576
v_mfma_f32_16x16x32_bf16 a[164:167], a[12:15], a[132:135], a[164:167]
ds_read_b64_tr_b16 a[150:151], v14 offset:25600
v_mfma_f32_16x16x32_bf16 a[168:171], a[16:19], a[128:131], a[168:171]
buffer_load_dwordx4 v6, s[12:15], s29 offen offset:0 lds
v_mfma_f32_16x16x32_bf16 a[168:171], a[20:23], a[132:135], a[168:171]
v_mfma_f32_16x16x32_bf16 a[172:175], a[24:27], a[128:131], a[172:175]
v_mfma_f32_16x16x32_bf16 a[172:175], a[28:31], a[132:135], a[172:175]
v_mfma_f32_16x16x32_bf16 a[176:179], a[32:35], a[128:131], a[176:179]
v_mfma_f32_16x16x32_bf16 a[176:179], a[36:39], a[132:135], a[176:179]
buffer_load_dwordx4 v7, s[12:15], s29 offen offset:1024 lds
v_mfma_f32_16x16x32_bf16 a[180:183], a[40:43], a[128:131], a[180:183]
v_mfma_f32_16x16x32_bf16 a[180:183], a[44:47], a[132:135], a[180:183]
v_mfma_f32_16x16x32_bf16 a[184:187], a[48:51], a[128:131], a[184:187]
v_mfma_f32_16x16x32_bf16 a[184:187], a[52:55], a[132:135], a[184:187]
v_mfma_f32_16x16x32_bf16 a[188:191], a[56:59], a[128:131], a[188:191]
buffer_load_dwordx4 v8, s[12:15], s29 offen offset:2048 lds
v_mfma_f32_16x16x32_bf16 a[188:191], a[60:63], a[132:135], a[188:191]
s_waitcnt lgkmcnt(0)
v_mfma_f32_16x16x32_bf16 v[160:163], a[0:3], a[136:139], v[160:163]
ds_read_b64_tr_b16 a[152:153], v15 offset:16384
v_mfma_f32_16x16x32_bf16 v[160:163], a[4:7], a[140:143], v[160:163]
ds_read_b64_tr_b16 a[154:155], v15 offset:17408
v_mfma_f32_16x16x32_bf16 v[164:167], a[8:11], a[136:139], v[164:167]
ds_read_b64_tr_b16 a[156:157], v15 offset:24576
v_mfma_f32_16x16x32_bf16 v[164:167], a[12:15], a[140:143], v[164:167]
ds_read_b64_tr_b16 a[158:159], v15 offset:25600
v_mfma_f32_16x16x32_bf16 v[192:195], a[16:19], a[136:139], v[192:195]
buffer_load_dwordx4 v9, s[12:15], s29 offen offset:3072 lds
v_mfma_f32_16x16x32_bf16 v[192:195], a[20:23], a[140:143], v[192:195]
s_add_u32 m0, m0, 4096
s_add_u32 s32, s29, 131072
v_mfma_f32_16x16x32_bf16 v[196:199], a[24:27], a[136:139], v[196:199]
v_mfma_f32_16x16x32_bf16 v[196:199], a[28:31], a[140:143], v[196:199]
v_mfma_f32_16x16x32_bf16 v[224:227], a[32:35], a[136:139], v[224:227]
v_mfma_f32_16x16x32_bf16 v[224:227], a[36:39], a[140:143], v[224:227]
buffer_load_dwordx4 v6, s[12:15], s32 offen offset:0 lds
v_mfma_f32_16x16x32_bf16 v[228:231], a[40:43], a[136:139], v[228:231]
v_mfma_f32_16x16x32_bf16 v[228:231], a[44:47], a[140:143], v[228:231]
v_mfma_f32_16x16x32_bf16 v[184:187], a[48:51], a[136:139], v[184:187]
v_mfma_f32_16x16x32_bf16 v[184:187], a[52:55], a[140:143], v[184:187]
v_mfma_f32_16x16x32_bf16 v[188:191], a[56:59], a[136:139], v[188:191]
buffer_load_dwordx4 v7, s[12:15], s32 offen offset:1024 lds
v_mfma_f32_16x16x32_bf16 v[188:191], a[60:63], a[140:143], v[188:191]
s_waitcnt lgkmcnt(0)
v_mfma_f32_16x16x32_bf16 v[168:171], a[0:3], a[144:147], v[168:171]
ds_read_b64_tr_b16 a[128:129], v12 offset:0
v_mfma_f32_16x16x32_bf16 v[168:171], a[4:7], a[148:151], v[168:171]
ds_read_b64_tr_b16 a[130:131], v12 offset:1024
v_mfma_f32_16x16x32_bf16 v[172:175], a[8:11], a[144:147], v[172:175]
ds_read_b64_tr_b16 a[132:133], v12 offset:8192
v_mfma_f32_16x16x32_bf16 v[172:175], a[12:15], a[148:151], v[172:175]
ds_read_b64_tr_b16 a[134:135], v12 offset:9216
v_mfma_f32_16x16x32_bf16 v[200:203], a[16:19], a[144:147], v[200:203]
buffer_load_dwordx4 v8, s[12:15], s32 offen offset:2048 lds
v_mfma_f32_16x16x32_bf16 v[200:203], a[20:23], a[148:151], v[200:203]
v_mfma_f32_16x16x32_bf16 v[204:207], a[24:27], a[144:147], v[204:207]
v_mfma_f32_16x16x32_bf16 v[204:207], a[28:31], a[148:151], v[204:207]
v_mfma_f32_16x16x32_bf16 v[232:235], a[32:35], a[144:147], v[232:235]
v_mfma_f32_16x16x32_bf16 v[232:235], a[36:39], a[148:151], v[232:235]
buffer_load_dwordx4 v9, s[12:15], s32 offen offset:3072 lds
v_mfma_f32_16x16x32_bf16 v[236:239], a[40:43], a[144:147], v[236:239]
s_add_u32 s28, s28, 128
s_add_u32 s29, s29, 524288
s_xor_b32 s30, s30, 0x10000
v_mfma_f32_16x16x32_bf16 v[236:239], a[44:47], a[148:151], v[236:239]
s_mov_b32 s33, 4194304
v_mfma_f32_16x16x32_bf16 v[216:219], a[48:51], a[144:147], v[216:219]
buffer_load_dword v28, v30, s[68:71], s33 offen
v_mfma_f32_16x16x32_bf16 v[216:219], a[52:55], a[148:151], v[216:219]
s_mov_b32 s33, 2097152
v_mfma_f32_16x16x32_bf16 v[220:223], a[56:59], a[144:147], v[220:223]
buffer_load_dword v28, v30, s[72:75], s33 offen
v_mfma_f32_16x16x32_bf16 v[220:223], a[60:63], a[148:151], v[220:223]
s_waitcnt lgkmcnt(0)
v_lshrrev_b32 v19, 0, v0
v_mul_u32_u24 v19, 128, v19
v_mfma_f32_16x16x32_bf16 v[176:179], a[0:3], a[152:155], v[176:179]
ds_read_b64_tr_b16 a[136:137], v13 offset:0
v_mfma_f32_16x16x32_bf16 v[176:179], a[4:7], a[156:159], v[176:179]
ds_read_b64_tr_b16 a[138:139], v13 offset:1024
v_mfma_f32_16x16x32_bf16 v[180:183], a[8:11], a[152:155], v[180:183]
ds_read_b64_tr_b16 a[140:141], v13 offset:8192
v_lshrrev_b32 v17, 3, v1
v_mfma_f32_16x16x32_bf16 v[180:183], a[12:15], a[156:159], v[180:183]
ds_read_b64_tr_b16 a[142:143], v13 offset:9216
v_lshlrev_b32 v17, 8, v17
v_mfma_f32_16x16x32_bf16 v[208:211], a[16:19], a[152:155], v[208:211]
buffer_load_dword v28, v19, s[76:79], 0 offen
v_mfma_f32_16x16x32_bf16 v[208:211], a[20:23], a[156:159], v[208:211]
v_add_u32 v2, v2, v17
v_add_u32 v17, 2048, v17
v_mfma_f32_16x16x32_bf16 v[212:215], a[24:27], a[152:155], v[212:215]
v_add_u32 v3, v3, v17
v_add_u32 v17, 2048, v17
v_mfma_f32_16x16x32_bf16 v[212:215], a[28:31], a[156:159], v[212:215]
v_add_u32 v4, v4, v17
v_add_u32 v17, 2048, v17
v_mfma_f32_16x16x32_bf16 v[240:243], a[32:35], a[152:155], v[240:243]
v_add_u32 v5, v5, v17
v_mfma_f32_16x16x32_bf16 v[240:243], a[36:39], a[156:159], v[240:243]
v_mfma_f32_16x16x32_bf16 v[244:247], a[40:43], a[152:155], v[244:247]
v_mfma_f32_16x16x32_bf16 v[244:247], a[44:47], a[156:159], v[244:247]
v_mfma_f32_16x16x32_bf16 v[248:251], a[48:51], a[152:155], v[248:251]
v_mfma_f32_16x16x32_bf16 v[248:251], a[52:55], a[156:159], v[248:251]
v_mfma_f32_16x16x32_bf16 v[252:255], a[56:59], a[152:155], v[252:255]
v_accvgpr_read_b32 v18, a220
v_accvgpr_read_b32 v19, a221
v_mfma_f32_16x16x32_bf16 v[252:255], a[60:63], a[156:159], v[252:255]
s_waitcnt lgkmcnt(0)
v_mfma_f32_16x16x32_bf16 v[96:99], a[128:131], a[0:3], v[96:99]
ds_read_b64_tr_b16 a[144:145], v14 offset:0
v_mfma_f32_16x16x32_bf16 v[96:99], a[132:135], a[4:7], v[96:99]
ds_read_b64_tr_b16 a[146:147], v14 offset:1024
v_mfma_f32_16x16x32_bf16 v[100:103], a[128:131], a[8:11], v[100:103]
ds_read_b64_tr_b16 a[148:149], v14 offset:8192
v_mfma_f32_16x16x32_bf16 v[100:103], a[132:135], a[12:15], v[100:103]
ds_read_b64_tr_b16 a[150:151], v14 offset:9216
v_mfma_f32_16x16x32_bf16 v[104:107], a[128:131], a[16:19], v[104:107]
ds_read_b64_tr_b16 a[152:153], v15 offset:0
v_mfma_f32_16x16x32_bf16 v[104:107], a[132:135], a[20:23], v[104:107]
ds_read_b64_tr_b16 a[154:155], v15 offset:1024
v_mfma_f32_16x16x32_bf16 v[108:111], a[128:131], a[24:27], v[108:111]
ds_read_b64_tr_b16 a[156:157], v15 offset:8192
v_mfma_f32_16x16x32_bf16 v[108:111], a[132:135], a[28:31], v[108:111]
ds_read_b64_tr_b16 a[158:159], v15 offset:9216
v_mfma_f32_16x16x32_bf16 v[32:35], a[128:131], a[32:35], v[32:35]
global_load_dword v28, v[18:19], off
v_mfma_f32_16x16x32_bf16 v[32:35], a[132:135], a[36:39], v[32:35]
v_mfma_f32_16x16x32_bf16 v[36:39], a[128:131], a[40:43], v[36:39]
v_mfma_f32_16x16x32_bf16 v[36:39], a[132:135], a[44:47], v[36:39]
v_mfma_f32_16x16x32_bf16 v[40:43], a[128:131], a[48:51], v[40:43]
v_xor_b32 v10, 0x10000, v10
v_xor_b32 v11, 0x10000, v11
v_mfma_f32_16x16x32_bf16 v[40:43], a[132:135], a[52:55], v[40:43]
v_xor_b32 v12, 0x10000, v12
v_xor_b32 v13, 0x10000, v13
v_mfma_f32_16x16x32_bf16 v[44:47], a[128:131], a[56:59], v[44:47]
v_xor_b32 v14, 0x10000, v14
v_xor_b32 v15, 0x10000, v15
v_mfma_f32_16x16x32_bf16 v[44:47], a[132:135], a[60:63], v[44:47]
s_waitcnt lgkmcnt(0)
v_mfma_f32_16x16x32_bf16 v[112:115], a[136:139], a[0:3], v[112:115]
s_waitcnt vmcnt(4)
s_barrier
v_mfma_f32_16x16x32_bf16 v[112:115], a[140:143], a[4:7], v[112:115]
ds_read_b128 a[64:67], v10 offset:0
v_mfma_f32_16x16x32_bf16 v[116:119], a[136:139], a[8:11], v[116:119]
s_add_u32 m0, s36, 0
v_mfma_f32_16x16x32_bf16 v[116:119], a[140:143], a[12:15], v[116:119]
ds_read_b128 a[68:71], v11 offset:0
v_mfma_f32_16x16x32_bf16 v[120:123], a[136:139], a[16:19], v[120:123]
buffer_load_dwordx4 v2, s[64:67], s41 offen offset:0 lds
v_mfma_f32_16x16x32_bf16 v[120:123], a[140:143], a[20:23], v[120:123]
ds_read_b128 a[72:75], v10 offset:2048
v_mfma_f32_16x16x32_bf16 v[124:127], a[136:139], a[24:27], v[124:127]
v_mfma_f32_16x16x32_bf16 v[124:127], a[140:143], a[28:31], v[124:127]
ds_read_b128 a[76:79], v11 offset:2048
v_mfma_f32_16x16x32_bf16 v[48:51], a[136:139], a[32:35], v[48:51]
v_mfma_f32_16x16x32_bf16 v[48:51], a[140:143], a[36:39], v[48:51]
ds_read_b128 a[80:83], v10 offset:4096
v_mfma_f32_16x16x32_bf16 v[52:55], a[136:139], a[40:43], v[52:55]
buffer_load_dwordx4 v3, s[64:67], s41 offen offset:1024 lds
v_mfma_f32_16x16x32_bf16 v[52:55], a[140:143], a[44:47], v[52:55]
ds_read_b128 a[84:87], v11 offset:4096
v_mfma_f32_16x16x32_bf16 v[56:59], a[136:139], a[48:51], v[56:59]
v_mfma_f32_16x16x32_bf16 v[56:59], a[140:143], a[52:55], v[56:59]
ds_read_b128 a[88:91], v10 offset:6144
v_mfma_f32_16x16x32_bf16 v[60:63], a[136:139], a[56:59], v[60:63]
v_mfma_f32_16x16x32_bf16 v[60:63], a[140:143], a[60:63], v[60:63]
ds_read_b128 a[92:95], v11 offset:6144
v_mfma_f32_16x16x32_bf16 v[128:131], a[144:147], a[0:3], v[128:131]
buffer_load_dwordx4 v4, s[64:67], s41 offen offset:2048 lds
v_mfma_f32_16x16x32_bf16 v[128:131], a[148:151], a[4:7], v[128:131]
ds_read_b128 a[96:99], v10 offset:8192
v_mfma_f32_16x16x32_bf16 v[132:135], a[144:147], a[8:11], v[132:135]
v_mfma_f32_16x16x32_bf16 v[132:135], a[148:151], a[12:15], v[132:135]
ds_read_b128 a[100:103], v11 offset:8192
v_mfma_f32_16x16x32_bf16 v[136:139], a[144:147], a[16:19], v[136:139]
v_mfma_f32_16x16x32_bf16 v[136:139], a[148:151], a[20:23], v[136:139]
ds_read_b128 a[104:107], v10 offset:10240
v_mfma_f32_16x16x32_bf16 v[140:143], a[144:147], a[24:27], v[140:143]
buffer_load_dwordx4 v5, s[64:67], s41 offen offset:3072 lds
v_mfma_f32_16x16x32_bf16 v[140:143], a[148:151], a[28:31], v[140:143]
s_add_u32 m0, s36, 4096
ds_read_b128 a[108:111], v11 offset:10240
v_mfma_f32_16x16x32_bf16 v[64:67], a[144:147], a[32:35], v[64:67]
v_mfma_f32_16x16x32_bf16 v[64:67], a[148:151], a[36:39], v[64:67]
ds_read_b128 a[112:115], v10 offset:12288
v_mfma_f32_16x16x32_bf16 v[68:71], a[144:147], a[40:43], v[68:71]
v_mfma_f32_16x16x32_bf16 v[68:71], a[148:151], a[44:47], v[68:71]
ds_read_b128 a[116:119], v11 offset:12288
v_mfma_f32_16x16x32_bf16 v[72:75], a[144:147], a[48:51], v[72:75]
buffer_load_dwordx4 v2, s[64:67], s57 offen offset:0 lds
v_mfma_f32_16x16x32_bf16 v[72:75], a[148:151], a[52:55], v[72:75]
ds_read_b128 a[120:123], v10 offset:14336
v_mfma_f32_16x16x32_bf16 v[76:79], a[144:147], a[56:59], v[76:79]
v_mfma_f32_16x16x32_bf16 v[76:79], a[148:151], a[60:63], v[76:79]
ds_read_b128 a[124:127], v11 offset:14336
v_mfma_f32_16x16x32_bf16 v[144:147], a[152:155], a[0:3], v[144:147]
v_mfma_f32_16x16x32_bf16 v[144:147], a[156:159], a[4:7], v[144:147]
ds_read_b64_tr_b16 a[128:129], v12 offset:16384
v_mfma_f32_16x16x32_bf16 v[148:151], a[152:155], a[8:11], v[148:151]
ds_read_b64_tr_b16 a[130:131], v12 offset:17408
v_mfma_f32_16x16x32_bf16 v[148:151], a[156:159], a[12:15], v[148:151]
ds_read_b64_tr_b16 a[132:133], v12 offset:24576
v_mfma_f32_16x16x32_bf16 v[152:155], a[152:155], a[16:19], v[152:155]
ds_read_b64_tr_b16 a[134:135], v12 offset:25600
v_mfma_f32_16x16x32_bf16 v[152:155], a[156:159], a[20:23], v[152:155]
ds_read_b64_tr_b16 a[136:137], v13 offset:16384
v_mfma_f32_16x16x32_bf16 v[156:159], a[152:155], a[24:27], v[156:159]
ds_read_b64_tr_b16 a[138:139], v13 offset:17408
v_mfma_f32_16x16x32_bf16 v[156:159], a[156:159], a[28:31], v[156:159]
ds_read_b64_tr_b16 a[140:141], v13 offset:24576
v_mfma_f32_16x16x32_bf16 v[80:83], a[152:155], a[32:35], v[80:83]
ds_read_b64_tr_b16 a[142:143], v13 offset:25600
v_mfma_f32_16x16x32_bf16 v[80:83], a[156:159], a[36:39], v[80:83]
buffer_load_dwordx4 v3, s[64:67], s57 offen offset:1024 lds
v_mfma_f32_16x16x32_bf16 v[84:87], a[152:155], a[40:43], v[84:87]
v_mfma_f32_16x16x32_bf16 v[84:87], a[156:159], a[44:47], v[84:87]
v_mfma_f32_16x16x32_bf16 v[88:91], a[152:155], a[48:51], v[88:91]
v_mfma_f32_16x16x32_bf16 v[88:91], a[156:159], a[52:55], v[88:91]
v_mfma_f32_16x16x32_bf16 v[92:95], a[152:155], a[56:59], v[92:95]
buffer_load_dwordx4 v4, s[64:67], s57 offen offset:2048 lds
v_mfma_f32_16x16x32_bf16 v[92:95], a[156:159], a[60:63], v[92:95]
s_waitcnt lgkmcnt(0)
buffer_load_dwordx4 v5, s[64:67], s57 offen offset:3072 lds
s_add_u32 m0, s35, 32768
s_cmp_ge_u32 s52, 800
s_cbranch_scc1 RL_f_done
s_cmp_ge_u32 s52, 640
s_cbranch_scc1 RL_f_bwo
v_lshrrev_b32 v18, 1, v26
v_mul_u32_u24 v18, 40, v18
v_add_u32 v17, v24, v18
s_cmp_ge_u32 s52, 320
s_cbranch_scc1 RL_f_v
v_and_b32 v18, 1, v1
v_mul_u32_u24 v18, 80, v18
v_add_u32 v17, v17, v18
ds_read_b64_tr_b16 a[192:193], v17 offset:0
ds_read_b64_tr_b16 a[194:195], v17 offset:2560
ds_read_b64_tr_b16 a[196:197], v17 offset:8
ds_read_b64_tr_b16 a[198:199], v17 offset:2568
ds_read_b64_tr_b16 a[200:201], v17 offset:16
ds_read_b64_tr_b16 a[202:203], v17 offset:2576
ds_read_b64_tr_b16 a[204:205], v17 offset:24
ds_read_b64_tr_b16 a[206:207], v17 offset:2584
ds_read_b64_tr_b16 a[208:209], v17 offset:32
ds_read_b64_tr_b16 a[210:211], v17 offset:2592
s_waitcnt lgkmcnt(0)
buffer_store_dwordx4 a[192:195], v16, s[16:19], s54 offen offset:0 sc1
buffer_store_dwordx4 a[196:199], v16, s[16:19], s54 offen offset:1024 sc1
buffer_store_dwordx4 a[200:203], v16, s[16:19], s54 offen offset:2048 sc1
buffer_store_dwordx4 a[204:207], v16, s[16:19], s54 offen offset:3072 sc1
s_add_u32 s54, s54, 4096
buffer_store_dwordx4 a[208:211], v16, s[16:19], s54 offen offset:0 sc1
s_branch RL_f_done
RL_f_v:
s_add_u32 s54, s54, 5120
v_accvgpr_write_b32 a208, 0
v_accvgpr_write_b32 a209, 0
v_accvgpr_write_b32 a210, 0
v_accvgpr_write_b32 a211, 0
ds_read_b64_tr_b16 a[192:193], v25 offset:80
ds_read_b64_tr_b16 a[194:195], v25 offset:2640
ds_read_b64_tr_b16 a[196:197], v25 offset:120
ds_read_b64_tr_b16 a[198:199], v25 offset:2680
ds_read_b64_tr_b16 a[200:201], v17 offset:112
ds_read_b64_tr_b16 a[202:203], v17 offset:2672
s_waitcnt lgkmcnt(0)
buffer_store_dwordx4 a[192:195], v16, s[16:19], s54 offen offset:0 sc1
buffer_store_dwordx4 a[196:199], v16, s[16:19], s54 offen offset:1024 sc1
buffer_store_dwordx4 a[200:203], v16, s[16:19], s54 offen offset:2048 sc1
buffer_store_dwordx4 a[208:211], v16, s[16:19], s63 offen sc1
s_branch RL_f_done
RL_f_bwo:
ds_read_b64_tr_b16 a[192:193], v25 offset:0
ds_read_b64_tr_b16 a[194:195], v25 offset:2560
ds_read_b64_tr_b16 a[196:197], v25 offset:32
ds_read_b64_tr_b16 a[198:199], v25 offset:2592
ds_read_b64_tr_b16 a[200:201], v25 offset:64
ds_read_b64_tr_b16 a[202:203], v25 offset:2624
ds_read_b64_tr_b16 a[204:205], v25 offset:96
ds_read_b64_tr_b16 a[206:207], v25 offset:2656
ds_read_b64_tr_b16 a[208:209], v25 offset:128
ds_read_b64_tr_b16 a[210:211], v25 offset:2688
s_waitcnt lgkmcnt(0)
buffer_store_dwordx4 a[192:195], v16, s[16:19], s54 offen offset:0 sc1
buffer_store_dwordx4 a[196:199], v16, s[16:19], s54 offen offset:1024 sc1
buffer_store_dwordx4 a[200:203], v16, s[16:19], s54 offen offset:2048 sc1
buffer_store_dwordx4 a[204:207], v16, s[16:19], s54 offen offset:3072 sc1
s_add_u32 s54, s54, 4096
buffer_store_dwordx4 a[208:211], v16, s[16:19], s54 offen offset:0 sc1
RL_f_done:
v_mfma_f32_16x16x32_bf16 a[160:163], a[64:67], a[128:131], a[160:163]
buffer_load_dwordx4 v6, s[68:71], s58 offen offset:0 lds
v_mfma_f32_16x16x32_bf16 a[160:163], a[68:71], a[132:135], a[160:163]
ds_read_b64_tr_b16 a[0:1], v14 offset:16384
v_mfma_f32_16x16x32_bf16 a[164:167], a[72:75], a[128:131], a[164:167]
ds_read_b64_tr_b16 a[2:3], v14 offset:17408
v_mfma_f32_16x16x32_bf16 a[164:167], a[76:79], a[132:135], a[164:167]
ds_read_b64_tr_b16 a[4:5], v14 offset:24576
v_mfma_f32_16x16x32_bf16 a[168:171], a[80:83], a[128:131], a[168:171]
ds_read_b64_tr_b16 a[6:7], v14 offset:25600
v_mfma_f32_16x16x32_bf16 a[168:171], a[84:87], a[132:135], a[168:171]
ds_read_b64_tr_b16 a[8:9], v15 offset:16384
v_mfma_f32_16x16x32_bf16 a[172:175], a[88:91], a[128:131], a[172:175]
buffer_load_dwordx4 v7, s[68:71], s58 offen offset:1024 lds
v_mfma_f32_16x16x32_bf16 a[172:175], a[92:95], a[132:135], a[172:175]
ds_read_b64_tr_b16 a[10:11], v15 offset:17408
v_mfma_f32_16x16x32_bf16 a[176:179], a[96:99], a[128:131], a[176:179]
ds_read_b64_tr_b16 a[12:13], v15 offset:24576
v_mfma_f32_16x16x32_bf16 a[176:179], a[100:103], a[132:135], a[176:179]
ds_read_b64_tr_b16 a[14:15], v15 offset:25600
v_mfma_f32_16x16x32_bf16 a[180:183], a[104:107], a[128:131], a[180:183]
ds_read_b64_tr_b16 a[16:17], v12 offset:0
v_mfma_f32_16x16x32_bf16 a[180:183], a[108:111], a[132:135], a[180:183]
ds_read_b64_tr_b16 a[18:19], v12 offset:1024
v_mfma_f32_16x16x32_bf16 a[184:187], a[112:115], a[128:131], a[184:187]
buffer_load_dwordx4 v8, s[68:71], s58 offen offset:2048 lds
v_mfma_f32_16x16x32_bf16 a[184:187], a[116:119], a[132:135], a[184:187]
ds_read_b64_tr_b16 a[20:21], v12 offset:8192
v_mfma_f32_16x16x32_bf16 a[188:191], a[120:123], a[128:131], a[188:191]
ds_read_b64_tr_b16 a[22:23], v12 offset:9216
v_mfma_f32_16x16x32_bf16 a[188:191], a[124:127], a[132:135], a[188:191]
ds_read_b64_tr_b16 a[24:25], v13 offset:0
v_mfma_f32_16x16x32_bf16 v[160:163], a[64:67], a[136:139], v[160:163]
ds_read_b64_tr_b16 a[26:27], v13 offset:1024
v_mfma_f32_16x16x32_bf16 v[160:163], a[68:71], a[140:143], v[160:163]
ds_read_b64_tr_b16 a[28:29], v13 offset:8192
v_mfma_f32_16x16x32_bf16 v[164:167], a[72:75], a[136:139], v[164:167]
buffer_load_dwordx4 v9, s[68:71], s58 offen offset:3072 lds
v_mfma_f32_16x16x32_bf16 v[164:167], a[76:79], a[140:143], v[164:167]
s_add_u32 s41, s41, 128
s_add_u32 s57, s57, 128
s_add_u32 s58, s58, 524288
v_mfma_f32_16x16x32_bf16 v[192:195], a[80:83], a[136:139], v[192:195]
ds_read_b64_tr_b16 a[30:31], v13 offset:9216
v_mfma_f32_16x16x32_bf16 v[192:195], a[84:87], a[140:143], v[192:195]
ds_read_b64_tr_b16 a[32:33], v14 offset:0
v_mfma_f32_16x16x32_bf16 v[196:199], a[88:91], a[136:139], v[196:199]
ds_read_b64_tr_b16 a[34:35], v14 offset:1024
v_mfma_f32_16x16x32_bf16 v[196:199], a[92:95], a[140:143], v[196:199]
ds_read_b64_tr_b16 a[36:37], v14 offset:8192
v_accvgpr_read_b32 v24, a184
v_mfma_f32_16x16x32_bf16 v[224:227], a[96:99], a[136:139], v[224:227]
ds_read_b64_tr_b16 a[38:39], v14 offset:9216
v_accvgpr_read_b32 v25, a185
v_mfma_f32_16x16x32_bf16 v[224:227], a[100:103], a[140:143], v[224:227]
ds_read_b64_tr_b16 a[40:41], v15 offset:0
v_accvgpr_read_b32 v26, a186
v_mfma_f32_16x16x32_bf16 v[228:231], a[104:107], a[136:139], v[228:231]
ds_read_b64_tr_b16 a[42:43], v15 offset:1024
v_accvgpr_read_b32 v27, a187
v_mfma_f32_16x16x32_bf16 v[228:231], a[108:111], a[140:143], v[228:231]
ds_read_b64_tr_b16 a[44:45], v15 offset:8192
v_cvt_pk_bf16_f32 v24, v24, v25
v_mfma_f32_16x16x32_bf16 v[184:187], a[112:115], a[136:139], v[184:187]
ds_read_b64_tr_b16 a[46:47], v15 offset:9216
v_cvt_pk_bf16_f32 v25, v26, v27
v_mfma_f32_16x16x32_bf16 v[184:187], a[116:119], a[140:143], v[184:187]
v_add_u32 v24, 0x10001000, v24
v_add_u32 v25, 0x10001000, v25
v_mfma_f32_16x16x32_bf16 v[188:191], a[120:123], a[136:139], v[188:191]
v_accvgpr_write_b32 a224, v24
v_accvgpr_write_b32 a225, v25
v_mfma_f32_16x16x32_bf16 v[188:191], a[124:127], a[140:143], v[188:191]
s_waitcnt lgkmcnt(0)
s_barrier
v_mfma_f32_16x16x32_bf16 v[168:171], a[64:67], a[0:3], v[168:171]
s_add_u32 m0, s36, 49152
v_add_u32 v10, s36, v22
v_xor_b32 v11, 64, v10
v_mfma_f32_16x16x32_bf16 v[168:171], a[68:71], a[4:7], v[168:171]
buffer_load_dwordx4 v2, s[64:67], s41 offen offset:0 lds
v_mfma_f32_16x16x32_bf16 v[172:175], a[72:75], a[0:3], v[172:175]
v_add_u32 v12, 0x8000, v23
v_xor_b32 v13, 32, v12
v_mfma_f32_16x16x32_bf16 v[172:175], a[76:79], a[4:7], v[172:175]
v_xor_b32 v14, 64, v12
v_xor_b32 v15, 96, v12
v_mfma_f32_16x16x32_bf16 v[200:203], a[80:83], a[0:3], v[200:203]
v_accvgpr_read_b32 v24, a188
v_accvgpr_read_b32 v25, a189
v_mfma_f32_16x16x32_bf16 v[200:203], a[84:87], a[4:7], v[200:203]
buffer_load_dwordx4 v3, s[64:67], s41 offen offset:1024 lds
v_mfma_f32_16x16x32_bf16 v[204:207], a[88:91], a[0:3], v[204:207]
v_accvgpr_read_b32 v26, a190
v_accvgpr_read_b32 v27, a191
v_mfma_f32_16x16x32_bf16 v[204:207], a[92:95], a[4:7], v[204:207]
v_cvt_pk_bf16_f32 v24, v24, v25
v_cvt_pk_bf16_f32 v25, v26, v27
v_mfma_f32_16x16x32_bf16 v[232:235], a[96:99], a[0:3], v[232:235]
v_add_u32 v24, 0x10001000, v24
v_add_u32 v25, 0x10001000, v25
v_mfma_f32_16x16x32_bf16 v[232:235], a[100:103], a[4:7], v[232:235]
buffer_load_dwordx4 v4, s[64:67], s41 offen offset:2048 lds
v_mfma_f32_16x16x32_bf16 v[236:239], a[104:107], a[0:3], v[236:239]
v_accvgpr_write_b32 a226, v24
v_accvgpr_write_b32 a227, v25
v_mfma_f32_16x16x32_bf16 v[236:239], a[108:111], a[4:7], v[236:239]
v_cvt_pk_bf16_f32 v160, v160, v161
v_cvt_pk_bf16_f32 v161, v162, v163
v_mfma_f32_16x16x32_bf16 v[216:219], a[112:115], a[0:3], v[216:219]
v_cvt_pk_bf16_f32 v162, v164, v165
v_cvt_pk_bf16_f32 v163, v166, v167
v_mfma_f32_16x16x32_bf16 v[216:219], a[116:119], a[4:7], v[216:219]
buffer_load_dwordx4 v5, s[64:67], s41 offen offset:3072 lds
v_mfma_f32_16x16x32_bf16 v[220:223], a[120:123], a[0:3], v[220:223]
s_add_u32 m0, s36, 53248
v_accvgpr_read_b32 v24, a160
v_accvgpr_read_b32 v25, a161
v_mfma_f32_16x16x32_bf16 v[220:223], a[124:127], a[4:7], v[220:223]
v_accvgpr_read_b32 v26, a162
v_accvgpr_read_b32 v27, a163
v_mfma_f32_16x16x32_bf16 v[176:179], a[64:67], a[8:11], v[176:179]
v_cvt_pk_bf16_f32 v164, v24, v25
v_cvt_pk_bf16_f32 v165, v26, v27
v_mfma_f32_16x16x32_bf16 v[176:179], a[68:71], a[12:15], v[176:179]
buffer_load_dwordx4 v2, s[64:67], s57 offen offset:0 lds
v_mfma_f32_16x16x32_bf16 v[180:183], a[72:75], a[8:11], v[180:183]
v_accvgpr_read_b32 v24, a164
v_accvgpr_read_b32 v25, a165
v_mfma_f32_16x16x32_bf16 v[180:183], a[76:79], a[12:15], v[180:183]
v_accvgpr_read_b32 v26, a166
v_accvgpr_read_b32 v27, a167
v_mfma_f32_16x16x32_bf16 v[208:211], a[80:83], a[8:11], v[208:211]
v_cvt_pk_bf16_f32 v166, v24, v25
v_cvt_pk_bf16_f32 v167, v26, v27
v_mfma_f32_16x16x32_bf16 v[208:211], a[84:87], a[12:15], v[208:211]
buffer_load_dwordx4 v3, s[64:67], s57 offen offset:1024 lds
v_mfma_f32_16x16x32_bf16 v[212:215], a[88:91], a[8:11], v[212:215]
v_cvt_pk_bf16_f32 v192, v192, v193
v_cvt_pk_bf16_f32 v193, v194, v195
v_mfma_f32_16x16x32_bf16 v[212:215], a[92:95], a[12:15], v[212:215]
v_cvt_pk_bf16_f32 v194, v196, v197
v_cvt_pk_bf16_f32 v195, v198, v199
v_mfma_f32_16x16x32_bf16 v[240:243], a[96:99], a[8:11], v[240:243]
v_accvgpr_read_b32 v24, a168
v_accvgpr_read_b32 v25, a169
v_mfma_f32_16x16x32_bf16 v[240:243], a[100:103], a[12:15], v[240:243]
buffer_load_dwordx4 v4, s[64:67], s57 offen offset:2048 lds
v_mfma_f32_16x16x32_bf16 v[244:247], a[104:107], a[8:11], v[244:247]
v_accvgpr_read_b32 v26, a170
v_accvgpr_read_b32 v27, a171
v_mfma_f32_16x16x32_bf16 v[244:247], a[108:111], a[12:15], v[244:247]
v_cvt_pk_bf16_f32 v196, v24, v25
v_cvt_pk_bf16_f32 v197, v26, v27
v_mfma_f32_16x16x32_bf16 v[248:251], a[112:115], a[8:11], v[248:251]
v_accvgpr_read_b32 v24, a172
v_accvgpr_read_b32 v25, a173
v_mfma_f32_16x16x32_bf16 v[248:251], a[116:119], a[12:15], v[248:251]
buffer_load_dwordx4 v5, s[64:67], s57 offen offset:3072 lds
v_mfma_f32_16x16x32_bf16 v[252:255], a[120:123], a[8:11], v[252:255]
s_add_u32 m0, s35, 81920
v_accvgpr_read_b32 v26, a174
v_accvgpr_read_b32 v27, a175
v_mfma_f32_16x16x32_bf16 v[252:255], a[124:127], a[12:15], v[252:255]
v_cvt_pk_bf16_f32 v198, v24, v25
v_cvt_pk_bf16_f32 v199, v26, v27
v_mfma_f32_16x16x32_bf16 v[96:99], a[16:19], a[64:67], v[96:99]
v_cvt_pk_bf16_f32 v224, v224, v225
v_cvt_pk_bf16_f32 v225, v226, v227
v_mfma_f32_16x16x32_bf16 v[96:99], a[20:23], a[68:71], v[96:99]
buffer_load_dwordx4 v6, s[68:71], s58 offen offset:0 lds
v_mfma_f32_16x16x32_bf16 v[100:103], a[16:19], a[72:75], v[100:103]
v_cvt_pk_bf16_f32 v226, v228, v229
v_cvt_pk_bf16_f32 v227, v230, v231
v_mfma_f32_16x16x32_bf16 v[100:103], a[20:23], a[76:79], v[100:103]
v_accvgpr_read_b32 v24, a176
v_accvgpr_read_b32 v25, a177
v_mfma_f32_16x16x32_bf16 v[104:107], a[16:19], a[80:83], v[104:107]
v_accvgpr_read_b32 v26, a178
v_accvgpr_read_b32 v27, a179
v_mfma_f32_16x16x32_bf16 v[104:107], a[20:23], a[84:87], v[104:107]
buffer_load_dwordx4 v7, s[68:71], s58 offen offset:1024 lds
v_mfma_f32_16x16x32_bf16 v[108:111], a[16:19], a[88:91], v[108:111]
v_cvt_pk_bf16_f32 v228, v24, v25
v_cvt_pk_bf16_f32 v229, v26, v27
v_mfma_f32_16x16x32_bf16 v[108:111], a[20:23], a[92:95], v[108:111]
v_accvgpr_read_b32 v24, a180
v_accvgpr_read_b32 v25, a181
v_mfma_f32_16x16x32_bf16 v[32:35], a[16:19], a[96:99], v[32:35]
v_accvgpr_read_b32 v26, a182
v_accvgpr_read_b32 v27, a183
v_mfma_f32_16x16x32_bf16 v[32:35], a[20:23], a[100:103], v[32:35]
buffer_load_dwordx4 v8, s[68:71], s58 offen offset:2048 lds
v_mfma_f32_16x16x32_bf16 v[36:39], a[16:19], a[104:107], v[36:39]
v_cvt_pk_bf16_f32 v230, v24, v25
v_cvt_pk_bf16_f32 v231, v26, v27
v_mfma_f32_16x16x32_bf16 v[36:39], a[20:23], a[108:111], v[36:39]
v_cvt_pk_bf16_f32 v184, v184, v185
v_cvt_pk_bf16_f32 v185, v186, v187
v_mfma_f32_16x16x32_bf16 v[40:43], a[16:19], a[112:115], v[40:43]
v_add_u32 v184, 0x10001000, v184
v_add_u32 v185, 0x10001000, v185
v_mfma_f32_16x16x32_bf16 v[40:43], a[20:23], a[116:119], v[40:43]
buffer_load_dwordx4 v9, s[68:71], s58 offen offset:3072 lds
v_mfma_f32_16x16x32_bf16 v[44:47], a[16:19], a[120:123], v[44:47]
s_add_u32 s41, s41, 128
s_add_u32 s57, s57, 128
s_add_u32 s58, s58, 524288
v_mfma_f32_16x16x32_bf16 v[44:47], a[20:23], a[124:127], v[44:47]
s_add_u32 m0, s36, 98304
v_accvgpr_write_b32 a228, v184
v_accvgpr_write_b32 a229, v185
v_mfma_f32_16x16x32_bf16 v[112:115], a[24:27], a[64:67], v[112:115]
v_cvt_pk_bf16_f32 v188, v188, v189
v_cvt_pk_bf16_f32 v189, v190, v191
v_mfma_f32_16x16x32_bf16 v[112:115], a[28:31], a[68:71], v[112:115]
buffer_load_dwordx4 v2, s[64:67], s41 offen offset:0 lds
v_mfma_f32_16x16x32_bf16 v[116:119], a[24:27], a[72:75], v[116:119]
v_add_u32 v188, 0x10001000, v188
v_add_u32 v189, 0x10001000, v189
v_mfma_f32_16x16x32_bf16 v[116:119], a[28:31], a[76:79], v[116:119]
v_accvgpr_write_b32 a230, v188
v_accvgpr_write_b32 a231, v189
v_mfma_f32_16x16x32_bf16 v[120:123], a[24:27], a[80:83], v[120:123]
v_cvt_pk_bf16_f32 v168, v168, v169
v_cvt_pk_bf16_f32 v169, v170, v171
v_mfma_f32_16x16x32_bf16 v[120:123], a[28:31], a[84:87], v[120:123]
buffer_load_dwordx4 v3, s[64:67], s41 offen offset:1024 lds
v_mfma_f32_16x16x32_bf16 v[124:127], a[24:27], a[88:91], v[124:127]
v_cvt_pk_bf16_f32 v170, v172, v173
v_cvt_pk_bf16_f32 v171, v174, v175
v_mfma_f32_16x16x32_bf16 v[124:127], a[28:31], a[92:95], v[124:127]
v_cvt_pk_bf16_f32 v200, v200, v201
v_cvt_pk_bf16_f32 v201, v202, v203
v_mfma_f32_16x16x32_bf16 v[48:51], a[24:27], a[96:99], v[48:51]
v_cvt_pk_bf16_f32 v202, v204, v205
v_cvt_pk_bf16_f32 v203, v206, v207
v_mfma_f32_16x16x32_bf16 v[48:51], a[28:31], a[100:103], v[48:51]
buffer_load_dwordx4 v4, s[64:67], s41 offen offset:2048 lds
v_mfma_f32_16x16x32_bf16 v[52:55], a[24:27], a[104:107], v[52:55]
v_cvt_pk_bf16_f32 v232, v232, v233
v_cvt_pk_bf16_f32 v233, v234, v235
v_mfma_f32_16x16x32_bf16 v[52:55], a[28:31], a[108:111], v[52:55]
v_cvt_pk_bf16_f32 v234, v236, v237
v_cvt_pk_bf16_f32 v235, v238, v239
v_mfma_f32_16x16x32_bf16 v[56:59], a[24:27], a[112:115], v[56:59]
v_cvt_pk_bf16_f32 v216, v216, v217
v_cvt_pk_bf16_f32 v217, v218, v219
v_mfma_f32_16x16x32_bf16 v[56:59], a[28:31], a[116:119], v[56:59]
buffer_load_dwordx4 v5, s[64:67], s41 offen offset:3072 lds
v_mfma_f32_16x16x32_bf16 v[60:63], a[24:27], a[120:123], v[60:63]
s_add_u32 m0, s36, 102400
v_add_u32 v216, 0x10001000, v216
v_add_u32 v217, 0x10001000, v217
v_mfma_f32_16x16x32_bf16 v[60:63], a[28:31], a[124:127], v[60:63]
v_accvgpr_write_b32 a232, v216
v_accvgpr_write_b32 a233, v217
v_mfma_f32_16x16x32_bf16 v[128:131], a[32:35], a[64:67], v[128:131]
s_waitcnt vmcnt(16)
s_barrier
s_cmp_ge_u32 s52, 800
s_cbranch_scc1 L_nsig
s_cmp_lg_u32 s3, 0
s_cbranch_scc1 w0_concat_4
v_mov_b32 v31, 0
v_mov_b32 v29, 1
s_mov_b64 exec, 1
s_mov_b32 s60, s62
buffer_atomic_add v29, v31, s[16:19], s60 offen sc1
s_mov_b64 exec, -1
w0_concat_4:
L_nsig:
v_mfma_f32_16x16x32_bf16 v[128:131], a[36:39], a[68:71], v[128:131]
buffer_load_dwordx4 v2, s[64:67], s57 offen offset:0 lds
v_mfma_f32_16x16x32_bf16 v[132:135], a[32:35], a[72:75], v[132:135]
ds_read_b128 a[160:163], v10 offset:0
v_cvt_pk_bf16_f32 v220, v220, v221
v_mfma_f32_16x16x32_bf16 v[132:135], a[36:39], a[76:79], v[132:135]
ds_read_b128 a[164:167], v11 offset:0
v_cvt_pk_bf16_f32 v221, v222, v223
v_mfma_f32_16x16x32_bf16 v[136:139], a[32:35], a[80:83], v[136:139]
ds_read_b128 a[168:171], v10 offset:2048
v_add_u32 v220, 0x10001000, v220
v_mfma_f32_16x16x32_bf16 v[136:139], a[36:39], a[84:87], v[136:139]
buffer_load_dwordx4 v3, s[64:67], s57 offen offset:1024 lds
v_mfma_f32_16x16x32_bf16 v[140:143], a[32:35], a[88:91], v[140:143]
ds_read_b128 a[172:175], v11 offset:2048
v_add_u32 v221, 0x10001000, v221
v_mfma_f32_16x16x32_bf16 v[140:143], a[36:39], a[92:95], v[140:143]
ds_read_b128 a[176:179], v10 offset:4096
v_accvgpr_write_b32 a234, v220
v_mfma_f32_16x16x32_bf16 v[64:67], a[32:35], a[96:99], v[64:67]
ds_read_b128 a[180:183], v11 offset:4096
v_accvgpr_write_b32 a235, v221
v_mfma_f32_16x16x32_bf16 v[64:67], a[36:39], a[100:103], v[64:67]
buffer_load_dwordx4 v4, s[64:67], s57 offen offset:2048 lds
v_mfma_f32_16x16x32_bf16 v[68:71], a[32:35], a[104:107], v[68:71]
ds_read_b128 a[184:187], v10 offset:6144
v_cvt_pk_bf16_f32 v176, v176, v177
v_mfma_f32_16x16x32_bf16 v[68:71], a[36:39], a[108:111], v[68:71]
ds_read_b128 a[188:191], v11 offset:6144
v_cvt_pk_bf16_f32 v177, v178, v179
v_mfma_f32_16x16x32_bf16 v[72:75], a[32:35], a[112:115], v[72:75]
ds_read_b64_tr_b16 a[128:129], v12 offset:0
v_cvt_pk_bf16_f32 v178, v180, v181
v_mfma_f32_16x16x32_bf16 v[72:75], a[36:39], a[116:119], v[72:75]
buffer_load_dwordx4 v5, s[64:67], s57 offen offset:3072 lds
v_mfma_f32_16x16x32_bf16 v[76:79], a[32:35], a[120:123], v[76:79]
s_add_u32 m0, s35, 131072
ds_read_b64_tr_b16 a[130:131], v12 offset:1024
v_mfma_f32_16x16x32_bf16 v[76:79], a[36:39], a[124:127], v[76:79]
ds_read_b64_tr_b16 a[132:133], v12 offset:8192
v_cvt_pk_bf16_f32 v179, v182, v183
v_mfma_f32_16x16x32_bf16 v[144:147], a[40:43], a[64:67], v[144:147]
ds_read_b64_tr_b16 a[134:135], v12 offset:9216
v_cvt_pk_bf16_f32 v208, v208, v209
v_mfma_f32_16x16x32_bf16 v[144:147], a[44:47], a[68:71], v[144:147]
buffer_load_dwordx4 v6, s[68:71], s58 offen offset:0 lds
v_mfma_f32_16x16x32_bf16 v[148:151], a[40:43], a[72:75], v[148:151]
ds_read_b64_tr_b16 a[136:137], v13 offset:0
v_cvt_pk_bf16_f32 v209, v210, v211
v_mfma_f32_16x16x32_bf16 v[148:151], a[44:47], a[76:79], v[148:151]
ds_read_b64_tr_b16 a[138:139], v13 offset:1024
v_cvt_pk_bf16_f32 v210, v212, v213
v_mfma_f32_16x16x32_bf16 v[152:155], a[40:43], a[80:83], v[152:155]
ds_read_b64_tr_b16 a[140:141], v13 offset:8192
v_cvt_pk_bf16_f32 v211, v214, v215
v_mfma_f32_16x16x32_bf16 v[152:155], a[44:47], a[84:87], v[152:155]
buffer_load_dwordx4 v7, s[68:71], s58 offen offset:1024 lds
v_mfma_f32_16x16x32_bf16 v[156:159], a[40:43], a[88:91], v[156:159]
ds_read_b64_tr_b16 a[142:143], v13 offset:9216
v_cvt_pk_bf16_f32 v240, v240, v241
v_mfma_f32_16x16x32_bf16 v[156:159], a[44:47], a[92:95], v[156:159]
ds_read_b64_tr_b16 a[144:145], v14 offset:0
v_cvt_pk_bf16_f32 v241, v242, v243
v_mfma_f32_16x16x32_bf16 v[80:83], a[40:43], a[96:99], v[80:83]
ds_read_b64_tr_b16 a[146:147], v14 offset:1024
v_cvt_pk_bf16_f32 v242, v244, v245
v_mfma_f32_16x16x32_bf16 v[80:83], a[44:47], a[100:103], v[80:83]
buffer_load_dwordx4 v8, s[68:71], s58 offen offset:2048 lds
v_mfma_f32_16x16x32_bf16 v[84:87], a[40:43], a[104:107], v[84:87]
ds_read_b64_tr_b16 a[148:149], v14 offset:8192
v_cvt_pk_bf16_f32 v243, v246, v247
v_mfma_f32_16x16x32_bf16 v[84:87], a[44:47], a[108:111], v[84:87]
ds_read_b64_tr_b16 a[150:151], v14 offset:9216
v_cvt_pk_bf16_f32 v248, v248, v249
v_mfma_f32_16x16x32_bf16 v[88:91], a[40:43], a[112:115], v[88:91]
v_cvt_pk_bf16_f32 v249, v250, v251
v_add_u32 v248, 0x10001000, v248
v_mfma_f32_16x16x32_bf16 v[88:91], a[44:47], a[116:119], v[88:91]
buffer_load_dwordx4 v9, s[68:71], s58 offen offset:3072 lds
v_mfma_f32_16x16x32_bf16 v[92:95], a[40:43], a[120:123], v[92:95]
s_add_u32 s41, s41, 128
s_add_u32 s57, s57, 128
s_add_u32 s58, s58, 524288
v_mfma_f32_16x16x32_bf16 v[92:95], a[44:47], a[124:127], v[92:95]
v_add_u32 v249, 0x10001000, v249
v_accvgpr_write_b32 a236, v248
v_accvgpr_write_b32 a237, v249
v_cvt_pk_bf16_f32 v252, v252, v253
v_cvt_pk_bf16_f32 v253, v254, v255
v_add_u32 v252, 0x10001000, v252
v_add_u32 v253, 0x10001000, v253
v_accvgpr_write_b32 a238, v252
v_accvgpr_write_b32 a239, v253
v_cvt_pk_bf16_f32 v172, v96, v97
v_cvt_pk_bf16_f32 v173, v98, v99
v_cvt_pk_bf16_f32 v180, v100, v101
v_cvt_pk_bf16_f32 v181, v102, v103
v_cvt_pk_bf16_f32 v204, v104, v105
v_cvt_pk_bf16_f32 v205, v106, v107
v_cvt_pk_bf16_f32 v212, v108, v109
v_cvt_pk_bf16_f32 v213, v110, v111
v_cvt_pk_bf16_f32 v236, v32, v33
v_cvt_pk_bf16_f32 v237, v34, v35
v_cvt_pk_bf16_f32 v244, v36, v37
v_cvt_pk_bf16_f32 v245, v38, v39
v_cvt_pk_bf16_f32 v40, v40, v41
v_cvt_pk_bf16_f32 v41, v42, v43
v_accvgpr_write_b32 a240, v40
v_accvgpr_write_b32 a241, v41
v_cvt_pk_bf16_f32 v44, v44, v45
v_cvt_pk_bf16_f32 v45, v46, v47
v_accvgpr_write_b32 a244, v44
v_accvgpr_write_b32 a245, v45
v_cvt_pk_bf16_f32 v174, v112, v113
v_cvt_pk_bf16_f32 v175, v114, v115
v_cvt_pk_bf16_f32 v182, v116, v117
v_cvt_pk_bf16_f32 v183, v118, v119
v_cvt_pk_bf16_f32 v206, v120, v121
v_cvt_pk_bf16_f32 v207, v122, v123
v_cvt_pk_bf16_f32 v214, v124, v125
v_cvt_pk_bf16_f32 v215, v126, v127
v_cvt_pk_bf16_f32 v238, v48, v49
v_cvt_pk_bf16_f32 v239, v50, v51
v_cvt_pk_bf16_f32 v246, v52, v53
v_cvt_pk_bf16_f32 v247, v54, v55
v_cvt_pk_bf16_f32 v56, v56, v57
v_cvt_pk_bf16_f32 v57, v58, v59
v_accvgpr_write_b32 a242, v56
v_accvgpr_write_b32 a243, v57
v_cvt_pk_bf16_f32 v60, v60, v61
v_cvt_pk_bf16_f32 v61, v62, v63
v_accvgpr_write_b32 a246, v60
v_accvgpr_write_b32 a247, v61
s_mov_b32 s31, 0x3e0293ee
s_waitcnt lgkmcnt(2)
v_mfma_f32_16x16x32_bf16 v[96:99], a[128:131], a[160:163], 0
ds_read_b64_tr_b16 a[152:153], v15 offset:0
v_add_u32 v10, 0xc000, v10
v_mfma_f32_16x16x32_bf16 v[96:99], a[132:135], a[164:167], v[96:99]
ds_read_b64_tr_b16 a[154:155], v15 offset:1024
v_add_u32 v11, 0xc000, v11
v_mfma_f32_16x16x32_bf16 v[100:103], a[128:131], a[168:171], 0
s_lshl_b32 s62, s88, 8
ds_read_b64_tr_b16 a[156:157], v15 offset:8192
v_mfma_f32_16x16x32_bf16 v[100:103], a[132:135], a[172:175], v[100:103]
s_add_u32 s62, s62, 64210944
ds_read_b64_tr_b16 a[158:159], v15 offset:9216
v_mfma_f32_16x16x32_bf16 v[104:107], a[128:131], a[176:179], 0
s_mov_b32 s63, 64215040
ds_read_b64_tr_b16 a[96:97], v12 offset:512
v_mfma_f32_16x16x32_bf16 v[104:107], a[132:135], a[180:183], v[104:107]
s_mov_b32 s33, 0
ds_read_b64_tr_b16 a[98:99], v12 offset:1536
v_mfma_f32_16x16x32_bf16 v[108:111], a[128:131], a[184:187], 0
ds_read_b64_tr_b16 a[100:101], v12 offset:8704
v_cvt_pk_bf16_f32 v184, v128, v129
v_mfma_f32_16x16x32_bf16 v[108:111], a[132:135], a[188:191], v[108:111]
ds_read_b64_tr_b16 a[102:103], v12 offset:9728
v_cvt_pk_bf16_f32 v185, v130, v131
v_mfma_f32_16x16x32_bf16 v[32:35], a[136:139], a[160:163], 0
ds_read_b64_tr_b16 a[104:105], v13 offset:512
v_cvt_pk_bf16_f32 v188, v132, v133
v_mfma_f32_16x16x32_bf16 v[32:35], a[140:143], a[164:167], v[32:35]
ds_read_b64_tr_b16 a[106:107], v13 offset:1536
v_cvt_pk_bf16_f32 v189, v134, v135
v_mfma_f32_16x16x32_bf16 v[36:39], a[136:139], a[168:171], 0
ds_read_b64_tr_b16 a[108:109], v13 offset:8704
v_cvt_pk_bf16_f32 v216, v136, v137
v_mfma_f32_16x16x32_bf16 v[36:39], a[140:143], a[172:175], v[36:39]
ds_read_b64_tr_b16 a[110:111], v13 offset:9728
v_cvt_pk_bf16_f32 v217, v138, v139
v_mfma_f32_16x16x32_bf16 v[40:43], a[136:139], a[176:179], 0
ds_read_b64_tr_b16 a[128:129], v14 offset:512
v_cvt_pk_bf16_f32 v220, v140, v141
v_mfma_f32_16x16x32_bf16 v[40:43], a[140:143], a[180:183], v[40:43]
ds_read_b64_tr_b16 a[130:131], v14 offset:1536
v_cvt_pk_bf16_f32 v221, v142, v143
v_mfma_f32_16x16x32_bf16 v[44:47], a[136:139], a[184:187], 0
ds_read_b64_tr_b16 a[132:133], v14 offset:8704
v_cvt_pk_bf16_f32 v248, v64, v65
v_mfma_f32_16x16x32_bf16 v[44:47], a[140:143], a[188:191], v[44:47]
ds_read_b64_tr_b16 a[134:135], v14 offset:9728
v_cvt_pk_bf16_f32 v249, v66, v67
v_mfma_f32_16x16x32_bf16 v[112:115], a[144:147], a[160:163], 0
s_waitcnt lgkmcnt(5)
ds_read_b64_tr_b16 a[136:137], v15 offset:512
v_cvt_pk_bf16_f32 v252, v68, v69
v_mfma_f32_16x16x32_bf16 v[112:115], a[148:151], a[164:167], v[112:115]
ds_read_b64_tr_b16 a[138:139], v15 offset:1536
v_cvt_pk_bf16_f32 v253, v70, v71
v_mfma_f32_16x16x32_bf16 v[116:119], a[144:147], a[168:171], 0
ds_read_b64_tr_b16 a[140:141], v15 offset:8704
v_cvt_pk_bf16_f32 v72, v72, v73
v_mfma_f32_16x16x32_bf16 v[116:119], a[148:151], a[172:175], v[116:119]
ds_read_b64_tr_b16 a[142:143], v15 offset:9728
v_add_u32 v12, 0xc000, v12
v_mfma_f32_16x16x32_bf16 v[120:123], a[144:147], a[176:179], 0
v_add_u32 v13, 0xc000, v13
v_add_u32 v14, 0xc000, v14
v_mfma_f32_16x16x32_bf16 v[120:123], a[148:151], a[180:183], v[120:123]
v_add_u32 v15, 0xc000, v15
v_cvt_pk_bf16_f32 v73, v74, v75
v_mfma_f32_16x16x32_bf16 v[124:127], a[144:147], a[184:187], 0
buffer_load_dword v28, v30, s[72:75], s33 offen
v_mfma_f32_16x16x32_bf16 v[124:127], a[148:151], a[188:191], v[124:127]
v_accvgpr_write_b32 a248, v72
v_accvgpr_write_b32 a249, v73
v_mfma_f32_16x16x32_bf16 v[48:51], a[152:155], a[160:163], 0
v_cvt_pk_bf16_f32 v76, v76, v77
v_cvt_pk_bf16_f32 v77, v78, v79
v_mfma_f32_16x16x32_bf16 v[48:51], a[156:159], a[164:167], v[48:51]
v_accvgpr_write_b32 a252, v76
v_accvgpr_write_b32 a253, v77
v_mfma_f32_16x16x32_bf16 v[52:55], a[152:155], a[168:171], 0
v_cvt_pk_bf16_f32 v186, v144, v145
v_cvt_pk_bf16_f32 v187, v146, v147
v_mfma_f32_16x16x32_bf16 v[52:55], a[156:159], a[172:175], v[52:55]
v_cvt_pk_bf16_f32 v190, v148, v149
v_cvt_pk_bf16_f32 v191, v150, v151
v_mfma_f32_16x16x32_bf16 v[56:59], a[152:155], a[176:179], 0
v_cvt_pk_bf16_f32 v218, v152, v153
v_cvt_pk_bf16_f32 v219, v154, v155
v_mfma_f32_16x16x32_bf16 v[56:59], a[156:159], a[180:183], v[56:59]
v_cvt_pk_bf16_f32 v222, v156, v157
v_cvt_pk_bf16_f32 v223, v158, v159
v_mfma_f32_16x16x32_bf16 v[60:63], a[152:155], a[184:187], 0
s_add_u32 s34, s55, 0
v_cvt_pk_bf16_f32 v250, v80, v81
v_cvt_pk_bf16_f32 v251, v82, v83
v_mfma_f32_16x16x32_bf16 v[60:63], a[156:159], a[188:191], v[60:63]
buffer_store_dwordx4 v[172:175], v16, s[16:19], s34 offen offset:0 sc1
v_mfma_f32_16x16x32_bf16 v[128:131], a[96:99], a[160:163], 0
v_cvt_pk_bf16_f32 v254, v84, v85
v_cvt_pk_bf16_f32 v255, v86, v87
v_mfma_f32_16x16x32_bf16 v[128:131], a[100:103], a[164:167], v[128:131]
v_cvt_pk_bf16_f32 v88, v88, v89
v_cvt_pk_bf16_f32 v89, v90, v91
v_mfma_f32_16x16x32_bf16 v[132:135], a[96:99], a[168:171], 0
v_accvgpr_write_b32 a250, v88
v_accvgpr_write_b32 a251, v89
v_mfma_f32_16x16x32_bf16 v[132:135], a[100:103], a[172:175], v[132:135]
v_cvt_pk_bf16_f32 v92, v92, v93
v_cvt_pk_bf16_f32 v93, v94, v95
v_mfma_f32_16x16x32_bf16 v[136:139], a[96:99], a[176:179], 0
s_waitcnt vmcnt(14) lgkmcnt(0)
s_barrier
v_mfma_f32_16x16x32_bf16 v[136:139], a[100:103], a[180:183], v[136:139]
s_add_u32 m0, s36, 0
ds_read_b128 a[64:67], v10 offset:0
v_mfma_f32_16x16x32_bf16 v[140:143], a[96:99], a[184:187], 0
buffer_load_dwordx4 v2, s[64:67], s41 offen offset:0 lds
v_mfma_f32_16x16x32_bf16 v[140:143], a[100:103], a[188:191], v[140:143]
ds_read_b128 a[68:71], v11 offset:0
v_accvgpr_write_b32 a254, v92
v_mfma_f32_16x16x32_bf16 v[64:67], a[104:107], a[160:163], 0
ds_read_b128 a[72:75], v10 offset:2048
v_accvgpr_write_b32 a255, v93
v_mfma_f32_16x16x32_bf16 v[64:67], a[108:111], a[164:167], v[64:67]
ds_read_b128 a[76:79], v11 offset:2048
v_mfma_f32_16x16x32_bf16 v[68:71], a[104:107], a[168:171], 0
ds_read_b128 a[80:83], v10 offset:4096
v_mfma_f32_16x16x32_bf16 v[68:71], a[108:111], a[172:175], v[68:71]
buffer_load_dwordx4 v3, s[64:67], s41 offen offset:1024 lds
v_mfma_f32_16x16x32_bf16 v[72:75], a[104:107], a[176:179], 0
ds_read_b128 a[84:87], v11 offset:4096
v_mfma_f32_16x16x32_bf16 v[72:75], a[108:111], a[180:183], v[72:75]
ds_read_b128 a[88:91], v10 offset:6144
v_mfma_f32_16x16x32_bf16 v[76:79], a[104:107], a[184:187], 0
ds_read_b128 a[92:95], v11 offset:6144
v_mfma_f32_16x16x32_bf16 v[76:79], a[108:111], a[188:191], v[76:79]
ds_read_b64_tr_b16 a[144:145], v12 offset:0
v_mfma_f32_16x16x32_bf16 v[144:147], a[128:131], a[160:163], 0
buffer_load_dwordx4 v4, s[64:67], s41 offen offset:2048 lds
v_mfma_f32_16x16x32_bf16 v[144:147], a[132:135], a[164:167], v[144:147]
ds_read_b64_tr_b16 a[146:147], v12 offset:1024
v_mfma_f32_16x16x32_bf16 v[148:151], a[128:131], a[168:171], 0
ds_read_b64_tr_b16 a[148:149], v12 offset:8192
v_mfma_f32_16x16x32_bf16 v[148:151], a[132:135], a[172:175], v[148:151]
ds_read_b64_tr_b16 a[150:151], v12 offset:9216
v_mfma_f32_16x16x32_bf16 v[152:155], a[128:131], a[176:179], 0
ds_read_b64_tr_b16 a[152:153], v13 offset:0
v_mfma_f32_16x16x32_bf16 v[152:155], a[132:135], a[180:183], v[152:155]
buffer_load_dwordx4 v5, s[64:67], s41 offen offset:3072 lds
v_mfma_f32_16x16x32_bf16 v[156:159], a[128:131], a[184:187], 0
s_add_u32 m0, s36, 4096
ds_read_b64_tr_b16 a[154:155], v13 offset:1024
v_mfma_f32_16x16x32_bf16 v[156:159], a[132:135], a[188:191], v[156:159]
ds_read_b64_tr_b16 a[156:157], v13 offset:8192
v_mfma_f32_16x16x32_bf16 v[80:83], a[136:139], a[160:163], 0
ds_read_b64_tr_b16 a[158:159], v13 offset:9216
v_mfma_f32_16x16x32_bf16 v[80:83], a[140:143], a[164:167], v[80:83]
ds_read_b64_tr_b16 a[96:97], v14 offset:0
v_mfma_f32_16x16x32_bf16 v[84:87], a[136:139], a[168:171], 0
buffer_load_dwordx4 v2, s[64:67], s57 offen offset:0 lds
v_mfma_f32_16x16x32_bf16 v[84:87], a[140:143], a[172:175], v[84:87]
ds_read_b64_tr_b16 a[98:99], v14 offset:1024
v_mfma_f32_16x16x32_bf16 v[88:91], a[136:139], a[176:179], 0
ds_read_b64_tr_b16 a[100:101], v14 offset:8192
v_mfma_f32_16x16x32_bf16 v[88:91], a[140:143], a[180:183], v[88:91]
ds_read_b64_tr_b16 a[102:103], v14 offset:9216
v_mfma_f32_16x16x32_bf16 v[92:95], a[136:139], a[184:187], 0
v_mfma_f32_16x16x32_bf16 v[92:95], a[140:143], a[188:191], v[92:95]
s_waitcnt lgkmcnt(2)
v_mfma_f32_16x16x32_bf16 v[96:99], a[144:147], a[64:67], v[96:99]
buffer_load_dwordx4 v3, s[64:67], s57 offen offset:1024 lds
v_mfma_f32_16x16x32_bf16 v[96:99], a[148:151], a[68:71], v[96:99]
ds_read_b64_tr_b16 a[104:105], v15 offset:0
v_add_u32 v10, 0xc000, v10
v_mfma_f32_16x16x32_bf16 v[100:103], a[144:147], a[72:75], v[100:103]
ds_read_b64_tr_b16 a[106:107], v15 offset:1024
v_add_u32 v11, 0xc000, v11
v_mfma_f32_16x16x32_bf16 v[100:103], a[148:151], a[76:79], v[100:103]
ds_read_b64_tr_b16 a[108:109], v15 offset:8192
v_mfma_f32_16x16x32_bf16 v[104:107], a[144:147], a[80:83], v[104:107]
buffer_load_dwordx4 v4, s[64:67], s57 offen offset:2048 lds
v_mfma_f32_16x16x32_bf16 v[104:107], a[148:151], a[84:87], v[104:107]
ds_read_b64_tr_b16 a[110:111], v15 offset:9216
v_mfma_f32_16x16x32_bf16 v[108:111], a[144:147], a[88:91], v[108:111]
ds_read_b64_tr_b16 a[128:129], v12 offset:512
v_mfma_f32_16x16x32_bf16 v[108:111], a[148:151], a[92:95], v[108:111]
ds_read_b64_tr_b16 a[130:131], v12 offset:1536
v_mfma_f32_16x16x32_bf16 v[32:35], a[152:155], a[64:67], v[32:35]
buffer_load_dwordx4 v5, s[64:67], s57 offen offset:3072 lds
v_mfma_f32_16x16x32_bf16 v[32:35], a[156:159], a[68:71], v[32:35]
s_add_u32 m0, s35, 32768
ds_read_b64_tr_b16 a[132:133], v12 offset:8704
v_mfma_f32_16x16x32_bf16 v[36:39], a[152:155], a[72:75], v[36:39]
ds_read_b64_tr_b16 a[134:135], v12 offset:9728
v_mfma_f32_16x16x32_bf16 v[36:39], a[156:159], a[76:79], v[36:39]
ds_read_b64_tr_b16 a[136:137], v13 offset:512
v_mfma_f32_16x16x32_bf16 v[40:43], a[152:155], a[80:83], v[40:43]
buffer_load_dwordx4 v6, s[68:71], s58 offen offset:0 lds
v_mfma_f32_16x16x32_bf16 v[40:43], a[156:159], a[84:87], v[40:43]
ds_read_b64_tr_b16 a[138:139], v13 offset:1536
v_mfma_f32_16x16x32_bf16 v[44:47], a[152:155], a[88:91], v[44:47]
ds_read_b64_tr_b16 a[140:141], v13 offset:8704
v_mfma_f32_16x16x32_bf16 v[44:47], a[156:159], a[92:95], v[44:47]
ds_read_b64_tr_b16 a[142:143], v13 offset:9728
v_mfma_f32_16x16x32_bf16 v[112:115], a[96:99], a[64:67], v[112:115]
s_waitcnt lgkmcnt(4)
buffer_load_dwordx4 v7, s[68:71], s58 offen offset:1024 lds
v_mfma_f32_16x16x32_bf16 v[112:115], a[100:103], a[68:71], v[112:115]
ds_read_b64_tr_b16 a[144:145], v14 offset:512
v_mfma_f32_16x16x32_bf16 v[116:119], a[96:99], a[72:75], v[116:119]
ds_read_b64_tr_b16 a[146:147], v14 offset:1536
v_mfma_f32_16x16x32_bf16 v[116:119], a[100:103], a[76:79], v[116:119]
ds_read_b64_tr_b16 a[148:149], v14 offset:8704
v_mfma_f32_16x16x32_bf16 v[120:123], a[96:99], a[80:83], v[120:123]
buffer_load_dwordx4 v8, s[68:71], s58 offen offset:2048 lds
v_mfma_f32_16x16x32_bf16 v[120:123], a[100:103], a[84:87], v[120:123]
ds_read_b64_tr_b16 a[150:151], v14 offset:9728
v_mfma_f32_16x16x32_bf16 v[124:127], a[96:99], a[88:91], v[124:127]
ds_read_b64_tr_b16 a[152:153], v15 offset:512
v_mfma_f32_16x16x32_bf16 v[124:127], a[100:103], a[92:95], v[124:127]
ds_read_b64_tr_b16 a[154:155], v15 offset:1536
v_mfma_f32_16x16x32_bf16 v[48:51], a[104:107], a[64:67], v[48:51]
buffer_load_dwordx4 v9, s[68:71], s58 offen offset:3072 lds
v_mfma_f32_16x16x32_bf16 v[48:51], a[108:111], a[68:71], v[48:51]
s_add_u32 s41, s41, 128
s_add_u32 s57, s57, 128
s_add_u32 s58, s58, 524288
v_mfma_f32_16x16x32_bf16 v[52:55], a[104:107], a[72:75], v[52:55]
ds_read_b64_tr_b16 a[156:157], v15 offset:8704
v_mfma_f32_16x16x32_bf16 v[52:55], a[108:111], a[76:79], v[52:55]
ds_read_b64_tr_b16 a[158:159], v15 offset:9728
v_add_u32 v12, 0xc000, v12
v_mfma_f32_16x16x32_bf16 v[56:59], a[104:107], a[80:83], v[56:59]
v_add_u32 v13, 0xc000, v13
v_add_u32 v14, 0xc000, v14
v_mfma_f32_16x16x32_bf16 v[56:59], a[108:111], a[84:87], v[56:59]
v_add_u32 v15, 0xc000, v15
v_mfma_f32_16x16x32_bf16 v[60:63], a[104:107], a[88:91], v[60:63]
buffer_store_dwordx4 v[184:187], v16, s[16:19], s34 offen offset:1024 sc1
v_mfma_f32_16x16x32_bf16 v[60:63], a[108:111], a[92:95], v[60:63]
v_mfma_f32_16x16x32_bf16 v[128:131], a[128:131], a[64:67], v[128:131]
v_mfma_f32_16x16x32_bf16 v[128:131], a[132:135], a[68:71], v[128:131]
v_mfma_f32_16x16x32_bf16 v[132:135], a[128:131], a[72:75], v[132:135]
v_mfma_f32_16x16x32_bf16 v[132:135], a[132:135], a[76:79], v[132:135]
v_mfma_f32_16x16x32_bf16 v[136:139], a[128:131], a[80:83], v[136:139]
s_waitcnt vmcnt(15) lgkmcnt(0)
s_barrier
v_mfma_f32_16x16x32_bf16 v[136:139], a[132:135], a[84:87], v[136:139]
s_add_u32 m0, s36, 49152
ds_read_b128 a[160:163], v10 offset:0
v_mfma_f32_16x16x32_bf16 v[140:143], a[128:131], a[88:91], v[140:143]
buffer_load_dwordx4 v2, s[64:67], s41 offen offset:0 lds
v_mfma_f32_16x16x32_bf16 v[140:143], a[132:135], a[92:95], v[140:143]
ds_read_b128 a[164:167], v11 offset:0
v_mfma_f32_16x16x32_bf16 v[64:67], a[136:139], a[64:67], v[64:67]
ds_read_b128 a[168:171], v10 offset:2048
v_mfma_f32_16x16x32_bf16 v[64:67], a[140:143], a[68:71], v[64:67]
ds_read_b128 a[172:175], v11 offset:2048
v_mfma_f32_16x16x32_bf16 v[68:71], a[136:139], a[72:75], v[68:71]
ds_read_b128 a[176:179], v10 offset:4096
v_mfma_f32_16x16x32_bf16 v[68:71], a[140:143], a[76:79], v[68:71]
buffer_load_dwordx4 v3, s[64:67], s41 offen offset:1024 lds
v_mfma_f32_16x16x32_bf16 v[72:75], a[136:139], a[80:83], v[72:75]
ds_read_b128 a[180:183], v11 offset:4096
v_mfma_f32_16x16x32_bf16 v[72:75], a[140:143], a[84:87], v[72:75]
ds_read_b128 a[184:187], v10 offset:6144
v_mfma_f32_16x16x32_bf16 v[76:79], a[136:139], a[88:91], v[76:79]
ds_read_b128 a[188:191], v11 offset:6144
v_mfma_f32_16x16x32_bf16 v[76:79], a[140:143], a[92:95], v[76:79]
ds_read_b64_tr_b16 a[96:97], v12 offset:0
v_mfma_f32_16x16x32_bf16 v[144:147], a[144:147], a[64:67], v[144:147]
buffer_load_dwordx4 v4, s[64:67], s41 offen offset:2048 lds
v_mfma_f32_16x16x32_bf16 v[144:147], a[148:151], a[68:71], v[144:147]
ds_read_b64_tr_b16 a[98:99], v12 offset:1024
v_mfma_f32_16x16x32_bf16 v[148:151], a[144:147], a[72:75], v[148:151]
ds_read_b64_tr_b16 a[100:101], v12 offset:8192
v_mfma_f32_16x16x32_bf16 v[148:151], a[148:151], a[76:79], v[148:151]
ds_read_b64_tr_b16 a[102:103], v12 offset:9216
v_mfma_f32_16x16x32_bf16 v[152:155], a[144:147], a[80:83], v[152:155]
ds_read_b64_tr_b16 a[104:105], v13 offset:0
v_mfma_f32_16x16x32_bf16 v[152:155], a[148:151], a[84:87], v[152:155]
buffer_load_dwordx4 v5, s[64:67], s41 offen offset:3072 lds
v_mfma_f32_16x16x32_bf16 v[156:159], a[144:147], a[88:91], v[156:159]
s_add_u32 m0, s36, 53248
ds_read_b64_tr_b16 a[106:107], v13 offset:1024
v_mfma_f32_16x16x32_bf16 v[156:159], a[148:151], a[92:95], v[156:159]
ds_read_b64_tr_b16 a[108:109], v13 offset:8192
v_mfma_f32_16x16x32_bf16 v[80:83], a[152:155], a[64:67], v[80:83]
ds_read_b64_tr_b16 a[110:111], v13 offset:9216
v_mfma_f32_16x16x32_bf16 v[80:83], a[156:159], a[68:71], v[80:83]
ds_read_b64_tr_b16 a[128:129], v14 offset:0
v_mfma_f32_16x16x32_bf16 v[84:87], a[152:155], a[72:75], v[84:87]
buffer_load_dwordx4 v2, s[64:67], s57 offen offset:0 lds
v_mfma_f32_16x16x32_bf16 v[84:87], a[156:159], a[76:79], v[84:87]
ds_read_b64_tr_b16 a[130:131], v14 offset:1024
v_mfma_f32_16x16x32_bf16 v[88:91], a[152:155], a[80:83], v[88:91]
ds_read_b64_tr_b16 a[132:133], v14 offset:8192
v_mfma_f32_16x16x32_bf16 v[88:91], a[156:159], a[84:87], v[88:91]
ds_read_b64_tr_b16 a[134:135], v14 offset:9216
v_mfma_f32_16x16x32_bf16 v[92:95], a[152:155], a[88:91], v[92:95]
v_mfma_f32_16x16x32_bf16 v[92:95], a[156:159], a[92:95], v[92:95]
s_waitcnt lgkmcnt(2)
v_mfma_f32_16x16x32_bf16 v[96:99], a[96:99], a[160:163], v[96:99]
buffer_load_dwordx4 v3, s[64:67], s57 offen offset:1024 lds
v_mfma_f32_16x16x32_bf16 v[96:99], a[100:103], a[164:167], v[96:99]
ds_read_b64_tr_b16 a[136:137], v15 offset:0
v_add_u32 v10, 0xfffe8000, v10
v_mfma_f32_16x16x32_bf16 v[100:103], a[96:99], a[168:171], v[100:103]
ds_read_b64_tr_b16 a[138:139], v15 offset:1024
v_add_u32 v11, 0xfffe8000, v11
v_mfma_f32_16x16x32_bf16 v[100:103], a[100:103], a[172:175], v[100:103]
ds_read_b64_tr_b16 a[140:141], v15 offset:8192
v_add_u32 v164, 0x10001000, v164
v_mfma_f32_16x16x32_bf16 v[104:107], a[96:99], a[176:179], v[104:107]
buffer_load_dwordx4 v4, s[64:67], s57 offen offset:2048 lds
v_mfma_f32_16x16x32_bf16 v[104:107], a[100:103], a[180:183], v[104:107]
ds_read_b64_tr_b16 a[142:143], v15 offset:9216
v_add_u32 v165, 0x10001000, v165
v_mfma_f32_16x16x32_bf16 v[108:111], a[96:99], a[184:187], v[108:111]
ds_read_b64_tr_b16 a[144:145], v12 offset:512
v_add_u32 v166, 0x10001000, v166
v_mfma_f32_16x16x32_bf16 v[108:111], a[100:103], a[188:191], v[108:111]
ds_read_b64_tr_b16 a[146:147], v12 offset:1536
v_add_u32 v167, 0x10001000, v167
v_mfma_f32_16x16x32_bf16 v[32:35], a[104:107], a[160:163], v[32:35]
buffer_load_dwordx4 v5, s[64:67], s57 offen offset:3072 lds
v_mfma_f32_16x16x32_bf16 v[32:35], a[108:111], a[164:167], v[32:35]
s_add_u32 m0, s35, 81920
ds_read_b64_tr_b16 a[148:149], v12 offset:8704
v_mfma_f32_16x16x32_bf16 v[36:39], a[104:107], a[168:171], v[36:39]
ds_read_b64_tr_b16 a[150:151], v12 offset:9728
v_add_u32 v160, 0x10001000, v160
v_mfma_f32_16x16x32_bf16 v[36:39], a[108:111], a[172:175], v[36:39]
ds_read_b64_tr_b16 a[152:153], v13 offset:512
v_add_u32 v161, 0x10001000, v161
v_mfma_f32_16x16x32_bf16 v[40:43], a[104:107], a[176:179], v[40:43]
buffer_load_dwordx4 v6, s[68:71], s58 offen offset:0 lds
v_mfma_f32_16x16x32_bf16 v[40:43], a[108:111], a[180:183], v[40:43]
ds_read_b64_tr_b16 a[154:155], v13 offset:1536
v_add_u32 v162, 0x10001000, v162
v_mfma_f32_16x16x32_bf16 v[44:47], a[104:107], a[184:187], v[44:47]
ds_read_b64_tr_b16 a[156:157], v13 offset:8704
v_add_u32 v163, 0x10001000, v163
v_mfma_f32_16x16x32_bf16 v[44:47], a[108:111], a[188:191], v[44:47]
ds_read_b64_tr_b16 a[158:159], v13 offset:9728
v_add_u32 v168, 0x10001000, v168
v_mfma_f32_16x16x32_bf16 v[112:115], a[128:131], a[160:163], v[112:115]
s_waitcnt lgkmcnt(4)
buffer_load_dwordx4 v7, s[68:71], s58 offen offset:1024 lds
v_mfma_f32_16x16x32_bf16 v[112:115], a[132:135], a[164:167], v[112:115]
ds_read_b64_tr_b16 a[96:97], v14 offset:512
v_add_u32 v169, 0x10001000, v169
v_mfma_f32_16x16x32_bf16 v[116:119], a[128:131], a[168:171], v[116:119]
ds_read_b64_tr_b16 a[98:99], v14 offset:1536
v_add_u32 v170, 0x10001000, v170
v_mfma_f32_16x16x32_bf16 v[116:119], a[132:135], a[172:175], v[116:119]
ds_read_b64_tr_b16 a[100:101], v14 offset:8704
v_add_u32 v171, 0x10001000, v171
v_mfma_f32_16x16x32_bf16 v[120:123], a[128:131], a[176:179], v[120:123]
buffer_load_dwordx4 v8, s[68:71], s58 offen offset:2048 lds
v_mfma_f32_16x16x32_bf16 v[120:123], a[132:135], a[180:183], v[120:123]
ds_read_b64_tr_b16 a[102:103], v14 offset:9728
v_add_u32 v176, 0x10001000, v176
v_mfma_f32_16x16x32_bf16 v[124:127], a[128:131], a[184:187], v[124:127]
ds_read_b64_tr_b16 a[104:105], v15 offset:512
v_add_u32 v177, 0x10001000, v177
v_mfma_f32_16x16x32_bf16 v[124:127], a[132:135], a[188:191], v[124:127]
ds_read_b64_tr_b16 a[106:107], v15 offset:1536
v_add_u32 v178, 0x10001000, v178
v_mfma_f32_16x16x32_bf16 v[48:51], a[136:139], a[160:163], v[48:51]
buffer_load_dwordx4 v9, s[68:71], s58 offen offset:3072 lds
v_mfma_f32_16x16x32_bf16 v[48:51], a[140:143], a[164:167], v[48:51]
s_add_u32 s41, s41, 128
s_add_u32 s57, s57, 128
s_add_u32 s58, s58, 524288
v_mfma_f32_16x16x32_bf16 v[52:55], a[136:139], a[168:171], v[52:55]
ds_read_b64_tr_b16 a[108:109], v15 offset:8704
v_add_u32 v179, 0x10001000, v179
v_mfma_f32_16x16x32_bf16 v[52:55], a[140:143], a[172:175], v[52:55]
ds_read_b64_tr_b16 a[110:111], v15 offset:9728
v_add_u32 v12, 0xfffe8000, v12
v_mfma_f32_16x16x32_bf16 v[56:59], a[136:139], a[176:179], v[56:59]
v_add_u32 v13, 0xfffe8000, v13
v_add_u32 v14, 0xfffe8000, v14
v_mfma_f32_16x16x32_bf16 v[56:59], a[140:143], a[180:183], v[56:59]
v_add_u32 v15, 0xfffe8000, v15
v_add_u32 v196, 0x10001000, v196
v_mfma_f32_16x16x32_bf16 v[60:63], a[136:139], a[184:187], v[60:63]
s_add_u32 s34, s55, 4096
v_add_u32 v197, 0x10001000, v197
v_add_u32 v198, 0x10001000, v198
v_mfma_f32_16x16x32_bf16 v[60:63], a[140:143], a[188:191], v[60:63]
buffer_store_dwordx4 v[180:183], v16, s[16:19], s34 offen offset:0 sc1
v_mfma_f32_16x16x32_bf16 v[128:131], a[144:147], a[160:163], v[128:131]
v_add_u32 v199, 0x10001000, v199
v_add_u32 v192, 0x10001000, v192
v_mfma_f32_16x16x32_bf16 v[128:131], a[148:151], a[164:167], v[128:131]
v_add_u32 v193, 0x10001000, v193
v_add_u32 v194, 0x10001000, v194
v_mfma_f32_16x16x32_bf16 v[132:135], a[144:147], a[168:171], v[132:135]
v_add_u32 v195, 0x10001000, v195
v_mfma_f32_16x16x32_bf16 v[132:135], a[148:151], a[172:175], v[132:135]
v_mfma_f32_16x16x32_bf16 v[136:139], a[144:147], a[176:179], v[136:139]
s_waitcnt vmcnt(14) lgkmcnt(0)
s_barrier
v_mfma_f32_16x16x32_bf16 v[136:139], a[148:151], a[180:183], v[136:139]
s_add_u32 m0, s36, 98304
ds_read_b128 a[64:67], v10 offset:0
v_mfma_f32_16x16x32_bf16 v[140:143], a[144:147], a[184:187], v[140:143]
buffer_load_dwordx4 v2, s[64:67], s41 offen offset:0 lds
v_mfma_f32_16x16x32_bf16 v[140:143], a[148:151], a[188:191], v[140:143]
ds_read_b128 a[68:71], v11 offset:0
v_mfma_f32_16x16x32_bf16 v[64:67], a[152:155], a[160:163], v[64:67]
ds_read_b128 a[72:75], v10 offset:2048
v_mfma_f32_16x16x32_bf16 v[64:67], a[156:159], a[164:167], v[64:67]
ds_read_b128 a[76:79], v11 offset:2048
v_mfma_f32_16x16x32_bf16 v[68:71], a[152:155], a[168:171], v[68:71]
ds_read_b128 a[80:83], v10 offset:4096
v_mfma_f32_16x16x32_bf16 v[68:71], a[156:159], a[172:175], v[68:71]
buffer_load_dwordx4 v3, s[64:67], s41 offen offset:1024 lds
v_mfma_f32_16x16x32_bf16 v[72:75], a[152:155], a[176:179], v[72:75]
ds_read_b128 a[84:87], v11 offset:4096
v_mfma_f32_16x16x32_bf16 v[72:75], a[156:159], a[180:183], v[72:75]
ds_read_b128 a[88:91], v10 offset:6144
v_mfma_f32_16x16x32_bf16 v[76:79], a[152:155], a[184:187], v[76:79]
ds_read_b128 a[92:95], v11 offset:6144
v_mfma_f32_16x16x32_bf16 v[76:79], a[156:159], a[188:191], v[76:79]
ds_read_b64_tr_b16 a[128:129], v12 offset:0
v_mfma_f32_16x16x32_bf16 v[144:147], a[96:99], a[160:163], v[144:147]
buffer_load_dwordx4 v4, s[64:67], s41 offen offset:2048 lds
v_mfma_f32_16x16x32_bf16 v[144:147], a[100:103], a[164:167], v[144:147]
ds_read_b64_tr_b16 a[130:131], v12 offset:1024
v_mfma_f32_16x16x32_bf16 v[148:151], a[96:99], a[168:171], v[148:151]
ds_read_b64_tr_b16 a[132:133], v12 offset:8192
v_mfma_f32_16x16x32_bf16 v[148:151], a[100:103], a[172:175], v[148:151]
ds_read_b64_tr_b16 a[134:135], v12 offset:9216
v_mfma_f32_16x16x32_bf16 v[152:155], a[96:99], a[176:179], v[152:155]
ds_read_b64_tr_b16 a[136:137], v13 offset:0
v_mfma_f32_16x16x32_bf16 v[152:155], a[100:103], a[180:183], v[152:155]
buffer_load_dwordx4 v5, s[64:67], s41 offen offset:3072 lds
v_mfma_f32_16x16x32_bf16 v[156:159], a[96:99], a[184:187], v[156:159]
s_add_u32 m0, s36, 102400
ds_read_b64_tr_b16 a[138:139], v13 offset:1024
v_mfma_f32_16x16x32_bf16 v[156:159], a[100:103], a[188:191], v[156:159]
ds_read_b64_tr_b16 a[140:141], v13 offset:8192
v_mfma_f32_16x16x32_bf16 v[80:83], a[104:107], a[160:163], v[80:83]
ds_read_b64_tr_b16 a[142:143], v13 offset:9216
v_mfma_f32_16x16x32_bf16 v[80:83], a[108:111], a[164:167], v[80:83]
ds_read_b64_tr_b16 a[144:145], v14 offset:0
v_mfma_f32_16x16x32_bf16 v[84:87], a[104:107], a[168:171], v[84:87]
buffer_load_dwordx4 v2, s[64:67], s57 offen offset:0 lds
v_mfma_f32_16x16x32_bf16 v[84:87], a[108:111], a[172:175], v[84:87]
ds_read_b64_tr_b16 a[146:147], v14 offset:1024
v_mfma_f32_16x16x32_bf16 v[88:91], a[104:107], a[176:179], v[88:91]
ds_read_b64_tr_b16 a[148:149], v14 offset:8192
v_mfma_f32_16x16x32_bf16 v[88:91], a[108:111], a[180:183], v[88:91]
ds_read_b64_tr_b16 a[150:151], v14 offset:9216
v_mfma_f32_16x16x32_bf16 v[92:95], a[104:107], a[184:187], v[92:95]
v_mfma_f32_16x16x32_bf16 v[92:95], a[108:111], a[188:191], v[92:95]
s_waitcnt lgkmcnt(2)
v_mfma_f32_16x16x32_bf16 v[96:99], a[128:131], a[64:67], v[96:99]
buffer_load_dwordx4 v3, s[64:67], s57 offen offset:1024 lds
v_mfma_f32_16x16x32_bf16 v[96:99], a[132:135], a[68:71], v[96:99]
ds_read_b64_tr_b16 a[152:153], v15 offset:0
v_add_u32 v10, 0xc000, v10
v_mfma_f32_16x16x32_bf16 v[100:103], a[128:131], a[72:75], v[100:103]
ds_read_b64_tr_b16 a[154:155], v15 offset:1024
v_add_u32 v11, 0xc000, v11
v_mfma_f32_16x16x32_bf16 v[100:103], a[132:135], a[76:79], v[100:103]
ds_read_b64_tr_b16 a[156:157], v15 offset:8192
v_add_u32 v200, 0x10001000, v200
v_mfma_f32_16x16x32_bf16 v[104:107], a[128:131], a[80:83], v[104:107]
buffer_load_dwordx4 v4, s[64:67], s57 offen offset:2048 lds
v_mfma_f32_16x16x32_bf16 v[104:107], a[132:135], a[84:87], v[104:107]
ds_read_b64_tr_b16 a[158:159], v15 offset:9216
v_add_u32 v201, 0x10001000, v201
v_mfma_f32_16x16x32_bf16 v[108:111], a[128:131], a[88:91], v[108:111]
ds_read_b64_tr_b16 a[96:97], v12 offset:512
v_add_u32 v202, 0x10001000, v202
v_mfma_f32_16x16x32_bf16 v[108:111], a[132:135], a[92:95], v[108:111]
ds_read_b64_tr_b16 a[98:99], v12 offset:1536
v_add_u32 v203, 0x10001000, v203
v_mfma_f32_16x16x32_bf16 v[32:35], a[136:139], a[64:67], v[32:35]
buffer_load_dwordx4 v5, s[64:67], s57 offen offset:3072 lds
v_mfma_f32_16x16x32_bf16 v[32:35], a[140:143], a[68:71], v[32:35]
s_add_u32 m0, s35, 131072
ds_read_b64_tr_b16 a[100:101], v12 offset:8704
v_mfma_f32_16x16x32_bf16 v[36:39], a[136:139], a[72:75], v[36:39]
ds_read_b64_tr_b16 a[102:103], v12 offset:9728
v_add_u32 v208, 0x10001000, v208
v_mfma_f32_16x16x32_bf16 v[36:39], a[140:143], a[76:79], v[36:39]
ds_read_b64_tr_b16 a[104:105], v13 offset:512
v_add_u32 v209, 0x10001000, v209
v_mfma_f32_16x16x32_bf16 v[40:43], a[136:139], a[80:83], v[40:43]
buffer_load_dwordx4 v6, s[68:71], s58 offen offset:0 lds
v_mfma_f32_16x16x32_bf16 v[40:43], a[140:143], a[84:87], v[40:43]
ds_read_b64_tr_b16 a[106:107], v13 offset:1536
v_add_u32 v210, 0x10001000, v210
v_mfma_f32_16x16x32_bf16 v[44:47], a[136:139], a[88:91], v[44:47]
ds_read_b64_tr_b16 a[108:109], v13 offset:8704
v_add_u32 v211, 0x10001000, v211
v_mfma_f32_16x16x32_bf16 v[44:47], a[140:143], a[92:95], v[44:47]
ds_read_b64_tr_b16 a[110:111], v13 offset:9728
v_add_u32 v228, 0x10001000, v228
v_mfma_f32_16x16x32_bf16 v[112:115], a[144:147], a[64:67], v[112:115]
s_waitcnt lgkmcnt(4)
buffer_load_dwordx4 v7, s[68:71], s58 offen offset:1024 lds
v_mfma_f32_16x16x32_bf16 v[112:115], a[148:151], a[68:71], v[112:115]
ds_read_b64_tr_b16 a[128:129], v14 offset:512
v_add_u32 v229, 0x10001000, v229
v_mfma_f32_16x16x32_bf16 v[116:119], a[144:147], a[72:75], v[116:119]
ds_read_b64_tr_b16 a[130:131], v14 offset:1536
v_add_u32 v230, 0x10001000, v230
v_mfma_f32_16x16x32_bf16 v[116:119], a[148:151], a[76:79], v[116:119]
ds_read_b64_tr_b16 a[132:133], v14 offset:8704
v_add_u32 v231, 0x10001000, v231
v_mfma_f32_16x16x32_bf16 v[120:123], a[144:147], a[80:83], v[120:123]
buffer_load_dwordx4 v8, s[68:71], s58 offen offset:2048 lds
v_mfma_f32_16x16x32_bf16 v[120:123], a[148:151], a[84:87], v[120:123]
ds_read_b64_tr_b16 a[134:135], v14 offset:9728
v_add_u32 v224, 0x10001000, v224
v_mfma_f32_16x16x32_bf16 v[124:127], a[144:147], a[88:91], v[124:127]
ds_read_b64_tr_b16 a[136:137], v15 offset:512
v_add_u32 v225, 0x10001000, v225
v_mfma_f32_16x16x32_bf16 v[124:127], a[148:151], a[92:95], v[124:127]
ds_read_b64_tr_b16 a[138:139], v15 offset:1536
v_add_u32 v226, 0x10001000, v226
v_mfma_f32_16x16x32_bf16 v[48:51], a[152:155], a[64:67], v[48:51]
buffer_load_dwordx4 v9, s[68:71], s58 offen offset:3072 lds
v_mfma_f32_16x16x32_bf16 v[48:51], a[156:159], a[68:71], v[48:51]
s_add_u32 s41, s41, 128
s_add_u32 s57, s57, 128
s_add_u32 s58, s58, 524288
v_mfma_f32_16x16x32_bf16 v[52:55], a[152:155], a[72:75], v[52:55]
ds_read_b64_tr_b16 a[140:141], v15 offset:8704
v_add_u32 v227, 0x10001000, v227
v_mfma_f32_16x16x32_bf16 v[52:55], a[156:159], a[76:79], v[52:55]
ds_read_b64_tr_b16 a[142:143], v15 offset:9728
v_add_u32 v12, 0xc000, v12
v_mfma_f32_16x16x32_bf16 v[56:59], a[152:155], a[80:83], v[56:59]
v_add_u32 v13, 0xc000, v13
v_add_u32 v14, 0xc000, v14
v_mfma_f32_16x16x32_bf16 v[56:59], a[156:159], a[84:87], v[56:59]
v_add_u32 v15, 0xc000, v15
v_add_u32 v232, 0x10001000, v232
v_mfma_f32_16x16x32_bf16 v[60:63], a[152:155], a[88:91], v[60:63]
buffer_store_dwordx4 v[188:191], v16, s[16:19], s34 offen offset:1024 sc1
v_mfma_f32_16x16x32_bf16 v[60:63], a[156:159], a[92:95], v[60:63]
v_add_u32 v233, 0x10001000, v233
v_add_u32 v234, 0x10001000, v234
v_mfma_f32_16x16x32_bf16 v[128:131], a[96:99], a[64:67], v[128:131]
v_add_u32 v235, 0x10001000, v235
v_add_u32 v240, 0x10001000, v240
v_mfma_f32_16x16x32_bf16 v[128:131], a[100:103], a[68:71], v[128:131]
v_add_u32 v241, 0x10001000, v241
v_add_u32 v242, 0x10001000, v242
v_mfma_f32_16x16x32_bf16 v[132:135], a[96:99], a[72:75], v[132:135]
v_add_u32 v243, 0x10001000, v243
v_mfma_f32_16x16x32_bf16 v[132:135], a[100:103], a[76:79], v[132:135]
v_mfma_f32_16x16x32_bf16 v[136:139], a[96:99], a[80:83], v[136:139]
s_waitcnt vmcnt(14) lgkmcnt(0)
s_barrier
v_mfma_f32_16x16x32_bf16 v[136:139], a[100:103], a[84:87], v[136:139]
s_add_u32 m0, s36, 0
ds_read_b128 a[160:163], v10 offset:0
v_mfma_f32_16x16x32_bf16 v[140:143], a[96:99], a[88:91], v[140:143]
buffer_load_dwordx4 v2, s[64:67], s41 offen offset:0 lds
v_mfma_f32_16x16x32_bf16 v[140:143], a[100:103], a[92:95], v[140:143]
ds_read_b128 a[164:167], v11 offset:0
v_mfma_f32_16x16x32_bf16 v[64:67], a[104:107], a[64:67], v[64:67]
ds_read_b128 a[168:171], v10 offset:2048
v_mfma_f32_16x16x32_bf16 v[64:67], a[108:111], a[68:71], v[64:67]
ds_read_b128 a[172:175], v11 offset:2048
v_mfma_f32_16x16x32_bf16 v[68:71], a[104:107], a[72:75], v[68:71]
ds_read_b128 a[176:179], v10 offset:4096
v_mfma_f32_16x16x32_bf16 v[68:71], a[108:111], a[76:79], v[68:71]
buffer_load_dwordx4 v3, s[64:67], s41 offen offset:1024 lds
v_mfma_f32_16x16x32_bf16 v[72:75], a[104:107], a[80:83], v[72:75]
ds_read_b128 a[180:183], v11 offset:4096
v_mfma_f32_16x16x32_bf16 v[72:75], a[108:111], a[84:87], v[72:75]
ds_read_b128 a[184:187], v10 offset:6144
v_mfma_f32_16x16x32_bf16 v[76:79], a[104:107], a[88:91], v[76:79]
ds_read_b128 a[188:191], v11 offset:6144
v_mfma_f32_16x16x32_bf16 v[76:79], a[108:111], a[92:95], v[76:79]
ds_read_b64_tr_b16 a[144:145], v12 offset:0
v_mfma_f32_16x16x32_bf16 v[144:147], a[128:131], a[64:67], v[144:147]
buffer_load_dwordx4 v4, s[64:67], s41 offen offset:2048 lds
v_mfma_f32_16x16x32_bf16 v[144:147], a[132:135], a[68:71], v[144:147]
ds_read_b64_tr_b16 a[146:147], v12 offset:1024
v_mfma_f32_16x16x32_bf16 v[148:151], a[128:131], a[72:75], v[148:151]
ds_read_b64_tr_b16 a[148:149], v12 offset:8192
v_mfma_f32_16x16x32_bf16 v[148:151], a[132:135], a[76:79], v[148:151]
ds_read_b64_tr_b16 a[150:151], v12 offset:9216
v_mfma_f32_16x16x32_bf16 v[152:155], a[128:131], a[80:83], v[152:155]
ds_read_b64_tr_b16 a[152:153], v13 offset:0
v_mfma_f32_16x16x32_bf16 v[152:155], a[132:135], a[84:87], v[152:155]
buffer_load_dwordx4 v5, s[64:67], s41 offen offset:3072 lds
v_mfma_f32_16x16x32_bf16 v[156:159], a[128:131], a[88:91], v[156:159]
s_add_u32 m0, s36, 4096
ds_read_b64_tr_b16 a[154:155], v13 offset:1024
v_mfma_f32_16x16x32_bf16 v[156:159], a[132:135], a[92:95], v[156:159]
ds_read_b64_tr_b16 a[156:157], v13 offset:8192
v_mfma_f32_16x16x32_bf16 v[80:83], a[136:139], a[64:67], v[80:83]
ds_read_b64_tr_b16 a[158:159], v13 offset:9216
v_mfma_f32_16x16x32_bf16 v[80:83], a[140:143], a[68:71], v[80:83]
ds_read_b64_tr_b16 a[96:97], v14 offset:0
v_mfma_f32_16x16x32_bf16 v[84:87], a[136:139], a[72:75], v[84:87]
buffer_load_dwordx4 v2, s[64:67], s57 offen offset:0 lds
v_mfma_f32_16x16x32_bf16 v[84:87], a[140:143], a[76:79], v[84:87]
ds_read_b64_tr_b16 a[98:99], v14 offset:1024
v_mfma_f32_16x16x32_bf16 v[88:91], a[136:139], a[80:83], v[88:91]
ds_read_b64_tr_b16 a[100:101], v14 offset:8192
v_mfma_f32_16x16x32_bf16 v[88:91], a[140:143], a[84:87], v[88:91]
ds_read_b64_tr_b16 a[102:103], v14 offset:9216
v_mfma_f32_16x16x32_bf16 v[92:95], a[136:139], a[88:91], v[92:95]
v_mfma_f32_16x16x32_bf16 v[92:95], a[140:143], a[92:95], v[92:95]
s_waitcnt lgkmcnt(2)
v_mfma_f32_16x16x32_bf16 v[96:99], a[144:147], a[160:163], v[96:99]
buffer_load_dwordx4 v3, s[64:67], s57 offen offset:1024 lds
v_mfma_f32_16x16x32_bf16 v[96:99], a[148:151], a[164:167], v[96:99]
ds_read_b64_tr_b16 a[104:105], v15 offset:0
v_add_u32 v10, 0xc000, v10
v_mfma_f32_16x16x32_bf16 v[100:103], a[144:147], a[168:171], v[100:103]
ds_read_b64_tr_b16 a[106:107], v15 offset:1024
v_add_u32 v11, 0xc000, v11
v_mfma_f32_16x16x32_bf16 v[100:103], a[148:151], a[172:175], v[100:103]
ds_read_b64_tr_b16 a[108:109], v15 offset:8192
v_accvgpr_read_b32 v26, a220
v_mfma_f32_16x16x32_bf16 v[104:107], a[144:147], a[176:179], v[104:107]
buffer_load_dwordx4 v4, s[64:67], s57 offen offset:2048 lds
v_mfma_f32_16x16x32_bf16 v[104:107], a[148:151], a[180:183], v[104:107]
ds_read_b64_tr_b16 a[110:111], v15 offset:9216
v_accvgpr_read_b32 v27, a221
v_mfma_f32_16x16x32_bf16 v[108:111], a[144:147], a[184:187], v[108:111]
ds_read_b64_tr_b16 a[128:129], v12 offset:512
v_mfma_f32_16x16x32_bf16 v[108:111], a[148:151], a[188:191], v[108:111]
ds_read_b64_tr_b16 a[130:131], v12 offset:1536
v_mfma_f32_16x16x32_bf16 v[32:35], a[152:155], a[160:163], v[32:35]
buffer_load_dwordx4 v5, s[64:67], s57 offen offset:3072 lds
v_mfma_f32_16x16x32_bf16 v[32:35], a[156:159], a[164:167], v[32:35]
s_add_u32 m0, s35, 32768
ds_read_b64_tr_b16 a[132:133], v12 offset:8704
v_mfma_f32_16x16x32_bf16 v[36:39], a[152:155], a[168:171], v[36:39]
ds_read_b64_tr_b16 a[134:135], v12 offset:9728
v_mfma_f32_16x16x32_bf16 v[36:39], a[156:159], a[172:175], v[36:39]
ds_read_b64_tr_b16 a[136:137], v13 offset:512
v_mfma_f32_16x16x32_bf16 v[40:43], a[152:155], a[176:179], v[40:43]
buffer_load_dwordx4 v6, s[68:71], s58 offen offset:0 lds
v_mfma_f32_16x16x32_bf16 v[40:43], a[156:159], a[180:183], v[40:43]
ds_read_b64_tr_b16 a[138:139], v13 offset:1536
v_mfma_f32_16x16x32_bf16 v[44:47], a[152:155], a[184:187], v[44:47]
ds_read_b64_tr_b16 a[140:141], v13 offset:8704
v_mfma_f32_16x16x32_bf16 v[44:47], a[156:159], a[188:191], v[44:47]
ds_read_b64_tr_b16 a[142:143], v13 offset:9728
v_mfma_f32_16x16x32_bf16 v[112:115], a[96:99], a[160:163], v[112:115]
s_waitcnt lgkmcnt(4)
buffer_load_dwordx4 v7, s[68:71], s58 offen offset:1024 lds
v_mfma_f32_16x16x32_bf16 v[112:115], a[100:103], a[164:167], v[112:115]
ds_read_b64_tr_b16 a[144:145], v14 offset:512
v_mfma_f32_16x16x32_bf16 v[116:119], a[96:99], a[168:171], v[116:119]
ds_read_b64_tr_b16 a[146:147], v14 offset:1536
v_mfma_f32_16x16x32_bf16 v[116:119], a[100:103], a[172:175], v[116:119]
ds_read_b64_tr_b16 a[148:149], v14 offset:8704
v_mfma_f32_16x16x32_bf16 v[120:123], a[96:99], a[176:179], v[120:123]
buffer_load_dwordx4 v8, s[68:71], s58 offen offset:2048 lds
v_mfma_f32_16x16x32_bf16 v[120:123], a[100:103], a[180:183], v[120:123]
ds_read_b64_tr_b16 a[150:151], v14 offset:9728
v_mfma_f32_16x16x32_bf16 v[124:127], a[96:99], a[184:187], v[124:127]
ds_read_b64_tr_b16 a[152:153], v15 offset:512
v_mfma_f32_16x16x32_bf16 v[124:127], a[100:103], a[188:191], v[124:127]
ds_read_b64_tr_b16 a[154:155], v15 offset:1536
v_mfma_f32_16x16x32_bf16 v[48:51], a[104:107], a[160:163], v[48:51]
buffer_load_dwordx4 v9, s[68:71], s58 offen offset:3072 lds
v_mfma_f32_16x16x32_bf16 v[48:51], a[108:111], a[164:167], v[48:51]
s_add_u32 s41, s41, 128
s_add_u32 s57, s57, 128
s_add_u32 s58, s58, 524288
v_mfma_f32_16x16x32_bf16 v[52:55], a[104:107], a[168:171], v[52:55]
ds_read_b64_tr_b16 a[156:157], v15 offset:8704
v_mfma_f32_16x16x32_bf16 v[52:55], a[108:111], a[172:175], v[52:55]
ds_read_b64_tr_b16 a[158:159], v15 offset:9728
v_add_u32 v12, 0xc000, v12
v_mfma_f32_16x16x32_bf16 v[56:59], a[104:107], a[176:179], v[56:59]
v_add_u32 v13, 0xc000, v13
v_add_u32 v14, 0xc000, v14
v_mfma_f32_16x16x32_bf16 v[56:59], a[108:111], a[180:183], v[56:59]
v_add_u32 v15, 0xc000, v15
v_mfma_f32_16x16x32_bf16 v[60:63], a[104:107], a[184:187], v[60:63]
s_add_u32 s34, s56, 0
v_mfma_f32_16x16x32_bf16 v[60:63], a[108:111], a[188:191], v[60:63]
buffer_store_dwordx4 v[164:167], v16, s[16:19], s34 offen offset:0 sc1
v_mfma_f32_16x16x32_bf16 v[128:131], a[128:131], a[160:163], v[128:131]
v_mfma_f32_16x16x32_bf16 v[128:131], a[132:135], a[164:167], v[128:131]
v_mfma_f32_16x16x32_bf16 v[132:135], a[128:131], a[168:171], v[132:135]
v_mfma_f32_16x16x32_bf16 v[132:135], a[132:135], a[172:175], v[132:135]
v_mfma_f32_16x16x32_bf16 v[136:139], a[128:131], a[176:179], v[136:139]
s_waitcnt vmcnt(14) lgkmcnt(0)
s_barrier
s_cmp_lg_u32 s3, 0
s_cbranch_scc1 w0_concat_5
v_mov_b32 v31, 0
buffer_load_dword v21, v31, s[16:19], s62 offen sc1
buffer_load_dword v20, v31, s[16:19], s63 offen sc1
w0_concat_5:
v_mfma_f32_16x16x32_bf16 v[136:139], a[132:135], a[180:183], v[136:139]
s_add_u32 m0, s36, 49152
ds_read_b128 a[64:67], v10 offset:0
v_mfma_f32_16x16x32_bf16 v[140:143], a[128:131], a[184:187], v[140:143]
buffer_load_dwordx4 v2, s[64:67], s41 offen offset:0 lds
v_mfma_f32_16x16x32_bf16 v[140:143], a[132:135], a[188:191], v[140:143]
ds_read_b128 a[68:71], v11 offset:0
v_mfma_f32_16x16x32_bf16 v[64:67], a[136:139], a[160:163], v[64:67]
ds_read_b128 a[72:75], v10 offset:2048
v_mfma_f32_16x16x32_bf16 v[64:67], a[140:143], a[164:167], v[64:67]
ds_read_b128 a[76:79], v11 offset:2048
v_mfma_f32_16x16x32_bf16 v[68:71], a[136:139], a[168:171], v[68:71]
ds_read_b128 a[80:83], v10 offset:4096
v_mfma_f32_16x16x32_bf16 v[68:71], a[140:143], a[172:175], v[68:71]
buffer_load_dwordx4 v3, s[64:67], s41 offen offset:1024 lds
v_mfma_f32_16x16x32_bf16 v[72:75], a[136:139], a[176:179], v[72:75]
ds_read_b128 a[84:87], v11 offset:4096
v_mfma_f32_16x16x32_bf16 v[72:75], a[140:143], a[180:183], v[72:75]
ds_read_b128 a[88:91], v10 offset:6144
v_mfma_f32_16x16x32_bf16 v[76:79], a[136:139], a[184:187], v[76:79]
ds_read_b128 a[92:95], v11 offset:6144
v_mfma_f32_16x16x32_bf16 v[76:79], a[140:143], a[188:191], v[76:79]
ds_read_b64_tr_b16 a[96:97], v12 offset:0
v_mfma_f32_16x16x32_bf16 v[144:147], a[144:147], a[160:163], v[144:147]
buffer_load_dwordx4 v4, s[64:67], s41 offen offset:2048 lds
v_mfma_f32_16x16x32_bf16 v[144:147], a[148:151], a[164:167], v[144:147]
ds_read_b64_tr_b16 a[98:99], v12 offset:1024
v_mfma_f32_16x16x32_bf16 v[148:151], a[144:147], a[168:171], v[148:151]
ds_read_b64_tr_b16 a[100:101], v12 offset:8192
v_mfma_f32_16x16x32_bf16 v[148:151], a[148:151], a[172:175], v[148:151]
ds_read_b64_tr_b16 a[102:103], v12 offset:9216
v_mfma_f32_16x16x32_bf16 v[152:155], a[144:147], a[176:179], v[152:155]
ds_read_b64_tr_b16 a[104:105], v13 offset:0
v_mfma_f32_16x16x32_bf16 v[152:155], a[148:151], a[180:183], v[152:155]
buffer_load_dwordx4 v5, s[64:67], s41 offen offset:3072 lds
v_mfma_f32_16x16x32_bf16 v[156:159], a[144:147], a[184:187], v[156:159]
s_add_u32 m0, s36, 53248
ds_read_b64_tr_b16 a[106:107], v13 offset:1024
v_mfma_f32_16x16x32_bf16 v[156:159], a[148:151], a[188:191], v[156:159]
ds_read_b64_tr_b16 a[108:109], v13 offset:8192
v_mfma_f32_16x16x32_bf16 v[80:83], a[152:155], a[160:163], v[80:83]
ds_read_b64_tr_b16 a[110:111], v13 offset:9216
v_mfma_f32_16x16x32_bf16 v[80:83], a[156:159], a[164:167], v[80:83]
ds_read_b64_tr_b16 a[128:129], v14 offset:0
v_mfma_f32_16x16x32_bf16 v[84:87], a[152:155], a[168:171], v[84:87]
buffer_load_dwordx4 v2, s[64:67], s57 offen offset:0 lds
v_mfma_f32_16x16x32_bf16 v[84:87], a[156:159], a[172:175], v[84:87]
ds_read_b64_tr_b16 a[130:131], v14 offset:1024
v_mfma_f32_16x16x32_bf16 v[88:91], a[152:155], a[176:179], v[88:91]
ds_read_b64_tr_b16 a[132:133], v14 offset:8192
v_mfma_f32_16x16x32_bf16 v[88:91], a[156:159], a[180:183], v[88:91]
ds_read_b64_tr_b16 a[134:135], v14 offset:9216
v_mfma_f32_16x16x32_bf16 v[92:95], a[152:155], a[184:187], v[92:95]
v_mfma_f32_16x16x32_bf16 v[92:95], a[156:159], a[188:191], v[92:95]
s_waitcnt lgkmcnt(2)
v_mfma_f32_16x16x32_bf16 v[96:99], a[96:99], a[64:67], v[96:99]
buffer_load_dwordx4 v3, s[64:67], s57 offen offset:1024 lds
v_mfma_f32_16x16x32_bf16 v[96:99], a[100:103], a[68:71], v[96:99]
ds_read_b64_tr_b16 a[136:137], v15 offset:0
v_add_u32 v10, 0xfffe8000, v10
v_mfma_f32_16x16x32_bf16 v[100:103], a[96:99], a[72:75], v[100:103]
ds_read_b64_tr_b16 a[138:139], v15 offset:1024
v_add_u32 v11, 0xfffe8000, v11
v_mfma_f32_16x16x32_bf16 v[100:103], a[100:103], a[76:79], v[100:103]
ds_read_b64_tr_b16 a[140:141], v15 offset:8192
v_mfma_f32_16x16x32_bf16 v[104:107], a[96:99], a[80:83], v[104:107]
buffer_load_dwordx4 v4, s[64:67], s57 offen offset:2048 lds
v_mfma_f32_16x16x32_bf16 v[104:107], a[100:103], a[84:87], v[104:107]
ds_read_b64_tr_b16 a[142:143], v15 offset:9216
v_mfma_f32_16x16x32_bf16 v[108:111], a[96:99], a[88:91], v[108:111]
ds_read_b64_tr_b16 a[144:145], v12 offset:512
v_mfma_f32_16x16x32_bf16 v[108:111], a[100:103], a[92:95], v[108:111]
ds_read_b64_tr_b16 a[146:147], v12 offset:1536
v_mfma_f32_16x16x32_bf16 v[32:35], a[104:107], a[64:67], v[32:35]
buffer_load_dwordx4 v5, s[64:67], s57 offen offset:3072 lds
v_mfma_f32_16x16x32_bf16 v[32:35], a[108:111], a[68:71], v[32:35]
s_add_u32 m0, s35, 81920
ds_read_b64_tr_b16 a[148:149], v12 offset:8704
v_mfma_f32_16x16x32_bf16 v[36:39], a[104:107], a[72:75], v[36:39]
ds_read_b64_tr_b16 a[150:151], v12 offset:9728
v_mfma_f32_16x16x32_bf16 v[36:39], a[108:111], a[76:79], v[36:39]
ds_read_b64_tr_b16 a[152:153], v13 offset:512
v_mfma_f32_16x16x32_bf16 v[40:43], a[104:107], a[80:83], v[40:43]
buffer_load_dwordx4 v6, s[68:71], s58 offen offset:0 lds
v_mfma_f32_16x16x32_bf16 v[40:43], a[108:111], a[84:87], v[40:43]
ds_read_b64_tr_b16 a[154:155], v13 offset:1536
v_mfma_f32_16x16x32_bf16 v[44:47], a[104:107], a[88:91], v[44:47]
ds_read_b64_tr_b16 a[156:157], v13 offset:8704
v_mfma_f32_16x16x32_bf16 v[44:47], a[108:111], a[92:95], v[44:47]
ds_read_b64_tr_b16 a[158:159], v13 offset:9728
v_mfma_f32_16x16x32_bf16 v[112:115], a[128:131], a[64:67], v[112:115]
s_waitcnt lgkmcnt(4)
buffer_load_dwordx4 v7, s[68:71], s58 offen offset:1024 lds
v_mfma_f32_16x16x32_bf16 v[112:115], a[132:135], a[68:71], v[112:115]
ds_read_b64_tr_b16 a[96:97], v14 offset:512
v_mfma_f32_16x16x32_bf16 v[116:119], a[128:131], a[72:75], v[116:119]
ds_read_b64_tr_b16 a[98:99], v14 offset:1536
v_mfma_f32_16x16x32_bf16 v[116:119], a[132:135], a[76:79], v[116:119]
ds_read_b64_tr_b16 a[100:101], v14 offset:8704
v_mfma_f32_16x16x32_bf16 v[120:123], a[128:131], a[80:83], v[120:123]
buffer_load_dwordx4 v8, s[68:71], s58 offen offset:2048 lds
v_mfma_f32_16x16x32_bf16 v[120:123], a[132:135], a[84:87], v[120:123]
ds_read_b64_tr_b16 a[102:103], v14 offset:9728
v_mfma_f32_16x16x32_bf16 v[124:127], a[128:131], a[88:91], v[124:127]
ds_read_b64_tr_b16 a[104:105], v15 offset:512
v_mfma_f32_16x16x32_bf16 v[124:127], a[132:135], a[92:95], v[124:127]
ds_read_b64_tr_b16 a[106:107], v15 offset:1536
v_mfma_f32_16x16x32_bf16 v[48:51], a[136:139], a[64:67], v[48:51]
buffer_load_dwordx4 v9, s[68:71], s58 offen offset:3072 lds
v_mfma_f32_16x16x32_bf16 v[48:51], a[140:143], a[68:71], v[48:51]
s_add_u32 s41, s41, 128
s_add_u32 s57, s57, 128
s_add_u32 s58, s58, 524288
v_mfma_f32_16x16x32_bf16 v[52:55], a[136:139], a[72:75], v[52:55]
ds_read_b64_tr_b16 a[108:109], v15 offset:8704
v_mfma_f32_16x16x32_bf16 v[52:55], a[140:143], a[76:79], v[52:55]
ds_read_b64_tr_b16 a[110:111], v15 offset:9728
v_add_u32 v12, 0xfffe8000, v12
v_mfma_f32_16x16x32_bf16 v[56:59], a[136:139], a[80:83], v[56:59]
v_add_u32 v13, 0xfffe8000, v13
v_add_u32 v14, 0xfffe8000, v14
v_mfma_f32_16x16x32_bf16 v[56:59], a[140:143], a[84:87], v[56:59]
v_add_u32 v15, 0xfffe8000, v15
v_mfma_f32_16x16x32_bf16 v[60:63], a[136:139], a[88:91], v[60:63]
buffer_store_dwordx4 v[160:163], v16, s[16:19], s34 offen offset:1024 sc1
v_mfma_f32_16x16x32_bf16 v[60:63], a[140:143], a[92:95], v[60:63]
v_mfma_f32_16x16x32_bf16 v[128:131], a[144:147], a[64:67], v[128:131]
v_mfma_f32_16x16x32_bf16 v[128:131], a[148:151], a[68:71], v[128:131]
v_mfma_f32_16x16x32_bf16 v[132:135], a[144:147], a[72:75], v[132:135]
v_mfma_f32_16x16x32_bf16 v[132:135], a[148:151], a[76:79], v[132:135]
v_mfma_f32_16x16x32_bf16 v[136:139], a[144:147], a[80:83], v[136:139]
s_waitcnt vmcnt(14) lgkmcnt(0)
s_barrier
v_mfma_f32_16x16x32_bf16 v[136:139], a[148:151], a[84:87], v[136:139]
s_add_u32 m0, s36, 98304
ds_read_b128 a[160:163], v10 offset:0
v_mfma_f32_16x16x32_bf16 v[140:143], a[144:147], a[88:91], v[140:143]
buffer_load_dwordx4 v2, s[64:67], s41 offen offset:0 lds
v_mfma_f32_16x16x32_bf16 v[140:143], a[148:151], a[92:95], v[140:143]
ds_read_b128 a[164:167], v11 offset:0
v_mfma_f32_16x16x32_bf16 v[64:67], a[152:155], a[64:67], v[64:67]
ds_read_b128 a[168:171], v10 offset:2048
v_mfma_f32_16x16x32_bf16 v[64:67], a[156:159], a[68:71], v[64:67]
ds_read_b128 a[172:175], v11 offset:2048
v_mfma_f32_16x16x32_bf16 v[68:71], a[152:155], a[72:75], v[68:71]
ds_read_b128 a[176:179], v10 offset:4096
v_mfma_f32_16x16x32_bf16 v[68:71], a[156:159], a[76:79], v[68:71]
buffer_load_dwordx4 v3, s[64:67], s41 offen offset:1024 lds
v_mfma_f32_16x16x32_bf16 v[72:75], a[152:155], a[80:83], v[72:75]
ds_read_b128 a[180:183], v11 offset:4096
v_mfma_f32_16x16x32_bf16 v[72:75], a[156:159], a[84:87], v[72:75]
ds_read_b128 a[184:187], v10 offset:6144
v_mfma_f32_16x16x32_bf16 v[76:79], a[152:155], a[88:91], v[76:79]
ds_read_b128 a[188:191], v11 offset:6144
v_mfma_f32_16x16x32_bf16 v[76:79], a[156:159], a[92:95], v[76:79]
ds_read_b64_tr_b16 a[128:129], v12 offset:0
v_mfma_f32_16x16x32_bf16 v[144:147], a[96:99], a[64:67], v[144:147]
buffer_load_dwordx4 v4, s[64:67], s41 offen offset:2048 lds
v_mfma_f32_16x16x32_bf16 v[144:147], a[100:103], a[68:71], v[144:147]
ds_read_b64_tr_b16 a[130:131], v12 offset:1024
v_mfma_f32_16x16x32_bf16 v[148:151], a[96:99], a[72:75], v[148:151]
ds_read_b64_tr_b16 a[132:133], v12 offset:8192
v_mfma_f32_16x16x32_bf16 v[148:151], a[100:103], a[76:79], v[148:151]
ds_read_b64_tr_b16 a[134:135], v12 offset:9216
v_mfma_f32_16x16x32_bf16 v[152:155], a[96:99], a[80:83], v[152:155]
ds_read_b64_tr_b16 a[136:137], v13 offset:0
v_mfma_f32_16x16x32_bf16 v[152:155], a[100:103], a[84:87], v[152:155]
buffer_load_dwordx4 v5, s[64:67], s41 offen offset:3072 lds
v_mfma_f32_16x16x32_bf16 v[156:159], a[96:99], a[88:91], v[156:159]
s_add_u32 m0, s36, 102400
ds_read_b64_tr_b16 a[138:139], v13 offset:1024
v_mfma_f32_16x16x32_bf16 v[156:159], a[100:103], a[92:95], v[156:159]
ds_read_b64_tr_b16 a[140:141], v13 offset:8192
v_mfma_f32_16x16x32_bf16 v[80:83], a[104:107], a[64:67], v[80:83]
ds_read_b64_tr_b16 a[142:143], v13 offset:9216
v_mfma_f32_16x16x32_bf16 v[80:83], a[108:111], a[68:71], v[80:83]
ds_read_b64_tr_b16 a[144:145], v14 offset:0
v_mfma_f32_16x16x32_bf16 v[84:87], a[104:107], a[72:75], v[84:87]
buffer_load_dwordx4 v2, s[64:67], s57 offen offset:0 lds
v_mfma_f32_16x16x32_bf16 v[84:87], a[108:111], a[76:79], v[84:87]
ds_read_b64_tr_b16 a[146:147], v14 offset:1024
v_mfma_f32_16x16x32_bf16 v[88:91], a[104:107], a[80:83], v[88:91]
ds_read_b64_tr_b16 a[148:149], v14 offset:8192
v_mfma_f32_16x16x32_bf16 v[88:91], a[108:111], a[84:87], v[88:91]
ds_read_b64_tr_b16 a[150:151], v14 offset:9216
v_mfma_f32_16x16x32_bf16 v[92:95], a[104:107], a[88:91], v[92:95]
v_mfma_f32_16x16x32_bf16 v[92:95], a[108:111], a[92:95], v[92:95]
s_waitcnt lgkmcnt(2)
v_mfma_f32_16x16x32_bf16 v[96:99], a[128:131], a[160:163], v[96:99]
buffer_load_dwordx4 v3, s[64:67], s57 offen offset:1024 lds
v_mfma_f32_16x16x32_bf16 v[96:99], a[132:135], a[164:167], v[96:99]
ds_read_b64_tr_b16 a[152:153], v15 offset:0
v_add_u32 v10, 0xc000, v10
v_mfma_f32_16x16x32_bf16 v[100:103], a[128:131], a[168:171], v[100:103]
ds_read_b64_tr_b16 a[154:155], v15 offset:1024
v_add_u32 v11, 0xc000, v11
v_mfma_f32_16x16x32_bf16 v[100:103], a[132:135], a[172:175], v[100:103]
ds_read_b64_tr_b16 a[156:157], v15 offset:8192
v_mfma_f32_16x16x32_bf16 v[104:107], a[128:131], a[176:179], v[104:107]
buffer_load_dwordx4 v4, s[64:67], s57 offen offset:2048 lds
v_mfma_f32_16x16x32_bf16 v[104:107], a[132:135], a[180:183], v[104:107]
ds_read_b64_tr_b16 a[158:159], v15 offset:9216
v_mfma_f32_16x16x32_bf16 v[108:111], a[128:131], a[184:187], v[108:111]
ds_read_b64_tr_b16 a[96:97], v12 offset:512
v_mfma_f32_16x16x32_bf16 v[108:111], a[132:135], a[188:191], v[108:111]
ds_read_b64_tr_b16 a[98:99], v12 offset:1536
v_mfma_f32_16x16x32_bf16 v[32:35], a[136:139], a[160:163], v[32:35]
buffer_load_dwordx4 v5, s[64:67], s57 offen offset:3072 lds
v_mfma_f32_16x16x32_bf16 v[32:35], a[140:143], a[164:167], v[32:35]
s_add_u32 m0, s35, 131072
ds_read_b64_tr_b16 a[100:101], v12 offset:8704
v_mfma_f32_16x16x32_bf16 v[36:39], a[136:139], a[168:171], v[36:39]
ds_read_b64_tr_b16 a[102:103], v12 offset:9728
v_mfma_f32_16x16x32_bf16 v[36:39], a[140:143], a[172:175], v[36:39]
ds_read_b64_tr_b16 a[104:105], v13 offset:512
v_mfma_f32_16x16x32_bf16 v[40:43], a[136:139], a[176:179], v[40:43]
buffer_load_dwordx4 v6, s[68:71], s58 offen offset:0 lds
v_mfma_f32_16x16x32_bf16 v[40:43], a[140:143], a[180:183], v[40:43]
ds_read_b64_tr_b16 a[106:107], v13 offset:1536
v_mfma_f32_16x16x32_bf16 v[44:47], a[136:139], a[184:187], v[44:47]
ds_read_b64_tr_b16 a[108:109], v13 offset:8704
v_mfma_f32_16x16x32_bf16 v[44:47], a[140:143], a[188:191], v[44:47]
ds_read_b64_tr_b16 a[110:111], v13 offset:9728
v_mfma_f32_16x16x32_bf16 v[112:115], a[144:147], a[160:163], v[112:115]
s_waitcnt lgkmcnt(4)
buffer_load_dwordx4 v7, s[68:71], s58 offen offset:1024 lds
v_mfma_f32_16x16x32_bf16 v[112:115], a[148:151], a[164:167], v[112:115]
ds_read_b64_tr_b16 a[128:129], v14 offset:512
v_mfma_f32_16x16x32_bf16 v[116:119], a[144:147], a[168:171], v[116:119]
ds_read_b64_tr_b16 a[130:131], v14 offset:1536
v_mfma_f32_16x16x32_bf16 v[116:119], a[148:151], a[172:175], v[116:119]
ds_read_b64_tr_b16 a[132:133], v14 offset:8704
v_mfma_f32_16x16x32_bf16 v[120:123], a[144:147], a[176:179], v[120:123]
buffer_load_dwordx4 v8, s[68:71], s58 offen offset:2048 lds
v_mfma_f32_16x16x32_bf16 v[120:123], a[148:151], a[180:183], v[120:123]
ds_read_b64_tr_b16 a[134:135], v14 offset:9728
v_mfma_f32_16x16x32_bf16 v[124:127], a[144:147], a[184:187], v[124:127]
ds_read_b64_tr_b16 a[136:137], v15 offset:512
v_mfma_f32_16x16x32_bf16 v[124:127], a[148:151], a[188:191], v[124:127]
ds_read_b64_tr_b16 a[138:139], v15 offset:1536
v_mfma_f32_16x16x32_bf16 v[48:51], a[152:155], a[160:163], v[48:51]
buffer_load_dwordx4 v9, s[68:71], s58 offen offset:3072 lds
v_mfma_f32_16x16x32_bf16 v[48:51], a[156:159], a[164:167], v[48:51]
s_add_u32 s41, s41, 128
s_add_u32 s57, s57, 128
s_add_u32 s58, s58, 524288
v_mfma_f32_16x16x32_bf16 v[52:55], a[152:155], a[168:171], v[52:55]
ds_read_b64_tr_b16 a[140:141], v15 offset:8704
v_mfma_f32_16x16x32_bf16 v[52:55], a[156:159], a[172:175], v[52:55]
ds_read_b64_tr_b16 a[142:143], v15 offset:9728
v_add_u32 v12, 0xc000, v12
v_mfma_f32_16x16x32_bf16 v[56:59], a[152:155], a[176:179], v[56:59]
v_add_u32 v13, 0xc000, v13
v_add_u32 v14, 0xc000, v14
v_mfma_f32_16x16x32_bf16 v[56:59], a[156:159], a[180:183], v[56:59]
v_add_u32 v15, 0xc000, v15
v_mfma_f32_16x16x32_bf16 v[60:63], a[152:155], a[184:187], v[60:63]
buffer_store_dwordx4 v[168:171], v16, s[16:19], s34 offen offset:2048 sc1
v_mfma_f32_16x16x32_bf16 v[60:63], a[156:159], a[188:191], v[60:63]
v_mfma_f32_16x16x32_bf16 v[128:131], a[96:99], a[160:163], v[128:131]
v_mfma_f32_16x16x32_bf16 v[128:131], a[100:103], a[164:167], v[128:131]
v_mfma_f32_16x16x32_bf16 v[132:135], a[96:99], a[168:171], v[132:135]
v_mfma_f32_16x16x32_bf16 v[132:135], a[100:103], a[172:175], v[132:135]
v_mfma_f32_16x16x32_bf16 v[136:139], a[96:99], a[176:179], v[136:139]
s_waitcnt vmcnt(14) lgkmcnt(0)
s_cmp_lg_u32 s3, 0
s_cbranch_scc1 spinret_concat_7
v_readfirstlane_b32 s60, v21
s_cmp_lt_u32 s60, 10
s_cbranch_scc1 spin_concat_6
v_readfirstlane_b32 s60, v20
s_cmp_lt_u32 s60, 40
s_cbranch_scc1 spin_concat_6
spinret_concat_7:
s_barrier
v_mfma_f32_16x16x32_bf16 v[136:139], a[100:103], a[180:183], v[136:139]
s_add_u32 m0, s36, 0
ds_read_b128 a[64:67], v10 offset:0
v_mfma_f32_16x16x32_bf16 v[140:143], a[96:99], a[184:187], v[140:143]
buffer_load_dwordx4 v2, s[64:67], s41 offen offset:0 lds
v_mfma_f32_16x16x32_bf16 v[140:143], a[100:103], a[188:191], v[140:143]
ds_read_b128 a[68:71], v11 offset:0
v_mfma_f32_16x16x32_bf16 v[64:67], a[104:107], a[160:163], v[64:67]
ds_read_b128 a[72:75], v10 offset:2048
v_mfma_f32_16x16x32_bf16 v[64:67], a[108:111], a[164:167], v[64:67]
ds_read_b128 a[76:79], v11 offset:2048
v_mfma_f32_16x16x32_bf16 v[68:71], a[104:107], a[168:171], v[68:71]
ds_read_b128 a[80:83], v10 offset:4096
v_mfma_f32_16x16x32_bf16 v[68:71], a[108:111], a[172:175], v[68:71]
buffer_load_dwordx4 v3, s[64:67], s41 offen offset:1024 lds
v_mfma_f32_16x16x32_bf16 v[72:75], a[104:107], a[176:179], v[72:75]
ds_read_b128 a[84:87], v11 offset:4096
v_mfma_f32_16x16x32_bf16 v[72:75], a[108:111], a[180:183], v[72:75]
ds_read_b128 a[88:91], v10 offset:6144
v_mfma_f32_16x16x32_bf16 v[76:79], a[104:107], a[184:187], v[76:79]
ds_read_b128 a[92:95], v11 offset:6144
v_mfma_f32_16x16x32_bf16 v[76:79], a[108:111], a[188:191], v[76:79]
ds_read_b64_tr_b16 a[144:145], v12 offset:0
v_mfma_f32_16x16x32_bf16 v[144:147], a[128:131], a[160:163], v[144:147]
buffer_load_dwordx4 v4, s[64:67], s41 offen offset:2048 lds
v_mfma_f32_16x16x32_bf16 v[144:147], a[132:135], a[164:167], v[144:147]
ds_read_b64_tr_b16 a[146:147], v12 offset:1024
v_mfma_f32_16x16x32_bf16 v[148:151], a[128:131], a[168:171], v[148:151]
ds_read_b64_tr_b16 a[148:149], v12 offset:8192
v_mfma_f32_16x16x32_bf16 v[148:151], a[132:135], a[172:175], v[148:151]
ds_read_b64_tr_b16 a[150:151], v12 offset:9216
v_mfma_f32_16x16x32_bf16 v[152:155], a[128:131], a[176:179], v[152:155]
ds_read_b64_tr_b16 a[152:153], v13 offset:0
v_mfma_f32_16x16x32_bf16 v[152:155], a[132:135], a[180:183], v[152:155]
buffer_load_dwordx4 v5, s[64:67], s41 offen offset:3072 lds
v_mfma_f32_16x16x32_bf16 v[156:159], a[128:131], a[184:187], v[156:159]
s_add_u32 m0, s36, 4096
ds_read_b64_tr_b16 a[154:155], v13 offset:1024
v_mfma_f32_16x16x32_bf16 v[156:159], a[132:135], a[188:191], v[156:159]
ds_read_b64_tr_b16 a[156:157], v13 offset:8192
v_mfma_f32_16x16x32_bf16 v[80:83], a[136:139], a[160:163], v[80:83]
ds_read_b64_tr_b16 a[158:159], v13 offset:9216
v_mfma_f32_16x16x32_bf16 v[80:83], a[140:143], a[164:167], v[80:83]
ds_read_b64_tr_b16 a[96:97], v14 offset:0
v_mfma_f32_16x16x32_bf16 v[84:87], a[136:139], a[168:171], v[84:87]
buffer_load_dwordx4 v2, s[64:67], s57 offen offset:0 lds
v_mfma_f32_16x16x32_bf16 v[84:87], a[140:143], a[172:175], v[84:87]
ds_read_b64_tr_b16 a[98:99], v14 offset:1024
v_mfma_f32_16x16x32_bf16 v[88:91], a[136:139], a[176:179], v[88:91]
ds_read_b64_tr_b16 a[100:101], v14 offset:8192
v_mfma_f32_16x16x32_bf16 v[88:91], a[140:143], a[180:183], v[88:91]
ds_read_b64_tr_b16 a[102:103], v14 offset:9216
v_mfma_f32_16x16x32_bf16 v[92:95], a[136:139], a[184:187], v[92:95]
v_mfma_f32_16x16x32_bf16 v[92:95], a[140:143], a[188:191], v[92:95]
s_waitcnt lgkmcnt(2)
v_mfma_f32_16x16x32_bf16 v[96:99], a[144:147], a[64:67], v[96:99]
buffer_load_dwordx4 v3, s[64:67], s57 offen offset:1024 lds
v_mfma_f32_16x16x32_bf16 v[96:99], a[148:151], a[68:71], v[96:99]
ds_read_b64_tr_b16 a[104:105], v15 offset:0
v_add_u32 v10, 0xc000, v10
v_mfma_f32_16x16x32_bf16 v[100:103], a[144:147], a[72:75], v[100:103]
ds_read_b64_tr_b16 a[106:107], v15 offset:1024
v_add_u32 v11, 0xc000, v11
v_mfma_f32_16x16x32_bf16 v[100:103], a[148:151], a[76:79], v[100:103]
s_lshl_b32 s62, s4, 8
ds_read_b64_tr_b16 a[108:109], v15 offset:8192
v_mfma_f32_16x16x32_bf16 v[104:107], a[144:147], a[80:83], v[104:107]
buffer_load_dwordx4 v4, s[64:67], s57 offen offset:2048 lds
v_mfma_f32_16x16x32_bf16 v[104:107], a[148:151], a[84:87], v[104:107]
s_add_u32 s62, s62, 64159744
ds_read_b64_tr_b16 a[110:111], v15 offset:9216
v_mfma_f32_16x16x32_bf16 v[108:111], a[144:147], a[88:91], v[108:111]
s_lshl_b32 s63, s88, 8
ds_read_b64_tr_b16 a[128:129], v12 offset:512
v_mfma_f32_16x16x32_bf16 v[108:111], a[148:151], a[92:95], v[108:111]
s_add_u32 s63, s63, 64167936
ds_read_b64_tr_b16 a[130:131], v12 offset:1536
v_mfma_f32_16x16x32_bf16 v[32:35], a[152:155], a[64:67], v[32:35]
buffer_load_dwordx4 v5, s[64:67], s57 offen offset:3072 lds
v_mfma_f32_16x16x32_bf16 v[32:35], a[156:159], a[68:71], v[32:35]
s_add_u32 m0, s35, 32768
ds_read_b64_tr_b16 a[132:133], v12 offset:8704
v_mfma_f32_16x16x32_bf16 v[36:39], a[152:155], a[72:75], v[36:39]
ds_read_b64_tr_b16 a[134:135], v12 offset:9728
v_mfma_f32_16x16x32_bf16 v[36:39], a[156:159], a[76:79], v[36:39]
ds_read_b64_tr_b16 a[136:137], v13 offset:512
v_mfma_f32_16x16x32_bf16 v[40:43], a[152:155], a[80:83], v[40:43]
buffer_load_dwordx4 v6, s[68:71], s58 offen offset:0 lds
v_mfma_f32_16x16x32_bf16 v[40:43], a[156:159], a[84:87], v[40:43]
ds_read_b64_tr_b16 a[138:139], v13 offset:1536
v_mfma_f32_16x16x32_bf16 v[44:47], a[152:155], a[88:91], v[44:47]
ds_read_b64_tr_b16 a[140:141], v13 offset:8704
v_mfma_f32_16x16x32_bf16 v[44:47], a[156:159], a[92:95], v[44:47]
ds_read_b64_tr_b16 a[142:143], v13 offset:9728
v_mfma_f32_16x16x32_bf16 v[112:115], a[96:99], a[64:67], v[112:115]
s_waitcnt lgkmcnt(4)
buffer_load_dwordx4 v7, s[68:71], s58 offen offset:1024 lds
v_mfma_f32_16x16x32_bf16 v[112:115], a[100:103], a[68:71], v[112:115]
ds_read_b64_tr_b16 a[144:145], v14 offset:512
v_mfma_f32_16x16x32_bf16 v[116:119], a[96:99], a[72:75], v[116:119]
ds_read_b64_tr_b16 a[146:147], v14 offset:1536
v_mfma_f32_16x16x32_bf16 v[116:119], a[100:103], a[76:79], v[116:119]
ds_read_b64_tr_b16 a[148:149], v14 offset:8704
v_mfma_f32_16x16x32_bf16 v[120:123], a[96:99], a[80:83], v[120:123]
buffer_load_dwordx4 v8, s[68:71], s58 offen offset:2048 lds
v_mfma_f32_16x16x32_bf16 v[120:123], a[100:103], a[84:87], v[120:123]
ds_read_b64_tr_b16 a[150:151], v14 offset:9728
v_mfma_f32_16x16x32_bf16 v[124:127], a[96:99], a[88:91], v[124:127]
ds_read_b64_tr_b16 a[152:153], v15 offset:512
v_mfma_f32_16x16x32_bf16 v[124:127], a[100:103], a[92:95], v[124:127]
ds_read_b64_tr_b16 a[154:155], v15 offset:1536
v_mfma_f32_16x16x32_bf16 v[48:51], a[104:107], a[64:67], v[48:51]
buffer_load_dwordx4 v9, s[68:71], s58 offen offset:3072 lds
v_mfma_f32_16x16x32_bf16 v[48:51], a[108:111], a[68:71], v[48:51]
s_add_u32 s41, s41, 128
s_add_u32 s57, s57, 128
s_add_u32 s58, s58, 524288
v_mfma_f32_16x16x32_bf16 v[52:55], a[104:107], a[72:75], v[52:55]
ds_read_b64_tr_b16 a[156:157], v15 offset:8704
v_mfma_f32_16x16x32_bf16 v[52:55], a[108:111], a[76:79], v[52:55]
ds_read_b64_tr_b16 a[158:159], v15 offset:9728
v_add_u32 v12, 0xc000, v12
v_mfma_f32_16x16x32_bf16 v[56:59], a[104:107], a[80:83], v[56:59]
v_add_u32 v13, 0xc000, v13
v_add_u32 v14, 0xc000, v14
v_mfma_f32_16x16x32_bf16 v[56:59], a[108:111], a[84:87], v[56:59]
v_add_u32 v15, 0xc000, v15
v_mfma_f32_16x16x32_bf16 v[60:63], a[104:107], a[88:91], v[60:63]
buffer_store_dwordx4 v[176:179], v16, s[16:19], s34 offen offset:3072 sc1
v_mfma_f32_16x16x32_bf16 v[60:63], a[108:111], a[92:95], v[60:63]
v_mfma_f32_16x16x32_bf16 v[128:131], a[128:131], a[64:67], v[128:131]
v_mfma_f32_16x16x32_bf16 v[128:131], a[132:135], a[68:71], v[128:131]
v_mfma_f32_16x16x32_bf16 v[132:135], a[128:131], a[72:75], v[132:135]
v_mfma_f32_16x16x32_bf16 v[132:135], a[132:135], a[76:79], v[132:135]
v_mfma_f32_16x16x32_bf16 v[136:139], a[128:131], a[80:83], v[136:139]
s_waitcnt vmcnt(14) lgkmcnt(0)
s_barrier
v_mfma_f32_16x16x32_bf16 v[136:139], a[132:135], a[84:87], v[136:139]
s_add_u32 m0, s35, 65536
ds_read_b128 a[160:163], v10 offset:0
v_mfma_f32_16x16x32_bf16 v[140:143], a[128:131], a[88:91], v[140:143]
buffer_load_dwordx4 v2, s[72:75], s37 offen offset:0 lds
v_mfma_f32_16x16x32_bf16 v[140:143], a[132:135], a[92:95], v[140:143]
ds_read_b128 a[164:167], v11 offset:0
v_mfma_f32_16x16x32_bf16 v[64:67], a[136:139], a[64:67], v[64:67]
ds_read_b128 a[168:171], v10 offset:2048
v_mfma_f32_16x16x32_bf16 v[64:67], a[140:143], a[68:71], v[64:67]
ds_read_b128 a[172:175], v11 offset:2048
v_mfma_f32_16x16x32_bf16 v[68:71], a[136:139], a[72:75], v[68:71]
ds_read_b128 a[176:179], v10 offset:4096
v_mfma_f32_16x16x32_bf16 v[68:71], a[140:143], a[76:79], v[68:71]
buffer_load_dwordx4 v3, s[72:75], s37 offen offset:1024 lds
v_mfma_f32_16x16x32_bf16 v[72:75], a[136:139], a[80:83], v[72:75]
ds_read_b128 a[180:183], v11 offset:4096
v_mfma_f32_16x16x32_bf16 v[72:75], a[140:143], a[84:87], v[72:75]
ds_read_b128 a[184:187], v10 offset:6144
v_mfma_f32_16x16x32_bf16 v[76:79], a[136:139], a[88:91], v[76:79]
ds_read_b128 a[188:191], v11 offset:6144
v_mfma_f32_16x16x32_bf16 v[76:79], a[140:143], a[92:95], v[76:79]
ds_read_b64_tr_b16 a[96:97], v12 offset:0
v_mfma_f32_16x16x32_bf16 v[144:147], a[144:147], a[64:67], v[144:147]
buffer_load_dwordx4 v4, s[72:75], s37 offen offset:2048 lds
v_mfma_f32_16x16x32_bf16 v[144:147], a[148:151], a[68:71], v[144:147]
ds_read_b64_tr_b16 a[98:99], v12 offset:1024
v_mfma_f32_16x16x32_bf16 v[148:151], a[144:147], a[72:75], v[148:151]
ds_read_b64_tr_b16 a[100:101], v12 offset:8192
v_mfma_f32_16x16x32_bf16 v[148:151], a[148:151], a[76:79], v[148:151]
ds_read_b64_tr_b16 a[102:103], v12 offset:9216
v_mfma_f32_16x16x32_bf16 v[152:155], a[144:147], a[80:83], v[152:155]
ds_read_b64_tr_b16 a[104:105], v13 offset:0
v_mfma_f32_16x16x32_bf16 v[152:155], a[148:151], a[84:87], v[152:155]
buffer_load_dwordx4 v5, s[72:75], s37 offen offset:3072 lds
v_mfma_f32_16x16x32_bf16 v[156:159], a[144:147], a[88:91], v[156:159]
s_add_u32 m0, s35, 81920
ds_read_b64_tr_b16 a[106:107], v13 offset:1024
v_mfma_f32_16x16x32_bf16 v[156:159], a[148:151], a[92:95], v[156:159]
ds_read_b64_tr_b16 a[108:109], v13 offset:8192
v_mfma_f32_16x16x32_bf16 v[80:83], a[152:155], a[64:67], v[80:83]
ds_read_b64_tr_b16 a[110:111], v13 offset:9216
v_mfma_f32_16x16x32_bf16 v[80:83], a[156:159], a[68:71], v[80:83]
ds_read_b64_tr_b16 a[128:129], v14 offset:0
v_mfma_f32_16x16x32_bf16 v[84:87], a[152:155], a[72:75], v[84:87]
buffer_load_dwordx4 v16, s[16:19], s40 offen offset:0 sc1 lds
v_mfma_f32_16x16x32_bf16 v[84:87], a[156:159], a[76:79], v[84:87]
ds_read_b64_tr_b16 a[130:131], v14 offset:1024
v_mfma_f32_16x16x32_bf16 v[88:91], a[152:155], a[80:83], v[88:91]
ds_read_b64_tr_b16 a[132:133], v14 offset:8192
v_mfma_f32_16x16x32_bf16 v[88:91], a[156:159], a[84:87], v[88:91]
ds_read_b64_tr_b16 a[134:135], v14 offset:9216
v_mfma_f32_16x16x32_bf16 v[92:95], a[152:155], a[88:91], v[92:95]
v_mfma_f32_16x16x32_bf16 v[92:95], a[156:159], a[92:95], v[92:95]
s_waitcnt lgkmcnt(2)
v_mfma_f32_16x16x32_bf16 v[96:99], a[96:99], a[160:163], v[96:99]
buffer_load_dwordx4 v16, s[16:19], s40 offen offset:1024 sc1 lds
v_mfma_f32_16x16x32_bf16 v[96:99], a[100:103], a[164:167], v[96:99]
ds_read_b64_tr_b16 a[136:137], v15 offset:0
v_add_u32 v10, 0xfffe8000, v10
v_mfma_f32_16x16x32_bf16 v[100:103], a[96:99], a[168:171], v[100:103]
ds_read_b64_tr_b16 a[138:139], v15 offset:1024
v_add_u32 v11, 0xfffe8000, v11
v_mfma_f32_16x16x32_bf16 v[100:103], a[100:103], a[172:175], v[100:103]
ds_read_b64_tr_b16 a[140:141], v15 offset:8192
v_mov_b32 v24, s31
v_mfma_f32_16x16x32_bf16 v[104:107], a[96:99], a[176:179], v[104:107]
ds_read_b64_tr_b16 a[142:143], v15 offset:9216
v_mfma_f32_16x16x32_bf16 v[104:107], a[100:103], a[180:183], v[104:107]
buffer_load_dwordx4 v16, s[16:19], s40 offen offset:2048 sc1 lds
v_mfma_f32_16x16x32_bf16 v[108:111], a[96:99], a[184:187], v[108:111]
ds_read_b64_tr_b16 a[144:145], v12 offset:512
v_mfma_f32_16x16x32_bf16 v[108:111], a[100:103], a[188:191], v[108:111]
ds_read_b64_tr_b16 a[146:147], v12 offset:1536
v_mfma_f32_16x16x32_bf16 v[32:35], a[104:107], a[160:163], v[32:35]
ds_read_b64_tr_b16 a[148:149], v12 offset:8704
v_mfma_f32_16x16x32_bf16 v[32:35], a[108:111], a[164:167], v[32:35]
ds_read_b64_tr_b16 a[150:151], v12 offset:9728
v_mfma_f32_16x16x32_bf16 v[36:39], a[104:107], a[168:171], v[36:39]
buffer_load_dwordx4 v16, s[16:19], s40 offen offset:3072 sc1 lds
v_mfma_f32_16x16x32_bf16 v[36:39], a[108:111], a[172:175], v[36:39]
s_add_u32 s37, s37, 128
s_add_u32 s40, s40, 16384
v_mfma_f32_16x16x32_bf16 v[40:43], a[104:107], a[176:179], v[40:43]
ds_read_b64_tr_b16 a[152:153], v13 offset:512
v_mfma_f32_16x16x32_bf16 v[40:43], a[108:111], a[180:183], v[40:43]
ds_read_b64_tr_b16 a[154:155], v13 offset:1536
v_mfma_f32_16x16x32_bf16 v[44:47], a[104:107], a[184:187], v[44:47]
ds_read_b64_tr_b16 a[156:157], v13 offset:8704
v_mfma_f32_16x16x32_bf16 v[44:47], a[108:111], a[188:191], v[44:47]
ds_read_b64_tr_b16 a[158:159], v13 offset:9728
v_mfma_f32_16x16x32_bf16 v[112:115], a[128:131], a[160:163], v[112:115]
s_waitcnt lgkmcnt(4)
ds_read_b64_tr_b16 a[96:97], v14 offset:512
v_mfma_f32_16x16x32_bf16 v[112:115], a[132:135], a[164:167], v[112:115]
ds_read_b64_tr_b16 a[98:99], v14 offset:1536
v_mfma_f32_16x16x32_bf16 v[116:119], a[128:131], a[168:171], v[116:119]
ds_read_b64_tr_b16 a[100:101], v14 offset:8704
v_mfma_f32_16x16x32_bf16 v[116:119], a[132:135], a[172:175], v[116:119]
ds_read_b64_tr_b16 a[102:103], v14 offset:9728
v_mfma_f32_16x16x32_bf16 v[120:123], a[128:131], a[176:179], v[120:123]
ds_read_b64_tr_b16 a[104:105], v15 offset:512
v_mfma_f32_16x16x32_bf16 v[120:123], a[132:135], a[180:183], v[120:123]
ds_read_b64_tr_b16 a[106:107], v15 offset:1536
v_mfma_f32_16x16x32_bf16 v[124:127], a[128:131], a[184:187], v[124:127]
s_add_u32 s34, s55, 131072
ds_read_b64_tr_b16 a[108:109], v15 offset:8704
v_mfma_f32_16x16x32_bf16 v[124:127], a[132:135], a[188:191], v[124:127]
buffer_store_dwordx4 v[204:207], v16, s[16:19], s34 offen offset:0 sc1
v_mfma_f32_16x16x32_bf16 v[48:51], a[136:139], a[160:163], v[48:51]
ds_read_b64_tr_b16 a[110:111], v15 offset:9728
v_add_u32 v12, 0xfffe8000, v12
v_mfma_f32_16x16x32_bf16 v[48:51], a[140:143], a[164:167], v[48:51]
v_add_u32 v13, 0xfffe8000, v13
v_add_u32 v14, 0xfffe8000, v14
v_mfma_f32_16x16x32_bf16 v[52:55], a[136:139], a[168:171], v[52:55]
v_add_u32 v15, 0xfffe8000, v15
v_mfma_f32_16x16x32_bf16 v[52:55], a[140:143], a[172:175], v[52:55]
global_load_dword v28, v[26:27], off
v_mfma_f32_16x16x32_bf16 v[56:59], a[136:139], a[176:179], v[56:59]
v_mfma_f32_16x16x32_bf16 v[56:59], a[140:143], a[180:183], v[56:59]
buffer_store_dwordx4 v[216:219], v16, s[16:19], s34 offen offset:1024 sc1
v_mfma_f32_16x16x32_bf16 v[60:63], a[136:139], a[184:187], v[60:63]
v_mfma_f32_16x16x32_bf16 v[60:63], a[140:143], a[188:191], v[60:63]
v_mfma_f32_16x16x32_bf16 v[128:131], a[144:147], a[160:163], v[128:131]
v_mfma_f32_16x16x32_bf16 v[128:131], a[148:151], a[164:167], v[128:131]
v_mfma_f32_16x16x32_bf16 v[132:135], a[144:147], a[168:171], v[132:135]
v_mfma_f32_16x16x32_bf16 v[132:135], a[148:151], a[172:175], v[132:135]
v_mfma_f32_16x16x32_bf16 v[136:139], a[144:147], a[176:179], v[136:139]
s_waitcnt vmcnt(12) lgkmcnt(0)
s_barrier
v_mfma_f32_16x16x32_bf16 v[136:139], a[148:151], a[180:183], v[136:139]
s_add_u32 m0, s35, 98304
ds_read_b128 a[64:67], v10 offset:0
v_mfma_f32_16x16x32_bf16 v[140:143], a[144:147], a[184:187], v[140:143]
buffer_load_dwordx4 v2, s[72:75], s37 offen offset:0 lds
v_mfma_f32_16x16x32_bf16 v[140:143], a[148:151], a[188:191], v[140:143]
ds_read_b128 a[68:71], v11 offset:0
v_mfma_f32_16x16x32_bf16 v[64:67], a[152:155], a[160:163], v[64:67]
ds_read_b128 a[72:75], v10 offset:2048
v_mfma_f32_16x16x32_bf16 v[64:67], a[156:159], a[164:167], v[64:67]
ds_read_b128 a[76:79], v11 offset:2048
v_mfma_f32_16x16x32_bf16 v[68:71], a[152:155], a[168:171], v[68:71]
ds_read_b128 a[80:83], v10 offset:4096
v_mfma_f32_16x16x32_bf16 v[68:71], a[156:159], a[172:175], v[68:71]
buffer_load_dwordx4 v3, s[72:75], s37 offen offset:1024 lds
v_mfma_f32_16x16x32_bf16 v[72:75], a[152:155], a[176:179], v[72:75]
ds_read_b128 a[84:87], v11 offset:4096
v_mfma_f32_16x16x32_bf16 v[72:75], a[156:159], a[180:183], v[72:75]
ds_read_b128 a[88:91], v10 offset:6144
v_mfma_f32_16x16x32_bf16 v[76:79], a[152:155], a[184:187], v[76:79]
ds_read_b128 a[92:95], v11 offset:6144
v_mfma_f32_16x16x32_bf16 v[76:79], a[156:159], a[188:191], v[76:79]
ds_read_b64_tr_b16 a[128:129], v12 offset:0
v_mfma_f32_16x16x32_bf16 v[144:147], a[96:99], a[160:163], v[144:147]
buffer_load_dwordx4 v4, s[72:75], s37 offen offset:2048 lds
v_mfma_f32_16x16x32_bf16 v[144:147], a[100:103], a[164:167], v[144:147]
ds_read_b64_tr_b16 a[130:131], v12 offset:1024
v_mfma_f32_16x16x32_bf16 v[148:151], a[96:99], a[168:171], v[148:151]
ds_read_b64_tr_b16 a[132:133], v12 offset:8192
v_mfma_f32_16x16x32_bf16 v[148:151], a[100:103], a[172:175], v[148:151]
ds_read_b64_tr_b16 a[134:135], v12 offset:9216
v_mfma_f32_16x16x32_bf16 v[152:155], a[96:99], a[176:179], v[152:155]
ds_read_b64_tr_b16 a[136:137], v13 offset:0
v_mfma_f32_16x16x32_bf16 v[152:155], a[100:103], a[180:183], v[152:155]
buffer_load_dwordx4 v5, s[72:75], s37 offen offset:3072 lds
v_mfma_f32_16x16x32_bf16 v[156:159], a[96:99], a[184:187], v[156:159]
s_add_u32 m0, s35, 114688
ds_read_b64_tr_b16 a[138:139], v13 offset:1024
v_mfma_f32_16x16x32_bf16 v[156:159], a[100:103], a[188:191], v[156:159]
ds_read_b64_tr_b16 a[140:141], v13 offset:8192
v_mfma_f32_16x16x32_bf16 v[80:83], a[104:107], a[160:163], v[80:83]
ds_read_b64_tr_b16 a[142:143], v13 offset:9216
v_mfma_f32_16x16x32_bf16 v[80:83], a[108:111], a[164:167], v[80:83]
ds_read_b64_tr_b16 a[144:145], v14 offset:0
v_mfma_f32_16x16x32_bf16 v[84:87], a[104:107], a[168:171], v[84:87]
buffer_load_dwordx4 v16, s[16:19], s40 offen offset:0 sc1 lds
v_mfma_f32_16x16x32_bf16 v[84:87], a[108:111], a[172:175], v[84:87]
ds_read_b64_tr_b16 a[146:147], v14 offset:1024
v_mfma_f32_16x16x32_bf16 v[88:91], a[104:107], a[176:179], v[88:91]
ds_read_b64_tr_b16 a[148:149], v14 offset:8192
v_mfma_f32_16x16x32_bf16 v[88:91], a[108:111], a[180:183], v[88:91]
ds_read_b64_tr_b16 a[150:151], v14 offset:9216
v_mfma_f32_16x16x32_bf16 v[92:95], a[104:107], a[184:187], v[92:95]
v_mfma_f32_16x16x32_bf16 v[92:95], a[108:111], a[188:191], v[92:95]
s_waitcnt lgkmcnt(2)
v_mfma_f32_16x16x32_bf16 v[96:99], a[128:131], a[64:67], v[96:99]
buffer_load_dwordx4 v16, s[16:19], s40 offen offset:1024 sc1 lds
v_mfma_f32_16x16x32_bf16 v[96:99], a[132:135], a[68:71], v[96:99]
ds_read_b64_tr_b16 a[152:153], v15 offset:0
v_mfma_f32_16x16x32_bf16 v[100:103], a[128:131], a[72:75], v[100:103]
ds_read_b64_tr_b16 a[154:155], v15 offset:1024
v_mfma_f32_16x16x32_bf16 v[100:103], a[132:135], a[76:79], v[100:103]
ds_read_b64_tr_b16 a[156:157], v15 offset:8192
v_mfma_f32_16x16x32_bf16 v[104:107], a[128:131], a[80:83], v[104:107]
ds_read_b64_tr_b16 a[158:159], v15 offset:9216
v_mfma_f32_16x16x32_bf16 v[104:107], a[132:135], a[84:87], v[104:107]
buffer_load_dwordx4 v16, s[16:19], s40 offen offset:2048 sc1 lds
v_mfma_f32_16x16x32_bf16 v[108:111], a[128:131], a[88:91], v[108:111]
ds_read_b64_tr_b16 a[96:97], v12 offset:512
v_mfma_f32_16x16x32_bf16 v[108:111], a[132:135], a[92:95], v[108:111]
ds_read_b64_tr_b16 a[98:99], v12 offset:1536
v_mfma_f32_16x16x32_bf16 v[32:35], a[136:139], a[64:67], v[32:35]
ds_read_b64_tr_b16 a[100:101], v12 offset:8704
v_mfma_f32_16x16x32_bf16 v[32:35], a[140:143], a[68:71], v[32:35]
ds_read_b64_tr_b16 a[102:103], v12 offset:9728
v_mul_f32 v96, s31, v96
v_mfma_f32_16x16x32_bf16 v[36:39], a[136:139], a[72:75], v[36:39]
buffer_load_dwordx4 v16, s[16:19], s40 offen offset:3072 sc1 lds
v_mfma_f32_16x16x32_bf16 v[36:39], a[140:143], a[76:79], v[36:39]
s_add_u32 s37, s37, 128
s_add_u32 s40, s40, 16384
v_mul_f32 v97, s31, v97
v_mfma_f32_16x16x32_bf16 v[40:43], a[136:139], a[80:83], v[40:43]
s_lshl_b32 s32, s3, 10
v_add_u32 v17, s32, v16
v_mov_b32 v18, 0x100000
v_mfma_f32_16x16x32_bf16 v[40:43], a[140:143], a[84:87], v[40:43]
ds_read_b64_tr_b16 a[104:105], v13 offset:512
v_cmp_gt_u32 vcc, 1600, v17
v_mfma_f32_16x16x32_bf16 v[44:47], a[136:139], a[88:91], v[44:47]
s_add_u32 m0, s32, 139264
s_mul_i32 s33, s88, 1600
v_cndmask_b32 v17, v18, v17, vcc
v_mfma_f32_16x16x32_bf16 v[44:47], a[140:143], a[92:95], v[44:47]
buffer_load_dwordx4 v17, s[76:79], s33 offen lds
v_mfma_f32_16x16x32_bf16 v[112:115], a[144:147], a[64:67], v[112:115]
s_waitcnt lgkmcnt(1)
ds_read_b64_tr_b16 a[106:107], v13 offset:1536
v_mul_f32 v98, s31, v98
v_mfma_f32_16x16x32_bf16 v[112:115], a[148:151], a[68:71], v[112:115]
ds_read_b64_tr_b16 a[108:109], v13 offset:8704
v_mul_f32 v99, s31, v99
v_mfma_f32_16x16x32_bf16 v[116:119], a[144:147], a[72:75], v[116:119]
ds_read_b64_tr_b16 a[110:111], v13 offset:9728
v_cvt_pk_bf16_f32 v96, v96, v97
v_mfma_f32_16x16x32_bf16 v[116:119], a[148:151], a[76:79], v[116:119]
ds_read_b64_tr_b16 a[128:129], v14 offset:512
v_cvt_pk_bf16_f32 v97, v98, v99
v_mfma_f32_16x16x32_bf16 v[120:123], a[144:147], a[80:83], v[120:123]
ds_read_b64_tr_b16 a[130:131], v14 offset:1536
v_mul_f32 v100, s31, v100
v_mfma_f32_16x16x32_bf16 v[120:123], a[148:151], a[84:87], v[120:123]
ds_read_b64_tr_b16 a[132:133], v14 offset:8704
v_mul_f32 v101, s31, v101
v_mfma_f32_16x16x32_bf16 v[124:127], a[144:147], a[88:91], v[124:127]
ds_read_b64_tr_b16 a[134:135], v14 offset:9728
v_mul_f32 v102, s31, v102
v_mfma_f32_16x16x32_bf16 v[124:127], a[148:151], a[92:95], v[124:127]
ds_read_b64_tr_b16 a[136:137], v15 offset:512
v_mul_f32 v103, s31, v103
v_mfma_f32_16x16x32_bf16 v[48:51], a[152:155], a[64:67], v[48:51]
ds_read_b64_tr_b16 a[138:139], v15 offset:1536
v_cvt_pk_bf16_f32 v100, v100, v101
v_mfma_f32_16x16x32_bf16 v[48:51], a[156:159], a[68:71], v[48:51]
ds_read_b64_tr_b16 a[140:141], v15 offset:8704
v_cvt_pk_bf16_f32 v101, v102, v103
v_mfma_f32_16x16x32_bf16 v[52:55], a[152:155], a[72:75], v[52:55]
s_add_u32 s34, s55, 135168
ds_read_b64_tr_b16 a[142:143], v15 offset:9728
v_mfma_f32_16x16x32_bf16 v[52:55], a[156:159], a[76:79], v[52:55]
buffer_store_dwordx4 v[212:215], v16, s[16:19], s34 offen offset:0 sc1
v_mfma_f32_16x16x32_bf16 v[56:59], a[152:155], a[80:83], v[56:59]
v_add_u32 v10, s35, v22
v_add_u32 v10, 0x10000, v10
v_mfma_f32_16x16x32_bf16 v[56:59], a[156:159], a[84:87], v[56:59]
v_xor_b32 v11, 64, v10
v_add_u32 v12, 0x10000, v16
v_mfma_f32_16x16x32_bf16 v[60:63], a[152:155], a[88:91], v[60:63]
v_mul_f32 v104, s31, v104
v_mul_f32 v105, s31, v105
v_mfma_f32_16x16x32_bf16 v[60:63], a[156:159], a[92:95], v[60:63]
buffer_store_dwordx4 v[220:223], v16, s[16:19], s34 offen offset:1024 sc1
v_mfma_f32_16x16x32_bf16 v[128:131], a[96:99], a[64:67], v[128:131]
v_mul_f32 v106, s31, v106
v_mul_f32 v107, s31, v107
v_mfma_f32_16x16x32_bf16 v[128:131], a[100:103], a[68:71], v[128:131]
v_cvt_pk_bf16_f32 v104, v104, v105
v_cvt_pk_bf16_f32 v105, v106, v107
v_mfma_f32_16x16x32_bf16 v[132:135], a[96:99], a[72:75], v[132:135]
v_mul_f32 v108, s31, v108
v_mul_f32 v109, s31, v109
v_mfma_f32_16x16x32_bf16 v[132:135], a[100:103], a[76:79], v[132:135]
v_mul_f32 v110, s31, v110
v_mul_f32 v111, s31, v111
v_mfma_f32_16x16x32_bf16 v[136:139], a[96:99], a[80:83], v[136:139]
s_waitcnt vmcnt(14) lgkmcnt(0)
s_barrier
s_cmp_lg_u32 s3, 0
s_cbranch_scc1 w0_concat_8
v_mov_b32 v31, 0
v_mov_b32 v29, 1
s_mov_b64 exec, 1
s_mov_b32 s60, s62
buffer_atomic_add v29, v31, s[16:19], s60 offen sc1
s_mov_b64 exec, -1
w0_concat_8:
v_mfma_f32_16x16x32_bf16 v[136:139], a[100:103], a[84:87], v[136:139]
s_add_u32 m0, s35, 0
ds_read_b128 a[160:163], v10 offset:0
v_mfma_f32_16x16x32_bf16 v[140:143], a[96:99], a[88:91], v[140:143]
buffer_load_dwordx4 v2, s[72:75], s37 offen offset:0 lds
v_mfma_f32_16x16x32_bf16 v[140:143], a[100:103], a[92:95], v[140:143]
ds_read_b128 a[164:167], v11 offset:0
v_cvt_pk_bf16_f32 v108, v108, v109
v_mfma_f32_16x16x32_bf16 v[64:67], a[104:107], a[64:67], v[64:67]
ds_read_b128 a[168:171], v10 offset:2048
v_cvt_pk_bf16_f32 v109, v110, v111
v_mfma_f32_16x16x32_bf16 v[64:67], a[108:111], a[68:71], v[64:67]
buffer_load_dwordx4 v3, s[72:75], s37 offen offset:1024 lds
v_mfma_f32_16x16x32_bf16 v[68:71], a[104:107], a[72:75], v[68:71]
ds_read_b128 a[172:175], v11 offset:2048
v_mul_f32 v32, s31, v32
v_mfma_f32_16x16x32_bf16 v[68:71], a[108:111], a[76:79], v[68:71]
ds_read_b128 a[0:3], v12 offset:16384
v_mul_f32 v33, s31, v33
v_mfma_f32_16x16x32_bf16 v[72:75], a[104:107], a[80:83], v[72:75]
buffer_load_dwordx4 v4, s[72:75], s37 offen offset:2048 lds
v_mfma_f32_16x16x32_bf16 v[72:75], a[108:111], a[84:87], v[72:75]
ds_read_b128 a[4:7], v12 offset:24576
v_mul_f32 v34, s31, v34
v_mfma_f32_16x16x32_bf16 v[76:79], a[104:107], a[88:91], v[76:79]
ds_read_b128 a[8:11], v12 offset:17408
v_mul_f32 v35, s31, v35
v_mfma_f32_16x16x32_bf16 v[76:79], a[108:111], a[92:95], v[76:79]
buffer_load_dwordx4 v5, s[72:75], s37 offen offset:3072 lds
v_mfma_f32_16x16x32_bf16 v[144:147], a[128:131], a[64:67], v[144:147]
s_add_u32 m0, s35, 16384
ds_read_b128 a[12:15], v12 offset:25600
v_mfma_f32_16x16x32_bf16 v[144:147], a[132:135], a[68:71], v[144:147]
ds_read_b128 a[16:19], v12 offset:18432
v_cvt_pk_bf16_f32 v98, v32, v33
v_mfma_f32_16x16x32_bf16 v[148:151], a[128:131], a[72:75], v[148:151]
buffer_load_dwordx4 v16, s[16:19], s40 offen offset:0 sc1 lds
v_mfma_f32_16x16x32_bf16 v[148:151], a[132:135], a[76:79], v[148:151]
ds_read_b128 a[20:23], v12 offset:26624
v_cvt_pk_bf16_f32 v99, v34, v35
v_mfma_f32_16x16x32_bf16 v[152:155], a[128:131], a[80:83], v[152:155]
ds_read_b128 a[24:27], v12 offset:19456
v_mul_f32 v36, s31, v36
v_mfma_f32_16x16x32_bf16 v[152:155], a[132:135], a[84:87], v[152:155]
buffer_load_dwordx4 v16, s[16:19], s40 offen offset:1024 sc1 lds
v_mfma_f32_16x16x32_bf16 v[156:159], a[128:131], a[88:91], v[156:159]
ds_read_b128 a[28:31], v12 offset:27648
v_mul_f32 v37, s31, v37
v_mfma_f32_16x16x32_bf16 v[156:159], a[132:135], a[92:95], v[156:159]
ds_read_b128 a[32:35], v12 offset:20480
v_mul_f32 v38, s31, v38
v_mfma_f32_16x16x32_bf16 v[80:83], a[136:139], a[64:67], v[80:83]
buffer_load_dwordx4 v16, s[16:19], s40 offen offset:2048 sc1 lds
v_mfma_f32_16x16x32_bf16 v[80:83], a[140:143], a[68:71], v[80:83]
ds_read_b128 a[36:39], v12 offset:28672
v_mul_f32 v39, s31, v39
v_mfma_f32_16x16x32_bf16 v[84:87], a[136:139], a[72:75], v[84:87]
ds_read_b128 a[40:43], v12 offset:21504
v_cvt_pk_bf16_f32 v102, v36, v37
v_mfma_f32_16x16x32_bf16 v[84:87], a[140:143], a[76:79], v[84:87]
buffer_load_dwordx4 v16, s[16:19], s40 offen offset:3072 sc1 lds
v_mfma_f32_16x16x32_bf16 v[88:91], a[136:139], a[80:83], v[88:91]
s_add_u32 s37, s37, 128
s_add_u32 s40, s40, 16384
v_cvt_pk_bf16_f32 v103, v38, v39
v_mfma_f32_16x16x32_bf16 v[88:91], a[140:143], a[84:87], v[88:91]
ds_read_b128 a[44:47], v12 offset:29696
v_mul_f32 v40, s31, v40
v_mfma_f32_16x16x32_bf16 v[92:95], a[136:139], a[88:91], v[92:95]
ds_read_b128 a[48:51], v12 offset:22528
v_mul_f32 v41, s31, v41
v_mfma_f32_16x16x32_bf16 v[92:95], a[140:143], a[92:95], v[92:95]
ds_read_b128 a[52:55], v12 offset:30720
v_mul_f32 v42, s31, v42
ds_read_b128 a[56:59], v12 offset:23552
ds_read_b128 a[60:63], v12 offset:31744
v_mul_f32 v43, s31, v43
v_cvt_pk_bf16_f32 v106, v40, v41
v_cvt_pk_bf16_f32 v107, v42, v43
v_pk_mul_f32 v[44:45], v[44:45], v[24:25] op_sel_hi:[1,0]
v_pk_mul_f32 v[46:47], v[46:47], v[24:25] op_sel_hi:[1,0]
v_cvt_pk_bf16_f32 v110, v44, v45
v_cvt_pk_bf16_f32 v111, v46, v47
v_pk_mul_f32 v[112:113], v[112:113], v[24:25] op_sel_hi:[1,0]
v_pk_mul_f32 v[114:115], v[114:115], v[24:25] op_sel_hi:[1,0]
v_cvt_pk_bf16_f32 v112, v112, v113
v_cvt_pk_bf16_f32 v113, v114, v115
v_pk_mul_f32 v[116:117], v[116:117], v[24:25] op_sel_hi:[1,0]
v_pk_mul_f32 v[118:119], v[118:119], v[24:25] op_sel_hi:[1,0]
v_cvt_pk_bf16_f32 v116, v116, v117
v_cvt_pk_bf16_f32 v117, v118, v119
v_pk_mul_f32 v[120:121], v[120:121], v[24:25] op_sel_hi:[1,0]
v_pk_mul_f32 v[122:123], v[122:123], v[24:25] op_sel_hi:[1,0]
v_cvt_pk_bf16_f32 v120, v120, v121
v_cvt_pk_bf16_f32 v121, v122, v123
v_pk_mul_f32 v[124:125], v[124:125], v[24:25] op_sel_hi:[1,0]
v_pk_mul_f32 v[126:127], v[126:127], v[24:25] op_sel_hi:[1,0]
v_cvt_pk_bf16_f32 v124, v124, v125
v_cvt_pk_bf16_f32 v125, v126, v127
v_pk_mul_f32 v[48:49], v[48:49], v[24:25] op_sel_hi:[1,0]
v_pk_mul_f32 v[50:51], v[50:51], v[24:25] op_sel_hi:[1,0]
v_cvt_pk_bf16_f32 v114, v48, v49
v_cvt_pk_bf16_f32 v115, v50, v51
s_waitcnt lgkmcnt(0)
v_mfma_f32_16x16x32_bf16 v[160:163], a[0:3], a[160:163], 0
s_waitcnt vmcnt(11)
s_barrier
v_mfma_f32_16x16x32_bf16 v[160:163], a[4:7], a[164:167], v[160:163]
s_add_u32 m0, s35, 32768
ds_read_b128 a[176:179], v10 offset:32768
v_mfma_f32_16x16x32_bf16 v[164:167], a[0:3], a[168:171], 0
buffer_load_dwordx4 v2, s[72:75], s37 offen offset:0 lds
v_mfma_f32_16x16x32_bf16 v[164:167], a[4:7], a[172:175], v[164:167]
ds_read_b128 a[180:183], v11 offset:32768
v_mul_f32 v52, s31, v52
v_mfma_f32_16x16x32_bf16 v[168:171], a[8:11], a[160:163], 0
ds_read_b128 a[184:187], v10 offset:34816
v_mul_f32 v53, s31, v53
v_mfma_f32_16x16x32_bf16 v[168:171], a[12:15], a[164:167], v[168:171]
buffer_load_dwordx4 v3, s[72:75], s37 offen offset:1024 lds
v_mfma_f32_16x16x32_bf16 v[172:175], a[8:11], a[168:171], 0
ds_read_b128 a[188:191], v11 offset:34816
v_mul_f32 v54, s31, v54
v_mfma_f32_16x16x32_bf16 v[172:175], a[12:15], a[172:175], v[172:175]
ds_read_b128 a[64:67], v12 offset:49152
v_mul_f32 v55, s31, v55
v_mfma_f32_16x16x32_bf16 v[176:179], a[16:19], a[160:163], 0
buffer_load_dwordx4 v4, s[72:75], s37 offen offset:2048 lds
v_mfma_f32_16x16x32_bf16 v[176:179], a[20:23], a[164:167], v[176:179]
ds_read_b128 a[68:71], v12 offset:57344
v_cvt_pk_bf16_f32 v118, v52, v53
v_mfma_f32_16x16x32_bf16 v[180:183], a[16:19], a[168:171], 0
ds_read_b128 a[72:75], v12 offset:50176
v_cvt_pk_bf16_f32 v119, v54, v55
v_mfma_f32_16x16x32_bf16 v[180:183], a[20:23], a[172:175], v[180:183]
buffer_load_dwordx4 v5, s[72:75], s37 offen offset:3072 lds
v_mfma_f32_16x16x32_bf16 v[184:187], a[24:27], a[160:163], 0
s_add_u32 m0, s35, 49152
ds_read_b128 a[76:79], v12 offset:58368
v_mfma_f32_16x16x32_bf16 v[184:187], a[28:31], a[164:167], v[184:187]
ds_read_b128 a[80:83], v12 offset:51200
v_mul_f32 v56, s31, v56
v_mfma_f32_16x16x32_bf16 v[188:191], a[24:27], a[168:171], 0
buffer_load_dwordx4 v16, s[16:19], s40 offen offset:0 sc1 lds
v_mfma_f32_16x16x32_bf16 v[188:191], a[28:31], a[172:175], v[188:191]
ds_read_b128 a[84:87], v12 offset:59392
v_mul_f32 v57, s31, v57
v_mfma_f32_16x16x32_bf16 v[32:35], a[32:35], a[160:163], 0
ds_read_b128 a[88:91], v12 offset:52224
v_mul_f32 v58, s31, v58
v_mfma_f32_16x16x32_bf16 v[32:35], a[36:39], a[164:167], v[32:35]
buffer_load_dwordx4 v16, s[16:19], s40 offen offset:1024 sc1 lds
v_mfma_f32_16x16x32_bf16 v[36:39], a[32:35], a[168:171], 0
ds_read_b128 a[92:95], v12 offset:60416
v_mul_f32 v59, s31, v59
v_mfma_f32_16x16x32_bf16 v[36:39], a[36:39], a[172:175], v[36:39]
ds_read_b128 a[96:99], v12 offset:53248
v_cvt_pk_bf16_f32 v122, v56, v57
v_mfma_f32_16x16x32_bf16 v[40:43], a[160:163], a[40:43], 0
buffer_load_dwordx4 v16, s[16:19], s40 offen offset:2048 sc1 lds
v_mfma_f32_16x16x32_bf16 v[40:43], a[164:167], a[44:47], v[40:43]
ds_read_b128 a[100:103], v12 offset:61440
v_cvt_pk_bf16_f32 v123, v58, v59
v_mfma_f32_16x16x32_bf16 v[44:47], a[168:171], a[40:43], 0
ds_read_b128 a[104:107], v12 offset:54272
v_mul_f32 v60, s31, v60
v_mfma_f32_16x16x32_bf16 v[44:47], a[172:175], a[44:47], v[44:47]
buffer_load_dwordx4 v16, s[16:19], s40 offen offset:3072 sc1 lds
v_mfma_f32_16x16x32_bf16 v[48:51], a[160:163], a[48:51], 0
s_add_u32 s37, s37, 128
s_add_u32 s40, s40, 16384
v_mul_f32 v61, s31, v61
v_mfma_f32_16x16x32_bf16 v[48:51], a[164:167], a[52:55], v[48:51]
ds_read_b128 a[108:111], v12 offset:62464
v_mul_f32 v62, s31, v62
v_mfma_f32_16x16x32_bf16 v[52:55], a[168:171], a[48:51], 0
ds_read_b128 a[112:115], v12 offset:55296
v_mul_f32 v63, s31, v63
v_mfma_f32_16x16x32_bf16 v[52:55], a[172:175], a[52:55], v[52:55]
ds_read_b128 a[116:119], v12 offset:63488
v_cvt_pk_bf16_f32 v126, v60, v61
v_mfma_f32_16x16x32_bf16 v[56:59], a[160:163], a[56:59], 0
ds_read_b128 a[120:123], v12 offset:56320
v_cvt_pk_bf16_f32 v127, v62, v63
v_mfma_f32_16x16x32_bf16 v[56:59], a[164:167], a[60:63], v[56:59]
ds_read_b128 a[124:127], v12 offset:64512
v_mfma_f32_16x16x32_bf16 v[60:63], a[168:171], a[56:59], 0
v_mfma_f32_16x16x32_bf16 v[60:63], a[172:175], a[60:63], v[60:63]
s_waitcnt lgkmcnt(0)
v_mfma_f32_16x16x32_bf16 v[160:163], a[64:67], a[176:179], v[160:163]
s_waitcnt vmcnt(8)
s_barrier
v_xor_b32 v10, 0x10000, v10
v_xor_b32 v11, 0x10000, v11
v_xor_b32 v12, 0x10000, v12
v_mfma_f32_16x16x32_bf16 v[160:163], a[68:71], a[180:183], v[160:163]
s_add_u32 m0, s35, 65536
ds_read_b128 a[160:163], v10 offset:0
v_mfma_f32_16x16x32_bf16 v[164:167], a[64:67], a[184:187], v[164:167]
buffer_load_dwordx4 v2, s[72:75], s37 offen offset:0 lds
v_mfma_f32_16x16x32_bf16 v[164:167], a[68:71], a[188:191], v[164:167]
ds_read_b128 a[164:167], v11 offset:0
v_mul_f32 v128, s31, v128
v_mfma_f32_16x16x32_bf16 v[168:171], a[72:75], a[176:179], v[168:171]
ds_read_b128 a[168:171], v10 offset:2048
v_mul_f32 v129, s31, v129
v_mfma_f32_16x16x32_bf16 v[168:171], a[76:79], a[180:183], v[168:171]
buffer_load_dwordx4 v3, s[72:75], s37 offen offset:1024 lds
v_mfma_f32_16x16x32_bf16 v[172:175], a[72:75], a[184:187], v[172:175]
ds_read_b128 a[172:175], v11 offset:2048
v_mul_f32 v130, s31, v130
v_mfma_f32_16x16x32_bf16 v[172:175], a[76:79], a[188:191], v[172:175]
ds_read_b128 a[0:3], v12 offset:16384
v_mul_f32 v131, s31, v131
v_mfma_f32_16x16x32_bf16 v[176:179], a[80:83], a[176:179], v[176:179]
buffer_load_dwordx4 v4, s[72:75], s37 offen offset:2048 lds
v_mfma_f32_16x16x32_bf16 v[176:179], a[84:87], a[180:183], v[176:179]
ds_read_b128 a[4:7], v12 offset:24576
v_cvt_pk_bf16_f32 v128, v128, v129
v_mfma_f32_16x16x32_bf16 v[180:183], a[80:83], a[184:187], v[180:183]
ds_read_b128 a[8:11], v12 offset:17408
v_cvt_pk_bf16_f32 v129, v130, v131
v_mfma_f32_16x16x32_bf16 v[180:183], a[84:87], a[188:191], v[180:183]
buffer_load_dwordx4 v5, s[72:75], s37 offen offset:3072 lds
v_mfma_f32_16x16x32_bf16 v[184:187], a[88:91], a[176:179], v[184:187]
s_add_u32 m0, s35, 81920
ds_read_b128 a[12:15], v12 offset:25600
v_mfma_f32_16x16x32_bf16 v[184:187], a[92:95], a[180:183], v[184:187]
ds_read_b128 a[16:19], v12 offset:18432
v_mul_f32 v132, s31, v132
v_mfma_f32_16x16x32_bf16 v[188:191], a[88:91], a[184:187], v[188:191]
buffer_load_dwordx4 v16, s[16:19], s40 offen offset:0 sc1 lds
v_mfma_f32_16x16x32_bf16 v[188:191], a[92:95], a[188:191], v[188:191]
ds_read_b128 a[20:23], v12 offset:26624
v_mul_f32 v133, s31, v133
v_mfma_f32_16x16x32_bf16 v[32:35], a[96:99], a[176:179], v[32:35]
ds_read_b128 a[24:27], v12 offset:19456
v_mul_f32 v134, s31, v134
v_mfma_f32_16x16x32_bf16 v[32:35], a[100:103], a[180:183], v[32:35]
buffer_load_dwordx4 v16, s[16:19], s40 offen offset:1024 sc1 lds
v_mfma_f32_16x16x32_bf16 v[36:39], a[96:99], a[184:187], v[36:39]
ds_read_b128 a[28:31], v12 offset:27648
v_mul_f32 v135, s31, v135
v_mfma_f32_16x16x32_bf16 v[36:39], a[100:103], a[188:191], v[36:39]
ds_read_b128 a[32:35], v12 offset:20480
v_cvt_pk_bf16_f32 v132, v132, v133
v_mfma_f32_16x16x32_bf16 v[40:43], a[176:179], a[104:107], v[40:43]
buffer_load_dwordx4 v16, s[16:19], s40 offen offset:2048 sc1 lds
v_mfma_f32_16x16x32_bf16 v[40:43], a[180:183], a[108:111], v[40:43]
ds_read_b128 a[36:39], v12 offset:28672
v_cvt_pk_bf16_f32 v133, v134, v135
v_mfma_f32_16x16x32_bf16 v[44:47], a[184:187], a[104:107], v[44:47]
ds_read_b128 a[40:43], v12 offset:21504
v_mul_f32 v136, s31, v136
v_mfma_f32_16x16x32_bf16 v[44:47], a[188:191], a[108:111], v[44:47]
buffer_load_dwordx4 v16, s[16:19], s40 offen offset:3072 sc1 lds
v_mfma_f32_16x16x32_bf16 v[48:51], a[176:179], a[112:115], v[48:51]
s_add_u32 s37, s37, 128
s_add_u32 s40, s40, 16384
v_mul_f32 v137, s31, v137
v_mfma_f32_16x16x32_bf16 v[48:51], a[180:183], a[116:119], v[48:51]
ds_read_b128 a[44:47], v12 offset:29696
v_mul_f32 v138, s31, v138
v_mfma_f32_16x16x32_bf16 v[52:55], a[184:187], a[112:115], v[52:55]
ds_read_b128 a[48:51], v12 offset:22528
v_mul_f32 v139, s31, v139
v_mfma_f32_16x16x32_bf16 v[52:55], a[188:191], a[116:119], v[52:55]
ds_read_b128 a[52:55], v12 offset:30720
v_cvt_pk_bf16_f32 v136, v136, v137
v_mfma_f32_16x16x32_bf16 v[56:59], a[176:179], a[120:123], v[56:59]
ds_read_b128 a[56:59], v12 offset:23552
v_cvt_pk_bf16_f32 v137, v138, v139
v_mfma_f32_16x16x32_bf16 v[56:59], a[180:183], a[124:127], v[56:59]
ds_read_b128 a[60:63], v12 offset:31744
v_mfma_f32_16x16x32_bf16 v[60:63], a[184:187], a[120:123], v[60:63]
v_mfma_f32_16x16x32_bf16 v[60:63], a[188:191], a[124:127], v[60:63]
s_waitcnt lgkmcnt(0)
v_mfma_f32_16x16x32_bf16 v[160:163], a[0:3], a[160:163], v[160:163]
s_waitcnt vmcnt(8)
s_barrier
v_mfma_f32_16x16x32_bf16 v[160:163], a[4:7], a[164:167], v[160:163]
s_add_u32 m0, s35, 98304
ds_read_b128 a[176:179], v10 offset:32768
v_mfma_f32_16x16x32_bf16 v[164:167], a[0:3], a[168:171], v[164:167]
buffer_load_dwordx4 v2, s[72:75], s37 offen offset:0 lds
v_mfma_f32_16x16x32_bf16 v[164:167], a[4:7], a[172:175], v[164:167]
ds_read_b128 a[180:183], v11 offset:32768
v_mul_f32 v140, s31, v140
v_mfma_f32_16x16x32_bf16 v[168:171], a[8:11], a[160:163], v[168:171]
ds_read_b128 a[184:187], v10 offset:34816
v_mul_f32 v141, s31, v141
v_mfma_f32_16x16x32_bf16 v[168:171], a[12:15], a[164:167], v[168:171]
buffer_load_dwordx4 v3, s[72:75], s37 offen offset:1024 lds
v_mfma_f32_16x16x32_bf16 v[172:175], a[8:11], a[168:171], v[172:175]
ds_read_b128 a[188:191], v11 offset:34816
v_mul_f32 v142, s31, v142
v_mfma_f32_16x16x32_bf16 v[172:175], a[12:15], a[172:175], v[172:175]
ds_read_b128 a[64:67], v12 offset:49152
v_mul_f32 v143, s31, v143
v_mfma_f32_16x16x32_bf16 v[176:179], a[16:19], a[160:163], v[176:179]
buffer_load_dwordx4 v4, s[72:75], s37 offen offset:2048 lds
v_mfma_f32_16x16x32_bf16 v[176:179], a[20:23], a[164:167], v[176:179]
ds_read_b128 a[68:71], v12 offset:57344
v_cvt_pk_bf16_f32 v140, v140, v141
v_mfma_f32_16x16x32_bf16 v[180:183], a[16:19], a[168:171], v[180:183]
ds_read_b128 a[72:75], v12 offset:50176
v_cvt_pk_bf16_f32 v141, v142, v143
v_mfma_f32_16x16x32_bf16 v[180:183], a[20:23], a[172:175], v[180:183]
buffer_load_dwordx4 v5, s[72:75], s37 offen offset:3072 lds
v_mfma_f32_16x16x32_bf16 v[184:187], a[24:27], a[160:163], v[184:187]
s_add_u32 m0, s35, 114688
ds_read_b128 a[76:79], v12 offset:58368
v_mfma_f32_16x16x32_bf16 v[184:187], a[28:31], a[164:167], v[184:187]
ds_read_b128 a[80:83], v12 offset:51200
v_mul_f32 v64, s31, v64
v_mfma_f32_16x16x32_bf16 v[188:191], a[24:27], a[168:171], v[188:191]
buffer_load_dwordx4 v16, s[16:19], s40 offen offset:0 sc1 lds
v_mfma_f32_16x16x32_bf16 v[188:191], a[28:31], a[172:175], v[188:191]
ds_read_b128 a[84:87], v12 offset:59392
v_mul_f32 v65, s31, v65
v_mfma_f32_16x16x32_bf16 v[32:35], a[32:35], a[160:163], v[32:35]
ds_read_b128 a[88:91], v12 offset:52224
v_mul_f32 v66, s31, v66
v_mfma_f32_16x16x32_bf16 v[32:35], a[36:39], a[164:167], v[32:35]
buffer_load_dwordx4 v16, s[16:19], s40 offen offset:1024 sc1 lds
v_mfma_f32_16x16x32_bf16 v[36:39], a[32:35], a[168:171], v[36:39]
ds_read_b128 a[92:95], v12 offset:60416
v_mul_f32 v67, s31, v67
v_mfma_f32_16x16x32_bf16 v[36:39], a[36:39], a[172:175], v[36:39]
ds_read_b128 a[96:99], v12 offset:53248
v_cvt_pk_bf16_f32 v130, v64, v65
v_mfma_f32_16x16x32_bf16 v[40:43], a[160:163], a[40:43], v[40:43]
buffer_load_dwordx4 v16, s[16:19], s40 offen offset:2048 sc1 lds
v_mfma_f32_16x16x32_bf16 v[40:43], a[164:167], a[44:47], v[40:43]
ds_read_b128 a[100:103], v12 offset:61440
v_cvt_pk_bf16_f32 v131, v66, v67
v_mfma_f32_16x16x32_bf16 v[44:47], a[168:171], a[40:43], v[44:47]
ds_read_b128 a[104:107], v12 offset:54272
v_mul_f32 v68, s31, v68
v_mfma_f32_16x16x32_bf16 v[44:47], a[172:175], a[44:47], v[44:47]
buffer_load_dwordx4 v16, s[16:19], s40 offen offset:3072 sc1 lds
v_mfma_f32_16x16x32_bf16 v[48:51], a[160:163], a[48:51], v[48:51]
s_add_u32 s37, s37, 128
s_add_u32 s40, s40, 16384
v_mul_f32 v69, s31, v69
v_mfma_f32_16x16x32_bf16 v[48:51], a[164:167], a[52:55], v[48:51]
ds_read_b128 a[108:111], v12 offset:62464
v_mul_f32 v70, s31, v70
v_mfma_f32_16x16x32_bf16 v[52:55], a[168:171], a[48:51], v[52:55]
ds_read_b128 a[112:115], v12 offset:55296
v_mul_f32 v71, s31, v71
v_mfma_f32_16x16x32_bf16 v[52:55], a[172:175], a[52:55], v[52:55]
ds_read_b128 a[116:119], v12 offset:63488
v_cvt_pk_bf16_f32 v134, v68, v69
v_mfma_f32_16x16x32_bf16 v[56:59], a[160:163], a[56:59], v[56:59]
ds_read_b128 a[120:123], v12 offset:56320
v_cvt_pk_bf16_f32 v135, v70, v71
v_mfma_f32_16x16x32_bf16 v[56:59], a[164:167], a[60:63], v[56:59]
ds_read_b128 a[124:127], v12 offset:64512
v_mfma_f32_16x16x32_bf16 v[60:63], a[168:171], a[56:59], v[60:63]
v_mfma_f32_16x16x32_bf16 v[60:63], a[172:175], a[60:63], v[60:63]
s_waitcnt lgkmcnt(0)
v_mfma_f32_16x16x32_bf16 v[160:163], a[64:67], a[176:179], v[160:163]
s_waitcnt vmcnt(8)
s_barrier
v_xor_b32 v10, 0x10000, v10
v_xor_b32 v11, 0x10000, v11
v_xor_b32 v12, 0x10000, v12
v_mfma_f32_16x16x32_bf16 v[160:163], a[68:71], a[180:183], v[160:163]
s_add_u32 m0, s35, 0
ds_read_b128 a[160:163], v10 offset:0
v_mfma_f32_16x16x32_bf16 v[164:167], a[64:67], a[184:187], v[164:167]
buffer_load_dwordx4 v2, s[72:75], s37 offen offset:0 lds
v_mfma_f32_16x16x32_bf16 v[164:167], a[68:71], a[188:191], v[164:167]
ds_read_b128 a[164:167], v11 offset:0
v_mul_f32 v72, s31, v72
v_mfma_f32_16x16x32_bf16 v[168:171], a[72:75], a[176:179], v[168:171]
ds_read_b128 a[168:171], v10 offset:2048
v_mul_f32 v73, s31, v73
v_mfma_f32_16x16x32_bf16 v[168:171], a[76:79], a[180:183], v[168:171]
buffer_load_dwordx4 v3, s[72:75], s37 offen offset:1024 lds
v_mfma_f32_16x16x32_bf16 v[172:175], a[72:75], a[184:187], v[172:175]
ds_read_b128 a[172:175], v11 offset:2048
v_mul_f32 v74, s31, v74
v_mfma_f32_16x16x32_bf16 v[172:175], a[76:79], a[188:191], v[172:175]
ds_read_b128 a[0:3], v12 offset:16384
v_mul_f32 v75, s31, v75
v_mfma_f32_16x16x32_bf16 v[176:179], a[80:83], a[176:179], v[176:179]
buffer_load_dwordx4 v4, s[72:75], s37 offen offset:2048 lds
v_mfma_f32_16x16x32_bf16 v[176:179], a[84:87], a[180:183], v[176:179]
ds_read_b128 a[4:7], v12 offset:24576
v_cvt_pk_bf16_f32 v138, v72, v73
v_mfma_f32_16x16x32_bf16 v[180:183], a[80:83], a[184:187], v[180:183]
ds_read_b128 a[8:11], v12 offset:17408
v_cvt_pk_bf16_f32 v139, v74, v75
v_mfma_f32_16x16x32_bf16 v[180:183], a[84:87], a[188:191], v[180:183]
buffer_load_dwordx4 v5, s[72:75], s37 offen offset:3072 lds
v_mfma_f32_16x16x32_bf16 v[184:187], a[88:91], a[176:179], v[184:187]
s_add_u32 m0, s35, 16384
ds_read_b128 a[12:15], v12 offset:25600
v_mfma_f32_16x16x32_bf16 v[184:187], a[92:95], a[180:183], v[184:187]
ds_read_b128 a[16:19], v12 offset:18432
v_mul_f32 v76, s31, v76
v_mfma_f32_16x16x32_bf16 v[188:191], a[88:91], a[184:187], v[188:191]
buffer_load_dwordx4 v16, s[16:19], s40 offen offset:0 sc1 lds
v_mfma_f32_16x16x32_bf16 v[188:191], a[92:95], a[188:191], v[188:191]
ds_read_b128 a[20:23], v12 offset:26624
v_mul_f32 v77, s31, v77
v_mfma_f32_16x16x32_bf16 v[32:35], a[96:99], a[176:179], v[32:35]
ds_read_b128 a[24:27], v12 offset:19456
v_mul_f32 v78, s31, v78
v_mfma_f32_16x16x32_bf16 v[32:35], a[100:103], a[180:183], v[32:35]
buffer_load_dwordx4 v16, s[16:19], s40 offen offset:1024 sc1 lds
v_mfma_f32_16x16x32_bf16 v[36:39], a[96:99], a[184:187], v[36:39]
ds_read_b128 a[28:31], v12 offset:27648
v_mul_f32 v79, s31, v79
v_mfma_f32_16x16x32_bf16 v[36:39], a[100:103], a[188:191], v[36:39]
ds_read_b128 a[32:35], v12 offset:20480
v_cvt_pk_bf16_f32 v142, v76, v77
v_mfma_f32_16x16x32_bf16 v[40:43], a[176:179], a[104:107], v[40:43]
buffer_load_dwordx4 v16, s[16:19], s40 offen offset:2048 sc1 lds
v_mfma_f32_16x16x32_bf16 v[40:43], a[180:183], a[108:111], v[40:43]
ds_read_b128 a[36:39], v12 offset:28672
v_cvt_pk_bf16_f32 v143, v78, v79
v_mfma_f32_16x16x32_bf16 v[44:47], a[184:187], a[104:107], v[44:47]
ds_read_b128 a[40:43], v12 offset:21504
v_mul_f32 v144, s31, v144
v_mfma_f32_16x16x32_bf16 v[44:47], a[188:191], a[108:111], v[44:47]
buffer_load_dwordx4 v16, s[16:19], s40 offen offset:3072 sc1 lds
v_mfma_f32_16x16x32_bf16 v[48:51], a[176:179], a[112:115], v[48:51]
s_add_u32 s37, s37, 128
s_add_u32 s40, s40, 16384
v_mul_f32 v145, s31, v145
v_mfma_f32_16x16x32_bf16 v[48:51], a[180:183], a[116:119], v[48:51]
ds_read_b128 a[44:47], v12 offset:29696
v_mul_f32 v146, s31, v146
v_mfma_f32_16x16x32_bf16 v[52:55], a[184:187], a[112:115], v[52:55]
ds_read_b128 a[48:51], v12 offset:22528
v_mul_f32 v147, s31, v147
v_mfma_f32_16x16x32_bf16 v[52:55], a[188:191], a[116:119], v[52:55]
ds_read_b128 a[52:55], v12 offset:30720
v_cvt_pk_bf16_f32 v144, v144, v145
v_mfma_f32_16x16x32_bf16 v[56:59], a[176:179], a[120:123], v[56:59]
ds_read_b128 a[56:59], v12 offset:23552
v_cvt_pk_bf16_f32 v145, v146, v147
v_mfma_f32_16x16x32_bf16 v[56:59], a[180:183], a[124:127], v[56:59]
ds_read_b128 a[60:63], v12 offset:31744
v_mfma_f32_16x16x32_bf16 v[60:63], a[184:187], a[120:123], v[60:63]
v_mfma_f32_16x16x32_bf16 v[60:63], a[188:191], a[124:127], v[60:63]
s_waitcnt lgkmcnt(0)
v_mfma_f32_16x16x32_bf16 v[160:163], a[0:3], a[160:163], v[160:163]
s_waitcnt vmcnt(8)
s_barrier
v_mfma_f32_16x16x32_bf16 v[160:163], a[4:7], a[164:167], v[160:163]
s_add_u32 m0, s35, 32768
ds_read_b128 a[176:179], v10 offset:32768
v_mfma_f32_16x16x32_bf16 v[164:167], a[0:3], a[168:171], v[164:167]
buffer_load_dwordx4 v2, s[72:75], s37 offen offset:0 lds
v_mfma_f32_16x16x32_bf16 v[164:167], a[4:7], a[172:175], v[164:167]
ds_read_b128 a[180:183], v11 offset:32768
v_mul_f32 v148, s31, v148
v_mfma_f32_16x16x32_bf16 v[168:171], a[8:11], a[160:163], v[168:171]
ds_read_b128 a[184:187], v10 offset:34816
v_mul_f32 v149, s31, v149
v_mfma_f32_16x16x32_bf16 v[168:171], a[12:15], a[164:167], v[168:171]
buffer_load_dwordx4 v3, s[72:75], s37 offen offset:1024 lds
v_mfma_f32_16x16x32_bf16 v[172:175], a[8:11], a[168:171], v[172:175]
ds_read_b128 a[188:191], v11 offset:34816
v_mul_f32 v150, s31, v150
v_mfma_f32_16x16x32_bf16 v[172:175], a[12:15], a[172:175], v[172:175]
ds_read_b128 a[64:67], v12 offset:49152
v_mul_f32 v151, s31, v151
v_mfma_f32_16x16x32_bf16 v[176:179], a[16:19], a[160:163], v[176:179]
buffer_load_dwordx4 v4, s[72:75], s37 offen offset:2048 lds
v_mfma_f32_16x16x32_bf16 v[176:179], a[20:23], a[164:167], v[176:179]
ds_read_b128 a[68:71], v12 offset:57344
v_cvt_pk_bf16_f32 v148, v148, v149
v_mfma_f32_16x16x32_bf16 v[180:183], a[16:19], a[168:171], v[180:183]
ds_read_b128 a[72:75], v12 offset:50176
v_cvt_pk_bf16_f32 v149, v150, v151
v_mfma_f32_16x16x32_bf16 v[180:183], a[20:23], a[172:175], v[180:183]
buffer_load_dwordx4 v5, s[72:75], s37 offen offset:3072 lds
v_mfma_f32_16x16x32_bf16 v[184:187], a[24:27], a[160:163], v[184:187]
s_add_u32 m0, s35, 49152
ds_read_b128 a[76:79], v12 offset:58368
v_mfma_f32_16x16x32_bf16 v[184:187], a[28:31], a[164:167], v[184:187]
ds_read_b128 a[80:83], v12 offset:51200
v_mul_f32 v152, s31, v152
v_mfma_f32_16x16x32_bf16 v[188:191], a[24:27], a[168:171], v[188:191]
buffer_load_dwordx4 v16, s[16:19], s40 offen offset:0 sc1 lds
v_mfma_f32_16x16x32_bf16 v[188:191], a[28:31], a[172:175], v[188:191]
ds_read_b128 a[84:87], v12 offset:59392
v_mul_f32 v153, s31, v153
v_mfma_f32_16x16x32_bf16 v[32:35], a[32:35], a[160:163], v[32:35]
ds_read_b128 a[88:91], v12 offset:52224
v_mul_f32 v154, s31, v154
v_mfma_f32_16x16x32_bf16 v[32:35], a[36:39], a[164:167], v[32:35]
buffer_load_dwordx4 v16, s[16:19], s40 offen offset:1024 sc1 lds
v_mfma_f32_16x16x32_bf16 v[36:39], a[32:35], a[168:171], v[36:39]
ds_read_b128 a[92:95], v12 offset:60416
v_mul_f32 v155, s31, v155
v_mfma_f32_16x16x32_bf16 v[36:39], a[36:39], a[172:175], v[36:39]
ds_read_b128 a[96:99], v12 offset:53248
v_cvt_pk_bf16_f32 v152, v152, v153
v_mfma_f32_16x16x32_bf16 v[40:43], a[160:163], a[40:43], v[40:43]
buffer_load_dwordx4 v16, s[16:19], s40 offen offset:2048 sc1 lds
v_mfma_f32_16x16x32_bf16 v[40:43], a[164:167], a[44:47], v[40:43]
ds_read_b128 a[100:103], v12 offset:61440
v_cvt_pk_bf16_f32 v153, v154, v155
v_mfma_f32_16x16x32_bf16 v[44:47], a[168:171], a[40:43], v[44:47]
ds_read_b128 a[104:107], v12 offset:54272
v_mul_f32 v156, s31, v156
v_mfma_f32_16x16x32_bf16 v[44:47], a[172:175], a[44:47], v[44:47]
buffer_load_dwordx4 v16, s[16:19], s40 offen offset:3072 sc1 lds
v_mfma_f32_16x16x32_bf16 v[48:51], a[160:163], a[48:51], v[48:51]
s_add_u32 s37, s37, 128
s_add_u32 s40, s40, 16384
v_mul_f32 v157, s31, v157
v_mfma_f32_16x16x32_bf16 v[48:51], a[164:167], a[52:55], v[48:51]
ds_read_b128 a[108:111], v12 offset:62464
v_mul_f32 v158, s31, v158
v_mfma_f32_16x16x32_bf16 v[52:55], a[168:171], a[48:51], v[52:55]
ds_read_b128 a[112:115], v12 offset:55296
v_mul_f32 v159, s31, v159
v_mfma_f32_16x16x32_bf16 v[52:55], a[172:175], a[52:55], v[52:55]
ds_read_b128 a[116:119], v12 offset:63488
v_cvt_pk_bf16_f32 v156, v156, v157
v_mfma_f32_16x16x32_bf16 v[56:59], a[160:163], a[56:59], v[56:59]
ds_read_b128 a[120:123], v12 offset:56320
v_cvt_pk_bf16_f32 v157, v158, v159
v_mfma_f32_16x16x32_bf16 v[56:59], a[164:167], a[60:63], v[56:59]
ds_read_b128 a[124:127], v12 offset:64512
v_mfma_f32_16x16x32_bf16 v[60:63], a[168:171], a[56:59], v[60:63]
v_mfma_f32_16x16x32_bf16 v[60:63], a[172:175], a[60:63], v[60:63]
s_waitcnt lgkmcnt(0)
v_mfma_f32_16x16x32_bf16 v[160:163], a[64:67], a[176:179], v[160:163]
s_waitcnt vmcnt(8)
s_barrier
s_cmp_lg_u32 s3, 0
s_cbranch_scc1 w0_concat_9
v_mov_b32 v31, 0
buffer_load_dword v21, v31, s[16:19], s62 offen sc1
w0_concat_9:
v_xor_b32 v10, 0x10000, v10
v_xor_b32 v11, 0x10000, v11
v_xor_b32 v12, 0x10000, v12
v_mfma_f32_16x16x32_bf16 v[160:163], a[68:71], a[180:183], v[160:163]
s_add_u32 m0, s35, 65536
ds_read_b128 a[160:163], v10 offset:0
v_mfma_f32_16x16x32_bf16 v[164:167], a[64:67], a[184:187], v[164:167]
buffer_load_dwordx4 v2, s[72:75], s37 offen offset:0 lds
v_mfma_f32_16x16x32_bf16 v[164:167], a[68:71], a[188:191], v[164:167]
ds_read_b128 a[164:167], v11 offset:0
v_mul_f32 v80, s31, v80
v_mfma_f32_16x16x32_bf16 v[168:171], a[72:75], a[176:179], v[168:171]
ds_read_b128 a[168:171], v10 offset:2048
v_mul_f32 v81, s31, v81
v_mfma_f32_16x16x32_bf16 v[168:171], a[76:79], a[180:183], v[168:171]
buffer_load_dwordx4 v3, s[72:75], s37 offen offset:1024 lds
v_mfma_f32_16x16x32_bf16 v[172:175], a[72:75], a[184:187], v[172:175]
ds_read_b128 a[172:175], v11 offset:2048
v_mul_f32 v82, s31, v82
v_mfma_f32_16x16x32_bf16 v[172:175], a[76:79], a[188:191], v[172:175]
ds_read_b128 a[0:3], v12 offset:16384
v_mul_f32 v83, s31, v83
v_mfma_f32_16x16x32_bf16 v[176:179], a[80:83], a[176:179], v[176:179]
buffer_load_dwordx4 v4, s[72:75], s37 offen offset:2048 lds
v_mfma_f32_16x16x32_bf16 v[176:179], a[84:87], a[180:183], v[176:179]
ds_read_b128 a[4:7], v12 offset:24576
v_cvt_pk_bf16_f32 v146, v80, v81
v_mfma_f32_16x16x32_bf16 v[180:183], a[80:83], a[184:187], v[180:183]
ds_read_b128 a[8:11], v12 offset:17408
v_cvt_pk_bf16_f32 v147, v82, v83
v_mfma_f32_16x16x32_bf16 v[180:183], a[84:87], a[188:191], v[180:183]
buffer_load_dwordx4 v5, s[72:75], s37 offen offset:3072 lds
v_mfma_f32_16x16x32_bf16 v[184:187], a[88:91], a[176:179], v[184:187]
s_add_u32 m0, s35, 81920
ds_read_b128 a[12:15], v12 offset:25600
v_mfma_f32_16x16x32_bf16 v[184:187], a[92:95], a[180:183], v[184:187]
ds_read_b128 a[16:19], v12 offset:18432
v_mul_f32 v84, s31, v84
v_mfma_f32_16x16x32_bf16 v[188:191], a[88:91], a[184:187], v[188:191]
buffer_load_dwordx4 v16, s[16:19], s40 offen offset:0 sc1 lds
v_mfma_f32_16x16x32_bf16 v[188:191], a[92:95], a[188:191], v[188:191]
ds_read_b128 a[20:23], v12 offset:26624
v_mul_f32 v85, s31, v85
v_mfma_f32_16x16x32_bf16 v[32:35], a[96:99], a[176:179], v[32:35]
ds_read_b128 a[24:27], v12 offset:19456
v_mul_f32 v86, s31, v86
v_mfma_f32_16x16x32_bf16 v[32:35], a[100:103], a[180:183], v[32:35]
buffer_load_dwordx4 v16, s[16:19], s40 offen offset:1024 sc1 lds
v_mfma_f32_16x16x32_bf16 v[36:39], a[96:99], a[184:187], v[36:39]
ds_read_b128 a[28:31], v12 offset:27648
v_mul_f32 v87, s31, v87
v_mfma_f32_16x16x32_bf16 v[36:39], a[100:103], a[188:191], v[36:39]
ds_read_b128 a[32:35], v12 offset:20480
v_cvt_pk_bf16_f32 v150, v84, v85
v_mfma_f32_16x16x32_bf16 v[40:43], a[176:179], a[104:107], v[40:43]
buffer_load_dwordx4 v16, s[16:19], s40 offen offset:2048 sc1 lds
v_mfma_f32_16x16x32_bf16 v[40:43], a[180:183], a[108:111], v[40:43]
ds_read_b128 a[36:39], v12 offset:28672
v_cvt_pk_bf16_f32 v151, v86, v87
v_mfma_f32_16x16x32_bf16 v[44:47], a[184:187], a[104:107], v[44:47]
ds_read_b128 a[40:43], v12 offset:21504
v_mul_f32 v88, s31, v88
v_mfma_f32_16x16x32_bf16 v[44:47], a[188:191], a[108:111], v[44:47]
buffer_load_dwordx4 v16, s[16:19], s40 offen offset:3072 sc1 lds
v_mfma_f32_16x16x32_bf16 v[48:51], a[176:179], a[112:115], v[48:51]
s_add_u32 s37, s37, 128
s_add_u32 s40, s40, 16384
v_mul_f32 v89, s31, v89
v_mfma_f32_16x16x32_bf16 v[48:51], a[180:183], a[116:119], v[48:51]
ds_read_b128 a[44:47], v12 offset:29696
v_mul_f32 v90, s31, v90
v_mfma_f32_16x16x32_bf16 v[52:55], a[184:187], a[112:115], v[52:55]
ds_read_b128 a[48:51], v12 offset:22528
v_mul_f32 v91, s31, v91
v_mfma_f32_16x16x32_bf16 v[52:55], a[188:191], a[116:119], v[52:55]
ds_read_b128 a[52:55], v12 offset:30720
v_cvt_pk_bf16_f32 v154, v88, v89
v_mfma_f32_16x16x32_bf16 v[56:59], a[176:179], a[120:123], v[56:59]
ds_read_b128 a[56:59], v12 offset:23552
v_cvt_pk_bf16_f32 v155, v90, v91
v_mfma_f32_16x16x32_bf16 v[56:59], a[180:183], a[124:127], v[56:59]
ds_read_b128 a[60:63], v12 offset:31744
v_mfma_f32_16x16x32_bf16 v[60:63], a[184:187], a[120:123], v[60:63]
v_mfma_f32_16x16x32_bf16 v[60:63], a[188:191], a[124:127], v[60:63]
s_waitcnt lgkmcnt(0)
v_mfma_f32_16x16x32_bf16 v[160:163], a[0:3], a[160:163], v[160:163]
s_waitcnt vmcnt(8)
s_barrier
v_mfma_f32_16x16x32_bf16 v[160:163], a[4:7], a[164:167], v[160:163]
s_add_u32 m0, s35, 98304
ds_read_b128 a[176:179], v10 offset:32768
v_mfma_f32_16x16x32_bf16 v[164:167], a[0:3], a[168:171], v[164:167]
buffer_load_dwordx4 v2, s[72:75], s37 offen offset:0 lds
v_mfma_f32_16x16x32_bf16 v[164:167], a[4:7], a[172:175], v[164:167]
ds_read_b128 a[180:183], v11 offset:32768
v_mul_f32 v92, s31, v92
v_mfma_f32_16x16x32_bf16 v[168:171], a[8:11], a[160:163], v[168:171]
ds_read_b128 a[184:187], v10 offset:34816
v_mul_f32 v93, s31, v93
v_mfma_f32_16x16x32_bf16 v[168:171], a[12:15], a[164:167], v[168:171]
buffer_load_dwordx4 v3, s[72:75], s37 offen offset:1024 lds
v_mfma_f32_16x16x32_bf16 v[172:175], a[8:11], a[168:171], v[172:175]
ds_read_b128 a[188:191], v11 offset:34816
v_mul_f32 v94, s31, v94
v_mfma_f32_16x16x32_bf16 v[172:175], a[12:15], a[172:175], v[172:175]
ds_read_b128 a[64:67], v12 offset:49152
v_mul_f32 v95, s31, v95
v_mfma_f32_16x16x32_bf16 v[176:179], a[16:19], a[160:163], v[176:179]
buffer_load_dwordx4 v4, s[72:75], s37 offen offset:2048 lds
v_mfma_f32_16x16x32_bf16 v[176:179], a[20:23], a[164:167], v[176:179]
ds_read_b128 a[68:71], v12 offset:57344
v_cvt_pk_bf16_f32 v158, v92, v93
v_mfma_f32_16x16x32_bf16 v[180:183], a[16:19], a[168:171], v[180:183]
ds_read_b128 a[72:75], v12 offset:50176
v_cvt_pk_bf16_f32 v159, v94, v95
v_mfma_f32_16x16x32_bf16 v[180:183], a[20:23], a[172:175], v[180:183]
buffer_load_dwordx4 v5, s[72:75], s37 offen offset:3072 lds
v_mfma_f32_16x16x32_bf16 v[184:187], a[24:27], a[160:163], v[184:187]
s_add_u32 m0, s35, 114688
ds_read_b128 a[76:79], v12 offset:58368
v_mfma_f32_16x16x32_bf16 v[184:187], a[28:31], a[164:167], v[184:187]
ds_read_b128 a[80:83], v12 offset:51200
v_mfma_f32_16x16x32_bf16 v[188:191], a[24:27], a[168:171], v[188:191]
buffer_load_dwordx4 v16, s[16:19], s40 offen offset:0 sc1 lds
v_mfma_f32_16x16x32_bf16 v[188:191], a[28:31], a[172:175], v[188:191]
ds_read_b128 a[84:87], v12 offset:59392
v_mfma_f32_16x16x32_bf16 v[32:35], a[32:35], a[160:163], v[32:35]
ds_read_b128 a[88:91], v12 offset:52224
v_mfma_f32_16x16x32_bf16 v[32:35], a[36:39], a[164:167], v[32:35]
buffer_load_dwordx4 v16, s[16:19], s40 offen offset:1024 sc1 lds
v_mfma_f32_16x16x32_bf16 v[36:39], a[32:35], a[168:171], v[36:39]
ds_read_b128 a[92:95], v12 offset:60416
v_mfma_f32_16x16x32_bf16 v[36:39], a[36:39], a[172:175], v[36:39]
ds_read_b128 a[96:99], v12 offset:53248
v_mfma_f32_16x16x32_bf16 v[40:43], a[160:163], a[40:43], v[40:43]
buffer_load_dwordx4 v16, s[16:19], s40 offen offset:2048 sc1 lds
v_mfma_f32_16x16x32_bf16 v[40:43], a[164:167], a[44:47], v[40:43]
ds_read_b128 a[100:103], v12 offset:61440
v_mfma_f32_16x16x32_bf16 v[44:47], a[168:171], a[40:43], v[44:47]
ds_read_b128 a[104:107], v12 offset:54272
v_mfma_f32_16x16x32_bf16 v[44:47], a[172:175], a[44:47], v[44:47]
buffer_load_dwordx4 v16, s[16:19], s40 offen offset:3072 sc1 lds
v_mfma_f32_16x16x32_bf16 v[48:51], a[160:163], a[48:51], v[48:51]
s_add_u32 s37, s37, 128
s_add_u32 s40, s40, 16384
v_mfma_f32_16x16x32_bf16 v[48:51], a[164:167], a[52:55], v[48:51]
ds_read_b128 a[108:111], v12 offset:62464
v_mfma_f32_16x16x32_bf16 v[52:55], a[168:171], a[48:51], v[52:55]
ds_read_b128 a[112:115], v12 offset:55296
v_mfma_f32_16x16x32_bf16 v[52:55], a[172:175], a[52:55], v[52:55]
ds_read_b128 a[116:119], v12 offset:63488
v_mfma_f32_16x16x32_bf16 v[56:59], a[160:163], a[56:59], v[56:59]
ds_read_b128 a[120:123], v12 offset:56320
v_mfma_f32_16x16x32_bf16 v[56:59], a[164:167], a[60:63], v[56:59]
ds_read_b128 a[124:127], v12 offset:64512
v_mfma_f32_16x16x32_bf16 v[60:63], a[168:171], a[56:59], v[60:63]
v_mfma_f32_16x16x32_bf16 v[60:63], a[172:175], a[60:63], v[60:63]
s_waitcnt lgkmcnt(0)
v_mfma_f32_16x16x32_bf16 v[160:163], a[64:67], a[176:179], v[160:163]
s_waitcnt vmcnt(8)
s_cmp_lg_u32 s3, 0
s_cbranch_scc1 spinret_concat_11
v_readfirstlane_b32 s60, v21
s_cmp_lt_u32 s60, 8
s_cbranch_scc1 spin_concat_10
spinret_concat_11:
s_barrier
v_xor_b32 v10, 0x10000, v10
v_xor_b32 v11, 0x10000, v11
v_xor_b32 v12, 0x10000, v12
v_mfma_f32_16x16x32_bf16 v[160:163], a[68:71], a[180:183], v[160:163]
s_add_u32 m0, s35, 147456
ds_read_b128 a[160:163], v10 offset:0
v_mfma_f32_16x16x32_bf16 v[164:167], a[64:67], a[184:187], v[164:167]
buffer_load_dwordx4 v16, s[16:19], s59 offen offset:0 sc1 lds
v_mfma_f32_16x16x32_bf16 v[164:167], a[68:71], a[188:191], v[164:167]
ds_read_b128 a[164:167], v11 offset:0
v_mfma_f32_16x16x32_bf16 v[168:171], a[72:75], a[176:179], v[168:171]
ds_read_b128 a[168:171], v10 offset:2048
v_mfma_f32_16x16x32_bf16 v[168:171], a[76:79], a[180:183], v[168:171]
buffer_load_dwordx4 v16, s[16:19], s59 offen offset:1024 sc1 lds
v_mfma_f32_16x16x32_bf16 v[172:175], a[72:75], a[184:187], v[172:175]
ds_read_b128 a[172:175], v11 offset:2048
v_mfma_f32_16x16x32_bf16 v[172:175], a[76:79], a[188:191], v[172:175]
ds_read_b128 a[0:3], v12 offset:16384
v_mfma_f32_16x16x32_bf16 v[176:179], a[80:83], a[176:179], v[176:179]
buffer_load_dwordx4 v16, s[16:19], s59 offen offset:2048 sc1 lds
v_mfma_f32_16x16x32_bf16 v[176:179], a[84:87], a[180:183], v[176:179]
ds_read_b128 a[4:7], v12 offset:24576
v_mfma_f32_16x16x32_bf16 v[180:183], a[80:83], a[184:187], v[180:183]
ds_read_b128 a[8:11], v12 offset:17408
v_mfma_f32_16x16x32_bf16 v[180:183], a[84:87], a[188:191], v[180:183]
buffer_load_dwordx4 v16, s[16:19], s59 offen offset:3072 sc1 lds
v_mfma_f32_16x16x32_bf16 v[184:187], a[88:91], a[176:179], v[184:187]
s_mov_b32 m0, s39
ds_read_b128 a[12:15], v12 offset:25600
v_mfma_f32_16x16x32_bf16 v[184:187], a[92:95], a[180:183], v[184:187]
ds_read_b128 a[16:19], v12 offset:18432
v_mfma_f32_16x16x32_bf16 v[188:191], a[88:91], a[184:187], v[188:191]
buffer_load_dwordx4 v16, s[16:19], s38 offen offset:0 sc1 lds
v_mfma_f32_16x16x32_bf16 v[188:191], a[92:95], a[188:191], v[188:191]
ds_read_b128 a[20:23], v12 offset:26624
v_mfma_f32_16x16x32_bf16 v[32:35], a[96:99], a[176:179], v[32:35]
ds_read_b128 a[24:27], v12 offset:19456
v_mfma_f32_16x16x32_bf16 v[32:35], a[100:103], a[180:183], v[32:35]
buffer_load_dwordx4 v16, s[16:19], s38 offen offset:1024 sc1 lds
v_mfma_f32_16x16x32_bf16 v[36:39], a[96:99], a[184:187], v[36:39]
ds_read_b128 a[28:31], v12 offset:27648
v_mfma_f32_16x16x32_bf16 v[36:39], a[100:103], a[188:191], v[36:39]
ds_read_b128 a[32:35], v12 offset:20480
v_mfma_f32_16x16x32_bf16 v[40:43], a[176:179], a[104:107], v[40:43]
buffer_load_dwordx4 v16, s[16:19], s38 offen offset:2048 sc1 lds
v_mfma_f32_16x16x32_bf16 v[40:43], a[180:183], a[108:111], v[40:43]
ds_read_b128 a[36:39], v12 offset:28672
v_mfma_f32_16x16x32_bf16 v[44:47], a[184:187], a[104:107], v[44:47]
ds_read_b128 a[40:43], v12 offset:21504
v_mfma_f32_16x16x32_bf16 v[44:47], a[188:191], a[108:111], v[44:47]
buffer_load_dwordx4 v16, s[16:19], s38 offen offset:3072 sc1 lds
v_mfma_f32_16x16x32_bf16 v[48:51], a[176:179], a[112:115], v[48:51]
s_add_u32 s38, s38, 4096
ds_read_b128 a[44:47], v12 offset:29696
v_mfma_f32_16x16x32_bf16 v[48:51], a[180:183], a[116:119], v[48:51]
ds_read_b128 a[48:51], v12 offset:22528
v_mfma_f32_16x16x32_bf16 v[52:55], a[184:187], a[112:115], v[52:55]
ds_read_b128 a[52:55], v12 offset:30720
v_mfma_f32_16x16x32_bf16 v[52:55], a[188:191], a[116:119], v[52:55]
ds_read_b128 a[56:59], v12 offset:23552
v_mfma_f32_16x16x32_bf16 v[56:59], a[176:179], a[120:123], v[56:59]
ds_read_b128 a[60:63], v12 offset:31744
v_mfma_f32_16x16x32_bf16 v[56:59], a[180:183], a[124:127], v[56:59]
v_mfma_f32_16x16x32_bf16 v[60:63], a[184:187], a[120:123], v[60:63]
v_mfma_f32_16x16x32_bf16 v[60:63], a[188:191], a[124:127], v[60:63]
s_waitcnt lgkmcnt(0)
v_mfma_f32_16x16x32_bf16 v[160:163], a[0:3], a[160:163], v[160:163]
s_waitcnt vmcnt(8)
s_barrier
v_mfma_f32_16x16x32_bf16 v[160:163], a[4:7], a[164:167], v[160:163]
s_add_u32 m0, s39, 4096
ds_read_b128 a[176:179], v10 offset:32768
v_mfma_f32_16x16x32_bf16 v[164:167], a[0:3], a[168:171], v[164:167]
buffer_load_dwordx4 v16, s[16:19], s38 offen offset:0 sc1 lds
v_mfma_f32_16x16x32_bf16 v[164:167], a[4:7], a[172:175], v[164:167]
ds_read_b128 a[180:183], v11 offset:32768
v_lshrrev_b32 v17, 4, v1
v_mfma_f32_16x16x32_bf16 v[168:171], a[8:11], a[160:163], v[168:171]
ds_read_b128 a[184:187], v10 offset:34816
v_and_b32 v18, 3, v1
v_mfma_f32_16x16x32_bf16 v[168:171], a[12:15], a[164:167], v[168:171]
buffer_load_dwordx4 v16, s[16:19], s38 offen offset:1024 sc1 lds
v_mfma_f32_16x16x32_bf16 v[172:175], a[8:11], a[168:171], v[172:175]
ds_read_b128 a[188:191], v11 offset:34816
v_cmp_eq_u32 vcc, v17, v18
v_mfma_f32_16x16x32_bf16 v[172:175], a[12:15], a[172:175], v[172:175]
ds_read_b128 a[64:67], v12 offset:49152
v_lshrrev_b32 v17, 1, v17
v_mfma_f32_16x16x32_bf16 v[176:179], a[16:19], a[160:163], v[176:179]
buffer_load_dwordx4 v16, s[16:19], s38 offen offset:2048 sc1 lds
v_mfma_f32_16x16x32_bf16 v[176:179], a[20:23], a[164:167], v[176:179]
ds_read_b128 a[68:71], v12 offset:57344
v_mul_u32_u24 v17, 800, v17
v_mfma_f32_16x16x32_bf16 v[180:183], a[16:19], a[168:171], v[180:183]
ds_read_b128 a[72:75], v12 offset:50176
v_bfe_u32 v18, v1, 2, 2
v_mfma_f32_16x16x32_bf16 v[180:183], a[20:23], a[172:175], v[180:183]
buffer_load_dwordx4 v16, s[16:19], s38 offen offset:3072 sc1 lds
v_mfma_f32_16x16x32_bf16 v[184:187], a[24:27], a[160:163], v[184:187]
s_add_u32 s38, s38, 12288
s_add_u32 m0, s39, 32768
v_mul_u32_u24 v18, 40, v18
v_mfma_f32_16x16x32_bf16 v[184:187], a[28:31], a[164:167], v[184:187]
ds_read_b128 a[76:79], v12 offset:58368
v_add_u32 v17, v17, v18
v_mfma_f32_16x16x32_bf16 v[188:191], a[24:27], a[168:171], v[188:191]
buffer_load_dwordx4 v16, s[16:19], s38 offen offset:0 sc1 lds
v_mfma_f32_16x16x32_bf16 v[188:191], a[28:31], a[172:175], v[188:191]
ds_read_b128 a[80:83], v12 offset:51200
v_mov_b32 v19, 1600
v_mfma_f32_16x16x32_bf16 v[32:35], a[32:35], a[160:163], v[32:35]
ds_read_b128 a[84:87], v12 offset:59392
v_cndmask_b32 v17, v19, v17, vcc
v_mfma_f32_16x16x32_bf16 v[32:35], a[36:39], a[164:167], v[32:35]
buffer_load_dwordx4 v16, s[16:19], s38 offen offset:1024 sc1 lds
v_mfma_f32_16x16x32_bf16 v[36:39], a[32:35], a[168:171], v[36:39]
ds_read_b128 a[88:91], v12 offset:52224
v_add_u32 v13, 139264, v17
v_mfma_f32_16x16x32_bf16 v[36:39], a[36:39], a[172:175], v[36:39]
ds_read_b128 a[92:95], v12 offset:60416
v_mfma_f32_16x16x32_bf16 v[40:43], a[160:163], a[40:43], v[40:43]
buffer_load_dwordx4 v16, s[16:19], s38 offen offset:2048 sc1 lds
v_mfma_f32_16x16x32_bf16 v[40:43], a[164:167], a[44:47], v[40:43]
ds_read_b128 a[96:99], v12 offset:53248
v_mfma_f32_16x16x32_bf16 v[44:47], a[168:171], a[40:43], v[44:47]
ds_read_b128 a[100:103], v12 offset:61440
v_mfma_f32_16x16x32_bf16 v[44:47], a[172:175], a[44:47], v[44:47]
buffer_load_dwordx4 v16, s[16:19], s38 offen offset:3072 sc1 lds
v_mfma_f32_16x16x32_bf16 v[48:51], a[160:163], a[48:51], v[48:51]
s_add_u32 s38, s38, 4096
ds_read_b128 a[104:107], v12 offset:54272
v_mfma_f32_16x16x32_bf16 v[48:51], a[164:167], a[52:55], v[48:51]
ds_read_b128 a[108:111], v12 offset:62464
v_mfma_f32_16x16x32_bf16 v[52:55], a[168:171], a[48:51], v[52:55]
ds_read_b128 a[112:115], v12 offset:55296
v_mfma_f32_16x16x32_bf16 v[52:55], a[172:175], a[52:55], v[52:55]
ds_read_b128 a[116:119], v12 offset:63488
v_mfma_f32_16x16x32_bf16 v[56:59], a[160:163], a[56:59], v[56:59]
ds_read_b128 a[120:123], v12 offset:56320
v_mfma_f32_16x16x32_bf16 v[56:59], a[164:167], a[60:63], v[56:59]
ds_read_b128 a[124:127], v12 offset:64512
v_mfma_f32_16x16x32_bf16 v[60:63], a[168:171], a[56:59], v[60:63]
v_mfma_f32_16x16x32_bf16 v[60:63], a[172:175], a[60:63], v[60:63]
s_waitcnt lgkmcnt(0)
v_mfma_f32_16x16x32_bf16 v[160:163], a[64:67], a[176:179], v[160:163]
s_waitcnt vmcnt(16)
s_barrier
v_mfma_f32_16x16x32_bf16 v[160:163], a[68:71], a[180:183], v[160:163]
ds_read_b64_tr_b16 a[0:1], v13 offset:0
v_accvgpr_write_b32 a10, 0
v_mfma_f32_16x16x32_bf16 v[164:167], a[64:67], a[184:187], v[164:167]
ds_read_b64_tr_b16 a[2:3], v13 offset:160
v_accvgpr_write_b32 a11, 0
v_mfma_f32_16x16x32_bf16 v[164:167], a[68:71], a[188:191], v[164:167]
ds_read_b64_tr_b16 a[4:5], v13 offset:320
v_accvgpr_write_b32 a22, 0
v_mfma_f32_16x16x32_bf16 v[168:171], a[72:75], a[176:179], v[168:171]
ds_read_b64_tr_b16 a[6:7], v13 offset:480
v_accvgpr_write_b32 a23, 0
v_mfma_f32_16x16x32_bf16 v[168:171], a[76:79], a[180:183], v[168:171]
ds_read_b64_tr_b16 a[8:9], v13 offset:640
v_accvgpr_write_b32 a34, 0
v_mfma_f32_16x16x32_bf16 v[172:175], a[72:75], a[184:187], v[172:175]
ds_read_b64_tr_b16 a[12:13], v13 offset:8
v_accvgpr_write_b32 a35, 0
v_mfma_f32_16x16x32_bf16 v[172:175], a[76:79], a[188:191], v[172:175]
ds_read_b64_tr_b16 a[14:15], v13 offset:168
v_accvgpr_write_b32 a46, 0
v_mfma_f32_16x16x32_bf16 v[176:179], a[80:83], a[176:179], v[176:179]
ds_read_b64_tr_b16 a[16:17], v13 offset:328
v_accvgpr_write_b32 a47, 0
v_mfma_f32_16x16x32_bf16 v[176:179], a[84:87], a[180:183], v[176:179]
ds_read_b64_tr_b16 a[18:19], v13 offset:488
v_accvgpr_write_b32 a58, 0
v_mfma_f32_16x16x32_bf16 v[180:183], a[80:83], a[184:187], v[180:183]
ds_read_b64_tr_b16 a[20:21], v13 offset:648
v_accvgpr_write_b32 a59, 0
v_mfma_f32_16x16x32_bf16 v[180:183], a[84:87], a[188:191], v[180:183]
ds_read_b64_tr_b16 a[24:25], v13 offset:16
v_mfma_f32_16x16x32_bf16 v[184:187], a[88:91], a[176:179], v[184:187]
ds_read_b64_tr_b16 a[26:27], v13 offset:176
v_mfma_f32_16x16x32_bf16 v[184:187], a[92:95], a[180:183], v[184:187]
ds_read_b64_tr_b16 a[28:29], v13 offset:336
v_mfma_f32_16x16x32_bf16 v[188:191], a[88:91], a[184:187], v[188:191]
ds_read_b64_tr_b16 a[30:31], v13 offset:496
v_mfma_f32_16x16x32_bf16 v[188:191], a[92:95], a[188:191], v[188:191]
ds_read_b64_tr_b16 a[32:33], v13 offset:656
v_mfma_f32_16x16x32_bf16 v[32:35], a[96:99], a[176:179], v[32:35]
ds_read_b64_tr_b16 a[36:37], v13 offset:24
v_mfma_f32_16x16x32_bf16 v[32:35], a[100:103], a[180:183], v[32:35]
ds_read_b64_tr_b16 a[38:39], v13 offset:184
v_mfma_f32_16x16x32_bf16 v[36:39], a[96:99], a[184:187], v[36:39]
ds_read_b64_tr_b16 a[40:41], v13 offset:344
v_mfma_f32_16x16x32_bf16 v[36:39], a[100:103], a[188:191], v[36:39]
ds_read_b64_tr_b16 a[42:43], v13 offset:504
v_mfma_f32_16x16x32_bf16 v[40:43], a[176:179], a[104:107], v[40:43]
ds_read_b64_tr_b16 a[44:45], v13 offset:664
v_mfma_f32_16x16x32_bf16 v[40:43], a[180:183], a[108:111], v[40:43]
ds_read_b64_tr_b16 a[48:49], v13 offset:32
v_mfma_f32_16x16x32_bf16 v[44:47], a[184:187], a[104:107], v[44:47]
ds_read_b64_tr_b16 a[50:51], v13 offset:192
v_mfma_f32_16x16x32_bf16 v[44:47], a[188:191], a[108:111], v[44:47]
ds_read_b64_tr_b16 a[52:53], v13 offset:352
v_mfma_f32_16x16x32_bf16 v[48:51], a[176:179], a[112:115], v[48:51]
ds_read_b64_tr_b16 a[54:55], v13 offset:512
v_mfma_f32_16x16x32_bf16 v[48:51], a[180:183], a[116:119], v[48:51]
ds_read_b64_tr_b16 a[56:57], v13 offset:672
v_mfma_f32_16x16x32_bf16 v[52:55], a[184:187], a[112:115], v[52:55]
v_mfma_f32_16x16x32_bf16 v[52:55], a[188:191], a[116:119], v[52:55]
v_mfma_f32_16x16x32_bf16 v[56:59], a[176:179], a[120:123], v[56:59]
v_mfma_f32_16x16x32_bf16 v[56:59], a[180:183], a[124:127], v[56:59]
v_mfma_f32_16x16x32_bf16 v[60:63], a[184:187], a[120:123], v[60:63]
v_mfma_f32_16x16x32_bf16 v[60:63], a[188:191], a[124:127], v[60:63]
s_waitcnt lgkmcnt(0)
.p2align 3
s_nop 7
s_add_u32 m0, s39, 36864
s_nop 0
buffer_load_dwordx4 v16, s[16:19], s38 offen offset:0 sc1 lds
v_cvt_pk_bf16_f32 v64, v40, v41
v_cvt_pk_bf16_f32 v65, v42, v43
v_cvt_pk_bf16_f32 v66, v44, v45
v_cvt_pk_bf16_f32 v67, v46, v47
v_cvt_pk_bf16_f32 v68, v48, v49
v_cvt_pk_bf16_f32 v69, v50, v51
v_cvt_pk_bf16_f32 v70, v52, v53
v_cvt_pk_bf16_f32 v71, v54, v55
v_cvt_pk_bf16_f32 v72, v56, v57
v_cvt_pk_bf16_f32 v73, v58, v59
v_cvt_pk_bf16_f32 v74, v60, v61
v_cvt_pk_bf16_f32 v75, v62, v63
v_cvt_pk_bf16_f32 v40, v160, v161
v_cvt_pk_bf16_f32 v41, v162, v163
v_cvt_pk_bf16_f32 v42, v168, v169
v_cvt_pk_bf16_f32 v43, v170, v171
v_cvt_pk_bf16_f32 v44, v176, v177
v_cvt_pk_bf16_f32 v45, v178, v179
v_cvt_pk_bf16_f32 v46, v184, v185
v_cvt_pk_bf16_f32 v47, v186, v187
v_cvt_pk_bf16_f32 v48, v32, v33
v_cvt_pk_bf16_f32 v49, v34, v35
v_mov_b32 v50, 0
v_mov_b32 v51, 0
v_cvt_pk_bf16_f32 v52, v164, v165
v_cvt_pk_bf16_f32 v53, v166, v167
v_cvt_pk_bf16_f32 v54, v172, v173
v_cvt_pk_bf16_f32 v55, v174, v175
v_cvt_pk_bf16_f32 v56, v180, v181
buffer_load_dwordx4 v16, s[16:19], s38 offen offset:1024 sc1 lds
v_cvt_pk_bf16_f32 v57, v182, v183
v_cvt_pk_bf16_f32 v58, v188, v189
v_cvt_pk_bf16_f32 v59, v190, v191
v_cvt_pk_bf16_f32 v60, v36, v37
v_cvt_pk_bf16_f32 v61, v38, v39
v_mov_b32 v62, 0
v_mov_b32 v63, 0
s_nop 0
v_mfma_f32_16x16x32_bf16 v[160:163], a[0:3], v[40:43], 0
v_and_b32 v17, 7, v1
v_cmp_eq_u32 s[44:45], 2, v17
v_mfma_f32_16x16x32_bf16 v[160:163], a[4:7], v[44:47], v[160:163]
v_cmp_eq_u32 s[46:47], 5, v17
v_mul_u32_u24 v19, 80, v1
v_mfma_f32_16x16x32_bf16 v[160:163], a[8:11], v[48:51], v[160:163]
v_lshrrev_b32 v20, 2, v1
v_mul_u32_u24 v20, 80, v20
v_mfma_f32_16x16x32_bf16 v[168:171], a[12:15], v[40:43], 0
v_and_b32 v17, 3, v1
v_lshl_add_u32 v20, v17, 3, v20
v_mfma_f32_16x16x32_bf16 v[168:171], a[16:19], v[44:47], v[168:171]
s_add_u32 s32, s36, 65536
s_or_b64 s[44:45], s[44:45], s[46:47]
s_lshr_b32 s33, s3, 1
v_mfma_f32_16x16x32_bf16 v[168:171], a[20:23], v[48:51], v[168:171]
s_mul_i32 s46, s33, 2560
s_add_u32 s46, s46, 65536
v_add_u32 v19, s32, v19
v_mfma_f32_16x16x32_bf16 v[176:179], a[24:27], v[40:43], 0
v_add_u32 v20, s46, v20
buffer_load_dwordx4 v16, s[16:19], s38 offen offset:2048 sc1 lds
v_add_u32 v17, s32, v16
v_mfma_f32_16x16x32_bf16 v[176:179], a[28:31], v[44:47], v[176:179]
v_mov_b32 v18, 0x3f803f80
v_cndmask_b32 v72, v72, v18, s[44:45]
v_mfma_f32_16x16x32_bf16 v[176:179], a[32:35], v[48:51], v[176:179]
v_cndmask_b32 v73, v73, v18, s[44:45]
v_cndmask_b32 v74, v74, v18, s[44:45]
v_mfma_f32_16x16x32_bf16 v[184:187], a[36:39], v[40:43], 0
v_cndmask_b32 v75, v75, v18, s[44:45]
v_mov_b32 v76, 0x3fb8aa3b
v_mfma_f32_16x16x32_bf16 v[184:187], a[40:43], v[44:47], v[184:187]
ds_write_b128 v17, v[64:67] offset:5120
v_mfma_f32_16x16x32_bf16 v[184:187], a[44:47], v[48:51], v[184:187]
ds_write_b128 v17, v[68:71] offset:6144
v_mfma_f32_16x16x32_bf16 v[32:35], a[48:51], v[40:43], 0
ds_write_b128 v17, v[72:75] offset:7168
v_mfma_f32_16x16x32_bf16 v[32:35], a[52:55], v[44:47], v[32:35]
s_and_b32 s47, s3, 1
s_lshl_b32 s46, s47, 1
s_max_u32 s46, s46, s33
v_mfma_f32_16x16x32_bf16 v[32:35], a[56:59], v[48:51], v[32:35]
s_lshl_b32 s46, s46, 10
s_add_u32 s46, s46, 70656
v_add_u32 v18, s46, v16
v_mfma_f32_16x16x32_bf16 v[164:167], a[0:3], v[52:55], 0
v_mfma_f32_16x16x32_bf16 v[164:167], a[4:7], v[56:59], v[164:167]
v_mfma_f32_16x16x32_bf16 v[164:167], a[8:11], v[60:63], v[164:167]
v_mfma_f32_16x16x32_bf16 v[172:175], a[12:15], v[52:55], 0
v_mfma_f32_16x16x32_bf16 v[172:175], a[16:19], v[56:59], v[172:175]
v_mfma_f32_16x16x32_bf16 v[172:175], a[20:23], v[60:63], v[172:175]
buffer_load_dwordx4 v16, s[16:19], s38 offen offset:3072 sc1 lds
v_mfma_f32_16x16x32_bf16 v[180:183], a[24:27], v[52:55], 0
v_mfma_f32_16x16x32_bf16 v[180:183], a[28:31], v[56:59], v[180:183]
v_mfma_f32_16x16x32_bf16 v[180:183], a[32:35], v[60:63], v[180:183]
v_mfma_f32_16x16x32_bf16 v[188:191], a[36:39], v[52:55], 0
v_mfma_f32_16x16x32_bf16 v[188:191], a[40:43], v[56:59], v[188:191]
v_mfma_f32_16x16x32_bf16 v[188:191], a[44:47], v[60:63], v[188:191]
v_mfma_f32_16x16x32_bf16 v[36:39], a[48:51], v[52:55], 0
v_mfma_f32_16x16x32_bf16 v[36:39], a[52:55], v[56:59], v[36:39]
v_mfma_f32_16x16x32_bf16 v[36:39], a[56:59], v[60:63], v[36:39]
v_max3_f32 v78, v160, v161, v162
v_min3_f32 v80, v160, v161, v162
v_max3_f32 v78, v78, v163, v168
v_min3_f32 v80, v80, v163, v168
v_max3_f32 v78, v78, v169, v170
v_min3_f32 v80, v80, v169, v170
v_max3_f32 v78, v78, v171, v176
v_min3_f32 v80, v80, v171, v176
v_max3_f32 v78, v78, v177, v178
v_min3_f32 v80, v80, v177, v178
v_max3_f32 v78, v78, v179, v184
v_min3_f32 v80, v80, v179, v184
v_max3_f32 v78, v78, v185, v186
v_min3_f32 v80, v80, v185, v186
v_max3_f32 v78, v78, v187, v32
v_min3_f32 v80, v80, v187, v32
v_max3_f32 v78, v78, v33, v34
v_min3_f32 v80, v80, v33, v34
v_max_f32 v78, v78, v35
v_min_f32 v80, v80, v35
v_mul_f32 v78, v76, v78
s_add_u32 s38, s38, 12288
s_xor_b32 s39, s39, 0x10000
s_add_u32 s34, s56, 393216
buffer_store_dwordx4 a[224:227], v16, s[16:19], s34 offen offset:0 sc1
v_mul_f32 v80, v76, v80
v_pk_fma_f32 v[44:45], v[160:161], v[76:77], v[80:81] op_sel_hi:[1,0,0] neg_lo:[1,0,0] neg_hi:[1,0,0]
v_pk_fma_f32 v[160:161], v[160:161], v[76:77], v[78:79] op_sel_hi:[1,0,0] neg_lo:[0,0,1] neg_hi:[0,0,1]
v_pk_fma_f32 v[46:47], v[162:163], v[76:77], v[80:81] op_sel_hi:[1,0,0] neg_lo:[1,0,0] neg_hi:[1,0,0]
v_pk_fma_f32 v[162:163], v[162:163], v[76:77], v[78:79] op_sel_hi:[1,0,0] neg_lo:[0,0,1] neg_hi:[0,0,1]
v_pk_fma_f32 v[48:49], v[168:169], v[76:77], v[80:81] op_sel_hi:[1,0,0] neg_lo:[1,0,0] neg_hi:[1,0,0]
v_pk_fma_f32 v[168:169], v[168:169], v[76:77], v[78:79] op_sel_hi:[1,0,0] neg_lo:[0,0,1] neg_hi:[0,0,1]
v_pk_fma_f32 v[50:51], v[170:171], v[76:77], v[80:81] op_sel_hi:[1,0,0] neg_lo:[1,0,0] neg_hi:[1,0,0]
v_pk_fma_f32 v[170:171], v[170:171], v[76:77], v[78:79] op_sel_hi:[1,0,0] neg_lo:[0,0,1] neg_hi:[0,0,1]
v_pk_fma_f32 v[52:53], v[176:177], v[76:77], v[80:81] op_sel_hi:[1,0,0] neg_lo:[1,0,0] neg_hi:[1,0,0]
v_pk_fma_f32 v[176:177], v[176:177], v[76:77], v[78:79] op_sel_hi:[1,0,0] neg_lo:[0,0,1] neg_hi:[0,0,1]
v_pk_fma_f32 v[54:55], v[178:179], v[76:77], v[80:81] op_sel_hi:[1,0,0] neg_lo:[1,0,0] neg_hi:[1,0,0]
v_pk_fma_f32 v[178:179], v[178:179], v[76:77], v[78:79] op_sel_hi:[1,0,0] neg_lo:[0,0,1] neg_hi:[0,0,1]
v_pk_fma_f32 v[56:57], v[184:185], v[76:77], v[80:81] op_sel_hi:[1,0,0] neg_lo:[1,0,0] neg_hi:[1,0,0]
v_pk_fma_f32 v[184:185], v[184:185], v[76:77], v[78:79] op_sel_hi:[1,0,0] neg_lo:[0,0,1] neg_hi:[0,0,1]
v_pk_fma_f32 v[58:59], v[186:187], v[76:77], v[80:81] op_sel_hi:[1,0,0] neg_lo:[1,0,0] neg_hi:[1,0,0]
v_pk_fma_f32 v[186:187], v[186:187], v[76:77], v[78:79] op_sel_hi:[1,0,0] neg_lo:[0,0,1] neg_hi:[0,0,1]
v_pk_fma_f32 v[60:61], v[32:33], v[76:77], v[80:81] op_sel_hi:[1,0,0] neg_lo:[1,0,0] neg_hi:[1,0,0]
v_pk_fma_f32 v[32:33], v[32:33], v[76:77], v[78:79] op_sel_hi:[1,0,0] neg_lo:[0,0,1] neg_hi:[0,0,1]
v_pk_fma_f32 v[62:63], v[34:35], v[76:77], v[80:81] op_sel_hi:[1,0,0] neg_lo:[1,0,0] neg_hi:[1,0,0]
v_pk_fma_f32 v[34:35], v[34:35], v[76:77], v[78:79] op_sel_hi:[1,0,0] neg_lo:[0,0,1] neg_hi:[0,0,1]
v_exp_f32 v160, v160
v_exp_f32 v44, v44
v_exp_f32 v161, v161
v_exp_f32 v45, v45
v_exp_f32 v162, v162
v_exp_f32 v46, v46
v_exp_f32 v163, v163
v_exp_f32 v47, v47
v_exp_f32 v168, v168
s_add_u32 s34, s56, 131072
buffer_store_dwordx4 v[196:199], v16, s[16:19], s34 offen offset:0 sc1
v_exp_f32 v48, v48
v_exp_f32 v169, v169
v_exp_f32 v49, v49
v_exp_f32 v170, v170
v_exp_f32 v50, v50
v_exp_f32 v171, v171
v_exp_f32 v51, v51
v_exp_f32 v176, v176
v_exp_f32 v52, v52
v_exp_f32 v177, v177
v_exp_f32 v53, v53
v_exp_f32 v178, v178
v_exp_f32 v54, v54
v_exp_f32 v179, v179
v_exp_f32 v55, v55
v_exp_f32 v184, v184
v_exp_f32 v56, v56
v_exp_f32 v185, v185
v_exp_f32 v57, v57
v_exp_f32 v186, v186
v_exp_f32 v58, v58
v_exp_f32 v187, v187
v_exp_f32 v59, v59
v_exp_f32 v32, v32
v_exp_f32 v60, v60
v_exp_f32 v33, v33
v_exp_f32 v61, v61
v_exp_f32 v34, v34
v_exp_f32 v62, v62
v_exp_f32 v35, v35
buffer_store_dwordx4 v[192:195], v16, s[16:19], s34 offen offset:1024 sc1
v_exp_f32 v63, v63
v_pk_add_f32 v[40:41], v[160:161], v[162:163]
v_pk_add_f32 v[42:43], v[44:45], v[46:47]
v_pk_add_f32 v[40:41], v[40:41], v[168:169]
v_pk_add_f32 v[42:43], v[42:43], v[48:49]
v_pk_add_f32 v[40:41], v[40:41], v[170:171]
v_pk_add_f32 v[42:43], v[42:43], v[50:51]
v_pk_add_f32 v[40:41], v[40:41], v[176:177]
v_pk_add_f32 v[42:43], v[42:43], v[52:53]
v_pk_add_f32 v[40:41], v[40:41], v[178:179]
v_pk_add_f32 v[42:43], v[42:43], v[54:55]
v_pk_add_f32 v[40:41], v[40:41], v[184:185]
v_pk_add_f32 v[42:43], v[42:43], v[56:57]
v_pk_add_f32 v[40:41], v[40:41], v[186:187]
v_pk_add_f32 v[42:43], v[42:43], v[58:59]
v_pk_add_f32 v[40:41], v[40:41], v[32:33]
v_pk_add_f32 v[42:43], v[42:43], v[60:61]
v_pk_add_f32 v[40:41], v[40:41], v[34:35]
v_pk_add_f32 v[42:43], v[42:43], v[62:63]
v_add_f32 v40, v40, v41
v_add_f32 v42, v42, v43
v_rcp_f32 v40, v40
v_rcp_f32 v42, v42
s_nop 0
s_nop 0
v_pk_mul_f32 v[160:161], v[160:161], v[40:41] op_sel_hi:[1,0]
v_pk_mul_f32 v[44:45], v[44:45], v[42:43] op_sel_hi:[1,0]
v_pk_mul_f32 v[162:163], v[162:163], v[40:41] op_sel_hi:[1,0]
v_pk_mul_f32 v[46:47], v[46:47], v[42:43] op_sel_hi:[1,0]
v_pk_mul_f32 v[168:169], v[168:169], v[40:41] op_sel_hi:[1,0]
buffer_store_dwordx4 v[200:203], v16, s[16:19], s34 offen offset:2048 sc1
v_pk_mul_f32 v[48:49], v[48:49], v[42:43] op_sel_hi:[1,0]
v_pk_mul_f32 v[170:171], v[170:171], v[40:41] op_sel_hi:[1,0]
v_pk_mul_f32 v[50:51], v[50:51], v[42:43] op_sel_hi:[1,0]
v_pk_mul_f32 v[176:177], v[176:177], v[40:41] op_sel_hi:[1,0]
v_pk_mul_f32 v[52:53], v[52:53], v[42:43] op_sel_hi:[1,0]
v_pk_mul_f32 v[178:179], v[178:179], v[40:41] op_sel_hi:[1,0]
v_pk_mul_f32 v[54:55], v[54:55], v[42:43] op_sel_hi:[1,0]
v_pk_mul_f32 v[184:185], v[184:185], v[40:41] op_sel_hi:[1,0]
v_pk_mul_f32 v[56:57], v[56:57], v[42:43] op_sel_hi:[1,0]
v_pk_mul_f32 v[186:187], v[186:187], v[40:41] op_sel_hi:[1,0]
v_pk_mul_f32 v[58:59], v[58:59], v[42:43] op_sel_hi:[1,0]
v_pk_mul_f32 v[32:33], v[32:33], v[40:41] op_sel_hi:[1,0]
v_pk_mul_f32 v[60:61], v[60:61], v[42:43] op_sel_hi:[1,0]
v_pk_mul_f32 v[34:35], v[34:35], v[40:41] op_sel_hi:[1,0]
v_pk_mul_f32 v[62:63], v[62:63], v[42:43] op_sel_hi:[1,0]
v_cvt_pk_bf16_f32 v160, v160, v161
v_cvt_pk_bf16_f32 v161, v162, v163
v_cvt_pk_bf16_f32 v162, v168, v169
v_cvt_pk_bf16_f32 v163, v170, v171
v_cvt_pk_bf16_f32 v168, v176, v177
v_cvt_pk_bf16_f32 v169, v178, v179
v_cvt_pk_bf16_f32 v170, v184, v185
v_cvt_pk_bf16_f32 v171, v186, v187
v_cvt_pk_bf16_f32 v176, v32, v33
v_cvt_pk_bf16_f32 v177, v34, v35
v_cvt_pk_bf16_f32 v178, v44, v45
v_cvt_pk_bf16_f32 v179, v46, v47
v_cvt_pk_bf16_f32 v184, v48, v49
v_cvt_pk_bf16_f32 v185, v50, v51
v_cvt_pk_bf16_f32 v186, v52, v53
buffer_store_dwordx4 v[208:211], v16, s[16:19], s34 offen offset:3072 sc1
v_cvt_pk_bf16_f32 v187, v54, v55
v_cvt_pk_bf16_f32 v32, v56, v57
v_cvt_pk_bf16_f32 v33, v58, v59
v_cvt_pk_bf16_f32 v34, v60, v61
v_cvt_pk_bf16_f32 v35, v62, v63
v_max3_f32 v78, v164, v165, v166
v_min3_f32 v80, v164, v165, v166
v_max3_f32 v78, v78, v167, v172
v_min3_f32 v80, v80, v167, v172
v_max3_f32 v78, v78, v173, v174
v_min3_f32 v80, v80, v173, v174
v_max3_f32 v78, v78, v175, v180
v_min3_f32 v80, v80, v175, v180
v_max3_f32 v78, v78, v181, v182
v_min3_f32 v80, v80, v181, v182
v_max3_f32 v78, v78, v183, v188
v_min3_f32 v80, v80, v183, v188
v_max3_f32 v78, v78, v189, v190
v_min3_f32 v80, v80, v189, v190
v_max3_f32 v78, v78, v191, v36
v_min3_f32 v80, v80, v191, v36
v_max3_f32 v78, v78, v37, v38
v_min3_f32 v80, v80, v37, v38
v_max_f32 v78, v78, v39
v_min_f32 v80, v80, v39
v_mul_f32 v78, v76, v78
v_mul_f32 v80, v76, v80
v_pk_fma_f32 v[44:45], v[164:165], v[76:77], v[80:81] op_sel_hi:[1,0,0] neg_lo:[1,0,0] neg_hi:[1,0,0]
v_pk_fma_f32 v[164:165], v[164:165], v[76:77], v[78:79] op_sel_hi:[1,0,0] neg_lo:[0,0,1] neg_hi:[0,0,1]
s_add_u32 s34, s55, 262144
buffer_store_dwordx4 v[236:239], v16, s[16:19], s34 offen offset:0 sc1
v_pk_fma_f32 v[46:47], v[166:167], v[76:77], v[80:81] op_sel_hi:[1,0,0] neg_lo:[1,0,0] neg_hi:[1,0,0]
v_pk_fma_f32 v[166:167], v[166:167], v[76:77], v[78:79] op_sel_hi:[1,0,0] neg_lo:[0,0,1] neg_hi:[0,0,1]
v_pk_fma_f32 v[48:49], v[172:173], v[76:77], v[80:81] op_sel_hi:[1,0,0] neg_lo:[1,0,0] neg_hi:[1,0,0]
v_pk_fma_f32 v[172:173], v[172:173], v[76:77], v[78:79] op_sel_hi:[1,0,0] neg_lo:[0,0,1] neg_hi:[0,0,1]
v_pk_fma_f32 v[50:51], v[174:175], v[76:77], v[80:81] op_sel_hi:[1,0,0] neg_lo:[1,0,0] neg_hi:[1,0,0]
v_pk_fma_f32 v[174:175], v[174:175], v[76:77], v[78:79] op_sel_hi:[1,0,0] neg_lo:[0,0,1] neg_hi:[0,0,1]
v_pk_fma_f32 v[52:53], v[180:181], v[76:77], v[80:81] op_sel_hi:[1,0,0] neg_lo:[1,0,0] neg_hi:[1,0,0]
v_pk_fma_f32 v[180:181], v[180:181], v[76:77], v[78:79] op_sel_hi:[1,0,0] neg_lo:[0,0,1] neg_hi:[0,0,1]
v_pk_fma_f32 v[54:55], v[182:183], v[76:77], v[80:81] op_sel_hi:[1,0,0] neg_lo:[1,0,0] neg_hi:[1,0,0]
v_pk_fma_f32 v[182:183], v[182:183], v[76:77], v[78:79] op_sel_hi:[1,0,0] neg_lo:[0,0,1] neg_hi:[0,0,1]
v_pk_fma_f32 v[56:57], v[188:189], v[76:77], v[80:81] op_sel_hi:[1,0,0] neg_lo:[1,0,0] neg_hi:[1,0,0]
v_pk_fma_f32 v[188:189], v[188:189], v[76:77], v[78:79] op_sel_hi:[1,0,0] neg_lo:[0,0,1] neg_hi:[0,0,1]
v_pk_fma_f32 v[58:59], v[190:191], v[76:77], v[80:81] op_sel_hi:[1,0,0] neg_lo:[1,0,0] neg_hi:[1,0,0]
v_pk_fma_f32 v[190:191], v[190:191], v[76:77], v[78:79] op_sel_hi:[1,0,0] neg_lo:[0,0,1] neg_hi:[0,0,1]
v_pk_fma_f32 v[60:61], v[36:37], v[76:77], v[80:81] op_sel_hi:[1,0,0] neg_lo:[1,0,0] neg_hi:[1,0,0]
v_pk_fma_f32 v[36:37], v[36:37], v[76:77], v[78:79] op_sel_hi:[1,0,0] neg_lo:[0,0,1] neg_hi:[0,0,1]
v_pk_fma_f32 v[62:63], v[38:39], v[76:77], v[80:81] op_sel_hi:[1,0,0] neg_lo:[1,0,0] neg_hi:[1,0,0]
v_pk_fma_f32 v[38:39], v[38:39], v[76:77], v[78:79] op_sel_hi:[1,0,0] neg_lo:[0,0,1] neg_hi:[0,0,1]
v_exp_f32 v164, v164
v_exp_f32 v44, v44
v_exp_f32 v165, v165
v_exp_f32 v45, v45
v_exp_f32 v166, v166
v_exp_f32 v46, v46
v_exp_f32 v167, v167
v_exp_f32 v47, v47
v_exp_f32 v172, v172
v_exp_f32 v48, v48
v_exp_f32 v173, v173
v_exp_f32 v49, v49
buffer_store_dwordx4 v[248:251], v16, s[16:19], s34 offen offset:1024 sc1
v_exp_f32 v174, v174
v_exp_f32 v50, v50
v_exp_f32 v175, v175
v_exp_f32 v51, v51
v_exp_f32 v180, v180
v_exp_f32 v52, v52
v_exp_f32 v181, v181
v_exp_f32 v53, v53
v_exp_f32 v182, v182
v_exp_f32 v54, v54
v_exp_f32 v183, v183
v_exp_f32 v55, v55
v_exp_f32 v188, v188
v_exp_f32 v56, v56
v_exp_f32 v189, v189
v_exp_f32 v57, v57
v_exp_f32 v190, v190
v_exp_f32 v58, v58
v_exp_f32 v191, v191
v_exp_f32 v59, v59
v_exp_f32 v36, v36
v_exp_f32 v60, v60
v_exp_f32 v37, v37
v_exp_f32 v61, v61
v_exp_f32 v38, v38
v_exp_f32 v62, v62
v_exp_f32 v39, v39
v_exp_f32 v63, v63
v_pk_add_f32 v[40:41], v[164:165], v[166:167]
v_pk_add_f32 v[42:43], v[44:45], v[46:47]
s_add_u32 s34, s55, 266240
buffer_store_dwordx4 v[244:247], v16, s[16:19], s34 offen offset:0 sc1
v_pk_add_f32 v[40:41], v[40:41], v[172:173]
v_pk_add_f32 v[42:43], v[42:43], v[48:49]
v_pk_add_f32 v[40:41], v[40:41], v[174:175]
v_pk_add_f32 v[42:43], v[42:43], v[50:51]
v_pk_add_f32 v[40:41], v[40:41], v[180:181]
v_pk_add_f32 v[42:43], v[42:43], v[52:53]
v_pk_add_f32 v[40:41], v[40:41], v[182:183]
v_pk_add_f32 v[42:43], v[42:43], v[54:55]
v_pk_add_f32 v[40:41], v[40:41], v[188:189]
v_pk_add_f32 v[42:43], v[42:43], v[56:57]
v_pk_add_f32 v[40:41], v[40:41], v[190:191]
v_pk_add_f32 v[42:43], v[42:43], v[58:59]
v_pk_add_f32 v[40:41], v[40:41], v[36:37]
v_pk_add_f32 v[42:43], v[42:43], v[60:61]
v_pk_add_f32 v[40:41], v[40:41], v[38:39]
v_pk_add_f32 v[42:43], v[42:43], v[62:63]
v_add_f32 v40, v40, v41
v_add_f32 v42, v42, v43
v_rcp_f32 v40, v40
v_rcp_f32 v42, v42
s_nop 0
s_nop 0
v_pk_mul_f32 v[164:165], v[164:165], v[40:41] op_sel_hi:[1,0]
v_pk_mul_f32 v[44:45], v[44:45], v[42:43] op_sel_hi:[1,0]
v_pk_mul_f32 v[166:167], v[166:167], v[40:41] op_sel_hi:[1,0]
v_pk_mul_f32 v[46:47], v[46:47], v[42:43] op_sel_hi:[1,0]
v_pk_mul_f32 v[172:173], v[172:173], v[40:41] op_sel_hi:[1,0]
v_pk_mul_f32 v[48:49], v[48:49], v[42:43] op_sel_hi:[1,0]
v_pk_mul_f32 v[174:175], v[174:175], v[40:41] op_sel_hi:[1,0]
v_pk_mul_f32 v[50:51], v[50:51], v[42:43] op_sel_hi:[1,0]
buffer_store_dwordx4 v[252:255], v16, s[16:19], s34 offen offset:1024 sc1
v_pk_mul_f32 v[180:181], v[180:181], v[40:41] op_sel_hi:[1,0]
v_pk_mul_f32 v[52:53], v[52:53], v[42:43] op_sel_hi:[1,0]
v_pk_mul_f32 v[182:183], v[182:183], v[40:41] op_sel_hi:[1,0]
v_pk_mul_f32 v[54:55], v[54:55], v[42:43] op_sel_hi:[1,0]
v_pk_mul_f32 v[188:189], v[188:189], v[40:41] op_sel_hi:[1,0]
v_pk_mul_f32 v[56:57], v[56:57], v[42:43] op_sel_hi:[1,0]
v_pk_mul_f32 v[190:191], v[190:191], v[40:41] op_sel_hi:[1,0]
v_pk_mul_f32 v[58:59], v[58:59], v[42:43] op_sel_hi:[1,0]
v_pk_mul_f32 v[36:37], v[36:37], v[40:41] op_sel_hi:[1,0]
v_pk_mul_f32 v[60:61], v[60:61], v[42:43] op_sel_hi:[1,0]
v_pk_mul_f32 v[38:39], v[38:39], v[40:41] op_sel_hi:[1,0]
v_pk_mul_f32 v[62:63], v[62:63], v[42:43] op_sel_hi:[1,0]
v_cvt_pk_bf16_f32 v164, v164, v165
v_cvt_pk_bf16_f32 v165, v166, v167
v_cvt_pk_bf16_f32 v166, v172, v173
v_cvt_pk_bf16_f32 v167, v174, v175
v_cvt_pk_bf16_f32 v172, v180, v181
v_cvt_pk_bf16_f32 v173, v182, v183
v_cvt_pk_bf16_f32 v174, v188, v189
v_cvt_pk_bf16_f32 v175, v190, v191
v_cvt_pk_bf16_f32 v180, v36, v37
v_cvt_pk_bf16_f32 v181, v38, v39
v_cvt_pk_bf16_f32 v182, v44, v45
v_cvt_pk_bf16_f32 v183, v46, v47
v_cvt_pk_bf16_f32 v188, v48, v49
v_cvt_pk_bf16_f32 v189, v50, v51
v_cvt_pk_bf16_f32 v190, v52, v53
v_cvt_pk_bf16_f32 v191, v54, v55
v_cvt_pk_bf16_f32 v36, v56, v57
v_cvt_pk_bf16_f32 v37, v58, v59
s_add_u32 s34, s56, 262144
buffer_store_dwordx4 v[228:231], v16, s[16:19], s34 offen offset:0 sc1
v_cvt_pk_bf16_f32 v38, v60, v61
v_cvt_pk_bf16_f32 v39, v62, v63
s_nop 0
v_permlane16_swap_b32 v160, v164
v_permlane16_swap_b32 v161, v165
v_permlane16_swap_b32 v162, v166
v_permlane16_swap_b32 v163, v167
ds_write_b128 v19, v[164:167] offset:0
v_permlane16_swap_b32 v168, v172
v_permlane16_swap_b32 v169, v173
v_permlane16_swap_b32 v170, v174
v_permlane16_swap_b32 v171, v175
ds_write_b128 v19, v[172:175] offset:16
v_permlane16_swap_b32 v176, v180
v_permlane16_swap_b32 v177, v181
v_permlane16_swap_b32 v178, v182
v_permlane16_swap_b32 v179, v183
ds_write_b128 v19, v[180:183] offset:32
v_permlane16_swap_b32 v184, v188
v_permlane16_swap_b32 v185, v189
v_permlane16_swap_b32 v186, v190
v_permlane16_swap_b32 v187, v191
ds_write_b128 v19, v[188:191] offset:48
v_permlane16_swap_b32 v32, v36
v_permlane16_swap_b32 v33, v37
v_permlane16_swap_b32 v34, v38
v_permlane16_swap_b32 v35, v39
ds_write_b128 v19, v[36:39] offset:64
v_accvgpr_write_b32 a208, v160
v_accvgpr_write_b32 a209, v161
buffer_store_dwordx4 v[224:227], v16, s[16:19], s34 offen offset:1024 sc1
v_accvgpr_write_b32 a210, v162
v_accvgpr_write_b32 a211, v163
v_accvgpr_write_b32 a212, v168
v_accvgpr_write_b32 a213, v169
v_accvgpr_write_b32 a214, v170
v_accvgpr_write_b32 a215, v171
v_accvgpr_write_b32 a216, v176
v_accvgpr_write_b32 a217, v177
v_accvgpr_write_b32 a218, v178
v_accvgpr_write_b32 a219, v179
v_accvgpr_write_b32 a220, v184
v_accvgpr_write_b32 a221, v185
v_accvgpr_write_b32 a222, v186
v_accvgpr_write_b32 a223, v187
v_accvgpr_write_b32 a224, v32
v_accvgpr_write_b32 a225, v33
v_accvgpr_write_b32 a226, v34
v_accvgpr_write_b32 a227, v35
v_add_u32 v17, 147456, v16
s_waitcnt vmcnt(19) lgkmcnt(0)
s_barrier
ds_read_b128 a[112:115], v18 offset:0
ds_read_b64_tr_b16 a[64:65], v20 offset:0
ds_read_b64_tr_b16 a[66:67], v20 offset:1280
ds_read_b64_tr_b16 a[68:69], v20 offset:32
ds_read_b64_tr_b16 a[70:71], v20 offset:1312
ds_read_b64_tr_b16 a[72:73], v20 offset:64
ds_read_b64_tr_b16 a[74:75], v20 offset:1344
ds_read_b128 a[116:119], v18 offset:8192
ds_read_b64_tr_b16 a[76:77], v20 offset:8192
buffer_store_dwordx4 v[232:235], v16, s[16:19], s34 offen offset:2048 sc1
ds_read_b64_tr_b16 a[78:79], v20 offset:9472
ds_read_b64_tr_b16 a[80:81], v20 offset:8224
ds_read_b64_tr_b16 a[82:83], v20 offset:9504
ds_read_b64_tr_b16 a[84:85], v20 offset:8256
ds_read_b64_tr_b16 a[86:87], v20 offset:9536
ds_read_b128 a[120:123], v18 offset:16384
ds_read_b64_tr_b16 a[88:89], v20 offset:16384
ds_read_b64_tr_b16 a[90:91], v20 offset:17664
ds_read_b64_tr_b16 a[92:93], v20 offset:16416
ds_read_b64_tr_b16 a[94:95], v20 offset:17696
ds_read_b64_tr_b16 a[96:97], v20 offset:16448
ds_read_b64_tr_b16 a[98:99], v20 offset:17728
ds_read_b128 a[124:127], v18 offset:24576
ds_read_b64_tr_b16 a[100:101], v20 offset:24576
ds_read_b64_tr_b16 a[102:103], v20 offset:25856
ds_read_b64_tr_b16 a[104:105], v20 offset:24608
ds_read_b64_tr_b16 a[106:107], v20 offset:25888
ds_read_b64_tr_b16 a[108:109], v20 offset:24640
ds_read_b64_tr_b16 a[110:111], v20 offset:25920
s_waitcnt lgkmcnt(15)
v_mfma_f32_16x16x32_bf16 v[4:7], a[64:67], a[112:115], 0
s_waitcnt lgkmcnt(15)
v_mfma_f32_16x16x32_bf16 v[8:11], a[68:71], a[112:115], 0
s_waitcnt lgkmcnt(15)
v_mfma_f32_16x16x32_bf16 v[12:15], a[72:75], a[112:115], 0
s_waitcnt lgkmcnt(15)
v_mfma_f32_16x16x32_bf16 v[4:7], a[76:79], a[116:119], v[4:7]
s_waitcnt lgkmcnt(15)
v_mfma_f32_16x16x32_bf16 v[8:11], a[80:83], a[116:119], v[8:11]
s_waitcnt lgkmcnt(14)
buffer_store_dwordx4 v[240:243], v16, s[16:19], s34 offen offset:3072 sc1
v_mfma_f32_16x16x32_bf16 v[12:15], a[84:87], a[116:119], v[12:15]
s_waitcnt lgkmcnt(11)
v_mfma_f32_16x16x32_bf16 v[4:7], a[88:91], a[120:123], v[4:7]
s_waitcnt lgkmcnt(9)
v_mfma_f32_16x16x32_bf16 v[8:11], a[92:95], a[120:123], v[8:11]
s_waitcnt lgkmcnt(7)
v_mfma_f32_16x16x32_bf16 v[12:15], a[96:99], a[120:123], v[12:15]
s_waitcnt lgkmcnt(4)
v_mfma_f32_16x16x32_bf16 v[4:7], a[100:103], a[124:127], v[4:7]
s_waitcnt lgkmcnt(2)
v_mfma_f32_16x16x32_bf16 v[8:11], a[104:107], a[124:127], v[8:11]
s_waitcnt lgkmcnt(0)
v_mfma_f32_16x16x32_bf16 v[12:15], a[108:111], a[124:127], v[12:15]
ds_read_b128 a[144:147], v17 offset:0
ds_read_b128 a[148:151], v17 offset:1024
ds_read_b128 a[152:155], v17 offset:2048
ds_read_b128 a[156:159], v17 offset:3072
ds_read_b128 a[160:163], v17 offset:4096
ds_read_b128 a[164:167], v17 offset:5120
ds_read_b128 a[168:171], v17 offset:6144
ds_read_b128 a[172:175], v17 offset:7168
ds_read_b128 a[176:179], v17 offset:8192
ds_read_b128 a[180:183], v17 offset:9216
ds_read_b128 a[184:187], v17 offset:10240
ds_read_b128 a[188:191], v17 offset:11264
ds_read_b128 a[192:195], v17 offset:12288
ds_read_b128 a[196:199], v17 offset:13312
ds_read_b128 a[200:203], v17 offset:14336
ds_read_b128 a[204:207], v17 offset:15360
s_add_u32 s34, s56, 393216
v_and_b32 v224, 3, v1
v_cmp_eq_u32 vcc, 0, v224
v_mov_b32 v225, 0x4f804f80
s_nop 0
v_cndmask_b32 v224, 0, v225, vcc
v_mov_b32 v225, v224
v_mov_b32 v226, v224
v_mov_b32 v227, v224
v_mov_b32 v239, 0xff800000
v_mov_b32 v241, 0x40004000
v_and_b32 v237, 15, v1
v_lshrrev_b32 v238, 4, v1
v_lshlrev_b32 v238, 2, v238
v_sub_u32 v237, v237, v238
v_mov_b32 v238, 0xffff
v_cmp_le_i32 vcc, 0, v237
v_cmp_le_i32 s[44:45], 1, v237
s_nop 0
v_cndmask_b32 v242, 0, v238, vcc
v_cndmask_b32 v242, v242, -1, s[44:45]
v_cmp_le_i32 vcc, 2, v237
v_cmp_le_i32 s[44:45], 3, v237
s_nop 0
v_cndmask_b32 v243, 0, v238, vcc
v_cndmask_b32 v243, v243, -1, s[44:45]
s_lshl_b32 s32, s5, 2
s_add_u32 s37, s32, s3
s_cmp_gt_i32 s37, 0
s_cselect_b32 s32, -1, 0
v_and_b32 v252, s32, v242
v_and_b32 v253, s32, v243
s_waitcnt lgkmcnt(0)
v_mov_b32 v240, v16
v_mfma_f32_16x16x32_bf16 v[64:67], a[144:147], v[104:107], 0
buffer_store_dwordx4 a[228:231], v16, s[16:19], s34 offen offset:1024 sc1
v_mfma_f32_16x16x32_bf16 v[64:67], a[148:151], v[120:123], v[64:67]
v_mfma_f32_16x16x32_bf16 v[64:67], a[152:155], v[136:139], v[64:67]
v_mfma_f32_16x16x32_bf16 v[64:67], a[156:159], v[152:155], v[64:67]
v_mfma_f32_16x16x32_bf16 v[72:75], a[160:163], v[104:107], 0
v_mfma_f32_16x16x32_bf16 v[72:75], a[164:167], v[120:123], v[72:75]
v_mfma_f32_16x16x32_bf16 v[72:75], a[168:171], v[136:139], v[72:75]
v_mfma_f32_16x16x32_bf16 v[72:75], a[172:175], v[152:155], v[72:75]
v_mfma_f32_16x16x32_bf16 v[68:71], a[144:147], v[108:111], 0
buffer_store_dwordx4 a[232:235], v16, s[16:19], s34 offen offset:2048 sc1
v_mfma_f32_16x16x32_bf16 v[68:71], a[148:151], v[124:127], v[68:71]
v_mfma_f32_16x16x32_bf16 v[68:71], a[152:155], v[140:143], v[68:71]
v_max3_f32 v208, v64, v65, v66
s_nop 2
v_max3_f32 v208, v208, v67, v72
v_mfma_f32_16x16x32_bf16 v[68:71], a[156:159], v[156:159], v[68:71]
v_max3_f32 v208, v208, v73, v74
v_max_f32 v208, v208, v75
v_mfma_f32_16x16x32_bf16 v[76:79], a[160:163], v[108:111], 0
v_mov_b32 v209, v208
s_nop 1
v_permlane32_swap_b32 v209, v208
v_mfma_f32_16x16x32_bf16 v[76:79], a[164:167], v[124:127], v[76:79]
v_max_f32 v208, v208, v209
v_mov_b32 v209, v208
v_mfma_f32_16x16x32_bf16 v[76:79], a[168:171], v[140:143], v[76:79]
s_nop 0
v_permlane16_swap_b32 v209, v208
v_max_f32 v208, v208, v209
v_mfma_f32_16x16x32_bf16 v[76:79], a[172:175], v[156:159], v[76:79]
v_sub_f32 v200, 0xc2c80000, v208
v_sub_f32 v201, 0xc2c80000, v208
v_mfma_f32_16x16x32_bf16 v[32:35], a[144:147], v[96:99], 0
buffer_store_dwordx4 a[236:239], v16, s[16:19], s34 offen offset:3072 sc1
v_sub_f32 v202, 0xc2c80000, v208
v_sub_f32 v203, 0xc2c80000, v208
v_mfma_f32_16x16x32_bf16 v[32:35], a[148:151], v[112:115], v[32:35]
v_add_f32 v64, v64, v200
v_add_f32 v65, v65, v200
v_mfma_f32_16x16x32_bf16 v[32:35], a[152:155], v[128:131], v[32:35]
v_add_f32 v66, v66, v200
v_add_f32 v67, v67, v200
v_mfma_f32_16x16x32_bf16 v[32:35], a[156:159], v[144:147], v[32:35]
v_add_f32 v72, v72, v200
v_add_f32 v73, v73, v200
v_mfma_f32_16x16x32_bf16 v[40:43], a[160:163], v[96:99], 0
v_add_f32 v74, v74, v200
v_add_f32 v75, v75, v200
v_mfma_f32_16x16x32_bf16 v[40:43], a[164:167], v[112:115], v[40:43]
v_max3_f32 v210, v68, v69, v70
v_max3_f32 v210, v210, v71, v76
v_mfma_f32_16x16x32_bf16 v[40:43], a[168:171], v[128:131], v[40:43]
s_add_u32 s34, s55, 393216
buffer_store_dwordx4 a[240:243], v16, s[16:19], s34 offen offset:0 sc1
v_max3_f32 v210, v210, v77, v78
v_max_f32 v210, v210, v79
v_mfma_f32_16x16x32_bf16 v[40:43], a[172:175], v[144:147], v[40:43]
v_mov_b32 v211, v210
s_nop 1
v_permlane32_swap_b32 v211, v210
v_mfma_f32_16x16x32_bf16 v[36:39], a[144:147], v[100:103], 0
v_max_f32 v210, v210, v211
v_mov_b32 v211, v210
v_mfma_f32_16x16x32_bf16 v[36:39], a[148:151], v[116:119], v[36:39]
s_nop 0
v_permlane16_swap_b32 v211, v210
v_max_f32 v210, v210, v211
v_mfma_f32_16x16x32_bf16 v[36:39], a[152:155], v[132:135], v[36:39]
v_sub_f32 v204, 0xc2c80000, v210
v_sub_f32 v205, 0xc2c80000, v210
v_mfma_f32_16x16x32_bf16 v[36:39], a[156:159], v[148:151], v[36:39]
v_sub_f32 v206, 0xc2c80000, v210
v_sub_f32 v207, 0xc2c80000, v210
v_mfma_f32_16x16x32_bf16 v[44:47], a[160:163], v[100:103], 0
buffer_store_dwordx4 a[248:251], v16, s[16:19], s34 offen offset:1024 sc1
v_add_f32 v68, v68, v204
v_add_f32 v69, v69, v204
v_mfma_f32_16x16x32_bf16 v[44:47], a[164:167], v[116:119], v[44:47]
v_add_f32 v70, v70, v204
v_add_f32 v71, v71, v204
v_mfma_f32_16x16x32_bf16 v[44:47], a[168:171], v[132:135], v[44:47]
v_add_f32 v76, v76, v204
v_add_f32 v77, v77, v204
v_mfma_f32_16x16x32_bf16 v[44:47], a[172:175], v[148:151], v[44:47]
v_add_f32 v78, v78, v204
v_add_f32 v79, v79, v204
v_mfma_f32_16x16x32_bf16 v[80:83], a[176:179], v[104:107], v[200:203]
s_barrier
v_exp_f32 v228, v64
v_exp_f32 v229, v65
v_mfma_f32_16x16x32_bf16 v[80:83], a[180:183], v[120:123], v[80:83]
s_mov_b32 m0, s39
v_exp_f32 v230, v66
v_exp_f32 v231, v67
v_mfma_f32_16x16x32_bf16 v[80:83], a[184:187], v[136:139], v[80:83]
s_cmp_lg_u32 s37, 0
s_cbranch_scc1 L_nomask0
s_nop 7
s_call_b64 s[42:43], MK_0_0
L_nomask0:
v_cvt_pk_bf16_f32 v176, v228, v229
v_exp_f32 v232, v68
v_max3_f32 v212, v32, v33, v34
v_mfma_f32_16x16x32_bf16 v[80:83], a[188:191], v[152:155], v[80:83]
ds_read_b128 a[144:147], v240 offset:0
v_max3_f32 v214, v36, v37, v38
v_max3_f32 v212, v212, v35, v40
v_max3_f32 v214, v214, v39, v44
v_max3_f32 v212, v212, v41, v42
v_mfma_f32_16x16x32_bf16 v[88:91], a[192:195], v[104:107], v[200:203]
s_add_u32 s34, s55, 397312
buffer_store_dwordx4 a[244:247], v16, s[16:19], s34 offen offset:0 sc1
v_max3_f32 v214, v214, v45, v46
v_max_f32 v212, v212, v43
v_max_f32 v214, v214, v47
v_mov_b32 v213, v212
v_mfma_f32_16x16x32_bf16 v[88:91], a[196:199], v[120:123], v[88:91]
v_mov_b32 v215, v214
v_permlane32_swap_b32 v213, v212
s_nop 0
v_permlane32_swap_b32 v215, v214
v_max_f32 v212, v212, v213
v_mfma_f32_16x16x32_bf16 v[88:91], a[200:203], v[136:139], v[88:91]
ds_read_b128 a[148:151], v240 offset:1024
v_max_f32 v214, v214, v215
v_mov_b32 v213, v212
v_mov_b32 v215, v214
s_nop 0
v_permlane16_swap_b32 v213, v212
v_mfma_f32_16x16x32_bf16 v[88:91], a[204:207], v[152:155], v[88:91]
v_permlane16_swap_b32 v215, v214
v_max_f32 v212, v212, v213
v_max_f32 v214, v214, v215
v_sub_f32 v192, 0xc2c80000, v212
v_mfma_f32_16x16x32_bf16 v[84:87], a[176:179], v[108:111], v[204:207]
buffer_load_dwordx4 v16, s[16:19], s38 offen offset:0 sc1 lds
v_sub_f32 v196, 0xc2c80000, v214
v_sub_f32 v193, 0xc2c80000, v212
v_sub_f32 v197, 0xc2c80000, v214
v_sub_f32 v194, 0xc2c80000, v212
v_mfma_f32_16x16x32_bf16 v[84:87], a[180:183], v[124:127], v[84:87]
ds_read_b128 a[152:155], v240 offset:2048
v_sub_f32 v198, 0xc2c80000, v214
v_sub_f32 v195, 0xc2c80000, v212
v_sub_f32 v199, 0xc2c80000, v214
v_exp_f32 v233, v69
v_mfma_f32_16x16x32_bf16 v[84:87], a[184:187], v[140:143], v[84:87]
v_cvt_pk_bf16_f32 v177, v230, v231
v_exp_f32 v234, v70
v_exp_f32 v235, v71
v_mfma_f32_16x16x32_bf16 v[84:87], a[188:191], v[156:159], v[84:87]
v_cvt_pk_bf16_f32 v180, v232, v233
v_exp_f32 v228, v72
v_exp_f32 v229, v73
v_mfma_f32_16x16x32_bf16 v[92:95], a[192:195], v[108:111], v[204:207]
buffer_store_dwordx4 a[252:255], v16, s[16:19], s34 offen offset:1024 sc1
ds_read_b128 a[156:159], v240 offset:3072
v_cvt_pk_bf16_f32 v181, v234, v235
v_exp_f32 v230, v74
v_exp_f32 v231, v75
v_mfma_f32_16x16x32_bf16 v[92:95], a[196:199], v[124:127], v[92:95]
v_cvt_pk_bf16_f32 v178, v228, v229
v_exp_f32 v232, v76
v_exp_f32 v233, v77
v_mfma_f32_16x16x32_bf16 v[92:95], a[200:203], v[140:143], v[92:95]
buffer_load_dwordx4 v16, s[16:19], s38 offen offset:1024 sc1 lds
v_cvt_pk_bf16_f32 v179, v230, v231
v_exp_f32 v234, v78
v_exp_f32 v235, v79
v_mfma_f32_16x16x32_bf16 v[92:95], a[204:207], v[156:159], v[92:95]
ds_read_b128 a[160:163], v240 offset:4096
v_cvt_pk_bf16_f32 v182, v232, v233
v_cvt_pk_bf16_f32 v183, v234, v235
v_add_f32 v32, v32, v192
v_add_f32 v33, v33, v192
v_mfma_f32_16x16x32_bf16 v[48:51], a[176:179], v[96:99], v[192:195]
v_add_f32 v34, v34, v192
v_add_f32 v35, v35, v192
v_add_f32 v40, v40, v192
v_add_f32 v41, v41, v192
v_mfma_f32_16x16x32_bf16 v[48:51], a[180:183], v[112:115], v[48:51]
v_add_f32 v42, v42, v192
v_add_f32 v43, v43, v192
v_add_f32 v36, v36, v196
v_add_f32 v37, v37, v196
v_mfma_f32_16x16x32_bf16 v[48:51], a[184:187], v[128:131], v[48:51]
ds_read_b128 a[164:167], v240 offset:5120
v_add_f32 v38, v38, v196
v_add_f32 v39, v39, v196
v_add_f32 v44, v44, v196
v_add_f32 v45, v45, v196
v_mfma_f32_16x16x32_bf16 v[48:51], a[188:191], v[144:147], v[48:51]
v_add_f32 v46, v46, v196
v_add_f32 v47, v47, v196
v_exp_f32 v228, v32
v_mfma_f32_16x16x32_bf16 v[56:59], a[192:195], v[96:99], v[192:195]
buffer_load_dwordx4 v16, s[16:19], s38 offen offset:2048 sc1 lds
v_exp_f32 v229, v33
v_exp_f32 v230, v34
v_mfma_f32_16x16x32_bf16 v[56:59], a[196:199], v[112:115], v[56:59]
ds_read_b128 a[168:171], v240 offset:6144
v_exp_f32 v231, v35
v_cvt_pk_bf16_f32 v160, v228, v229
v_exp_f32 v232, v36
v_mfma_f32_16x16x32_bf16 v[56:59], a[200:203], v[128:131], v[56:59]
v_exp_f32 v233, v37
v_cvt_pk_bf16_f32 v161, v230, v231
v_exp_f32 v234, v38
v_mfma_f32_16x16x32_bf16 v[56:59], a[204:207], v[144:147], v[56:59]
v_exp_f32 v235, v39
v_cvt_pk_bf16_f32 v164, v232, v233
v_exp_f32 v228, v40
v_mfma_f32_16x16x32_bf16 v[52:55], a[176:179], v[100:103], v[196:199]
ds_read_b128 a[172:175], v240 offset:7168
v_exp_f32 v229, v41
v_cvt_pk_bf16_f32 v165, v234, v235
v_exp_f32 v230, v42
v_mfma_f32_16x16x32_bf16 v[52:55], a[180:183], v[116:119], v[52:55]
v_exp_f32 v231, v43
v_cvt_pk_bf16_f32 v162, v228, v229
v_exp_f32 v232, v44
v_mfma_f32_16x16x32_bf16 v[52:55], a[184:187], v[132:135], v[52:55]
buffer_load_dwordx4 v16, s[16:19], s38 offen offset:3072 sc1 lds
v_exp_f32 v233, v45
v_cvt_pk_bf16_f32 v163, v230, v231
v_exp_f32 v234, v46
v_mfma_f32_16x16x32_bf16 v[52:55], a[188:191], v[148:151], v[52:55]
v_exp_f32 v235, v47
v_cvt_pk_bf16_f32 v166, v232, v233
v_cvt_pk_bf16_f32 v167, v234, v235
v_mfma_f32_16x16x32_bf16 v[60:63], a[192:195], v[100:103], v[196:199]
s_add_u32 s38, s38, 4096
v_exp_f32 v228, v80
v_exp_f32 v229, v81
v_mfma_f32_16x16x32_bf16 v[60:63], a[196:199], v[116:119], v[60:63]
v_exp_f32 v230, v82
v_exp_f32 v231, v83
v_mfma_f32_16x16x32_bf16 v[60:63], a[200:203], v[132:135], v[60:63]
v_mfma_f32_16x16x32_bf16 v[60:63], a[204:207], v[148:151], v[60:63]
s_waitcnt lgkmcnt(0)
s_sub_u32 s37, s37, 1
s_cmp_gt_i32 s37, 0
s_cselect_b32 s58, -1, 0
s_cmp_ge_i32 s37, 0
s_cselect_b32 s59, -1, 0
v_mfma_f32_16x16x32_bf16 v[32:35], a[144:147], v[96:99], v[192:195]
v_exp_f32 v232, v84
v_mfma_f32_16x16x32_bf16 v[32:35], a[148:151], v[112:115], v[32:35]
ds_read_b128 a[176:179], v240 offset:24576
v_cvt_pk_bf16_f32 v184, v228, v229
v_mfma_f32_16x16x32_bf16 v[32:35], a[152:155], v[128:131], v[32:35]
v_cvt_pk_bf16_f32 v185, v230, v231
v_mfma_f32_16x16x32_bf16 v[32:35], a[156:159], v[144:147], v[32:35]
v_exp_f32 v233, v85
v_mfma_f32_16x16x32_bf16 v[36:39], a[144:147], v[100:103], v[196:199]
v_exp_f32 v234, v86
v_mfma_f32_16x16x32_bf16 v[36:39], a[148:151], v[116:119], v[36:39]
ds_read_b128 a[180:183], v240 offset:25600
v_cvt_pk_bf16_f32 v188, v232, v233
v_mfma_f32_16x16x32_bf16 v[36:39], a[152:155], v[132:135], v[36:39]
v_or3_b32 v236, v184, v185, v188
v_mfma_f32_16x16x32_bf16 v[36:39], a[156:159], v[148:151], v[36:39]
v_exp_f32 v235, v87
v_mfma_f32_16x16x32_bf16 v[64:67], a[144:147], v[104:107], v[200:203]
s_add_u32 m0, s39, 4096
v_exp_f32 v228, v88
v_mfma_f32_16x16x32_bf16 v[64:67], a[148:151], v[120:123], v[64:67]
ds_read_b128 a[184:187], v240 offset:26624
v_cvt_pk_bf16_f32 v189, v234, v235
v_mfma_f32_16x16x32_bf16 v[64:67], a[152:155], v[136:139], v[64:67]
buffer_load_dwordx4 v16, s[16:19], s38 offen offset:0 sc1 lds
v_mfma_f32_16x16x32_bf16 v[64:67], a[156:159], v[152:155], v[64:67]
v_exp_f32 v229, v89
v_mfma_f32_16x16x32_bf16 v[68:71], a[144:147], v[108:111], v[204:207]
v_cvt_pk_bf16_f32 v186, v228, v229
v_or3_b32 v236, v236, v189, v186
v_mfma_f32_16x16x32_bf16 v[68:71], a[148:151], v[124:127], v[68:71]
ds_read_b128 a[188:191], v240 offset:27648
v_mfma_f32_16x16x32_bf16 v[68:71], a[152:155], v[140:143], v[68:71]
v_exp_f32 v230, v90
v_mfma_f32_16x16x32_bf16 v[68:71], a[156:159], v[156:159], v[68:71]
s_waitcnt lgkmcnt(1)
v_exp_f32 v231, v91
v_mfma_f32_16x16x32_bf16 v[40:43], a[160:163], v[96:99], v[192:195]
v_cvt_pk_bf16_f32 v187, v230, v231
v_mfma_f32_16x16x32_bf16 v[40:43], a[164:167], v[112:115], v[40:43]
ds_read_b128 a[192:195], v240 offset:28672
v_exp_f32 v232, v92
v_mfma_f32_16x16x32_bf16 v[40:43], a[168:171], v[128:131], v[40:43]
v_mfma_f32_16x16x32_bf16 v[40:43], a[172:175], v[144:147], v[40:43]
v_exp_f32 v233, v93
v_mfma_f32_16x16x32_bf16 v[44:47], a[160:163], v[100:103], v[196:199]
v_exp_f32 v234, v94
v_mfma_f32_16x16x32_bf16 v[44:47], a[164:167], v[116:119], v[44:47]
ds_read_b128 a[196:199], v240 offset:29696
v_cvt_pk_bf16_f32 v190, v232, v233
v_mfma_f32_16x16x32_bf16 v[44:47], a[168:171], v[132:135], v[44:47]
v_or3_b32 v236, v236, v187, v190
v_mfma_f32_16x16x32_bf16 v[44:47], a[172:175], v[148:151], v[44:47]
v_exp_f32 v235, v95
v_mfma_f32_16x16x32_bf16 v[72:75], a[160:163], v[104:107], v[200:203]
v_exp_f32 v228, v48
v_mfma_f32_16x16x32_bf16 v[72:75], a[164:167], v[120:123], v[72:75]
ds_read_b128 a[200:203], v240 offset:30720
v_cvt_pk_bf16_f32 v191, v234, v235
v_mfma_f32_16x16x32_bf16 v[72:75], a[168:171], v[136:139], v[72:75]
buffer_load_dwordx4 v16, s[16:19], s38 offen offset:1024 sc1 lds
v_mfma_f32_16x16x32_bf16 v[72:75], a[172:175], v[152:155], v[72:75]
v_mfma_f32_16x16x32_bf16 v[76:79], a[160:163], v[108:111], v[204:207]
v_exp_f32 v229, v49
v_mfma_f32_16x16x32_bf16 v[76:79], a[164:167], v[124:127], v[76:79]
ds_read_b128 a[204:207], v240 offset:31744
v_cvt_pk_bf16_f32 v168, v228, v229
v_mfma_f32_16x16x32_bf16 v[76:79], a[168:171], v[140:143], v[76:79]
v_bitop3_b32 v168, v168, v252, s58 bitop3:0xe0
v_or3_b32 v236, v236, v191, v168
v_mfma_f32_16x16x32_bf16 v[76:79], a[172:175], v[156:159], v[76:79]
v_exp_f32 v230, v50
v_mfma_f32_16x16x32_bf16 a[128:131], v[224:227], v[160:163], 0
v_exp_f32 v231, v51
v_mfma_f32_16x16x32_bf16 a[132:135], v[224:227], v[164:167], 0
ds_read_b128 a[144:147], v240 offset:8192
v_cvt_pk_bf16_f32 v169, v230, v231
v_bitop3_b32 v169, v169, v253, s58 bitop3:0xe0
v_mfma_f32_16x16x32_bf16 a[136:139], v[224:227], v[176:179], 0
v_exp_f32 v232, v52
v_mfma_f32_16x16x32_bf16 a[140:143], v[224:227], v[180:183], 0
v_exp_f32 v233, v53
v_mfma_f32_16x16x32_bf16 a[0:3], a[176:179], v[160:163], 0
v_cvt_pk_bf16_f32 v172, v232, v233
v_and_b32 v172, s59, v172
v_mfma_f32_16x16x32_bf16 a[4:7], a[176:179], v[164:167], 0
ds_read_b128 a[148:151], v240 offset:9216
v_or3_b32 v236, v236, v169, v172
v_mfma_f32_16x16x32_bf16 a[64:67], a[176:179], v[176:179], 0
v_exp_f32 v234, v54
v_mfma_f32_16x16x32_bf16 a[68:71], a[176:179], v[180:183], 0
v_mfma_f32_16x16x32_bf16 a[8:11], a[180:183], v[160:163], 0
v_exp_f32 v235, v55
v_mfma_f32_16x16x32_bf16 a[12:15], a[180:183], v[164:167], 0
ds_read_b128 a[152:155], v240 offset:10240
v_cvt_pk_bf16_f32 v173, v234, v235
v_mfma_f32_16x16x32_bf16 a[72:75], a[180:183], v[176:179], 0
buffer_load_dwordx4 v16, s[16:19], s38 offen offset:2048 sc1 lds
v_mfma_f32_16x16x32_bf16 a[76:79], a[180:183], v[180:183], 0
v_exp_f32 v228, v56
v_mfma_f32_16x16x32_bf16 a[16:19], a[184:187], v[160:163], 0
v_and_b32 v173, s59, v173
v_mfma_f32_16x16x32_bf16 a[20:23], a[184:187], v[164:167], 0
ds_read_b128 a[156:159], v240 offset:11264
v_mfma_f32_16x16x32_bf16 a[80:83], a[184:187], v[176:179], 0
v_exp_f32 v229, v57
v_mfma_f32_16x16x32_bf16 a[84:87], a[184:187], v[180:183], 0
s_waitcnt lgkmcnt(1)
v_exp_f32 v230, v58
v_mfma_f32_16x16x32_bf16 a[24:27], a[188:191], v[160:163], 0
v_cvt_pk_bf16_f32 v170, v228, v229
v_and_b32 v170, s58, v170
v_mfma_f32_16x16x32_bf16 a[28:31], a[188:191], v[164:167], 0
ds_read_b128 a[160:163], v240 offset:12288
v_exp_f32 v231, v59
v_mfma_f32_16x16x32_bf16 a[88:91], a[188:191], v[176:179], 0
v_or3_b32 v236, v236, v173, v170
v_cvt_pk_bf16_f32 v171, v230, v231
v_mfma_f32_16x16x32_bf16 a[92:95], a[188:191], v[180:183], 0
v_exp_f32 v232, v60
v_mfma_f32_16x16x32_bf16 a[32:35], a[192:195], v[160:163], 0
v_exp_f32 v233, v61
v_mfma_f32_16x16x32_bf16 a[36:39], a[192:195], v[164:167], 0
ds_read_b128 a[164:167], v240 offset:13312
v_and_b32 v171, s58, v171
v_mfma_f32_16x16x32_bf16 a[96:99], a[192:195], v[176:179], 0
v_cvt_pk_bf16_f32 v174, v232, v233
v_bitop3_b32 v174, v174, v252, s58 bitop3:0xe0
v_mfma_f32_16x16x32_bf16 a[100:103], a[192:195], v[180:183], 0
v_exp_f32 v234, v62
v_mfma_f32_16x16x32_bf16 a[40:43], a[196:199], v[160:163], 0
v_or3_b32 v236, v236, v171, v174
v_and_b32 v252, s58, v252
v_mfma_f32_16x16x32_bf16 a[44:47], a[196:199], v[164:167], 0
ds_read_b128 a[168:171], v240 offset:14336
v_mfma_f32_16x16x32_bf16 a[104:107], a[196:199], v[176:179], 0
buffer_load_dwordx4 v16, s[16:19], s38 offen offset:3072 sc1 lds
v_mfma_f32_16x16x32_bf16 a[108:111], a[196:199], v[180:183], 0
s_add_u32 s38, s38, 12288
v_exp_f32 v235, v63
v_mfma_f32_16x16x32_bf16 a[48:51], a[200:203], v[160:163], 0
v_exp_f32 v228, v64
v_mfma_f32_16x16x32_bf16 a[52:55], a[200:203], v[164:167], 0
ds_read_b128 a[172:175], v240 offset:15360
v_cvt_pk_bf16_f32 v175, v234, v235
v_mfma_f32_16x16x32_bf16 a[112:115], a[200:203], v[176:179], 0
v_bitop3_b32 v175, v175, v253, s58 bitop3:0xe0
v_bitop3_b32 v236, v236, v175, v241 bitop3:0xa8
v_mfma_f32_16x16x32_bf16 a[116:119], a[200:203], v[180:183], 0
v_exp_f32 v229, v65
v_mfma_f32_16x16x32_bf16 a[56:59], a[204:207], v[160:163], 0
v_exp_f32 v230, v66
v_mfma_f32_16x16x32_bf16 a[60:63], a[204:207], v[164:167], 0
v_cmp_ne_u32 vcc, 0, v236
v_and_b32 v253, s58, v253
v_mfma_f32_16x16x32_bf16 a[120:123], a[204:207], v[176:179], 0
s_waitcnt lgkmcnt(4)
v_exp_f32 v231, v67
v_mfma_f32_16x16x32_bf16 a[124:127], a[204:207], v[180:183], 0
s_cbranch_vccnz fb_concat_12
fbret_concat_13:
s_waitcnt vmcnt(7)
s_barrier
s_cmp_lg_u32 s3, 0
s_cbranch_scc1 w0_concat_14
v_mov_b32 v31, 0
v_mov_b32 v29, 1
s_mov_b64 exec, 1
s_mov_b32 s60, s62
buffer_atomic_add v29, v31, s[16:19], s60 offen sc1
s_mov_b64 exec, -1
w0_concat_14:
s_sub_u32 s40, s5, 2
s_max_i32 s40, s40, 1
s_cmp_eq_u32 s5, 0
s_cbranch_scc1 A_D1_2
s_mov_b32 s31, s5
s_add_u32 s37, s3, 1
s_branch A_L1_2
.p2align 6
A_L1_0:
s_cmp_eq_u32 s31, s40
s_cbranch_scc1 LC_1
LCR_1:
v_mfma_f32_16x16x32_bf16 v[48:51], a[144:147], v[96:99], v[192:195]
s_waitcnt vmcnt(8)
s_barrier
v_mfma_f32_16x16x32_bf16 v[48:51], a[148:151], v[112:115], v[48:51]
ds_read_b128 a[176:179], v240 offset:16384
v_cvt_pk_bf16_f32 v176, v228, v229
v_mfma_f32_16x16x32_bf16 v[48:51], a[152:155], v[128:131], v[48:51]
v_exp_f32 v232, v68
v_mfma_f32_16x16x32_bf16 v[48:51], a[156:159], v[144:147], v[48:51]
v_exp_f32 v233, v69
v_mfma_f32_16x16x32_bf16 v[52:55], a[144:147], v[100:103], v[196:199]
v_cvt_pk_bf16_f32 v177, v230, v231
v_cvt_pk_bf16_f32 v180, v232, v233
v_mfma_f32_16x16x32_bf16 v[52:55], a[148:151], v[116:119], v[52:55]
ds_read_b128 a[180:183], v240 offset:17408
v_or3_b32 v236, v176, v177, v180
v_mfma_f32_16x16x32_bf16 v[52:55], a[152:155], v[132:135], v[52:55]
v_exp_f32 v234, v70
v_mfma_f32_16x16x32_bf16 v[52:55], a[156:159], v[148:151], v[52:55]
v_exp_f32 v235, v71
v_mfma_f32_16x16x32_bf16 v[80:83], a[144:147], v[104:107], v[200:203]
s_mov_b32 m0, s39
v_cvt_pk_bf16_f32 v181, v234, v235
v_mfma_f32_16x16x32_bf16 v[80:83], a[148:151], v[120:123], v[80:83]
ds_read_b128 a[184:187], v240 offset:18432
v_mfma_f32_16x16x32_bf16 v[80:83], a[152:155], v[136:139], v[80:83]
buffer_load_dwordx4 v16, s[16:19], s38 offen offset:0 sc1 lds
v_mfma_f32_16x16x32_bf16 v[80:83], a[156:159], v[152:155], v[80:83]
v_exp_f32 v228, v72
v_mfma_f32_16x16x32_bf16 v[84:87], a[144:147], v[108:111], v[204:207]
v_exp_f32 v229, v73
v_mfma_f32_16x16x32_bf16 v[84:87], a[148:151], v[124:127], v[84:87]
ds_read_b128 a[188:191], v240 offset:19456
v_cvt_pk_bf16_f32 v178, v228, v229
v_mfma_f32_16x16x32_bf16 v[84:87], a[152:155], v[140:143], v[84:87]
v_or3_b32 v236, v236, v181, v178
v_mfma_f32_16x16x32_bf16 v[84:87], a[156:159], v[156:159], v[84:87]
s_waitcnt lgkmcnt(1)
v_exp_f32 v230, v74
v_mfma_f32_16x16x32_bf16 v[56:59], a[160:163], v[96:99], v[192:195]
v_exp_f32 v231, v75
v_mfma_f32_16x16x32_bf16 v[56:59], a[164:167], v[112:115], v[56:59]
ds_read_b128 a[192:195], v240 offset:20480
v_cvt_pk_bf16_f32 v179, v230, v231
v_mfma_f32_16x16x32_bf16 v[56:59], a[168:171], v[128:131], v[56:59]
v_mfma_f32_16x16x32_bf16 v[56:59], a[172:175], v[144:147], v[56:59]
v_exp_f32 v232, v76
v_mfma_f32_16x16x32_bf16 v[60:63], a[160:163], v[100:103], v[196:199]
v_exp_f32 v233, v77
v_mfma_f32_16x16x32_bf16 v[60:63], a[164:167], v[116:119], v[60:63]
ds_read_b128 a[196:199], v240 offset:21504
v_cvt_pk_bf16_f32 v182, v232, v233
v_mfma_f32_16x16x32_bf16 v[60:63], a[168:171], v[132:135], v[60:63]
v_or3_b32 v236, v236, v179, v182
v_mfma_f32_16x16x32_bf16 v[60:63], a[172:175], v[148:151], v[60:63]
v_exp_f32 v234, v78
v_mfma_f32_16x16x32_bf16 v[88:91], a[160:163], v[104:107], v[200:203]
v_exp_f32 v235, v79
v_mfma_f32_16x16x32_bf16 v[88:91], a[164:167], v[120:123], v[88:91]
ds_read_b128 a[200:203], v240 offset:22528
v_cvt_pk_bf16_f32 v183, v234, v235
v_mfma_f32_16x16x32_bf16 v[88:91], a[168:171], v[136:139], v[88:91]
buffer_load_dwordx4 v16, s[16:19], s38 offen offset:1024 sc1 lds
v_mfma_f32_16x16x32_bf16 v[88:91], a[172:175], v[152:155], v[88:91]
v_exp_f32 v228, v32
v_mfma_f32_16x16x32_bf16 v[92:95], a[160:163], v[108:111], v[204:207]
v_mfma_f32_16x16x32_bf16 v[92:95], a[164:167], v[124:127], v[92:95]
ds_read_b128 a[204:207], v240 offset:23552
v_mfma_f32_16x16x32_bf16 v[92:95], a[168:171], v[140:143], v[92:95]
v_exp_f32 v229, v33
v_mfma_f32_16x16x32_bf16 v[92:95], a[172:175], v[156:159], v[92:95]
v_exp_f32 v230, v34
v_mfma_f32_16x16x32_bf16 a[128:131], v[224:227], v[168:171], a[128:131]
v_cvt_pk_bf16_f32 v160, v228, v229
v_or3_b32 v236, v236, v183, v160
v_mfma_f32_16x16x32_bf16 a[132:135], v[224:227], v[172:175], a[132:135]
ds_read_b128 a[144:147], v240 offset:0
v_mfma_f32_16x16x32_bf16 a[136:139], v[224:227], v[184:187], a[136:139]
v_exp_f32 v231, v35
v_mfma_f32_16x16x32_bf16 a[140:143], v[224:227], v[188:191], a[140:143]
v_exp_f32 v232, v36
v_mfma_f32_16x16x32_bf16 a[0:3], a[176:179], v[168:171], a[0:3]
v_cvt_pk_bf16_f32 v161, v230, v231
v_mfma_f32_16x16x32_bf16 a[4:7], a[176:179], v[172:175], a[4:7]
ds_read_b128 a[148:151], v240 offset:1024
v_mfma_f32_16x16x32_bf16 a[64:67], a[176:179], v[184:187], a[64:67]
v_exp_f32 v233, v37
v_mfma_f32_16x16x32_bf16 a[68:71], a[176:179], v[188:191], a[68:71]
v_exp_f32 v234, v38
v_mfma_f32_16x16x32_bf16 a[8:11], a[180:183], v[168:171], a[8:11]
v_cvt_pk_bf16_f32 v164, v232, v233
v_or3_b32 v236, v236, v161, v164
v_mfma_f32_16x16x32_bf16 a[12:15], a[180:183], v[172:175], a[12:15]
ds_read_b128 a[152:155], v240 offset:2048
v_mfma_f32_16x16x32_bf16 a[72:75], a[180:183], v[184:187], a[72:75]
buffer_load_dwordx4 v16, s[16:19], s38 offen offset:2048 sc1 lds
v_mfma_f32_16x16x32_bf16 a[76:79], a[180:183], v[188:191], a[76:79]
v_exp_f32 v235, v39
v_mfma_f32_16x16x32_bf16 a[16:19], a[184:187], v[168:171], a[16:19]
v_exp_f32 v228, v40
v_mfma_f32_16x16x32_bf16 a[20:23], a[184:187], v[172:175], a[20:23]
ds_read_b128 a[156:159], v240 offset:3072
v_cvt_pk_bf16_f32 v165, v234, v235
v_mfma_f32_16x16x32_bf16 a[80:83], a[184:187], v[184:187], a[80:83]
v_exp_f32 v229, v41
v_mfma_f32_16x16x32_bf16 a[84:87], a[184:187], v[188:191], a[84:87]
s_waitcnt lgkmcnt(1)
v_cvt_pk_bf16_f32 v162, v228, v229
v_or3_b32 v236, v236, v165, v162
v_mfma_f32_16x16x32_bf16 a[24:27], a[188:191], v[168:171], a[24:27]
v_exp_f32 v230, v42
v_mfma_f32_16x16x32_bf16 a[28:31], a[188:191], v[172:175], a[28:31]
ds_read_b128 a[160:163], v240 offset:4096
v_mfma_f32_16x16x32_bf16 a[88:91], a[188:191], v[184:187], a[88:91]
v_exp_f32 v231, v43
v_mfma_f32_16x16x32_bf16 a[92:95], a[188:191], v[188:191], a[92:95]
v_cvt_pk_bf16_f32 v163, v230, v231
v_mfma_f32_16x16x32_bf16 a[32:35], a[192:195], v[168:171], a[32:35]
v_exp_f32 v232, v44
v_mfma_f32_16x16x32_bf16 a[36:39], a[192:195], v[172:175], a[36:39]
ds_read_b128 a[164:167], v240 offset:5120
v_mfma_f32_16x16x32_bf16 a[96:99], a[192:195], v[184:187], a[96:99]
v_exp_f32 v233, v45
v_mfma_f32_16x16x32_bf16 a[100:103], a[192:195], v[188:191], a[100:103]
v_cvt_pk_bf16_f32 v166, v232, v233
v_or3_b32 v236, v236, v163, v166
v_mfma_f32_16x16x32_bf16 a[40:43], a[196:199], v[168:171], a[40:43]
v_exp_f32 v234, v46
v_mfma_f32_16x16x32_bf16 a[44:47], a[196:199], v[172:175], a[44:47]
ds_read_b128 a[168:171], v240 offset:6144
v_mfma_f32_16x16x32_bf16 a[104:107], a[196:199], v[184:187], a[104:107]
buffer_load_dwordx4 v16, s[16:19], s38 offen offset:3072 sc1 lds
v_mfma_f32_16x16x32_bf16 a[108:111], a[196:199], v[188:191], a[108:111]
s_add_u32 s38, s38, 4096
v_exp_f32 v235, v47
v_mfma_f32_16x16x32_bf16 a[48:51], a[200:203], v[168:171], a[48:51]
v_cvt_pk_bf16_f32 v167, v234, v235
v_bitop3_b32 v236, v236, v167, v241 bitop3:0xa8
v_mfma_f32_16x16x32_bf16 a[52:55], a[200:203], v[172:175], a[52:55]
ds_read_b128 a[172:175], v240 offset:7168
v_cmp_ne_u32 vcc, 0, v236
v_mfma_f32_16x16x32_bf16 a[112:115], a[200:203], v[184:187], a[112:115]
v_exp_f32 v228, v80
v_mfma_f32_16x16x32_bf16 a[116:119], a[200:203], v[188:191], a[116:119]
v_exp_f32 v229, v81
v_mfma_f32_16x16x32_bf16 a[56:59], a[204:207], v[168:171], a[56:59]
v_mfma_f32_16x16x32_bf16 a[60:63], a[204:207], v[172:175], a[60:63]
v_exp_f32 v230, v82
v_mfma_f32_16x16x32_bf16 a[120:123], a[204:207], v[184:187], a[120:123]
s_waitcnt lgkmcnt(4)
v_exp_f32 v231, v83
v_mfma_f32_16x16x32_bf16 a[124:127], a[204:207], v[188:191], a[124:127]
s_cbranch_vccnz fb_concat_15
fbret_concat_16:
v_mfma_f32_16x16x32_bf16 v[32:35], a[144:147], v[96:99], v[192:195]
v_exp_f32 v232, v84
v_mfma_f32_16x16x32_bf16 v[32:35], a[148:151], v[112:115], v[32:35]
ds_read_b128 a[176:179], v240 offset:24576
v_cvt_pk_bf16_f32 v184, v228, v229
v_mfma_f32_16x16x32_bf16 v[32:35], a[152:155], v[128:131], v[32:35]
v_exp_f32 v233, v85
v_mfma_f32_16x16x32_bf16 v[32:35], a[156:159], v[144:147], v[32:35]
v_cvt_pk_bf16_f32 v185, v230, v231
v_cvt_pk_bf16_f32 v188, v232, v233
v_mfma_f32_16x16x32_bf16 v[36:39], a[144:147], v[100:103], v[196:199]
v_exp_f32 v234, v86
v_mfma_f32_16x16x32_bf16 v[36:39], a[148:151], v[116:119], v[36:39]
ds_read_b128 a[180:183], v240 offset:25600
v_or3_b32 v236, v184, v185, v188
v_mfma_f32_16x16x32_bf16 v[36:39], a[152:155], v[132:135], v[36:39]
v_exp_f32 v235, v87
v_mfma_f32_16x16x32_bf16 v[36:39], a[156:159], v[148:151], v[36:39]
v_cvt_pk_bf16_f32 v189, v234, v235
v_mfma_f32_16x16x32_bf16 v[64:67], a[144:147], v[104:107], v[200:203]
s_add_u32 m0, s39, 4096
v_exp_f32 v228, v88
v_mfma_f32_16x16x32_bf16 v[64:67], a[148:151], v[120:123], v[64:67]
ds_read_b128 a[184:187], v240 offset:26624
v_mfma_f32_16x16x32_bf16 v[64:67], a[152:155], v[136:139], v[64:67]
buffer_load_dwordx4 v16, s[16:19], s38 offen offset:0 sc1 lds
v_mfma_f32_16x16x32_bf16 v[64:67], a[156:159], v[152:155], v[64:67]
v_exp_f32 v229, v89
v_mfma_f32_16x16x32_bf16 v[68:71], a[144:147], v[108:111], v[204:207]
v_cvt_pk_bf16_f32 v186, v228, v229
v_or3_b32 v236, v236, v189, v186
v_mfma_f32_16x16x32_bf16 v[68:71], a[148:151], v[124:127], v[68:71]
ds_read_b128 a[188:191], v240 offset:27648
v_mfma_f32_16x16x32_bf16 v[68:71], a[152:155], v[140:143], v[68:71]
v_exp_f32 v230, v90
v_mfma_f32_16x16x32_bf16 v[68:71], a[156:159], v[156:159], v[68:71]
s_waitcnt lgkmcnt(1)
v_exp_f32 v231, v91
v_mfma_f32_16x16x32_bf16 v[40:43], a[160:163], v[96:99], v[192:195]
v_cvt_pk_bf16_f32 v187, v230, v231
v_mfma_f32_16x16x32_bf16 v[40:43], a[164:167], v[112:115], v[40:43]
ds_read_b128 a[192:195], v240 offset:28672
v_mfma_f32_16x16x32_bf16 v[40:43], a[168:171], v[128:131], v[40:43]
v_exp_f32 v232, v92
v_mfma_f32_16x16x32_bf16 v[40:43], a[172:175], v[144:147], v[40:43]
v_exp_f32 v233, v93
v_mfma_f32_16x16x32_bf16 v[44:47], a[160:163], v[100:103], v[196:199]
v_cvt_pk_bf16_f32 v190, v232, v233
v_or3_b32 v236, v236, v187, v190
v_mfma_f32_16x16x32_bf16 v[44:47], a[164:167], v[116:119], v[44:47]
ds_read_b128 a[196:199], v240 offset:29696
v_mfma_f32_16x16x32_bf16 v[44:47], a[168:171], v[132:135], v[44:47]
v_exp_f32 v234, v94
v_mfma_f32_16x16x32_bf16 v[44:47], a[172:175], v[148:151], v[44:47]
v_exp_f32 v235, v95
v_mfma_f32_16x16x32_bf16 v[72:75], a[160:163], v[104:107], v[200:203]
v_cvt_pk_bf16_f32 v191, v234, v235
v_mfma_f32_16x16x32_bf16 v[72:75], a[164:167], v[120:123], v[72:75]
ds_read_b128 a[200:203], v240 offset:30720
v_mfma_f32_16x16x32_bf16 v[72:75], a[168:171], v[136:139], v[72:75]
buffer_load_dwordx4 v16, s[16:19], s38 offen offset:1024 sc1 lds
v_mfma_f32_16x16x32_bf16 v[72:75], a[172:175], v[152:155], v[72:75]
v_exp_f32 v228, v48
v_mfma_f32_16x16x32_bf16 v[76:79], a[160:163], v[108:111], v[204:207]
v_exp_f32 v229, v49
v_mfma_f32_16x16x32_bf16 v[76:79], a[164:167], v[124:127], v[76:79]
ds_read_b128 a[204:207], v240 offset:31744
v_cvt_pk_bf16_f32 v168, v228, v229
v_mfma_f32_16x16x32_bf16 v[76:79], a[168:171], v[140:143], v[76:79]
v_or3_b32 v236, v236, v191, v168
v_mfma_f32_16x16x32_bf16 v[76:79], a[172:175], v[156:159], v[76:79]
v_exp_f32 v230, v50
v_mfma_f32_16x16x32_bf16 a[128:131], v[224:227], v[160:163], a[128:131]
v_exp_f32 v231, v51
v_mfma_f32_16x16x32_bf16 a[132:135], v[224:227], v[164:167], a[132:135]
ds_read_b128 a[144:147], v240 offset:8192
v_cvt_pk_bf16_f32 v169, v230, v231
v_mfma_f32_16x16x32_bf16 a[136:139], v[224:227], v[176:179], a[136:139]
v_mfma_f32_16x16x32_bf16 a[140:143], v[224:227], v[180:183], a[140:143]
v_exp_f32 v232, v52
v_mfma_f32_16x16x32_bf16 a[0:3], a[176:179], v[160:163], a[0:3]
v_exp_f32 v233, v53
v_mfma_f32_16x16x32_bf16 a[4:7], a[176:179], v[164:167], a[4:7]
ds_read_b128 a[148:151], v240 offset:9216
v_cvt_pk_bf16_f32 v172, v232, v233
v_mfma_f32_16x16x32_bf16 a[64:67], a[176:179], v[176:179], a[64:67]
v_or3_b32 v236, v236, v169, v172
v_mfma_f32_16x16x32_bf16 a[68:71], a[176:179], v[180:183], a[68:71]
v_exp_f32 v234, v54
v_mfma_f32_16x16x32_bf16 a[8:11], a[180:183], v[160:163], a[8:11]
v_exp_f32 v235, v55
v_mfma_f32_16x16x32_bf16 a[12:15], a[180:183], v[164:167], a[12:15]
ds_read_b128 a[152:155], v240 offset:10240
v_cvt_pk_bf16_f32 v173, v234, v235
v_mfma_f32_16x16x32_bf16 a[72:75], a[180:183], v[176:179], a[72:75]
buffer_load_dwordx4 v16, s[16:19], s38 offen offset:2048 sc1 lds
v_mfma_f32_16x16x32_bf16 a[76:79], a[180:183], v[180:183], a[76:79]
v_mfma_f32_16x16x32_bf16 a[16:19], a[184:187], v[160:163], a[16:19]
v_exp_f32 v228, v56
v_mfma_f32_16x16x32_bf16 a[20:23], a[184:187], v[164:167], a[20:23]
ds_read_b128 a[156:159], v240 offset:11264
v_mfma_f32_16x16x32_bf16 a[80:83], a[184:187], v[176:179], a[80:83]
v_exp_f32 v229, v57
v_mfma_f32_16x16x32_bf16 a[84:87], a[184:187], v[180:183], a[84:87]
s_waitcnt lgkmcnt(1)
v_cvt_pk_bf16_f32 v170, v228, v229
v_or3_b32 v236, v236, v173, v170
v_mfma_f32_16x16x32_bf16 a[24:27], a[188:191], v[160:163], a[24:27]
v_exp_f32 v230, v58
v_mfma_f32_16x16x32_bf16 a[28:31], a[188:191], v[164:167], a[28:31]
ds_read_b128 a[160:163], v240 offset:12288
v_mfma_f32_16x16x32_bf16 a[88:91], a[188:191], v[176:179], a[88:91]
v_exp_f32 v231, v59
v_mfma_f32_16x16x32_bf16 a[92:95], a[188:191], v[180:183], a[92:95]
v_cvt_pk_bf16_f32 v171, v230, v231
v_mfma_f32_16x16x32_bf16 a[32:35], a[192:195], v[160:163], a[32:35]
v_exp_f32 v232, v60
v_mfma_f32_16x16x32_bf16 a[36:39], a[192:195], v[164:167], a[36:39]
ds_read_b128 a[164:167], v240 offset:13312
v_mfma_f32_16x16x32_bf16 a[96:99], a[192:195], v[176:179], a[96:99]
v_exp_f32 v233, v61
v_mfma_f32_16x16x32_bf16 a[100:103], a[192:195], v[180:183], a[100:103]
v_cvt_pk_bf16_f32 v174, v232, v233
v_or3_b32 v236, v236, v171, v174
v_mfma_f32_16x16x32_bf16 a[40:43], a[196:199], v[160:163], a[40:43]
v_exp_f32 v234, v62
v_mfma_f32_16x16x32_bf16 a[44:47], a[196:199], v[164:167], a[44:47]
ds_read_b128 a[168:171], v240 offset:14336
v_mfma_f32_16x16x32_bf16 a[104:107], a[196:199], v[176:179], a[104:107]
buffer_load_dwordx4 v16, s[16:19], s38 offen offset:3072 sc1 lds
v_mfma_f32_16x16x32_bf16 a[108:111], a[196:199], v[180:183], a[108:111]
s_add_u32 s38, s38, 12288
v_exp_f32 v235, v63
v_mfma_f32_16x16x32_bf16 a[48:51], a[200:203], v[160:163], a[48:51]
v_cvt_pk_bf16_f32 v175, v234, v235
v_bitop3_b32 v236, v236, v175, v241 bitop3:0xa8
v_mfma_f32_16x16x32_bf16 a[52:55], a[200:203], v[164:167], a[52:55]
ds_read_b128 a[172:175], v240 offset:15360
v_cmp_ne_u32 vcc, 0, v236
v_mfma_f32_16x16x32_bf16 a[112:115], a[200:203], v[176:179], a[112:115]
v_exp_f32 v228, v64
v_mfma_f32_16x16x32_bf16 a[116:119], a[200:203], v[180:183], a[116:119]
v_exp_f32 v229, v65
v_mfma_f32_16x16x32_bf16 a[56:59], a[204:207], v[160:163], a[56:59]
v_mfma_f32_16x16x32_bf16 a[60:63], a[204:207], v[164:167], a[60:63]
v_exp_f32 v230, v66
v_mfma_f32_16x16x32_bf16 a[120:123], a[204:207], v[176:179], a[120:123]
s_waitcnt lgkmcnt(4)
v_exp_f32 v231, v67
v_mfma_f32_16x16x32_bf16 a[124:127], a[204:207], v[180:183], a[124:127]
s_cbranch_vccnz fb_concat_17
fbret_concat_18:
A_L1_2:
v_mfma_f32_16x16x32_bf16 v[48:51], a[144:147], v[96:99], v[192:195]
s_waitcnt vmcnt(8)
s_barrier
v_mfma_f32_16x16x32_bf16 v[48:51], a[148:151], v[112:115], v[48:51]
ds_read_b128 a[176:179], v240 offset:49152
v_cvt_pk_bf16_f32 v176, v228, v229
v_mfma_f32_16x16x32_bf16 v[48:51], a[152:155], v[128:131], v[48:51]
v_exp_f32 v232, v68
v_mfma_f32_16x16x32_bf16 v[48:51], a[156:159], v[144:147], v[48:51]
v_exp_f32 v233, v69
v_mfma_f32_16x16x32_bf16 v[52:55], a[144:147], v[100:103], v[196:199]
v_cvt_pk_bf16_f32 v177, v230, v231
v_cvt_pk_bf16_f32 v180, v232, v233
v_mfma_f32_16x16x32_bf16 v[52:55], a[148:151], v[116:119], v[52:55]
ds_read_b128 a[180:183], v240 offset:50176
v_or3_b32 v236, v176, v177, v180
v_mfma_f32_16x16x32_bf16 v[52:55], a[152:155], v[132:135], v[52:55]
v_exp_f32 v234, v70
v_mfma_f32_16x16x32_bf16 v[52:55], a[156:159], v[148:151], v[52:55]
v_exp_f32 v235, v71
v_mfma_f32_16x16x32_bf16 v[80:83], a[144:147], v[104:107], v[200:203]
s_add_u32 m0, s39, 32768
v_cvt_pk_bf16_f32 v181, v234, v235
v_mfma_f32_16x16x32_bf16 v[80:83], a[148:151], v[120:123], v[80:83]
ds_read_b128 a[184:187], v240 offset:51200
v_mfma_f32_16x16x32_bf16 v[80:83], a[152:155], v[136:139], v[80:83]
buffer_load_dwordx4 v16, s[16:19], s38 offen offset:0 sc1 lds
v_mfma_f32_16x16x32_bf16 v[80:83], a[156:159], v[152:155], v[80:83]
v_exp_f32 v228, v72
v_mfma_f32_16x16x32_bf16 v[84:87], a[144:147], v[108:111], v[204:207]
v_exp_f32 v229, v73
v_mfma_f32_16x16x32_bf16 v[84:87], a[148:151], v[124:127], v[84:87]
ds_read_b128 a[188:191], v240 offset:52224
v_cvt_pk_bf16_f32 v178, v228, v229
v_mfma_f32_16x16x32_bf16 v[84:87], a[152:155], v[140:143], v[84:87]
v_or3_b32 v236, v236, v181, v178
v_mfma_f32_16x16x32_bf16 v[84:87], a[156:159], v[156:159], v[84:87]
s_waitcnt lgkmcnt(1)
v_exp_f32 v230, v74
v_mfma_f32_16x16x32_bf16 v[56:59], a[160:163], v[96:99], v[192:195]
v_exp_f32 v231, v75
v_mfma_f32_16x16x32_bf16 v[56:59], a[164:167], v[112:115], v[56:59]
ds_read_b128 a[192:195], v240 offset:53248
v_cvt_pk_bf16_f32 v179, v230, v231
v_mfma_f32_16x16x32_bf16 v[56:59], a[168:171], v[128:131], v[56:59]
v_mfma_f32_16x16x32_bf16 v[56:59], a[172:175], v[144:147], v[56:59]
v_exp_f32 v232, v76
v_mfma_f32_16x16x32_bf16 v[60:63], a[160:163], v[100:103], v[196:199]
v_exp_f32 v233, v77
v_mfma_f32_16x16x32_bf16 v[60:63], a[164:167], v[116:119], v[60:63]
ds_read_b128 a[196:199], v240 offset:54272
v_cvt_pk_bf16_f32 v182, v232, v233
v_mfma_f32_16x16x32_bf16 v[60:63], a[168:171], v[132:135], v[60:63]
v_or3_b32 v236, v236, v179, v182
v_mfma_f32_16x16x32_bf16 v[60:63], a[172:175], v[148:151], v[60:63]
v_exp_f32 v234, v78
v_mfma_f32_16x16x32_bf16 v[88:91], a[160:163], v[104:107], v[200:203]
v_exp_f32 v235, v79
v_mfma_f32_16x16x32_bf16 v[88:91], a[164:167], v[120:123], v[88:91]
ds_read_b128 a[200:203], v240 offset:55296
v_cvt_pk_bf16_f32 v183, v234, v235
v_mfma_f32_16x16x32_bf16 v[88:91], a[168:171], v[136:139], v[88:91]
buffer_load_dwordx4 v16, s[16:19], s38 offen offset:1024 sc1 lds
v_mfma_f32_16x16x32_bf16 v[88:91], a[172:175], v[152:155], v[88:91]
v_exp_f32 v228, v32
v_mfma_f32_16x16x32_bf16 v[92:95], a[160:163], v[108:111], v[204:207]
v_mfma_f32_16x16x32_bf16 v[92:95], a[164:167], v[124:127], v[92:95]
ds_read_b128 a[204:207], v240 offset:56320
v_mfma_f32_16x16x32_bf16 v[92:95], a[168:171], v[140:143], v[92:95]
v_exp_f32 v229, v33
v_mfma_f32_16x16x32_bf16 v[92:95], a[172:175], v[156:159], v[92:95]
v_exp_f32 v230, v34
v_mfma_f32_16x16x32_bf16 a[128:131], v[224:227], v[168:171], a[128:131]
v_cvt_pk_bf16_f32 v160, v228, v229
v_or3_b32 v236, v236, v183, v160
v_mfma_f32_16x16x32_bf16 a[132:135], v[224:227], v[172:175], a[132:135]
ds_read_b128 a[144:147], v240 offset:32768
v_mfma_f32_16x16x32_bf16 a[136:139], v[224:227], v[184:187], a[136:139]
v_exp_f32 v231, v35
v_mfma_f32_16x16x32_bf16 a[140:143], v[224:227], v[188:191], a[140:143]
v_exp_f32 v232, v36
v_mfma_f32_16x16x32_bf16 a[0:3], a[176:179], v[168:171], a[0:3]
v_cvt_pk_bf16_f32 v161, v230, v231
v_mfma_f32_16x16x32_bf16 a[4:7], a[176:179], v[172:175], a[4:7]
ds_read_b128 a[148:151], v240 offset:33792
v_mfma_f32_16x16x32_bf16 a[64:67], a[176:179], v[184:187], a[64:67]
v_exp_f32 v233, v37
v_mfma_f32_16x16x32_bf16 a[68:71], a[176:179], v[188:191], a[68:71]
v_exp_f32 v234, v38
v_mfma_f32_16x16x32_bf16 a[8:11], a[180:183], v[168:171], a[8:11]
v_cvt_pk_bf16_f32 v164, v232, v233
v_or3_b32 v236, v236, v161, v164
v_mfma_f32_16x16x32_bf16 a[12:15], a[180:183], v[172:175], a[12:15]
ds_read_b128 a[152:155], v240 offset:34816
v_mfma_f32_16x16x32_bf16 a[72:75], a[180:183], v[184:187], a[72:75]
buffer_load_dwordx4 v16, s[16:19], s38 offen offset:2048 sc1 lds
v_mfma_f32_16x16x32_bf16 a[76:79], a[180:183], v[188:191], a[76:79]
v_exp_f32 v235, v39
v_mfma_f32_16x16x32_bf16 a[16:19], a[184:187], v[168:171], a[16:19]
v_exp_f32 v228, v40
v_mfma_f32_16x16x32_bf16 a[20:23], a[184:187], v[172:175], a[20:23]
ds_read_b128 a[156:159], v240 offset:35840
v_cvt_pk_bf16_f32 v165, v234, v235
v_mfma_f32_16x16x32_bf16 a[80:83], a[184:187], v[184:187], a[80:83]
v_exp_f32 v229, v41
v_mfma_f32_16x16x32_bf16 a[84:87], a[184:187], v[188:191], a[84:87]
s_waitcnt lgkmcnt(1)
v_cvt_pk_bf16_f32 v162, v228, v229
v_or3_b32 v236, v236, v165, v162
v_mfma_f32_16x16x32_bf16 a[24:27], a[188:191], v[168:171], a[24:27]
v_exp_f32 v230, v42
v_mfma_f32_16x16x32_bf16 a[28:31], a[188:191], v[172:175], a[28:31]
ds_read_b128 a[160:163], v240 offset:36864
v_mfma_f32_16x16x32_bf16 a[88:91], a[188:191], v[184:187], a[88:91]
v_exp_f32 v231, v43
v_mfma_f32_16x16x32_bf16 a[92:95], a[188:191], v[188:191], a[92:95]
v_cvt_pk_bf16_f32 v163, v230, v231
v_mfma_f32_16x16x32_bf16 a[32:35], a[192:195], v[168:171], a[32:35]
v_exp_f32 v232, v44
v_mfma_f32_16x16x32_bf16 a[36:39], a[192:195], v[172:175], a[36:39]
ds_read_b128 a[164:167], v240 offset:37888
v_mfma_f32_16x16x32_bf16 a[96:99], a[192:195], v[184:187], a[96:99]
v_exp_f32 v233, v45
v_mfma_f32_16x16x32_bf16 a[100:103], a[192:195], v[188:191], a[100:103]
v_cvt_pk_bf16_f32 v166, v232, v233
v_or3_b32 v236, v236, v163, v166
v_mfma_f32_16x16x32_bf16 a[40:43], a[196:199], v[168:171], a[40:43]
v_exp_f32 v234, v46
v_mfma_f32_16x16x32_bf16 a[44:47], a[196:199], v[172:175], a[44:47]
ds_read_b128 a[168:171], v240 offset:38912
v_mfma_f32_16x16x32_bf16 a[104:107], a[196:199], v[184:187], a[104:107]
buffer_load_dwordx4 v16, s[16:19], s38 offen offset:3072 sc1 lds
v_mfma_f32_16x16x32_bf16 a[108:111], a[196:199], v[188:191], a[108:111]
s_add_u32 s38, s38, 4096
v_exp_f32 v235, v47
v_mfma_f32_16x16x32_bf16 a[48:51], a[200:203], v[168:171], a[48:51]
v_cvt_pk_bf16_f32 v167, v234, v235
v_bitop3_b32 v236, v236, v167, v241 bitop3:0xa8
v_mfma_f32_16x16x32_bf16 a[52:55], a[200:203], v[172:175], a[52:55]
ds_read_b128 a[172:175], v240 offset:39936
v_cmp_ne_u32 vcc, 0, v236
v_mfma_f32_16x16x32_bf16 a[112:115], a[200:203], v[184:187], a[112:115]
v_exp_f32 v228, v80
v_mfma_f32_16x16x32_bf16 a[116:119], a[200:203], v[188:191], a[116:119]
v_exp_f32 v229, v81
v_mfma_f32_16x16x32_bf16 a[56:59], a[204:207], v[168:171], a[56:59]
v_mfma_f32_16x16x32_bf16 a[60:63], a[204:207], v[172:175], a[60:63]
v_exp_f32 v230, v82
v_mfma_f32_16x16x32_bf16 a[120:123], a[204:207], v[184:187], a[120:123]
s_waitcnt lgkmcnt(4)
v_exp_f32 v231, v83
v_mfma_f32_16x16x32_bf16 a[124:127], a[204:207], v[188:191], a[124:127]
s_cbranch_vccnz fb_concat_19
fbret_concat_20:
v_mfma_f32_16x16x32_bf16 v[32:35], a[144:147], v[96:99], v[192:195]
v_exp_f32 v232, v84
v_mfma_f32_16x16x32_bf16 v[32:35], a[148:151], v[112:115], v[32:35]
ds_read_b128 a[176:179], v240 offset:57344
v_cvt_pk_bf16_f32 v184, v228, v229
v_mfma_f32_16x16x32_bf16 v[32:35], a[152:155], v[128:131], v[32:35]
v_exp_f32 v233, v85
v_mfma_f32_16x16x32_bf16 v[32:35], a[156:159], v[144:147], v[32:35]
v_cvt_pk_bf16_f32 v185, v230, v231
v_cvt_pk_bf16_f32 v188, v232, v233
v_mfma_f32_16x16x32_bf16 v[36:39], a[144:147], v[100:103], v[196:199]
v_exp_f32 v234, v86
v_mfma_f32_16x16x32_bf16 v[36:39], a[148:151], v[116:119], v[36:39]
ds_read_b128 a[180:183], v240 offset:58368
v_or3_b32 v236, v184, v185, v188
v_mfma_f32_16x16x32_bf16 v[36:39], a[152:155], v[132:135], v[36:39]
v_exp_f32 v235, v87
v_mfma_f32_16x16x32_bf16 v[36:39], a[156:159], v[148:151], v[36:39]
v_cvt_pk_bf16_f32 v189, v234, v235
v_mfma_f32_16x16x32_bf16 v[64:67], a[144:147], v[104:107], v[200:203]
s_add_u32 m0, s39, 36864
v_exp_f32 v228, v88
v_mfma_f32_16x16x32_bf16 v[64:67], a[148:151], v[120:123], v[64:67]
ds_read_b128 a[184:187], v240 offset:59392
v_mfma_f32_16x16x32_bf16 v[64:67], a[152:155], v[136:139], v[64:67]
buffer_load_dwordx4 v16, s[16:19], s38 offen offset:0 sc1 lds
v_mfma_f32_16x16x32_bf16 v[64:67], a[156:159], v[152:155], v[64:67]
v_exp_f32 v229, v89
v_mfma_f32_16x16x32_bf16 v[68:71], a[144:147], v[108:111], v[204:207]
v_cvt_pk_bf16_f32 v186, v228, v229
v_or3_b32 v236, v236, v189, v186
v_mfma_f32_16x16x32_bf16 v[68:71], a[148:151], v[124:127], v[68:71]
ds_read_b128 a[188:191], v240 offset:60416
v_mfma_f32_16x16x32_bf16 v[68:71], a[152:155], v[140:143], v[68:71]
v_exp_f32 v230, v90
v_mfma_f32_16x16x32_bf16 v[68:71], a[156:159], v[156:159], v[68:71]
s_waitcnt lgkmcnt(1)
v_exp_f32 v231, v91
v_mfma_f32_16x16x32_bf16 v[40:43], a[160:163], v[96:99], v[192:195]
v_cvt_pk_bf16_f32 v187, v230, v231
v_mfma_f32_16x16x32_bf16 v[40:43], a[164:167], v[112:115], v[40:43]
ds_read_b128 a[192:195], v240 offset:61440
v_mfma_f32_16x16x32_bf16 v[40:43], a[168:171], v[128:131], v[40:43]
v_exp_f32 v232, v92
v_mfma_f32_16x16x32_bf16 v[40:43], a[172:175], v[144:147], v[40:43]
v_exp_f32 v233, v93
v_mfma_f32_16x16x32_bf16 v[44:47], a[160:163], v[100:103], v[196:199]
v_cvt_pk_bf16_f32 v190, v232, v233
v_or3_b32 v236, v236, v187, v190
v_mfma_f32_16x16x32_bf16 v[44:47], a[164:167], v[116:119], v[44:47]
ds_read_b128 a[196:199], v240 offset:62464
v_mfma_f32_16x16x32_bf16 v[44:47], a[168:171], v[132:135], v[44:47]
v_exp_f32 v234, v94
v_mfma_f32_16x16x32_bf16 v[44:47], a[172:175], v[148:151], v[44:47]
v_exp_f32 v235, v95
v_mfma_f32_16x16x32_bf16 v[72:75], a[160:163], v[104:107], v[200:203]
v_cvt_pk_bf16_f32 v191, v234, v235
v_mfma_f32_16x16x32_bf16 v[72:75], a[164:167], v[120:123], v[72:75]
ds_read_b128 a[200:203], v240 offset:63488
v_mfma_f32_16x16x32_bf16 v[72:75], a[168:171], v[136:139], v[72:75]
buffer_load_dwordx4 v16, s[16:19], s38 offen offset:1024 sc1 lds
v_mfma_f32_16x16x32_bf16 v[72:75], a[172:175], v[152:155], v[72:75]
v_exp_f32 v228, v48
v_mfma_f32_16x16x32_bf16 v[76:79], a[160:163], v[108:111], v[204:207]
v_exp_f32 v229, v49
v_mfma_f32_16x16x32_bf16 v[76:79], a[164:167], v[124:127], v[76:79]
ds_read_b128 a[204:207], v240 offset:64512
v_cvt_pk_bf16_f32 v168, v228, v229
v_mfma_f32_16x16x32_bf16 v[76:79], a[168:171], v[140:143], v[76:79]
v_or3_b32 v236, v236, v191, v168
v_mfma_f32_16x16x32_bf16 v[76:79], a[172:175], v[156:159], v[76:79]
v_exp_f32 v230, v50
v_mfma_f32_16x16x32_bf16 a[128:131], v[224:227], v[160:163], a[128:131]
v_exp_f32 v231, v51
v_mfma_f32_16x16x32_bf16 a[132:135], v[224:227], v[164:167], a[132:135]
ds_read_b128 a[144:147], v240 offset:40960
v_cvt_pk_bf16_f32 v169, v230, v231
v_mfma_f32_16x16x32_bf16 a[136:139], v[224:227], v[176:179], a[136:139]
v_mfma_f32_16x16x32_bf16 a[140:143], v[224:227], v[180:183], a[140:143]
v_exp_f32 v232, v52
v_mfma_f32_16x16x32_bf16 a[0:3], a[176:179], v[160:163], a[0:3]
v_exp_f32 v233, v53
v_mfma_f32_16x16x32_bf16 a[4:7], a[176:179], v[164:167], a[4:7]
ds_read_b128 a[148:151], v240 offset:41984
v_cvt_pk_bf16_f32 v172, v232, v233
v_mfma_f32_16x16x32_bf16 a[64:67], a[176:179], v[176:179], a[64:67]
v_or3_b32 v236, v236, v169, v172
v_mfma_f32_16x16x32_bf16 a[68:71], a[176:179], v[180:183], a[68:71]
v_exp_f32 v234, v54
v_mfma_f32_16x16x32_bf16 a[8:11], a[180:183], v[160:163], a[8:11]
v_exp_f32 v235, v55
v_mfma_f32_16x16x32_bf16 a[12:15], a[180:183], v[164:167], a[12:15]
ds_read_b128 a[152:155], v240 offset:43008
v_cvt_pk_bf16_f32 v173, v234, v235
v_mfma_f32_16x16x32_bf16 a[72:75], a[180:183], v[176:179], a[72:75]
buffer_load_dwordx4 v16, s[16:19], s38 offen offset:2048 sc1 lds
v_mfma_f32_16x16x32_bf16 a[76:79], a[180:183], v[180:183], a[76:79]
v_mfma_f32_16x16x32_bf16 a[16:19], a[184:187], v[160:163], a[16:19]
v_exp_f32 v228, v56
v_mfma_f32_16x16x32_bf16 a[20:23], a[184:187], v[164:167], a[20:23]
ds_read_b128 a[156:159], v240 offset:44032
v_mfma_f32_16x16x32_bf16 a[80:83], a[184:187], v[176:179], a[80:83]
v_exp_f32 v229, v57
v_mfma_f32_16x16x32_bf16 a[84:87], a[184:187], v[180:183], a[84:87]
s_waitcnt lgkmcnt(1)
v_cvt_pk_bf16_f32 v170, v228, v229
v_or3_b32 v236, v236, v173, v170
v_mfma_f32_16x16x32_bf16 a[24:27], a[188:191], v[160:163], a[24:27]
v_exp_f32 v230, v58
v_mfma_f32_16x16x32_bf16 a[28:31], a[188:191], v[164:167], a[28:31]
ds_read_b128 a[160:163], v240 offset:45056
v_mfma_f32_16x16x32_bf16 a[88:91], a[188:191], v[176:179], a[88:91]
v_exp_f32 v231, v59
v_mfma_f32_16x16x32_bf16 a[92:95], a[188:191], v[180:183], a[92:95]
v_cvt_pk_bf16_f32 v171, v230, v231
v_mfma_f32_16x16x32_bf16 a[32:35], a[192:195], v[160:163], a[32:35]
v_exp_f32 v232, v60
v_mfma_f32_16x16x32_bf16 a[36:39], a[192:195], v[164:167], a[36:39]
ds_read_b128 a[164:167], v240 offset:46080
v_mfma_f32_16x16x32_bf16 a[96:99], a[192:195], v[176:179], a[96:99]
v_exp_f32 v233, v61
v_mfma_f32_16x16x32_bf16 a[100:103], a[192:195], v[180:183], a[100:103]
v_cvt_pk_bf16_f32 v174, v232, v233
v_or3_b32 v236, v236, v171, v174
v_mfma_f32_16x16x32_bf16 a[40:43], a[196:199], v[160:163], a[40:43]
v_exp_f32 v234, v62
v_mfma_f32_16x16x32_bf16 a[44:47], a[196:199], v[164:167], a[44:47]
ds_read_b128 a[168:171], v240 offset:47104
v_mfma_f32_16x16x32_bf16 a[104:107], a[196:199], v[176:179], a[104:107]
buffer_load_dwordx4 v16, s[16:19], s38 offen offset:3072 sc1 lds
v_mfma_f32_16x16x32_bf16 a[108:111], a[196:199], v[180:183], a[108:111]
s_add_u32 s38, s38, 12288
v_exp_f32 v235, v63
v_mfma_f32_16x16x32_bf16 a[48:51], a[200:203], v[160:163], a[48:51]
s_xor_b32 s39, s39, 0x10000
v_cvt_pk_bf16_f32 v175, v234, v235
v_bitop3_b32 v236, v236, v175, v241 bitop3:0xa8
v_mfma_f32_16x16x32_bf16 a[52:55], a[200:203], v[164:167], a[52:55]
ds_read_b128 a[172:175], v240 offset:48128
v_cmp_ne_u32 vcc, 0, v236
v_mfma_f32_16x16x32_bf16 a[112:115], a[200:203], v[176:179], a[112:115]
s_sub_u32 s31, s31, 1
v_exp_f32 v228, v64
v_mfma_f32_16x16x32_bf16 a[116:119], a[200:203], v[180:183], a[116:119]
s_cmp_lg_u32 s31, 0
v_exp_f32 v229, v65
v_mfma_f32_16x16x32_bf16 a[56:59], a[204:207], v[160:163], a[56:59]
v_xor_b32 v240, 0x10000, v240
v_mfma_f32_16x16x32_bf16 a[60:63], a[204:207], v[164:167], a[60:63]
v_exp_f32 v230, v66
v_mfma_f32_16x16x32_bf16 a[120:123], a[204:207], v[176:179], a[120:123]
s_waitcnt lgkmcnt(4)
v_exp_f32 v231, v67
v_mfma_f32_16x16x32_bf16 a[124:127], a[204:207], v[180:183], a[124:127]
s_cbranch_vccnz fb_concat_21
fbret_concat_22:
s_cbranch_scc1 A_L1_0
s_sub_u32 s37, s37, 1
s_cmp_gt_i32 s37, 0
s_cselect_b32 s58, -1, 0
s_cmp_ge_i32 s37, 0
s_cselect_b32 s59, -1, 0
v_mfma_f32_16x16x32_bf16 v[48:51], a[144:147], v[96:99], v[192:195]
s_waitcnt vmcnt(8)
s_barrier
v_mfma_f32_16x16x32_bf16 v[48:51], a[148:151], v[112:115], v[48:51]
ds_read_b128 a[176:179], v240 offset:16384
v_cvt_pk_bf16_f32 v176, v228, v229
v_mfma_f32_16x16x32_bf16 v[48:51], a[152:155], v[128:131], v[48:51]
v_exp_f32 v232, v68
v_mfma_f32_16x16x32_bf16 v[48:51], a[156:159], v[144:147], v[48:51]
v_cvt_pk_bf16_f32 v177, v230, v231
v_mfma_f32_16x16x32_bf16 v[52:55], a[144:147], v[100:103], v[196:199]
v_exp_f32 v233, v69
v_mfma_f32_16x16x32_bf16 v[52:55], a[148:151], v[116:119], v[52:55]
ds_read_b128 a[180:183], v240 offset:17408
v_cvt_pk_bf16_f32 v180, v232, v233
v_mfma_f32_16x16x32_bf16 v[52:55], a[152:155], v[132:135], v[52:55]
v_exp_f32 v234, v70
v_mfma_f32_16x16x32_bf16 v[52:55], a[156:159], v[148:151], v[52:55]
v_or3_b32 v236, v176, v177, v180
v_mfma_f32_16x16x32_bf16 v[80:83], a[144:147], v[104:107], v[200:203]
s_mov_b32 m0, s39
v_exp_f32 v235, v71
v_mfma_f32_16x16x32_bf16 v[80:83], a[148:151], v[120:123], v[80:83]
ds_read_b128 a[184:187], v240 offset:18432
v_exp_f32 v228, v72
v_mfma_f32_16x16x32_bf16 v[80:83], a[152:155], v[136:139], v[80:83]
buffer_load_dwordx4 v16, s[16:19], s38 offen offset:0 sc1 lds
v_mfma_f32_16x16x32_bf16 v[80:83], a[156:159], v[152:155], v[80:83]
v_cvt_pk_bf16_f32 v181, v234, v235
v_mfma_f32_16x16x32_bf16 v[84:87], a[144:147], v[108:111], v[204:207]
v_exp_f32 v229, v73
v_mfma_f32_16x16x32_bf16 v[84:87], a[148:151], v[124:127], v[84:87]
ds_read_b128 a[188:191], v240 offset:19456
v_cvt_pk_bf16_f32 v178, v228, v229
v_mfma_f32_16x16x32_bf16 v[84:87], a[152:155], v[140:143], v[84:87]
v_or3_b32 v236, v236, v181, v178
v_mfma_f32_16x16x32_bf16 v[84:87], a[156:159], v[156:159], v[84:87]
s_waitcnt lgkmcnt(1)
v_exp_f32 v230, v74
v_mfma_f32_16x16x32_bf16 v[56:59], a[160:163], v[96:99], v[192:195]
v_exp_f32 v231, v75
v_mfma_f32_16x16x32_bf16 v[56:59], a[164:167], v[112:115], v[56:59]
ds_read_b128 a[192:195], v240 offset:20480
v_cvt_pk_bf16_f32 v179, v230, v231
v_mfma_f32_16x16x32_bf16 v[56:59], a[168:171], v[128:131], v[56:59]
v_exp_f32 v232, v76
v_mfma_f32_16x16x32_bf16 v[56:59], a[172:175], v[144:147], v[56:59]
v_mfma_f32_16x16x32_bf16 v[60:63], a[160:163], v[100:103], v[196:199]
v_exp_f32 v233, v77
v_mfma_f32_16x16x32_bf16 v[60:63], a[164:167], v[116:119], v[60:63]
ds_read_b128 a[196:199], v240 offset:21504
v_cvt_pk_bf16_f32 v182, v232, v233
v_mfma_f32_16x16x32_bf16 v[60:63], a[168:171], v[132:135], v[60:63]
v_exp_f32 v234, v78
v_mfma_f32_16x16x32_bf16 v[60:63], a[172:175], v[148:151], v[60:63]
v_or3_b32 v236, v236, v179, v182
v_mfma_f32_16x16x32_bf16 v[88:91], a[160:163], v[104:107], v[200:203]
v_exp_f32 v235, v79
v_mfma_f32_16x16x32_bf16 v[88:91], a[164:167], v[120:123], v[88:91]
ds_read_b128 a[200:203], v240 offset:22528
v_exp_f32 v228, v32
v_mfma_f32_16x16x32_bf16 v[88:91], a[168:171], v[136:139], v[88:91]
buffer_load_dwordx4 v16, s[16:19], s38 offen offset:1024 sc1 lds
v_mfma_f32_16x16x32_bf16 v[88:91], a[172:175], v[152:155], v[88:91]
v_cvt_pk_bf16_f32 v183, v234, v235
v_mfma_f32_16x16x32_bf16 v[92:95], a[160:163], v[108:111], v[204:207]
v_exp_f32 v229, v33
v_mfma_f32_16x16x32_bf16 v[92:95], a[164:167], v[124:127], v[92:95]
ds_read_b128 a[204:207], v240 offset:23552
v_cvt_pk_bf16_f32 v160, v228, v229
v_mfma_f32_16x16x32_bf16 v[92:95], a[168:171], v[140:143], v[92:95]
v_bitop3_b32 v160, v160, v252, s58 bitop3:0xe0
v_or3_b32 v236, v236, v183, v160
v_mfma_f32_16x16x32_bf16 v[92:95], a[172:175], v[156:159], v[92:95]
v_exp_f32 v230, v34
v_mfma_f32_16x16x32_bf16 a[128:131], v[224:227], v[168:171], a[128:131]
v_exp_f32 v231, v35
v_mfma_f32_16x16x32_bf16 a[132:135], v[224:227], v[172:175], a[132:135]
ds_read_b128 a[144:147], v240 offset:0
v_cvt_pk_bf16_f32 v161, v230, v231
v_bitop3_b32 v161, v161, v253, s58 bitop3:0xe0
v_mfma_f32_16x16x32_bf16 a[136:139], v[224:227], v[184:187], a[136:139]
v_exp_f32 v232, v36
v_mfma_f32_16x16x32_bf16 a[140:143], v[224:227], v[188:191], a[140:143]
v_exp_f32 v233, v37
v_mfma_f32_16x16x32_bf16 a[0:3], a[176:179], v[168:171], a[0:3]
v_cvt_pk_bf16_f32 v164, v232, v233
v_and_b32 v164, s59, v164
v_mfma_f32_16x16x32_bf16 a[4:7], a[176:179], v[172:175], a[4:7]
ds_read_b128 a[148:151], v240 offset:1024
v_or3_b32 v236, v236, v161, v164
v_mfma_f32_16x16x32_bf16 a[64:67], a[176:179], v[184:187], a[64:67]
v_exp_f32 v234, v38
v_mfma_f32_16x16x32_bf16 a[68:71], a[176:179], v[188:191], a[68:71]
v_mfma_f32_16x16x32_bf16 a[8:11], a[180:183], v[168:171], a[8:11]
v_exp_f32 v235, v39
v_mfma_f32_16x16x32_bf16 a[12:15], a[180:183], v[172:175], a[12:15]
ds_read_b128 a[152:155], v240 offset:2048
v_cvt_pk_bf16_f32 v165, v234, v235
v_mfma_f32_16x16x32_bf16 a[72:75], a[180:183], v[184:187], a[72:75]
buffer_load_dwordx4 v16, s[16:19], s38 offen offset:2048 sc1 lds
v_mfma_f32_16x16x32_bf16 a[76:79], a[180:183], v[188:191], a[76:79]
v_exp_f32 v228, v40
v_mfma_f32_16x16x32_bf16 a[16:19], a[184:187], v[168:171], a[16:19]
v_and_b32 v165, s59, v165
v_mfma_f32_16x16x32_bf16 a[20:23], a[184:187], v[172:175], a[20:23]
ds_read_b128 a[156:159], v240 offset:3072
v_mfma_f32_16x16x32_bf16 a[80:83], a[184:187], v[184:187], a[80:83]
v_exp_f32 v229, v41
v_mfma_f32_16x16x32_bf16 a[84:87], a[184:187], v[188:191], a[84:87]
s_waitcnt lgkmcnt(1)
v_exp_f32 v230, v42
v_mfma_f32_16x16x32_bf16 a[24:27], a[188:191], v[168:171], a[24:27]
v_cvt_pk_bf16_f32 v162, v228, v229
v_and_b32 v162, s58, v162
v_mfma_f32_16x16x32_bf16 a[28:31], a[188:191], v[172:175], a[28:31]
ds_read_b128 a[160:163], v240 offset:4096
v_exp_f32 v231, v43
v_mfma_f32_16x16x32_bf16 a[88:91], a[188:191], v[184:187], a[88:91]
v_or3_b32 v236, v236, v165, v162
v_cvt_pk_bf16_f32 v163, v230, v231
v_mfma_f32_16x16x32_bf16 a[92:95], a[188:191], v[188:191], a[92:95]
v_exp_f32 v232, v44
v_mfma_f32_16x16x32_bf16 a[32:35], a[192:195], v[168:171], a[32:35]
v_exp_f32 v233, v45
v_mfma_f32_16x16x32_bf16 a[36:39], a[192:195], v[172:175], a[36:39]
ds_read_b128 a[164:167], v240 offset:5120
v_and_b32 v163, s58, v163
v_mfma_f32_16x16x32_bf16 a[96:99], a[192:195], v[184:187], a[96:99]
v_cvt_pk_bf16_f32 v166, v232, v233
v_bitop3_b32 v166, v166, v252, s58 bitop3:0xe0
v_mfma_f32_16x16x32_bf16 a[100:103], a[192:195], v[188:191], a[100:103]
v_exp_f32 v234, v46
v_mfma_f32_16x16x32_bf16 a[40:43], a[196:199], v[168:171], a[40:43]
v_or3_b32 v236, v236, v163, v166
v_and_b32 v252, s58, v252
v_mfma_f32_16x16x32_bf16 a[44:47], a[196:199], v[172:175], a[44:47]
ds_read_b128 a[168:171], v240 offset:6144
v_mfma_f32_16x16x32_bf16 a[104:107], a[196:199], v[184:187], a[104:107]
buffer_load_dwordx4 v16, s[16:19], s38 offen offset:3072 sc1 lds
v_mfma_f32_16x16x32_bf16 a[108:111], a[196:199], v[188:191], a[108:111]
s_add_u32 s38, s38, 4096
v_exp_f32 v235, v47
v_mfma_f32_16x16x32_bf16 a[48:51], a[200:203], v[168:171], a[48:51]
v_exp_f32 v228, v80
v_mfma_f32_16x16x32_bf16 a[52:55], a[200:203], v[172:175], a[52:55]
ds_read_b128 a[172:175], v240 offset:7168
v_cvt_pk_bf16_f32 v167, v234, v235
v_mfma_f32_16x16x32_bf16 a[112:115], a[200:203], v[184:187], a[112:115]
v_bitop3_b32 v167, v167, v253, s58 bitop3:0xe0
v_bitop3_b32 v236, v236, v167, v241 bitop3:0xa8
v_mfma_f32_16x16x32_bf16 a[116:119], a[200:203], v[188:191], a[116:119]
v_exp_f32 v229, v81
v_mfma_f32_16x16x32_bf16 a[56:59], a[204:207], v[168:171], a[56:59]
v_exp_f32 v230, v82
v_mfma_f32_16x16x32_bf16 a[60:63], a[204:207], v[172:175], a[60:63]
v_cmp_ne_u32 vcc, 0, v236
v_and_b32 v253, s58, v253
v_mfma_f32_16x16x32_bf16 a[120:123], a[204:207], v[184:187], a[120:123]
s_waitcnt lgkmcnt(4)
v_exp_f32 v231, v83
v_mfma_f32_16x16x32_bf16 a[124:127], a[204:207], v[188:191], a[124:127]
s_cbranch_vccnz fb_concat_23
fbret_concat_24:
s_sub_u32 s37, s37, 1
s_cmp_gt_i32 s37, 0
s_cselect_b32 s58, -1, 0
s_cmp_ge_i32 s37, 0
s_cselect_b32 s59, -1, 0
v_mfma_f32_16x16x32_bf16 v[32:35], a[144:147], v[96:99], v[192:195]
v_exp_f32 v232, v84
v_mfma_f32_16x16x32_bf16 v[32:35], a[148:151], v[112:115], v[32:35]
ds_read_b128 a[176:179], v240 offset:24576
v_cvt_pk_bf16_f32 v184, v228, v229
v_mfma_f32_16x16x32_bf16 v[32:35], a[152:155], v[128:131], v[32:35]
v_cvt_pk_bf16_f32 v185, v230, v231
v_mfma_f32_16x16x32_bf16 v[32:35], a[156:159], v[144:147], v[32:35]
v_exp_f32 v233, v85
v_mfma_f32_16x16x32_bf16 v[36:39], a[144:147], v[100:103], v[196:199]
v_exp_f32 v234, v86
v_mfma_f32_16x16x32_bf16 v[36:39], a[148:151], v[116:119], v[36:39]
ds_read_b128 a[180:183], v240 offset:25600
v_cvt_pk_bf16_f32 v188, v232, v233
v_mfma_f32_16x16x32_bf16 v[36:39], a[152:155], v[132:135], v[36:39]
v_or3_b32 v236, v184, v185, v188
v_mfma_f32_16x16x32_bf16 v[36:39], a[156:159], v[148:151], v[36:39]
v_exp_f32 v235, v87
v_mfma_f32_16x16x32_bf16 v[64:67], a[144:147], v[104:107], v[200:203]
s_add_u32 m0, s39, 4096
v_exp_f32 v228, v88
v_mfma_f32_16x16x32_bf16 v[64:67], a[148:151], v[120:123], v[64:67]
ds_read_b128 a[184:187], v240 offset:26624
v_cvt_pk_bf16_f32 v189, v234, v235
v_mfma_f32_16x16x32_bf16 v[64:67], a[152:155], v[136:139], v[64:67]
buffer_load_dwordx4 v16, s[16:19], s38 offen offset:0 sc1 lds
v_mfma_f32_16x16x32_bf16 v[64:67], a[156:159], v[152:155], v[64:67]
v_exp_f32 v229, v89
v_mfma_f32_16x16x32_bf16 v[68:71], a[144:147], v[108:111], v[204:207]
v_cvt_pk_bf16_f32 v186, v228, v229
v_or3_b32 v236, v236, v189, v186
v_mfma_f32_16x16x32_bf16 v[68:71], a[148:151], v[124:127], v[68:71]
ds_read_b128 a[188:191], v240 offset:27648
v_mfma_f32_16x16x32_bf16 v[68:71], a[152:155], v[140:143], v[68:71]
v_exp_f32 v230, v90
v_mfma_f32_16x16x32_bf16 v[68:71], a[156:159], v[156:159], v[68:71]
s_waitcnt lgkmcnt(1)
v_exp_f32 v231, v91
v_mfma_f32_16x16x32_bf16 v[40:43], a[160:163], v[96:99], v[192:195]
v_cvt_pk_bf16_f32 v187, v230, v231
v_mfma_f32_16x16x32_bf16 v[40:43], a[164:167], v[112:115], v[40:43]
ds_read_b128 a[192:195], v240 offset:28672
v_exp_f32 v232, v92
v_mfma_f32_16x16x32_bf16 v[40:43], a[168:171], v[128:131], v[40:43]
v_mfma_f32_16x16x32_bf16 v[40:43], a[172:175], v[144:147], v[40:43]
v_exp_f32 v233, v93
v_mfma_f32_16x16x32_bf16 v[44:47], a[160:163], v[100:103], v[196:199]
v_exp_f32 v234, v94
v_mfma_f32_16x16x32_bf16 v[44:47], a[164:167], v[116:119], v[44:47]
ds_read_b128 a[196:199], v240 offset:29696
v_cvt_pk_bf16_f32 v190, v232, v233
v_mfma_f32_16x16x32_bf16 v[44:47], a[168:171], v[132:135], v[44:47]
v_or3_b32 v236, v236, v187, v190
v_mfma_f32_16x16x32_bf16 v[44:47], a[172:175], v[148:151], v[44:47]
v_exp_f32 v235, v95
v_mfma_f32_16x16x32_bf16 v[72:75], a[160:163], v[104:107], v[200:203]
v_exp_f32 v228, v48
v_mfma_f32_16x16x32_bf16 v[72:75], a[164:167], v[120:123], v[72:75]
ds_read_b128 a[200:203], v240 offset:30720
v_cvt_pk_bf16_f32 v191, v234, v235
v_mfma_f32_16x16x32_bf16 v[72:75], a[168:171], v[136:139], v[72:75]
buffer_load_dwordx4 v16, s[16:19], s38 offen offset:1024 sc1 lds
v_mfma_f32_16x16x32_bf16 v[72:75], a[172:175], v[152:155], v[72:75]
v_mfma_f32_16x16x32_bf16 v[76:79], a[160:163], v[108:111], v[204:207]
v_exp_f32 v229, v49
v_mfma_f32_16x16x32_bf16 v[76:79], a[164:167], v[124:127], v[76:79]
ds_read_b128 a[204:207], v240 offset:31744
v_cvt_pk_bf16_f32 v168, v228, v229
v_mfma_f32_16x16x32_bf16 v[76:79], a[168:171], v[140:143], v[76:79]
v_bitop3_b32 v168, v168, v252, s58 bitop3:0xe0
v_or3_b32 v236, v236, v191, v168
v_mfma_f32_16x16x32_bf16 v[76:79], a[172:175], v[156:159], v[76:79]
v_exp_f32 v230, v50
v_mfma_f32_16x16x32_bf16 a[128:131], v[224:227], v[160:163], a[128:131]
v_exp_f32 v231, v51
v_mfma_f32_16x16x32_bf16 a[132:135], v[224:227], v[164:167], a[132:135]
ds_read_b128 a[144:147], v240 offset:8192
v_cvt_pk_bf16_f32 v169, v230, v231
v_bitop3_b32 v169, v169, v253, s58 bitop3:0xe0
v_mfma_f32_16x16x32_bf16 a[136:139], v[224:227], v[176:179], a[136:139]
v_exp_f32 v232, v52
v_mfma_f32_16x16x32_bf16 a[140:143], v[224:227], v[180:183], a[140:143]
v_exp_f32 v233, v53
v_mfma_f32_16x16x32_bf16 a[0:3], a[176:179], v[160:163], a[0:3]
v_cvt_pk_bf16_f32 v172, v232, v233
v_and_b32 v172, s59, v172
v_mfma_f32_16x16x32_bf16 a[4:7], a[176:179], v[164:167], a[4:7]
ds_read_b128 a[148:151], v240 offset:9216
v_or3_b32 v236, v236, v169, v172
v_mfma_f32_16x16x32_bf16 a[64:67], a[176:179], v[176:179], a[64:67]
v_exp_f32 v234, v54
v_mfma_f32_16x16x32_bf16 a[68:71], a[176:179], v[180:183], a[68:71]
v_mfma_f32_16x16x32_bf16 a[8:11], a[180:183], v[160:163], a[8:11]
v_exp_f32 v235, v55
v_mfma_f32_16x16x32_bf16 a[12:15], a[180:183], v[164:167], a[12:15]
ds_read_b128 a[152:155], v240 offset:10240
v_cvt_pk_bf16_f32 v173, v234, v235
v_mfma_f32_16x16x32_bf16 a[72:75], a[180:183], v[176:179], a[72:75]
buffer_load_dwordx4 v16, s[16:19], s38 offen offset:2048 sc1 lds
v_mfma_f32_16x16x32_bf16 a[76:79], a[180:183], v[180:183], a[76:79]
v_exp_f32 v228, v56
v_mfma_f32_16x16x32_bf16 a[16:19], a[184:187], v[160:163], a[16:19]
v_and_b32 v173, s59, v173
v_mfma_f32_16x16x32_bf16 a[20:23], a[184:187], v[164:167], a[20:23]
ds_read_b128 a[156:159], v240 offset:11264
v_mfma_f32_16x16x32_bf16 a[80:83], a[184:187], v[176:179], a[80:83]
v_exp_f32 v229, v57
v_mfma_f32_16x16x32_bf16 a[84:87], a[184:187], v[180:183], a[84:87]
s_waitcnt lgkmcnt(1)
v_exp_f32 v230, v58
v_mfma_f32_16x16x32_bf16 a[24:27], a[188:191], v[160:163], a[24:27]
v_cvt_pk_bf16_f32 v170, v228, v229
v_and_b32 v170, s58, v170
v_mfma_f32_16x16x32_bf16 a[28:31], a[188:191], v[164:167], a[28:31]
ds_read_b128 a[160:163], v240 offset:12288
v_exp_f32 v231, v59
v_mfma_f32_16x16x32_bf16 a[88:91], a[188:191], v[176:179], a[88:91]
v_or3_b32 v236, v236, v173, v170
v_cvt_pk_bf16_f32 v171, v230, v231
v_mfma_f32_16x16x32_bf16 a[92:95], a[188:191], v[180:183], a[92:95]
v_exp_f32 v232, v60
v_mfma_f32_16x16x32_bf16 a[32:35], a[192:195], v[160:163], a[32:35]
v_exp_f32 v233, v61
v_mfma_f32_16x16x32_bf16 a[36:39], a[192:195], v[164:167], a[36:39]
ds_read_b128 a[164:167], v240 offset:13312
v_and_b32 v171, s58, v171
v_mfma_f32_16x16x32_bf16 a[96:99], a[192:195], v[176:179], a[96:99]
v_cvt_pk_bf16_f32 v174, v232, v233
v_bitop3_b32 v174, v174, v252, s58 bitop3:0xe0
v_mfma_f32_16x16x32_bf16 a[100:103], a[192:195], v[180:183], a[100:103]
v_exp_f32 v234, v62
v_mfma_f32_16x16x32_bf16 a[40:43], a[196:199], v[160:163], a[40:43]
v_or3_b32 v236, v236, v171, v174
v_and_b32 v252, s58, v252
v_mfma_f32_16x16x32_bf16 a[44:47], a[196:199], v[164:167], a[44:47]
ds_read_b128 a[168:171], v240 offset:14336
v_mfma_f32_16x16x32_bf16 a[104:107], a[196:199], v[176:179], a[104:107]
buffer_load_dwordx4 v16, s[16:19], s38 offen offset:3072 sc1 lds
v_mfma_f32_16x16x32_bf16 a[108:111], a[196:199], v[180:183], a[108:111]
s_add_u32 s38, s38, 12288
v_exp_f32 v235, v63
v_mfma_f32_16x16x32_bf16 a[48:51], a[200:203], v[160:163], a[48:51]
v_exp_f32 v228, v64
v_mfma_f32_16x16x32_bf16 a[52:55], a[200:203], v[164:167], a[52:55]
ds_read_b128 a[172:175], v240 offset:15360
v_cvt_pk_bf16_f32 v175, v234, v235
v_mfma_f32_16x16x32_bf16 a[112:115], a[200:203], v[176:179], a[112:115]
v_bitop3_b32 v175, v175, v253, s58 bitop3:0xe0
v_bitop3_b32 v236, v236, v175, v241 bitop3:0xa8
v_mfma_f32_16x16x32_bf16 a[116:119], a[200:203], v[180:183], a[116:119]
v_exp_f32 v229, v65
v_mfma_f32_16x16x32_bf16 a[56:59], a[204:207], v[160:163], a[56:59]
v_exp_f32 v230, v66
v_mfma_f32_16x16x32_bf16 a[60:63], a[204:207], v[164:167], a[60:63]
v_cmp_ne_u32 vcc, 0, v236
v_and_b32 v253, s58, v253
v_mfma_f32_16x16x32_bf16 a[120:123], a[204:207], v[176:179], a[120:123]
s_waitcnt lgkmcnt(4)
v_exp_f32 v231, v67
v_mfma_f32_16x16x32_bf16 a[124:127], a[204:207], v[180:183], a[124:127]
s_cbranch_vccnz fb_concat_25
fbret_concat_26:
A_D1_2:
s_sub_u32 s37, s37, 1
s_cmp_gt_i32 s37, 0
s_cselect_b32 s58, -1, 0
s_cmp_ge_i32 s37, 0
s_cselect_b32 s59, -1, 0
v_mfma_f32_16x16x32_bf16 v[48:51], a[144:147], v[96:99], v[192:195]
s_waitcnt vmcnt(8)
s_barrier
v_mfma_f32_16x16x32_bf16 v[48:51], a[148:151], v[112:115], v[48:51]
s_lshr_b32 s33, s3, 1
ds_read_b128 a[176:179], v240 offset:49152
v_mfma_f32_16x16x32_bf16 v[48:51], a[152:155], v[128:131], v[48:51]
s_mul_i32 s32, s33, 6
s_and_b32 s33, s3, 1
s_add_u32 s32, s32, s33
v_cvt_pk_bf16_f32 v176, v228, v229
v_mfma_f32_16x16x32_bf16 v[48:51], a[156:159], v[144:147], v[48:51]
s_mul_i32 s33, s88, 12
s_add_u32 s32, s32, s33
s_lshl_b32 s32, s32, 10
v_mfma_f32_16x16x32_bf16 v[52:55], a[144:147], v[100:103], v[196:199]
s_add_u32 s32, s32, 63963136
s_add_u32 s33, s32, 4096
v_lshlrev_b32 v2, 2, v1
v_cvt_pk_bf16_f32 v177, v230, v231
v_mfma_f32_16x16x32_bf16 v[52:55], a[148:151], v[116:119], v[52:55]
ds_read_b128 a[180:183], v240 offset:50176
v_exp_f32 v232, v68
v_mfma_f32_16x16x32_bf16 v[52:55], a[152:155], v[132:135], v[52:55]
buffer_atomic_add_f32 v4, v2, s[16:19], s32 offen offset:0
v_mfma_f32_16x16x32_bf16 v[52:55], a[156:159], v[148:151], v[52:55]
v_exp_f32 v233, v69
v_mfma_f32_16x16x32_bf16 v[80:83], a[144:147], v[104:107], v[200:203]
s_add_u32 m0, s39, 32768
v_cvt_pk_bf16_f32 v180, v232, v233
v_or3_b32 v236, v176, v177, v180
v_mfma_f32_16x16x32_bf16 v[80:83], a[148:151], v[120:123], v[80:83]
ds_read_b128 a[184:187], v240 offset:51200
v_exp_f32 v234, v70
v_mfma_f32_16x16x32_bf16 v[80:83], a[152:155], v[136:139], v[80:83]
buffer_load_dwordx4 v16, s[16:19], s38 offen offset:0 sc1 lds
v_mfma_f32_16x16x32_bf16 v[80:83], a[156:159], v[152:155], v[80:83]
buffer_atomic_add_f32 v5, v2, s[16:19], s32 offen offset:256
v_mfma_f32_16x16x32_bf16 v[84:87], a[144:147], v[108:111], v[204:207]
v_exp_f32 v235, v71
v_mfma_f32_16x16x32_bf16 v[84:87], a[148:151], v[124:127], v[84:87]
ds_read_b128 a[188:191], v240 offset:52224
v_cvt_pk_bf16_f32 v181, v234, v235
v_mfma_f32_16x16x32_bf16 v[84:87], a[152:155], v[140:143], v[84:87]
buffer_atomic_add_f32 v6, v2, s[16:19], s32 offen offset:512
v_mfma_f32_16x16x32_bf16 v[84:87], a[156:159], v[156:159], v[84:87]
s_waitcnt lgkmcnt(1)
v_exp_f32 v228, v72
v_mfma_f32_16x16x32_bf16 v[56:59], a[160:163], v[96:99], v[192:195]
buffer_atomic_add_f32 v7, v2, s[16:19], s32 offen offset:768
v_mfma_f32_16x16x32_bf16 v[56:59], a[164:167], v[112:115], v[56:59]
ds_read_b128 a[192:195], v240 offset:53248
v_exp_f32 v229, v73
v_mfma_f32_16x16x32_bf16 v[56:59], a[168:171], v[128:131], v[56:59]
buffer_atomic_add_f32 v8, v2, s[16:19], s32 offen offset:2048
v_cvt_pk_bf16_f32 v178, v228, v229
v_mfma_f32_16x16x32_bf16 v[56:59], a[172:175], v[144:147], v[56:59]
v_or3_b32 v236, v236, v181, v178
v_mfma_f32_16x16x32_bf16 v[60:63], a[160:163], v[100:103], v[196:199]
buffer_atomic_add_f32 v9, v2, s[16:19], s32 offen offset:2304
v_mfma_f32_16x16x32_bf16 v[60:63], a[164:167], v[116:119], v[60:63]
ds_read_b128 a[196:199], v240 offset:54272
v_exp_f32 v230, v74
v_mfma_f32_16x16x32_bf16 v[60:63], a[168:171], v[132:135], v[60:63]
buffer_atomic_add_f32 v10, v2, s[16:19], s32 offen offset:2560
v_mfma_f32_16x16x32_bf16 v[60:63], a[172:175], v[148:151], v[60:63]
v_exp_f32 v231, v75
v_mfma_f32_16x16x32_bf16 v[88:91], a[160:163], v[104:107], v[200:203]
buffer_atomic_add_f32 v11, v2, s[16:19], s32 offen offset:2816
v_mfma_f32_16x16x32_bf16 v[88:91], a[164:167], v[120:123], v[88:91]
ds_read_b128 a[200:203], v240 offset:55296
v_cvt_pk_bf16_f32 v179, v230, v231
v_mfma_f32_16x16x32_bf16 v[88:91], a[168:171], v[136:139], v[88:91]
buffer_load_dwordx4 v16, s[16:19], s38 offen offset:1024 sc1 lds
v_mfma_f32_16x16x32_bf16 v[88:91], a[172:175], v[152:155], v[88:91]
buffer_atomic_add_f32 v12, v2, s[16:19], s33 offen offset:0
v_mfma_f32_16x16x32_bf16 v[92:95], a[160:163], v[108:111], v[204:207]
v_exp_f32 v232, v76
v_mfma_f32_16x16x32_bf16 v[92:95], a[164:167], v[124:127], v[92:95]
ds_read_b128 a[204:207], v240 offset:56320
v_exp_f32 v233, v77
v_mfma_f32_16x16x32_bf16 v[92:95], a[168:171], v[140:143], v[92:95]
buffer_atomic_add_f32 v13, v2, s[16:19], s33 offen offset:256
v_cvt_pk_bf16_f32 v182, v232, v233
v_mfma_f32_16x16x32_bf16 v[92:95], a[172:175], v[156:159], v[92:95]
v_or3_b32 v236, v236, v179, v182
v_mfma_f32_16x16x32_bf16 a[128:131], v[224:227], v[168:171], a[128:131]
buffer_atomic_add_f32 v14, v2, s[16:19], s33 offen offset:512
v_mfma_f32_16x16x32_bf16 a[132:135], v[224:227], v[172:175], a[132:135]
ds_read_b128 a[144:147], v240 offset:32768
v_exp_f32 v234, v78
v_mfma_f32_16x16x32_bf16 a[136:139], v[224:227], v[184:187], a[136:139]
buffer_atomic_add_f32 v15, v2, s[16:19], s33 offen offset:768
v_mfma_f32_16x16x32_bf16 a[140:143], v[224:227], v[188:191], a[140:143]
v_exp_f32 v235, v79
v_mfma_f32_16x16x32_bf16 a[0:3], a[176:179], v[168:171], a[0:3]
v_cvt_pk_bf16_f32 v183, v234, v235
v_exp_f32 v228, v32
v_mfma_f32_16x16x32_bf16 a[4:7], a[176:179], v[172:175], a[4:7]
ds_read_b128 a[148:151], v240 offset:33792
v_mfma_f32_16x16x32_bf16 a[64:67], a[176:179], v[184:187], a[64:67]
v_exp_f32 v229, v33
v_mfma_f32_16x16x32_bf16 a[68:71], a[176:179], v[188:191], a[68:71]
v_exp_f32 v230, v34
v_mfma_f32_16x16x32_bf16 a[8:11], a[180:183], v[168:171], a[8:11]
v_cvt_pk_bf16_f32 v160, v228, v229
v_bitop3_b32 v160, v160, v252, s58 bitop3:0xe0
v_mfma_f32_16x16x32_bf16 a[12:15], a[180:183], v[172:175], a[12:15]
ds_read_b128 a[152:155], v240 offset:34816
v_exp_f32 v231, v35
v_mfma_f32_16x16x32_bf16 a[72:75], a[180:183], v[184:187], a[72:75]
buffer_load_dwordx4 v16, s[16:19], s38 offen offset:2048 sc1 lds
v_or3_b32 v236, v236, v183, v160
v_mfma_f32_16x16x32_bf16 a[76:79], a[180:183], v[188:191], a[76:79]
v_exp_f32 v232, v36
v_mfma_f32_16x16x32_bf16 a[16:19], a[184:187], v[168:171], a[16:19]
v_cvt_pk_bf16_f32 v161, v230, v231
v_bitop3_b32 v161, v161, v253, s58 bitop3:0xe0
v_mfma_f32_16x16x32_bf16 a[20:23], a[184:187], v[172:175], a[20:23]
ds_read_b128 a[156:159], v240 offset:35840
v_exp_f32 v233, v37
v_mfma_f32_16x16x32_bf16 a[80:83], a[184:187], v[184:187], a[80:83]
v_cvt_pk_bf16_f32 v164, v232, v233
v_exp_f32 v234, v38
v_mfma_f32_16x16x32_bf16 a[84:87], a[184:187], v[188:191], a[84:87]
s_waitcnt lgkmcnt(1)
v_and_b32 v164, s59, v164
v_or3_b32 v236, v236, v161, v164
v_mfma_f32_16x16x32_bf16 a[24:27], a[188:191], v[168:171], a[24:27]
v_exp_f32 v235, v39
v_mfma_f32_16x16x32_bf16 a[28:31], a[188:191], v[172:175], a[28:31]
ds_read_b128 a[160:163], v240 offset:36864
v_exp_f32 v228, v40
v_mfma_f32_16x16x32_bf16 a[88:91], a[188:191], v[184:187], a[88:91]
v_cvt_pk_bf16_f32 v165, v234, v235
v_exp_f32 v229, v41
v_mfma_f32_16x16x32_bf16 a[92:95], a[188:191], v[188:191], a[92:95]
v_and_b32 v165, s59, v165
v_cvt_pk_bf16_f32 v162, v228, v229
v_and_b32 v162, s58, v162
v_mfma_f32_16x16x32_bf16 a[32:35], a[192:195], v[168:171], a[32:35]
v_or3_b32 v236, v236, v165, v162
v_exp_f32 v230, v42
v_mfma_f32_16x16x32_bf16 a[36:39], a[192:195], v[172:175], a[36:39]
ds_read_b128 a[164:167], v240 offset:37888
v_exp_f32 v231, v43
v_mfma_f32_16x16x32_bf16 a[96:99], a[192:195], v[184:187], a[96:99]
v_cvt_pk_bf16_f32 v163, v230, v231
v_and_b32 v163, s58, v163
v_mfma_f32_16x16x32_bf16 a[100:103], a[192:195], v[188:191], a[100:103]
v_exp_f32 v232, v44
v_mfma_f32_16x16x32_bf16 a[40:43], a[196:199], v[168:171], a[40:43]
v_exp_f32 v233, v45
v_mfma_f32_16x16x32_bf16 a[44:47], a[196:199], v[172:175], a[44:47]
ds_read_b128 a[168:171], v240 offset:38912
v_cvt_pk_bf16_f32 v166, v232, v233
v_bitop3_b32 v166, v166, v252, s58 bitop3:0xe0
v_mfma_f32_16x16x32_bf16 a[104:107], a[196:199], v[184:187], a[104:107]
buffer_load_dwordx4 v16, s[16:19], s38 offen offset:3072 sc1 lds
v_or3_b32 v236, v236, v163, v166
v_mfma_f32_16x16x32_bf16 a[108:111], a[196:199], v[188:191], a[108:111]
s_add_u32 s38, s38, 4096
v_exp_f32 v234, v46
v_and_b32 v252, s58, v252
v_mfma_f32_16x16x32_bf16 a[48:51], a[200:203], v[168:171], a[48:51]
v_exp_f32 v235, v47
v_mfma_f32_16x16x32_bf16 a[52:55], a[200:203], v[172:175], a[52:55]
ds_read_b128 a[172:175], v240 offset:39936
v_cvt_pk_bf16_f32 v167, v234, v235
v_bitop3_b32 v167, v167, v253, s58 bitop3:0xe0
v_mfma_f32_16x16x32_bf16 a[112:115], a[200:203], v[184:187], a[112:115]
v_bitop3_b32 v236, v236, v167, v241 bitop3:0xa8
v_exp_f32 v228, v80
v_mfma_f32_16x16x32_bf16 a[116:119], a[200:203], v[188:191], a[116:119]
v_exp_f32 v229, v81
v_mfma_f32_16x16x32_bf16 a[56:59], a[204:207], v[168:171], a[56:59]
v_cmp_ne_u32 vcc, 0, v236
v_and_b32 v253, s58, v253
v_mfma_f32_16x16x32_bf16 a[60:63], a[204:207], v[172:175], a[60:63]
v_exp_f32 v230, v82
v_mfma_f32_16x16x32_bf16 a[120:123], a[204:207], v[184:187], a[120:123]
s_waitcnt lgkmcnt(4)
v_exp_f32 v231, v83
v_mfma_f32_16x16x32_bf16 a[124:127], a[204:207], v[188:191], a[124:127]
s_cbranch_vccnz fb_concat_27
fbret_concat_28:
s_cmp_eq_u32 s5, 0
s_cselect_b32 s41, 0, 16
s_cmp_lg_u32 s3, 0
s_cbranch_scc1 w0_concat_29
v_mov_b32 v31, 0
buffer_load_dword v21, v31, s[16:19], s62 offen sc1
w0_concat_29:
s_sub_u32 s37, s37, 1
s_cmp_gt_i32 s37, 0
s_cselect_b32 s58, -1, 0
s_cmp_ge_i32 s37, 0
s_cselect_b32 s59, -1, 0
v_mfma_f32_16x16x32_bf16 v[64:67], a[144:147], v[104:107], v[200:203]
v_exp_f32 v232, v84
v_mfma_f32_16x16x32_bf16 v[64:67], a[148:151], v[120:123], v[64:67]
ds_read_b128 a[176:179], v240 offset:57344
v_cvt_pk_bf16_f32 v184, v228, v229
v_exp_f32 v233, v85
v_mfma_f32_16x16x32_bf16 v[64:67], a[152:155], v[136:139], v[64:67]
v_cvt_pk_bf16_f32 v185, v230, v231
v_cvt_pk_bf16_f32 v188, v232, v233
v_mfma_f32_16x16x32_bf16 v[64:67], a[156:159], v[152:155], v[64:67]
ds_read_b128 a[180:183], v240 offset:58368
v_or3_b32 v236, v184, v185, v188
v_exp_f32 v234, v86
v_mfma_f32_16x16x32_bf16 v[68:71], a[144:147], v[108:111], v[204:207]
v_exp_f32 v235, v87
v_mfma_f32_16x16x32_bf16 v[68:71], a[148:151], v[124:127], v[68:71]
ds_read_b128 a[184:187], v240 offset:59392
v_cvt_pk_bf16_f32 v189, v234, v235
v_mfma_f32_16x16x32_bf16 v[68:71], a[152:155], v[140:143], v[68:71]
s_waitcnt lgkmcnt(3)
v_exp_f32 v228, v88
v_mfma_f32_16x16x32_bf16 v[68:71], a[156:159], v[156:159], v[68:71]
ds_read_b128 a[188:191], v240 offset:60416
v_exp_f32 v229, v89
v_mfma_f32_16x16x32_bf16 v[72:75], a[160:163], v[104:107], v[200:203]
s_add_u32 m0, s39, 36864
v_cvt_pk_bf16_f32 v186, v228, v229
v_or3_b32 v236, v236, v189, v186
v_mfma_f32_16x16x32_bf16 v[72:75], a[164:167], v[120:123], v[72:75]
ds_read_b128 a[192:195], v240 offset:61440
v_exp_f32 v230, v90
v_mfma_f32_16x16x32_bf16 v[72:75], a[168:171], v[136:139], v[72:75]
buffer_load_dwordx4 v16, s[16:19], s38 offen offset:0 sc1 lds
v_mfma_f32_16x16x32_bf16 v[72:75], a[172:175], v[152:155], v[72:75]
ds_read_b128 a[196:199], v240 offset:62464
v_exp_f32 v231, v91
v_mfma_f32_16x16x32_bf16 v[76:79], a[160:163], v[108:111], v[204:207]
v_cvt_pk_bf16_f32 v187, v230, v231
v_mfma_f32_16x16x32_bf16 v[76:79], a[164:167], v[124:127], v[76:79]
ds_read_b128 a[200:203], v240 offset:63488
v_exp_f32 v232, v92
v_mfma_f32_16x16x32_bf16 v[76:79], a[168:171], v[140:143], v[76:79]
v_exp_f32 v233, v93
v_mfma_f32_16x16x32_bf16 v[76:79], a[172:175], v[156:159], v[76:79]
ds_read_b128 a[204:207], v240 offset:64512
v_cvt_pk_bf16_f32 v190, v232, v233
v_or3_b32 v236, v236, v187, v190
v_mfma_f32_16x16x32_bf16 a[128:131], v[224:227], v[160:163], a[128:131]
v_exp_f32 v234, v94
v_mfma_f32_16x16x32_bf16 a[132:135], v[224:227], v[164:167], a[132:135]
ds_read_b128 a[144:147], v240 offset:40960
v_exp_f32 v235, v95
v_mfma_f32_16x16x32_bf16 a[136:139], v[224:227], v[176:179], a[136:139]
v_cvt_pk_bf16_f32 v191, v234, v235
v_mfma_f32_16x16x32_bf16 a[140:143], v[224:227], v[180:183], a[140:143]
s_waitcnt lgkmcnt(2)
v_exp_f32 v228, v48
v_mfma_f32_16x16x32_bf16 a[0:3], a[176:179], v[160:163], a[0:3]
v_exp_f32 v229, v49
v_mfma_f32_16x16x32_bf16 a[4:7], a[176:179], v[164:167], a[4:7]
ds_read_b128 a[148:151], v240 offset:41984
v_cvt_pk_bf16_f32 v168, v228, v229
v_bitop3_b32 v168, v168, v252, s58 bitop3:0xe0
v_or3_b32 v236, v236, v191, v168
v_mfma_f32_16x16x32_bf16 a[64:67], a[176:179], v[176:179], a[64:67]
v_exp_f32 v230, v50
v_mfma_f32_16x16x32_bf16 a[68:71], a[176:179], v[180:183], a[68:71]
buffer_load_dwordx4 v16, s[16:19], s38 offen offset:1024 sc1 lds
v_mfma_f32_16x16x32_bf16 a[8:11], a[180:183], v[160:163], a[8:11]
v_exp_f32 v231, v51
v_mfma_f32_16x16x32_bf16 a[12:15], a[180:183], v[164:167], a[12:15]
ds_read_b128 a[152:155], v240 offset:43008
v_cvt_pk_bf16_f32 v169, v230, v231
v_bitop3_b32 v169, v169, v253, s58 bitop3:0xe0
v_mfma_f32_16x16x32_bf16 a[72:75], a[180:183], v[176:179], a[72:75]
v_exp_f32 v232, v52
v_mfma_f32_16x16x32_bf16 a[76:79], a[180:183], v[180:183], a[76:79]
v_exp_f32 v233, v53
v_mfma_f32_16x16x32_bf16 a[16:19], a[184:187], v[160:163], a[16:19]
v_cvt_pk_bf16_f32 v172, v232, v233
v_and_b32 v172, s59, v172
v_or3_b32 v236, v236, v169, v172
v_mfma_f32_16x16x32_bf16 a[20:23], a[184:187], v[164:167], a[20:23]
ds_read_b128 a[156:159], v240 offset:44032
v_exp_f32 v234, v54
v_mfma_f32_16x16x32_bf16 a[80:83], a[184:187], v[176:179], a[80:83]
v_exp_f32 v235, v55
v_mfma_f32_16x16x32_bf16 a[84:87], a[184:187], v[180:183], a[84:87]
v_cvt_pk_bf16_f32 v173, v234, v235
v_and_b32 v173, s59, v173
v_mfma_f32_16x16x32_bf16 a[24:27], a[188:191], v[160:163], a[24:27]
v_exp_f32 v228, v56
v_mfma_f32_16x16x32_bf16 a[28:31], a[188:191], v[164:167], a[28:31]
ds_read_b128 a[160:163], v240 offset:45056
v_exp_f32 v229, v57
v_mfma_f32_16x16x32_bf16 a[88:91], a[188:191], v[176:179], a[88:91]
buffer_load_dwordx4 v16, s[16:19], s38 offen offset:2048 sc1 lds
v_cvt_pk_bf16_f32 v170, v228, v229
v_mfma_f32_16x16x32_bf16 a[92:95], a[188:191], v[180:183], a[92:95]
v_and_b32 v170, s58, v170
v_or3_b32 v236, v236, v173, v170
v_mfma_f32_16x16x32_bf16 a[32:35], a[192:195], v[160:163], a[32:35]
v_exp_f32 v230, v58
v_mfma_f32_16x16x32_bf16 a[36:39], a[192:195], v[164:167], a[36:39]
ds_read_b128 a[164:167], v240 offset:46080
v_exp_f32 v231, v59
v_mfma_f32_16x16x32_bf16 a[96:99], a[192:195], v[176:179], a[96:99]
v_cvt_pk_bf16_f32 v171, v230, v231
v_and_b32 v171, s58, v171
v_mfma_f32_16x16x32_bf16 a[100:103], a[192:195], v[180:183], a[100:103]
v_exp_f32 v232, v60
v_mfma_f32_16x16x32_bf16 a[40:43], a[196:199], v[160:163], a[40:43]
v_exp_f32 v233, v61
v_mfma_f32_16x16x32_bf16 a[44:47], a[196:199], v[164:167], a[44:47]
ds_read_b128 a[168:171], v240 offset:47104
v_cvt_pk_bf16_f32 v174, v232, v233
v_bitop3_b32 v174, v174, v252, s58 bitop3:0xe0
v_mfma_f32_16x16x32_bf16 a[104:107], a[196:199], v[176:179], a[104:107]
v_exp_f32 v234, v62
v_mfma_f32_16x16x32_bf16 a[108:111], a[196:199], v[180:183], a[108:111]
v_or3_b32 v236, v236, v171, v174
v_exp_f32 v235, v63
v_mfma_f32_16x16x32_bf16 a[48:51], a[200:203], v[160:163], a[48:51]
buffer_load_dwordx4 v16, s[16:19], s38 offen offset:3072 sc1 lds
v_mfma_f32_16x16x32_bf16 a[52:55], a[200:203], v[164:167], a[52:55]
ds_read_b128 a[172:175], v240 offset:48128
v_cvt_pk_bf16_f32 v175, v234, v235
v_bitop3_b32 v175, v175, v253, s58 bitop3:0xe0
v_bitop3_b32 v236, v236, v175, v241 bitop3:0xa8
v_mfma_f32_16x16x32_bf16 a[112:115], a[200:203], v[176:179], a[112:115]
s_add_u32 s38, s38, 12288
v_cmp_ne_u32 vcc, 0, v236
v_exp_f32 v228, v64
v_mfma_f32_16x16x32_bf16 a[116:119], a[200:203], v[180:183], a[116:119]
s_waitcnt lgkmcnt(1)
s_xor_b32 s39, s39, 0x10000
v_exp_f32 v229, v65
v_mfma_f32_16x16x32_bf16 a[56:59], a[204:207], v[160:163], a[56:59]
v_and_b32 v252, s58, v252
v_and_b32 v253, s58, v253
v_mfma_f32_16x16x32_bf16 a[60:63], a[204:207], v[164:167], a[60:63]
v_exp_f32 v230, v66
v_mfma_f32_16x16x32_bf16 a[120:123], a[204:207], v[176:179], a[120:123]
s_waitcnt lgkmcnt(4)
v_exp_f32 v231, v67
v_mfma_f32_16x16x32_bf16 a[124:127], a[204:207], v[180:183], a[124:127]
s_cbranch_vccnz fb_concat_30
fbret_concat_31:
v_xor_b32 v240, 0x10000, v240
s_lshl_b32 s32, s5, 3
s_sub_u32 s37, 57, s32
s_add_u32 s37, s37, s3
v_mov_b32 v252, v242
v_mov_b32 v253, v243
s_sub_u32 s37, s37, 1
s_cmp_gt_i32 s37, 0
s_cselect_b32 s58, -1, 0
s_cmp_ge_i32 s37, 0
s_cselect_b32 s59, -1, 0
v_mfma_f32_16x16x32_bf16 v[80:83], a[144:147], v[104:107], v[200:203]
s_waitcnt vmcnt(4)
s_cmp_lg_u32 s3, 0
s_cbranch_scc1 spinret_concat_33
v_readfirstlane_b32 s60, v21
s_cmp_lt_u32 s60, s41
s_cbranch_scc1 spin_concat_32
spinret_concat_33:
s_barrier
s_cmp_lg_u32 s3, 0
s_cbranch_scc1 w0_concat_34
v_mov_b32 v31, 0
v_mov_b32 v29, 1
s_mov_b64 exec, 1
s_mov_b32 s60, s63
buffer_atomic_add v29, v31, s[16:19], s60 offen sc1
s_mov_b64 exec, -1
w0_concat_34:
v_mfma_f32_16x16x32_bf16 v[80:83], a[148:151], v[120:123], v[80:83]
ds_read_b128 a[176:179], v240 offset:16384
v_cvt_pk_bf16_f32 v176, v228, v229
v_mfma_f32_16x16x32_bf16 v[80:83], a[152:155], v[136:139], v[80:83]
v_exp_f32 v232, v68
v_mfma_f32_16x16x32_bf16 v[80:83], a[156:159], v[152:155], v[80:83]
ds_read_b128 a[180:183], v240 offset:17408
v_bitop3_b32 v176, v176, v252, s58 bitop3:0xe0
v_mfma_f32_16x16x32_bf16 v[84:87], a[144:147], v[108:111], v[204:207]
v_cvt_pk_bf16_f32 v177, v230, v231
v_bitop3_b32 v177, v177, v253, s58 bitop3:0xe0
v_mfma_f32_16x16x32_bf16 v[84:87], a[148:151], v[124:127], v[84:87]
ds_read_b128 a[184:187], v240 offset:18432
v_mfma_f32_16x16x32_bf16 v[84:87], a[152:155], v[140:143], v[84:87]
s_waitcnt lgkmcnt(3)
v_exp_f32 v233, v69
v_mfma_f32_16x16x32_bf16 v[84:87], a[156:159], v[156:159], v[84:87]
ds_read_b128 a[188:191], v240 offset:19456
v_cvt_pk_bf16_f32 v180, v232, v233
v_mfma_f32_16x16x32_bf16 v[88:91], a[160:163], v[104:107], v[200:203]
s_mov_b32 m0, s39
v_and_b32 v180, s59, v180
v_or3_b32 v236, v176, v177, v180
v_mfma_f32_16x16x32_bf16 v[88:91], a[164:167], v[120:123], v[88:91]
ds_read_b128 a[192:195], v240 offset:20480
v_mfma_f32_16x16x32_bf16 v[88:91], a[168:171], v[136:139], v[88:91]
buffer_load_dwordx4 v16, s[16:19], s38 offen offset:0 sc1 lds
v_mfma_f32_16x16x32_bf16 v[88:91], a[172:175], v[152:155], v[88:91]
ds_read_b128 a[196:199], v240 offset:21504
v_mfma_f32_16x16x32_bf16 v[92:95], a[160:163], v[108:111], v[204:207]
v_exp_f32 v234, v70
v_mfma_f32_16x16x32_bf16 v[92:95], a[164:167], v[124:127], v[92:95]
ds_read_b128 a[200:203], v240 offset:22528
v_mfma_f32_16x16x32_bf16 v[92:95], a[168:171], v[140:143], v[92:95]
v_mfma_f32_16x16x32_bf16 v[92:95], a[172:175], v[156:159], v[92:95]
ds_read_b128 a[204:207], v240 offset:23552
v_mfma_f32_16x16x32_bf16 a[128:131], v[224:227], v[168:171], a[128:131]
v_exp_f32 v235, v71
v_mfma_f32_16x16x32_bf16 a[132:135], v[224:227], v[172:175], a[132:135]
ds_read_b128 a[144:147], v240 offset:0
v_cvt_pk_bf16_f32 v181, v234, v235
v_mfma_f32_16x16x32_bf16 a[136:139], v[224:227], v[184:187], a[136:139]
v_and_b32 v181, s59, v181
v_mfma_f32_16x16x32_bf16 a[140:143], v[224:227], v[188:191], a[140:143]
s_waitcnt lgkmcnt(2)
v_exp_f32 v228, v72
v_mfma_f32_16x16x32_bf16 a[0:3], a[176:179], v[168:171], a[0:3]
v_mfma_f32_16x16x32_bf16 a[4:7], a[176:179], v[172:175], a[4:7]
ds_read_b128 a[148:151], v240 offset:1024
v_mfma_f32_16x16x32_bf16 a[64:67], a[176:179], v[184:187], a[64:67]
v_exp_f32 v229, v73
v_mfma_f32_16x16x32_bf16 a[68:71], a[176:179], v[188:191], a[68:71]
buffer_load_dwordx4 v16, s[16:19], s38 offen offset:1024 sc1 lds
v_mfma_f32_16x16x32_bf16 a[8:11], a[180:183], v[168:171], a[8:11]
v_cvt_pk_bf16_f32 v178, v228, v229
v_and_b32 v178, s58, v178
v_mfma_f32_16x16x32_bf16 a[12:15], a[180:183], v[172:175], a[12:15]
ds_read_b128 a[152:155], v240 offset:2048
v_or3_b32 v236, v236, v181, v178
v_mfma_f32_16x16x32_bf16 a[72:75], a[180:183], v[184:187], a[72:75]
v_exp_f32 v230, v74
v_mfma_f32_16x16x32_bf16 a[76:79], a[180:183], v[188:191], a[76:79]
v_mfma_f32_16x16x32_bf16 a[16:19], a[184:187], v[168:171], a[16:19]
v_exp_f32 v231, v75
v_mfma_f32_16x16x32_bf16 a[20:23], a[184:187], v[172:175], a[20:23]
ds_read_b128 a[156:159], v240 offset:3072
v_cvt_pk_bf16_f32 v179, v230, v231
v_mfma_f32_16x16x32_bf16 a[80:83], a[184:187], v[184:187], a[80:83]
v_exp_f32 v232, v76
v_mfma_f32_16x16x32_bf16 a[84:87], a[184:187], v[188:191], a[84:87]
v_and_b32 v179, s58, v179
v_mfma_f32_16x16x32_bf16 a[24:27], a[188:191], v[168:171], a[24:27]
v_exp_f32 v233, v77
v_mfma_f32_16x16x32_bf16 a[28:31], a[188:191], v[172:175], a[28:31]
ds_read_b128 a[160:163], v240 offset:4096
v_cvt_pk_bf16_f32 v182, v232, v233
v_mfma_f32_16x16x32_bf16 a[88:91], a[188:191], v[184:187], a[88:91]
buffer_load_dwordx4 v16, s[16:19], s38 offen offset:2048 sc1 lds
v_mfma_f32_16x16x32_bf16 a[92:95], a[188:191], v[188:191], a[92:95]
v_bitop3_b32 v182, v182, v252, s58 bitop3:0xe0
v_or3_b32 v236, v236, v179, v182
v_mfma_f32_16x16x32_bf16 a[32:35], a[192:195], v[168:171], a[32:35]
v_exp_f32 v234, v78
v_mfma_f32_16x16x32_bf16 a[36:39], a[192:195], v[172:175], a[36:39]
ds_read_b128 a[164:167], v240 offset:5120
v_and_b32 v252, s58, v252
v_mfma_f32_16x16x32_bf16 a[96:99], a[192:195], v[184:187], a[96:99]
v_mfma_f32_16x16x32_bf16 a[100:103], a[192:195], v[188:191], a[100:103]
v_exp_f32 v235, v79
v_mfma_f32_16x16x32_bf16 a[40:43], a[196:199], v[168:171], a[40:43]
v_cvt_pk_bf16_f32 v183, v234, v235
v_bitop3_b32 v183, v183, v253, s58 bitop3:0xe0
v_mfma_f32_16x16x32_bf16 a[44:47], a[196:199], v[172:175], a[44:47]
ds_read_b128 a[168:171], v240 offset:6144
v_bitop3_b32 v236, v236, v183, v241 bitop3:0xa8
v_mfma_f32_16x16x32_bf16 a[104:107], a[196:199], v[184:187], a[104:107]
v_exp_f32 v228, v80
v_mfma_f32_16x16x32_bf16 a[108:111], a[196:199], v[188:191], a[108:111]
v_cmp_ne_u32 vcc, 0, v236
v_and_b32 v253, s58, v253
v_mfma_f32_16x16x32_bf16 a[48:51], a[200:203], v[168:171], a[48:51]
buffer_load_dwordx4 v16, s[16:19], s38 offen offset:3072 sc1 lds
v_mfma_f32_16x16x32_bf16 a[52:55], a[200:203], v[172:175], a[52:55]
ds_read_b128 a[172:175], v240 offset:7168
v_mfma_f32_16x16x32_bf16 a[112:115], a[200:203], v[184:187], a[112:115]
s_add_u32 s38, s38, 4096
v_exp_f32 v229, v81
v_mfma_f32_16x16x32_bf16 a[116:119], a[200:203], v[188:191], a[116:119]
s_waitcnt lgkmcnt(1)
v_mfma_f32_16x16x32_bf16 a[56:59], a[204:207], v[168:171], a[56:59]
v_exp_f32 v230, v82
v_mfma_f32_16x16x32_bf16 a[60:63], a[204:207], v[172:175], a[60:63]
v_mfma_f32_16x16x32_bf16 a[120:123], a[204:207], v[184:187], a[120:123]
s_waitcnt lgkmcnt(4)
v_exp_f32 v231, v83
v_mfma_f32_16x16x32_bf16 a[124:127], a[204:207], v[188:191], a[124:127]
s_cbranch_vccnz fb_concat_35
fbret_concat_36:
global_load_dword v28, v[26:27], off
s_lshl_b32 s32, s5, 3
s_lshl_b32 s33, s3, 1
s_add_u32 s32, s32, s33
s_lshl_b32 s32, s32, 17
s_lshl_b32 s33, s4, 12
s_add_u32 s32, s32, s33
s_add_u32 s32, s32, 33554432
.p2align 3
s_nop 7
v_accvgpr_read_b32 v232, a128
v_accvgpr_read_b32 v234, a132
v_rcp_f32 v232, v232
v_rcp_f32 v234, v234
v_accvgpr_read_b32 v212, a8
v_accvgpr_read_b32 v213, a9
v_accvgpr_read_b32 v214, a10
v_accvgpr_read_b32 v215, a11
v_accvgpr_read_b32 v208, a0
v_accvgpr_read_b32 v209, a1
v_accvgpr_read_b32 v210, a2
v_accvgpr_read_b32 v211, a3
v_pk_mul_f32 v[208:209], v[208:209], v[232:233] op_sel_hi:[1,0]
v_pk_mul_f32 v[210:211], v[210:211], v[232:233] op_sel_hi:[1,0]
v_pk_mul_f32 v[212:213], v[212:213], v[232:233] op_sel_hi:[1,0]
v_pk_mul_f32 v[214:215], v[214:215], v[232:233] op_sel_hi:[1,0]
v_cvt_pk_bf16_f32 v208, v208, v209
v_cvt_pk_bf16_f32 v209, v210, v211
v_cvt_pk_bf16_f32 v210, v212, v213
v_cvt_pk_bf16_f32 v211, v214, v215
buffer_store_dwordx4 v[208:211], v16, s[16:19], s32 offen offset:0 sc1
v_accvgpr_read_b32 v220, a24
v_accvgpr_read_b32 v221, a25
v_accvgpr_read_b32 v222, a26
v_accvgpr_read_b32 v223, a27
v_accvgpr_read_b32 v216, a16
v_accvgpr_read_b32 v217, a17
v_accvgpr_read_b32 v218, a18
v_accvgpr_read_b32 v219, a19
v_pk_mul_f32 v[216:217], v[216:217], v[232:233] op_sel_hi:[1,0]
v_pk_mul_f32 v[218:219], v[218:219], v[232:233] op_sel_hi:[1,0]
v_pk_mul_f32 v[220:221], v[220:221], v[232:233] op_sel_hi:[1,0]
v_pk_mul_f32 v[222:223], v[222:223], v[232:233] op_sel_hi:[1,0]
v_cvt_pk_bf16_f32 v216, v216, v217
v_cvt_pk_bf16_f32 v217, v218, v219
v_cvt_pk_bf16_f32 v218, v220, v221
v_cvt_pk_bf16_f32 v219, v222, v223
buffer_store_dwordx4 v[216:219], v16, s[16:19], s32 offen offset:1024 sc1
v_accvgpr_read_b32 v212, a40
v_accvgpr_read_b32 v213, a41
v_accvgpr_read_b32 v214, a42
v_accvgpr_read_b32 v215, a43
v_accvgpr_read_b32 v208, a32
v_accvgpr_read_b32 v209, a33
v_accvgpr_read_b32 v210, a34
v_accvgpr_read_b32 v211, a35
v_pk_mul_f32 v[208:209], v[208:209], v[232:233] op_sel_hi:[1,0]
v_pk_mul_f32 v[210:211], v[210:211], v[232:233] op_sel_hi:[1,0]
v_pk_mul_f32 v[212:213], v[212:213], v[232:233] op_sel_hi:[1,0]
v_pk_mul_f32 v[214:215], v[214:215], v[232:233] op_sel_hi:[1,0]
v_cvt_pk_bf16_f32 v208, v208, v209
v_cvt_pk_bf16_f32 v209, v210, v211
v_cvt_pk_bf16_f32 v210, v212, v213
v_cvt_pk_bf16_f32 v211, v214, v215
buffer_store_dwordx4 v[208:211], v16, s[16:19], s32 offen offset:2048 sc1
v_accvgpr_read_b32 v220, a56
v_accvgpr_read_b32 v221, a57
v_accvgpr_read_b32 v222, a58
v_accvgpr_read_b32 v223, a59
v_accvgpr_read_b32 v216, a48
v_accvgpr_read_b32 v217, a49
v_accvgpr_read_b32 v218, a50
v_accvgpr_read_b32 v219, a51
v_pk_mul_f32 v[216:217], v[216:217], v[232:233] op_sel_hi:[1,0]
v_pk_mul_f32 v[218:219], v[218:219], v[232:233] op_sel_hi:[1,0]
v_pk_mul_f32 v[220:221], v[220:221], v[232:233] op_sel_hi:[1,0]
v_pk_mul_f32 v[222:223], v[222:223], v[232:233] op_sel_hi:[1,0]
v_cvt_pk_bf16_f32 v216, v216, v217
v_cvt_pk_bf16_f32 v217, v218, v219
v_cvt_pk_bf16_f32 v218, v220, v221
v_cvt_pk_bf16_f32 v219, v222, v223
buffer_store_dwordx4 v[216:219], v16, s[16:19], s32 offen offset:3072 sc1
s_add_u32 s32, s32, 131072
v_accvgpr_read_b32 v212, a12
v_accvgpr_read_b32 v213, a13
v_accvgpr_read_b32 v214, a14
v_accvgpr_read_b32 v215, a15
v_accvgpr_read_b32 v208, a4
v_accvgpr_read_b32 v209, a5
v_accvgpr_read_b32 v210, a6
v_accvgpr_read_b32 v211, a7
v_pk_mul_f32 v[208:209], v[208:209], v[234:235] op_sel_hi:[1,0]
v_pk_mul_f32 v[210:211], v[210:211], v[234:235] op_sel_hi:[1,0]
v_pk_mul_f32 v[212:213], v[212:213], v[234:235] op_sel_hi:[1,0]
v_pk_mul_f32 v[214:215], v[214:215], v[234:235] op_sel_hi:[1,0]
v_cvt_pk_bf16_f32 v208, v208, v209
v_cvt_pk_bf16_f32 v209, v210, v211
v_cvt_pk_bf16_f32 v210, v212, v213
v_cvt_pk_bf16_f32 v211, v214, v215
buffer_store_dwordx4 v[208:211], v16, s[16:19], s32 offen offset:0 sc1
v_accvgpr_read_b32 v220, a28
v_accvgpr_read_b32 v221, a29
v_accvgpr_read_b32 v222, a30
v_accvgpr_read_b32 v223, a31
v_accvgpr_read_b32 v216, a20
v_accvgpr_read_b32 v217, a21
v_accvgpr_read_b32 v218, a22
v_accvgpr_read_b32 v219, a23
v_pk_mul_f32 v[216:217], v[216:217], v[234:235] op_sel_hi:[1,0]
v_pk_mul_f32 v[218:219], v[218:219], v[234:235] op_sel_hi:[1,0]
v_pk_mul_f32 v[220:221], v[220:221], v[234:235] op_sel_hi:[1,0]
v_pk_mul_f32 v[222:223], v[222:223], v[234:235] op_sel_hi:[1,0]
v_cvt_pk_bf16_f32 v216, v216, v217
v_cvt_pk_bf16_f32 v217, v218, v219
v_cvt_pk_bf16_f32 v218, v220, v221
v_cvt_pk_bf16_f32 v219, v222, v223
buffer_store_dwordx4 v[216:219], v16, s[16:19], s32 offen offset:1024 sc1
v_accvgpr_read_b32 v212, a44
v_accvgpr_read_b32 v213, a45
v_accvgpr_read_b32 v214, a46
v_accvgpr_read_b32 v215, a47
v_accvgpr_read_b32 v208, a36
v_accvgpr_read_b32 v209, a37
v_accvgpr_read_b32 v210, a38
v_accvgpr_read_b32 v211, a39
v_pk_mul_f32 v[208:209], v[208:209], v[234:235] op_sel_hi:[1,0]
v_pk_mul_f32 v[210:211], v[210:211], v[234:235] op_sel_hi:[1,0]
v_pk_mul_f32 v[212:213], v[212:213], v[234:235] op_sel_hi:[1,0]
v_pk_mul_f32 v[214:215], v[214:215], v[234:235] op_sel_hi:[1,0]
v_cvt_pk_bf16_f32 v208, v208, v209
v_cvt_pk_bf16_f32 v209, v210, v211
v_cvt_pk_bf16_f32 v210, v212, v213
v_cvt_pk_bf16_f32 v211, v214, v215
buffer_store_dwordx4 v[208:211], v16, s[16:19], s32 offen offset:2048 sc1
v_accvgpr_read_b32 v220, a60
v_accvgpr_read_b32 v221, a61
v_accvgpr_read_b32 v222, a62
v_accvgpr_read_b32 v223, a63
v_accvgpr_read_b32 v216, a52
v_accvgpr_read_b32 v217, a53
v_accvgpr_read_b32 v218, a54
v_accvgpr_read_b32 v219, a55
v_pk_mul_f32 v[216:217], v[216:217], v[234:235] op_sel_hi:[1,0]
v_pk_mul_f32 v[218:219], v[218:219], v[234:235] op_sel_hi:[1,0]
v_pk_mul_f32 v[220:221], v[220:221], v[234:235] op_sel_hi:[1,0]
v_pk_mul_f32 v[222:223], v[222:223], v[234:235] op_sel_hi:[1,0]
v_cvt_pk_bf16_f32 v216, v216, v217
v_cvt_pk_bf16_f32 v217, v218, v219
v_cvt_pk_bf16_f32 v218, v220, v221
v_cvt_pk_bf16_f32 v219, v222, v223
buffer_store_dwordx4 v[216:219], v16, s[16:19], s32 offen offset:3072 sc1
v_mov_b32 v248, -1
v_mov_b32 v249, -1
v_mov_b32 v250, -1
v_mov_b32 v251, -1
s_mul_i32 s50, s2, 30720
s_mul_i32 s51, s3, 7680
s_add_u32 s50, s50, s51
s_add_u32 s50, s50, 65011712
s_add_u32 s51, s50, 3584
buffer_store_dwordx4 v[248:251], v16, s[16:19], s50 offen offset:0 sc1
buffer_store_dwordx4 v[248:251], v16, s[16:19], s50 offen offset:1024 sc1
buffer_store_dwordx4 v[248:251], v16, s[16:19], s50 offen offset:2048 sc1
buffer_store_dwordx4 v[248:251], v16, s[16:19], s50 offen offset:3072 sc1
buffer_store_dwordx4 v[248:251], v16, s[16:19], s51 offen offset:0 sc1
buffer_store_dwordx4 v[248:251], v16, s[16:19], s51 offen offset:1024 sc1
buffer_store_dwordx4 v[248:251], v16, s[16:19], s51 offen offset:2048 sc1
buffer_store_dwordx4 v[248:251], v16, s[16:19], s51 offen offset:3072 sc1
s_cmp_lg_u32 s3, 0
s_cbranch_scc1 w0_concat_37
v_mov_b32 v31, 0
buffer_load_dword v21, v31, s[16:19], s62 offen sc1
w0_concat_37:
s_mov_b32 s40, 13
s_cmp_eq_u32 s5, 7
s_cbranch_scc1 A_D2_1
s_lshl_b32 s31, s5, 1
s_sub_u32 s31, 14, s31
s_add_u32 s37, s3, 1
s_branch A_L2_1
.p2align 6
A_L2_0:
s_cmp_eq_u32 s31, s40
s_cbranch_scc1 LC_2
LCR_2:
v_mfma_f32_16x16x32_bf16 v[80:83], a[144:147], v[104:107], v[200:203]
s_waitcnt vmcnt(8)
s_barrier
v_mfma_f32_16x16x32_bf16 v[80:83], a[148:151], v[120:123], v[80:83]
ds_read_b128 a[176:179], v240 offset:16384
v_cvt_pk_bf16_f32 v176, v228, v229
v_mfma_f32_16x16x32_bf16 v[80:83], a[152:155], v[136:139], v[80:83]
s_mov_b32 m0, s39
v_exp_f32 v232, v68
v_mfma_f32_16x16x32_bf16 v[80:83], a[156:159], v[152:155], v[80:83]
ds_read_b128 a[180:183], v240 offset:17408
v_cvt_pk_bf16_f32 v177, v230, v231
v_mfma_f32_16x16x32_bf16 v[84:87], a[144:147], v[108:111], v[204:207]
buffer_load_dwordx4 v16, s[16:19], s38 offen offset:0 sc1 lds
v_mfma_f32_16x16x32_bf16 v[84:87], a[148:151], v[124:127], v[84:87]
ds_read_b128 a[184:187], v240 offset:18432
v_exp_f32 v233, v69
v_mfma_f32_16x16x32_bf16 v[84:87], a[152:155], v[140:143], v[84:87]
s_waitcnt lgkmcnt(3)
v_exp_f32 v234, v70
v_mfma_f32_16x16x32_bf16 v[84:87], a[156:159], v[156:159], v[84:87]
ds_read_b128 a[188:191], v240 offset:19456
v_cvt_pk_bf16_f32 v180, v232, v233
v_mfma_f32_16x16x32_bf16 v[88:91], a[160:163], v[104:107], v[200:203]
v_exp_f32 v235, v71
v_mfma_f32_16x16x32_bf16 v[88:91], a[164:167], v[120:123], v[88:91]
ds_read_b128 a[192:195], v240 offset:20480
v_exp_f32 v228, v72
v_mfma_f32_16x16x32_bf16 v[88:91], a[168:171], v[136:139], v[88:91]
v_exp_f32 v229, v73
v_mfma_f32_16x16x32_bf16 v[88:91], a[172:175], v[152:155], v[88:91]
ds_read_b128 a[196:199], v240 offset:21504
v_or3_b32 v236, v176, v177, v180
v_mfma_f32_16x16x32_bf16 v[92:95], a[160:163], v[108:111], v[204:207]
buffer_load_dwordx4 v16, s[16:19], s38 offen offset:1024 sc1 lds
v_mfma_f32_16x16x32_bf16 v[92:95], a[164:167], v[124:127], v[92:95]
ds_read_b128 a[200:203], v240 offset:22528
v_exp_f32 v230, v74
v_mfma_f32_16x16x32_bf16 v[92:95], a[168:171], v[140:143], v[92:95]
v_exp_f32 v231, v75
v_mfma_f32_16x16x32_bf16 v[92:95], a[172:175], v[156:159], v[92:95]
ds_read_b128 a[204:207], v240 offset:23552
v_cvt_pk_bf16_f32 v181, v234, v235
v_mfma_f32_16x16x32_bf16 a[136:139], v[224:227], v[184:187], a[136:139]
s_waitcnt lgkmcnt(3)
v_cvt_pk_bf16_f32 v178, v228, v229
v_or3_b32 v236, v236, v181, v178
v_mfma_f32_16x16x32_bf16 a[140:143], v[224:227], v[188:191], a[140:143]
ds_read_b128 a[144:147], v240 offset:0
v_exp_f32 v232, v76
v_mfma_f32_16x16x32_bf16 a[64:67], a[176:179], v[184:187], a[64:67]
v_exp_f32 v233, v77
v_mfma_f32_16x16x32_bf16 a[68:71], a[176:179], v[188:191], a[68:71]
ds_read_b128 a[148:151], v240 offset:1024
v_cvt_pk_bf16_f32 v179, v230, v231
v_mfma_f32_16x16x32_bf16 a[72:75], a[180:183], v[184:187], a[72:75]
buffer_load_dwordx4 v16, s[16:19], s38 offen offset:2048 sc1 lds
v_mfma_f32_16x16x32_bf16 a[76:79], a[180:183], v[188:191], a[76:79]
ds_read_b128 a[152:155], v240 offset:2048
v_cvt_pk_bf16_f32 v182, v232, v233
v_mfma_f32_16x16x32_bf16 a[80:83], a[184:187], v[184:187], a[80:83]
v_exp_f32 v234, v78
v_mfma_f32_16x16x32_bf16 a[84:87], a[184:187], v[188:191], a[84:87]
ds_read_b128 a[156:159], v240 offset:3072
v_or3_b32 v236, v236, v179, v182
v_mfma_f32_16x16x32_bf16 a[88:91], a[188:191], v[184:187], a[88:91]
v_exp_f32 v235, v79
v_mfma_f32_16x16x32_bf16 a[92:95], a[188:191], v[188:191], a[92:95]
ds_read_b128 a[160:163], v240 offset:4096
v_exp_f32 v228, v80
v_mfma_f32_16x16x32_bf16 a[96:99], a[192:195], v[184:187], a[96:99]
s_waitcnt lgkmcnt(3)
v_exp_f32 v229, v81
v_mfma_f32_16x16x32_bf16 a[100:103], a[192:195], v[188:191], a[100:103]
ds_read_b128 a[164:167], v240 offset:5120
v_cvt_pk_bf16_f32 v183, v234, v235
v_mfma_f32_16x16x32_bf16 a[104:107], a[196:199], v[184:187], a[104:107]
buffer_load_dwordx4 v16, s[16:19], s38 offen offset:3072 sc1 lds
v_mfma_f32_16x16x32_bf16 a[108:111], a[196:199], v[188:191], a[108:111]
ds_read_b128 a[168:171], v240 offset:6144
v_bitop3_b32 v236, v236, v183, v241 bitop3:0xa8
v_mfma_f32_16x16x32_bf16 a[112:115], a[200:203], v[184:187], a[112:115]
s_add_u32 s38, s38, 4096
v_exp_f32 v230, v82
v_mfma_f32_16x16x32_bf16 a[116:119], a[200:203], v[188:191], a[116:119]
ds_read_b128 a[172:175], v240 offset:7168
v_cmp_ne_u32 vcc, 0, v236
v_mfma_f32_16x16x32_bf16 a[120:123], a[204:207], v[184:187], a[120:123]
s_waitcnt lgkmcnt(4)
v_exp_f32 v231, v83
v_mfma_f32_16x16x32_bf16 a[124:127], a[204:207], v[188:191], a[124:127]
s_cbranch_vccnz fb_concat_38
fbret_concat_39:
A_L2_1:
v_mfma_f32_16x16x32_bf16 v[64:67], a[144:147], v[104:107], v[200:203]
v_exp_f32 v232, v84
v_mfma_f32_16x16x32_bf16 v[64:67], a[148:151], v[120:123], v[64:67]
ds_read_b128 a[176:179], v240 offset:24576
v_cvt_pk_bf16_f32 v184, v228, v229
v_mfma_f32_16x16x32_bf16 v[64:67], a[152:155], v[136:139], v[64:67]
s_add_u32 m0, s39, 4096
v_exp_f32 v233, v85
v_mfma_f32_16x16x32_bf16 v[64:67], a[156:159], v[152:155], v[64:67]
ds_read_b128 a[180:183], v240 offset:25600
v_cvt_pk_bf16_f32 v185, v230, v231
v_mfma_f32_16x16x32_bf16 v[68:71], a[144:147], v[108:111], v[204:207]
buffer_load_dwordx4 v16, s[16:19], s38 offen offset:0 sc1 lds
v_mfma_f32_16x16x32_bf16 v[68:71], a[148:151], v[124:127], v[68:71]
ds_read_b128 a[184:187], v240 offset:26624
v_cvt_pk_bf16_f32 v188, v232, v233
v_mfma_f32_16x16x32_bf16 v[68:71], a[152:155], v[140:143], v[68:71]
s_waitcnt lgkmcnt(3)
v_exp_f32 v234, v86
v_mfma_f32_16x16x32_bf16 v[68:71], a[156:159], v[156:159], v[68:71]
ds_read_b128 a[188:191], v240 offset:27648
v_or3_b32 v236, v184, v185, v188
v_mfma_f32_16x16x32_bf16 v[72:75], a[160:163], v[104:107], v[200:203]
v_exp_f32 v235, v87
v_mfma_f32_16x16x32_bf16 v[72:75], a[164:167], v[120:123], v[72:75]
ds_read_b128 a[192:195], v240 offset:28672
v_exp_f32 v228, v88
v_mfma_f32_16x16x32_bf16 v[72:75], a[168:171], v[136:139], v[72:75]
v_exp_f32 v229, v89
v_mfma_f32_16x16x32_bf16 v[72:75], a[172:175], v[152:155], v[72:75]
ds_read_b128 a[196:199], v240 offset:29696
v_cvt_pk_bf16_f32 v189, v234, v235
v_mfma_f32_16x16x32_bf16 v[76:79], a[160:163], v[108:111], v[204:207]
buffer_load_dwordx4 v16, s[16:19], s38 offen offset:1024 sc1 lds
v_mfma_f32_16x16x32_bf16 v[76:79], a[164:167], v[124:127], v[76:79]
ds_read_b128 a[200:203], v240 offset:30720
v_cvt_pk_bf16_f32 v186, v228, v229
v_mfma_f32_16x16x32_bf16 v[76:79], a[168:171], v[140:143], v[76:79]
v_exp_f32 v230, v90
v_mfma_f32_16x16x32_bf16 v[76:79], a[172:175], v[156:159], v[76:79]
ds_read_b128 a[204:207], v240 offset:31744
v_or3_b32 v236, v236, v189, v186
v_mfma_f32_16x16x32_bf16 a[136:139], v[224:227], v[176:179], a[136:139]
s_waitcnt lgkmcnt(3)
v_exp_f32 v231, v91
v_mfma_f32_16x16x32_bf16 a[140:143], v[224:227], v[180:183], a[140:143]
ds_read_b128 a[144:147], v240 offset:8192
v_exp_f32 v232, v92
v_mfma_f32_16x16x32_bf16 a[64:67], a[176:179], v[176:179], a[64:67]
v_exp_f32 v233, v93
v_mfma_f32_16x16x32_bf16 a[68:71], a[176:179], v[180:183], a[68:71]
ds_read_b128 a[148:151], v240 offset:9216
v_cvt_pk_bf16_f32 v187, v230, v231
v_mfma_f32_16x16x32_bf16 a[72:75], a[180:183], v[176:179], a[72:75]
buffer_load_dwordx4 v16, s[16:19], s38 offen offset:2048 sc1 lds
v_mfma_f32_16x16x32_bf16 a[76:79], a[180:183], v[180:183], a[76:79]
ds_read_b128 a[152:155], v240 offset:10240
v_cvt_pk_bf16_f32 v190, v232, v233
v_mfma_f32_16x16x32_bf16 a[80:83], a[184:187], v[176:179], a[80:83]
v_exp_f32 v234, v94
v_mfma_f32_16x16x32_bf16 a[84:87], a[184:187], v[180:183], a[84:87]
ds_read_b128 a[156:159], v240 offset:11264
v_or3_b32 v236, v236, v187, v190
v_mfma_f32_16x16x32_bf16 a[88:91], a[188:191], v[176:179], a[88:91]
v_exp_f32 v235, v95
v_mfma_f32_16x16x32_bf16 a[92:95], a[188:191], v[180:183], a[92:95]
ds_read_b128 a[160:163], v240 offset:12288
v_exp_f32 v228, v64
v_mfma_f32_16x16x32_bf16 a[96:99], a[192:195], v[176:179], a[96:99]
s_waitcnt lgkmcnt(3)
v_exp_f32 v229, v65
v_mfma_f32_16x16x32_bf16 a[100:103], a[192:195], v[180:183], a[100:103]
ds_read_b128 a[164:167], v240 offset:13312
v_cvt_pk_bf16_f32 v191, v234, v235
v_mfma_f32_16x16x32_bf16 a[104:107], a[196:199], v[176:179], a[104:107]
buffer_load_dwordx4 v16, s[16:19], s38 offen offset:3072 sc1 lds
v_mfma_f32_16x16x32_bf16 a[108:111], a[196:199], v[180:183], a[108:111]
ds_read_b128 a[168:171], v240 offset:14336
v_bitop3_b32 v236, v236, v191, v241 bitop3:0xa8
v_mfma_f32_16x16x32_bf16 a[112:115], a[200:203], v[176:179], a[112:115]
s_add_u32 s38, s38, 12288
v_exp_f32 v230, v66
v_mfma_f32_16x16x32_bf16 a[116:119], a[200:203], v[180:183], a[116:119]
ds_read_b128 a[172:175], v240 offset:15360
v_cmp_ne_u32 vcc, 0, v236
v_mfma_f32_16x16x32_bf16 a[120:123], a[204:207], v[176:179], a[120:123]
s_waitcnt lgkmcnt(4)
v_exp_f32 v231, v67
v_mfma_f32_16x16x32_bf16 a[124:127], a[204:207], v[180:183], a[124:127]
s_cbranch_vccnz fb_concat_40
fbret_concat_41:
v_mfma_f32_16x16x32_bf16 v[80:83], a[144:147], v[104:107], v[200:203]
s_waitcnt vmcnt(8)
s_barrier
v_mfma_f32_16x16x32_bf16 v[80:83], a[148:151], v[120:123], v[80:83]
ds_read_b128 a[176:179], v240 offset:49152
v_cvt_pk_bf16_f32 v176, v228, v229
v_mfma_f32_16x16x32_bf16 v[80:83], a[152:155], v[136:139], v[80:83]
s_add_u32 m0, s39, 32768
v_exp_f32 v232, v68
v_mfma_f32_16x16x32_bf16 v[80:83], a[156:159], v[152:155], v[80:83]
ds_read_b128 a[180:183], v240 offset:50176
v_cvt_pk_bf16_f32 v177, v230, v231
v_mfma_f32_16x16x32_bf16 v[84:87], a[144:147], v[108:111], v[204:207]
buffer_load_dwordx4 v16, s[16:19], s38 offen offset:0 sc1 lds
v_mfma_f32_16x16x32_bf16 v[84:87], a[148:151], v[124:127], v[84:87]
ds_read_b128 a[184:187], v240 offset:51200
v_exp_f32 v233, v69
v_mfma_f32_16x16x32_bf16 v[84:87], a[152:155], v[140:143], v[84:87]
s_waitcnt lgkmcnt(3)
v_exp_f32 v234, v70
v_mfma_f32_16x16x32_bf16 v[84:87], a[156:159], v[156:159], v[84:87]
ds_read_b128 a[188:191], v240 offset:52224
v_cvt_pk_bf16_f32 v180, v232, v233
v_mfma_f32_16x16x32_bf16 v[88:91], a[160:163], v[104:107], v[200:203]
v_exp_f32 v235, v71
v_mfma_f32_16x16x32_bf16 v[88:91], a[164:167], v[120:123], v[88:91]
ds_read_b128 a[192:195], v240 offset:53248
v_exp_f32 v228, v72
v_mfma_f32_16x16x32_bf16 v[88:91], a[168:171], v[136:139], v[88:91]
v_exp_f32 v229, v73
v_mfma_f32_16x16x32_bf16 v[88:91], a[172:175], v[152:155], v[88:91]
ds_read_b128 a[196:199], v240 offset:54272
v_or3_b32 v236, v176, v177, v180
v_mfma_f32_16x16x32_bf16 v[92:95], a[160:163], v[108:111], v[204:207]
buffer_load_dwordx4 v16, s[16:19], s38 offen offset:1024 sc1 lds
v_mfma_f32_16x16x32_bf16 v[92:95], a[164:167], v[124:127], v[92:95]
ds_read_b128 a[200:203], v240 offset:55296
v_exp_f32 v230, v74
v_mfma_f32_16x16x32_bf16 v[92:95], a[168:171], v[140:143], v[92:95]
v_exp_f32 v231, v75
v_mfma_f32_16x16x32_bf16 v[92:95], a[172:175], v[156:159], v[92:95]
ds_read_b128 a[204:207], v240 offset:56320
v_cvt_pk_bf16_f32 v181, v234, v235
v_mfma_f32_16x16x32_bf16 a[136:139], v[224:227], v[184:187], a[136:139]
s_waitcnt lgkmcnt(3)
v_cvt_pk_bf16_f32 v178, v228, v229
v_or3_b32 v236, v236, v181, v178
v_mfma_f32_16x16x32_bf16 a[140:143], v[224:227], v[188:191], a[140:143]
ds_read_b128 a[144:147], v240 offset:32768
v_exp_f32 v232, v76
v_mfma_f32_16x16x32_bf16 a[64:67], a[176:179], v[184:187], a[64:67]
v_exp_f32 v233, v77
v_mfma_f32_16x16x32_bf16 a[68:71], a[176:179], v[188:191], a[68:71]
ds_read_b128 a[148:151], v240 offset:33792
v_cvt_pk_bf16_f32 v179, v230, v231
v_mfma_f32_16x16x32_bf16 a[72:75], a[180:183], v[184:187], a[72:75]
buffer_load_dwordx4 v16, s[16:19], s38 offen offset:2048 sc1 lds
v_mfma_f32_16x16x32_bf16 a[76:79], a[180:183], v[188:191], a[76:79]
ds_read_b128 a[152:155], v240 offset:34816
v_cvt_pk_bf16_f32 v182, v232, v233
v_mfma_f32_16x16x32_bf16 a[80:83], a[184:187], v[184:187], a[80:83]
v_exp_f32 v234, v78
v_mfma_f32_16x16x32_bf16 a[84:87], a[184:187], v[188:191], a[84:87]
ds_read_b128 a[156:159], v240 offset:35840
v_or3_b32 v236, v236, v179, v182
v_mfma_f32_16x16x32_bf16 a[88:91], a[188:191], v[184:187], a[88:91]
v_exp_f32 v235, v79
v_mfma_f32_16x16x32_bf16 a[92:95], a[188:191], v[188:191], a[92:95]
ds_read_b128 a[160:163], v240 offset:36864
v_exp_f32 v228, v80
v_mfma_f32_16x16x32_bf16 a[96:99], a[192:195], v[184:187], a[96:99]
s_waitcnt lgkmcnt(3)
v_exp_f32 v229, v81
v_mfma_f32_16x16x32_bf16 a[100:103], a[192:195], v[188:191], a[100:103]
ds_read_b128 a[164:167], v240 offset:37888
v_cvt_pk_bf16_f32 v183, v234, v235
v_mfma_f32_16x16x32_bf16 a[104:107], a[196:199], v[184:187], a[104:107]
buffer_load_dwordx4 v16, s[16:19], s38 offen offset:3072 sc1 lds
v_mfma_f32_16x16x32_bf16 a[108:111], a[196:199], v[188:191], a[108:111]
ds_read_b128 a[168:171], v240 offset:38912
v_bitop3_b32 v236, v236, v183, v241 bitop3:0xa8
v_mfma_f32_16x16x32_bf16 a[112:115], a[200:203], v[184:187], a[112:115]
s_add_u32 s38, s38, 4096
v_exp_f32 v230, v82
v_mfma_f32_16x16x32_bf16 a[116:119], a[200:203], v[188:191], a[116:119]
ds_read_b128 a[172:175], v240 offset:39936
v_cmp_ne_u32 vcc, 0, v236
v_mfma_f32_16x16x32_bf16 a[120:123], a[204:207], v[184:187], a[120:123]
s_waitcnt lgkmcnt(4)
v_exp_f32 v231, v83
v_mfma_f32_16x16x32_bf16 a[124:127], a[204:207], v[188:191], a[124:127]
s_cbranch_vccnz fb_concat_42
fbret_concat_43:
v_mfma_f32_16x16x32_bf16 v[64:67], a[144:147], v[104:107], v[200:203]
v_exp_f32 v232, v84
v_mfma_f32_16x16x32_bf16 v[64:67], a[148:151], v[120:123], v[64:67]
ds_read_b128 a[176:179], v240 offset:57344
v_cvt_pk_bf16_f32 v184, v228, v229
v_mfma_f32_16x16x32_bf16 v[64:67], a[152:155], v[136:139], v[64:67]
s_add_u32 m0, s39, 36864
v_exp_f32 v233, v85
v_mfma_f32_16x16x32_bf16 v[64:67], a[156:159], v[152:155], v[64:67]
ds_read_b128 a[180:183], v240 offset:58368
v_cvt_pk_bf16_f32 v185, v230, v231
v_mfma_f32_16x16x32_bf16 v[68:71], a[144:147], v[108:111], v[204:207]
buffer_load_dwordx4 v16, s[16:19], s38 offen offset:0 sc1 lds
v_mfma_f32_16x16x32_bf16 v[68:71], a[148:151], v[124:127], v[68:71]
ds_read_b128 a[184:187], v240 offset:59392
v_exp_f32 v234, v86
v_mfma_f32_16x16x32_bf16 v[68:71], a[152:155], v[140:143], v[68:71]
s_waitcnt lgkmcnt(3)
v_exp_f32 v235, v87
v_mfma_f32_16x16x32_bf16 v[68:71], a[156:159], v[156:159], v[68:71]
ds_read_b128 a[188:191], v240 offset:60416
v_cvt_pk_bf16_f32 v188, v232, v233
v_mfma_f32_16x16x32_bf16 v[72:75], a[160:163], v[104:107], v[200:203]
v_or3_b32 v236, v184, v185, v188
v_cvt_pk_bf16_f32 v189, v234, v235
v_mfma_f32_16x16x32_bf16 v[72:75], a[164:167], v[120:123], v[72:75]
ds_read_b128 a[192:195], v240 offset:61440
v_exp_f32 v228, v88
v_mfma_f32_16x16x32_bf16 v[72:75], a[168:171], v[136:139], v[72:75]
v_exp_f32 v229, v89
v_mfma_f32_16x16x32_bf16 v[72:75], a[172:175], v[152:155], v[72:75]
ds_read_b128 a[196:199], v240 offset:62464
v_cvt_pk_bf16_f32 v186, v228, v229
v_mfma_f32_16x16x32_bf16 v[76:79], a[160:163], v[108:111], v[204:207]
buffer_load_dwordx4 v16, s[16:19], s38 offen offset:1024 sc1 lds
v_mfma_f32_16x16x32_bf16 v[76:79], a[164:167], v[124:127], v[76:79]
ds_read_b128 a[200:203], v240 offset:63488
v_exp_f32 v230, v90
v_mfma_f32_16x16x32_bf16 v[76:79], a[168:171], v[140:143], v[76:79]
v_exp_f32 v231, v91
v_mfma_f32_16x16x32_bf16 v[76:79], a[172:175], v[156:159], v[76:79]
ds_read_b128 a[204:207], v240 offset:64512
v_or3_b32 v236, v236, v189, v186
v_mfma_f32_16x16x32_bf16 a[136:139], v[224:227], v[176:179], a[136:139]
s_waitcnt lgkmcnt(3)
v_exp_f32 v232, v92
v_mfma_f32_16x16x32_bf16 a[140:143], v[224:227], v[180:183], a[140:143]
ds_read_b128 a[144:147], v240 offset:40960
v_exp_f32 v233, v93
v_mfma_f32_16x16x32_bf16 a[64:67], a[176:179], v[176:179], a[64:67]
v_exp_f32 v234, v94
v_mfma_f32_16x16x32_bf16 a[68:71], a[176:179], v[180:183], a[68:71]
ds_read_b128 a[148:151], v240 offset:41984
v_cvt_pk_bf16_f32 v187, v230, v231
v_mfma_f32_16x16x32_bf16 a[72:75], a[180:183], v[176:179], a[72:75]
buffer_load_dwordx4 v16, s[16:19], s38 offen offset:2048 sc1 lds
v_mfma_f32_16x16x32_bf16 a[76:79], a[180:183], v[180:183], a[76:79]
ds_read_b128 a[152:155], v240 offset:43008
v_cvt_pk_bf16_f32 v190, v232, v233
v_mfma_f32_16x16x32_bf16 a[80:83], a[184:187], v[176:179], a[80:83]
v_exp_f32 v235, v95
v_mfma_f32_16x16x32_bf16 a[84:87], a[184:187], v[180:183], a[84:87]
ds_read_b128 a[156:159], v240 offset:44032
v_or3_b32 v236, v236, v187, v190
v_mfma_f32_16x16x32_bf16 a[88:91], a[188:191], v[176:179], a[88:91]
v_cvt_pk_bf16_f32 v191, v234, v235
v_bitop3_b32 v236, v236, v191, v241 bitop3:0xa8
v_mfma_f32_16x16x32_bf16 a[92:95], a[188:191], v[180:183], a[92:95]
ds_read_b128 a[160:163], v240 offset:45056
v_exp_f32 v228, v64
v_mfma_f32_16x16x32_bf16 a[96:99], a[192:195], v[176:179], a[96:99]
s_waitcnt lgkmcnt(3)
v_exp_f32 v229, v65
v_mfma_f32_16x16x32_bf16 a[100:103], a[192:195], v[180:183], a[100:103]
ds_read_b128 a[164:167], v240 offset:46080
v_cmp_ne_u32 vcc, 0, v236
v_mfma_f32_16x16x32_bf16 a[104:107], a[196:199], v[176:179], a[104:107]
buffer_load_dwordx4 v16, s[16:19], s38 offen offset:3072 sc1 lds
v_mfma_f32_16x16x32_bf16 a[108:111], a[196:199], v[180:183], a[108:111]
ds_read_b128 a[168:171], v240 offset:47104
v_mfma_f32_16x16x32_bf16 a[112:115], a[200:203], v[176:179], a[112:115]
s_add_u32 s38, s38, 12288
v_exp_f32 v230, v66
v_mfma_f32_16x16x32_bf16 a[116:119], a[200:203], v[180:183], a[116:119]
ds_read_b128 a[172:175], v240 offset:48128
v_xor_b32 v240, 0x10000, v240
v_mfma_f32_16x16x32_bf16 a[120:123], a[204:207], v[176:179], a[120:123]
s_waitcnt lgkmcnt(4)
s_xor_b32 s39, s39, 0x10000
v_exp_f32 v231, v67
v_mfma_f32_16x16x32_bf16 a[124:127], a[204:207], v[180:183], a[124:127]
s_cbranch_vccnz fb_concat_44
fbret_concat_45:
s_sub_u32 s31, s31, 1
s_cmp_lg_u32 s31, 0
s_cbranch_scc1 A_L2_0
s_sub_u32 s37, s37, 1
s_cmp_gt_i32 s37, 0
s_cselect_b32 s58, -1, 0
s_cmp_ge_i32 s37, 0
s_cselect_b32 s59, -1, 0
v_mfma_f32_16x16x32_bf16 v[80:83], a[144:147], v[104:107], v[200:203]
s_waitcnt vmcnt(8)
s_barrier
v_mfma_f32_16x16x32_bf16 v[80:83], a[148:151], v[120:123], v[80:83]
ds_read_b128 a[176:179], v240 offset:16384
v_exp_f32 v232, v68
v_mfma_f32_16x16x32_bf16 v[80:83], a[152:155], v[136:139], v[80:83]
s_mov_b32 m0, s39
v_cvt_pk_bf16_f32 v176, v228, v229
v_bitop3_b32 v176, v176, v252, s58 bitop3:0xe0
v_mfma_f32_16x16x32_bf16 v[80:83], a[156:159], v[152:155], v[80:83]
ds_read_b128 a[180:183], v240 offset:17408
v_exp_f32 v233, v69
v_mfma_f32_16x16x32_bf16 v[84:87], a[144:147], v[108:111], v[204:207]
buffer_load_dwordx4 v16, s[16:19], s38 offen offset:0 sc1 lds
v_mfma_f32_16x16x32_bf16 v[84:87], a[148:151], v[124:127], v[84:87]
ds_read_b128 a[184:187], v240 offset:18432
v_cvt_pk_bf16_f32 v177, v230, v231
v_bitop3_b32 v177, v177, v253, s58 bitop3:0xe0
v_mfma_f32_16x16x32_bf16 v[84:87], a[152:155], v[140:143], v[84:87]
s_waitcnt lgkmcnt(3)
v_exp_f32 v234, v70
v_mfma_f32_16x16x32_bf16 v[84:87], a[156:159], v[156:159], v[84:87]
ds_read_b128 a[188:191], v240 offset:19456
v_exp_f32 v235, v71
v_mfma_f32_16x16x32_bf16 v[88:91], a[160:163], v[104:107], v[200:203]
v_cvt_pk_bf16_f32 v180, v232, v233
v_and_b32 v180, s59, v180
v_mfma_f32_16x16x32_bf16 v[88:91], a[164:167], v[120:123], v[88:91]
ds_read_b128 a[192:195], v240 offset:20480
v_exp_f32 v228, v72
v_mfma_f32_16x16x32_bf16 v[88:91], a[168:171], v[136:139], v[88:91]
v_or3_b32 v236, v176, v177, v180
v_cvt_pk_bf16_f32 v181, v234, v235
v_mfma_f32_16x16x32_bf16 v[88:91], a[172:175], v[152:155], v[88:91]
ds_read_b128 a[196:199], v240 offset:21504
v_exp_f32 v229, v73
v_mfma_f32_16x16x32_bf16 v[92:95], a[160:163], v[108:111], v[204:207]
buffer_load_dwordx4 v16, s[16:19], s38 offen offset:1024 sc1 lds
v_mfma_f32_16x16x32_bf16 v[92:95], a[164:167], v[124:127], v[92:95]
ds_read_b128 a[200:203], v240 offset:22528
v_and_b32 v181, s59, v181
v_cvt_pk_bf16_f32 v178, v228, v229
v_mfma_f32_16x16x32_bf16 v[92:95], a[168:171], v[140:143], v[92:95]
v_exp_f32 v230, v74
v_mfma_f32_16x16x32_bf16 v[92:95], a[172:175], v[156:159], v[92:95]
ds_read_b128 a[204:207], v240 offset:23552
v_and_b32 v178, s58, v178
v_or3_b32 v236, v236, v181, v178
v_mfma_f32_16x16x32_bf16 a[136:139], v[224:227], v[184:187], a[136:139]
s_waitcnt lgkmcnt(3)
v_exp_f32 v231, v75
v_mfma_f32_16x16x32_bf16 a[140:143], v[224:227], v[188:191], a[140:143]
ds_read_b128 a[144:147], v240 offset:0
v_exp_f32 v232, v76
v_mfma_f32_16x16x32_bf16 a[64:67], a[176:179], v[184:187], a[64:67]
v_cvt_pk_bf16_f32 v179, v230, v231
v_and_b32 v179, s58, v179
v_mfma_f32_16x16x32_bf16 a[68:71], a[176:179], v[188:191], a[68:71]
ds_read_b128 a[148:151], v240 offset:1024
v_exp_f32 v233, v77
v_mfma_f32_16x16x32_bf16 a[72:75], a[180:183], v[184:187], a[72:75]
buffer_load_dwordx4 v16, s[16:19], s38 offen offset:2048 sc1 lds
v_mfma_f32_16x16x32_bf16 a[76:79], a[180:183], v[188:191], a[76:79]
ds_read_b128 a[152:155], v240 offset:2048
v_cvt_pk_bf16_f32 v182, v232, v233
v_bitop3_b32 v182, v182, v252, s58 bitop3:0xe0
v_mfma_f32_16x16x32_bf16 a[80:83], a[184:187], v[184:187], a[80:83]
v_exp_f32 v234, v78
v_mfma_f32_16x16x32_bf16 a[84:87], a[184:187], v[188:191], a[84:87]
ds_read_b128 a[156:159], v240 offset:3072
v_or3_b32 v236, v236, v179, v182
v_and_b32 v252, s58, v252
v_mfma_f32_16x16x32_bf16 a[88:91], a[188:191], v[184:187], a[88:91]
v_exp_f32 v235, v79
v_mfma_f32_16x16x32_bf16 a[92:95], a[188:191], v[188:191], a[92:95]
ds_read_b128 a[160:163], v240 offset:4096
v_cvt_pk_bf16_f32 v183, v234, v235
v_bitop3_b32 v183, v183, v253, s58 bitop3:0xe0
v_mfma_f32_16x16x32_bf16 a[96:99], a[192:195], v[184:187], a[96:99]
s_waitcnt lgkmcnt(3)
v_exp_f32 v228, v80
v_mfma_f32_16x16x32_bf16 a[100:103], a[192:195], v[188:191], a[100:103]
ds_read_b128 a[164:167], v240 offset:5120
v_exp_f32 v229, v81
v_mfma_f32_16x16x32_bf16 a[104:107], a[196:199], v[184:187], a[104:107]
buffer_load_dwordx4 v16, s[16:19], s38 offen offset:3072 sc1 lds
v_mfma_f32_16x16x32_bf16 a[108:111], a[196:199], v[188:191], a[108:111]
ds_read_b128 a[168:171], v240 offset:6144
v_bitop3_b32 v236, v236, v183, v241 bitop3:0xa8
v_cmp_ne_u32 vcc, 0, v236
v_mfma_f32_16x16x32_bf16 a[112:115], a[200:203], v[184:187], a[112:115]
s_add_u32 s38, s38, 4096
v_exp_f32 v230, v82
v_mfma_f32_16x16x32_bf16 a[116:119], a[200:203], v[188:191], a[116:119]
ds_read_b128 a[172:175], v240 offset:7168
v_and_b32 v253, s58, v253
v_mfma_f32_16x16x32_bf16 a[120:123], a[204:207], v[184:187], a[120:123]
s_waitcnt lgkmcnt(4)
v_exp_f32 v231, v83
v_mfma_f32_16x16x32_bf16 a[124:127], a[204:207], v[188:191], a[124:127]
s_cbranch_vccnz fb_concat_46
fbret_concat_47:
A_D2_1:
s_sub_u32 s37, s37, 1
s_cmp_gt_i32 s37, 0
s_cselect_b32 s58, -1, 0
s_cmp_ge_i32 s37, 0
s_cselect_b32 s59, -1, 0
v_mfma_f32_16x16x32_bf16 v[64:67], a[144:147], v[104:107], v[200:203]
v_exp_f32 v232, v84
v_mfma_f32_16x16x32_bf16 v[64:67], a[148:151], v[120:123], v[64:67]
ds_read_b128 a[176:179], v240 offset:24576
v_cvt_pk_bf16_f32 v184, v228, v229
v_mfma_f32_16x16x32_bf16 v[64:67], a[152:155], v[136:139], v[64:67]
s_add_u32 m0, s39, 4096
v_bitop3_b32 v184, v184, v252, s58 bitop3:0xe0
v_cvt_pk_bf16_f32 v185, v230, v231
v_mfma_f32_16x16x32_bf16 v[64:67], a[156:159], v[152:155], v[64:67]
ds_read_b128 a[180:183], v240 offset:25600
v_exp_f32 v233, v85
v_mfma_f32_16x16x32_bf16 v[68:71], a[144:147], v[108:111], v[204:207]
buffer_load_dwordx4 v16, s[16:19], s38 offen offset:0 sc1 lds
v_mfma_f32_16x16x32_bf16 v[68:71], a[148:151], v[124:127], v[68:71]
ds_read_b128 a[184:187], v240 offset:26624
v_exp_f32 v234, v86
v_mfma_f32_16x16x32_bf16 v[68:71], a[152:155], v[140:143], v[68:71]
s_waitcnt lgkmcnt(3)
v_bitop3_b32 v185, v185, v253, s58 bitop3:0xe0
v_cvt_pk_bf16_f32 v188, v232, v233
v_mfma_f32_16x16x32_bf16 v[68:71], a[156:159], v[156:159], v[68:71]
ds_read_b128 a[188:191], v240 offset:27648
v_exp_f32 v235, v87
v_mfma_f32_16x16x32_bf16 v[72:75], a[160:163], v[104:107], v[200:203]
v_and_b32 v188, s59, v188
v_or3_b32 v236, v184, v185, v188
v_mfma_f32_16x16x32_bf16 v[72:75], a[164:167], v[120:123], v[72:75]
ds_read_b128 a[192:195], v240 offset:28672
v_exp_f32 v228, v88
v_mfma_f32_16x16x32_bf16 v[72:75], a[168:171], v[136:139], v[72:75]
v_exp_f32 v229, v89
v_mfma_f32_16x16x32_bf16 v[72:75], a[172:175], v[152:155], v[72:75]
ds_read_b128 a[196:199], v240 offset:29696
v_cvt_pk_bf16_f32 v189, v234, v235
v_and_b32 v189, s59, v189
v_mfma_f32_16x16x32_bf16 v[76:79], a[160:163], v[108:111], v[204:207]
buffer_load_dwordx4 v16, s[16:19], s38 offen offset:1024 sc1 lds
v_mfma_f32_16x16x32_bf16 v[76:79], a[164:167], v[124:127], v[76:79]
ds_read_b128 a[200:203], v240 offset:30720
v_exp_f32 v230, v90
v_mfma_f32_16x16x32_bf16 v[76:79], a[168:171], v[140:143], v[76:79]
v_cvt_pk_bf16_f32 v186, v228, v229
v_and_b32 v186, s58, v186
v_mfma_f32_16x16x32_bf16 v[76:79], a[172:175], v[156:159], v[76:79]
ds_read_b128 a[204:207], v240 offset:31744
v_exp_f32 v231, v91
v_mfma_f32_16x16x32_bf16 a[136:139], v[224:227], v[176:179], a[136:139]
s_waitcnt lgkmcnt(3)
v_exp_f32 v232, v92
v_mfma_f32_16x16x32_bf16 a[140:143], v[224:227], v[180:183], a[140:143]
ds_read_b128 a[144:147], v240 offset:8192
v_or3_b32 v236, v236, v189, v186
v_cvt_pk_bf16_f32 v187, v230, v231
v_mfma_f32_16x16x32_bf16 a[64:67], a[176:179], v[176:179], a[64:67]
v_exp_f32 v233, v93
v_mfma_f32_16x16x32_bf16 a[68:71], a[176:179], v[180:183], a[68:71]
ds_read_b128 a[148:151], v240 offset:9216
v_and_b32 v187, s58, v187
v_cvt_pk_bf16_f32 v190, v232, v233
v_mfma_f32_16x16x32_bf16 a[72:75], a[180:183], v[176:179], a[72:75]
buffer_load_dwordx4 v16, s[16:19], s38 offen offset:2048 sc1 lds
v_mfma_f32_16x16x32_bf16 a[76:79], a[180:183], v[180:183], a[76:79]
ds_read_b128 a[152:155], v240 offset:10240
v_exp_f32 v234, v94
v_mfma_f32_16x16x32_bf16 a[80:83], a[184:187], v[176:179], a[80:83]
v_exp_f32 v235, v95
v_mfma_f32_16x16x32_bf16 a[84:87], a[184:187], v[180:183], a[84:87]
ds_read_b128 a[156:159], v240 offset:11264
v_bitop3_b32 v190, v190, v252, s58 bitop3:0xe0
v_or3_b32 v236, v236, v187, v190
v_mfma_f32_16x16x32_bf16 a[88:91], a[188:191], v[176:179], a[88:91]
v_exp_f32 v228, v64
v_mfma_f32_16x16x32_bf16 a[92:95], a[188:191], v[180:183], a[92:95]
ds_read_b128 a[160:163], v240 offset:12288
v_cvt_pk_bf16_f32 v191, v234, v235
v_bitop3_b32 v191, v191, v253, s58 bitop3:0xe0
v_mfma_f32_16x16x32_bf16 a[96:99], a[192:195], v[176:179], a[96:99]
s_waitcnt lgkmcnt(3)
v_exp_f32 v229, v65
v_mfma_f32_16x16x32_bf16 a[100:103], a[192:195], v[180:183], a[100:103]
ds_read_b128 a[164:167], v240 offset:13312
v_bitop3_b32 v236, v236, v191, v241 bitop3:0xa8
v_mfma_f32_16x16x32_bf16 a[104:107], a[196:199], v[176:179], a[104:107]
buffer_load_dwordx4 v16, s[16:19], s38 offen offset:3072 sc1 lds
v_mfma_f32_16x16x32_bf16 a[108:111], a[196:199], v[180:183], a[108:111]
ds_read_b128 a[168:171], v240 offset:14336
v_exp_f32 v230, v66
v_mfma_f32_16x16x32_bf16 a[112:115], a[200:203], v[176:179], a[112:115]
s_add_u32 s38, s38, 12288
v_cmp_ne_u32 vcc, 0, v236
v_and_b32 v252, s58, v252
v_mfma_f32_16x16x32_bf16 a[116:119], a[200:203], v[180:183], a[116:119]
ds_read_b128 a[172:175], v240 offset:15360
v_and_b32 v253, s58, v253
v_mfma_f32_16x16x32_bf16 a[120:123], a[204:207], v[176:179], a[120:123]
s_waitcnt lgkmcnt(4)
v_exp_f32 v231, v67
v_mfma_f32_16x16x32_bf16 a[124:127], a[204:207], v[180:183], a[124:127]
s_cbranch_vccnz fb_concat_48
fbret_concat_49:
v_add_u32 v2, 0, v16
v_add_u32 v3, 20480, v16
v_add_u32 v4, 40960, v16
v_add_u32 v5, 61440, v16
v_add_u32 v6, 4096, v16
s_mul_i32 s32, s3, 5
s_mul_i32 s29, s7, 20
s_add_u32 s29, s29, s32
s_mul_i32 s29, s29, 5120
s_add_u32 s29, s29, 56623104
s_mul_i32 s28, s6, 80
s_add_u32 s28, s28, s32
s_lshl_b32 s28, s28, 10
s_add_u32 s28, s28, 60817408
global_load_dword v28, v[26:27], off
s_sub_u32 s37, s37, 1
s_cmp_gt_i32 s37, 0
s_cselect_b32 s58, -1, 0
s_cmp_ge_i32 s37, 0
s_cselect_b32 s59, -1, 0
v_mfma_f32_16x16x32_bf16 v[80:83], a[144:147], v[104:107], v[200:203]
s_waitcnt vmcnt(8)
s_barrier
v_mfma_f32_16x16x32_bf16 v[80:83], a[148:151], v[120:123], v[80:83]
ds_read_b128 a[176:179], v240 offset:49152
v_exp_f32 v232, v68
v_mfma_f32_16x16x32_bf16 v[80:83], a[152:155], v[136:139], v[80:83]
buffer_load_dwordx4 a[0:3], v16, s[16:19], s29 offen offset:0 sc1
v_cvt_pk_bf16_f32 v176, v228, v229
v_mfma_f32_16x16x32_bf16 v[80:83], a[156:159], v[152:155], v[80:83]
ds_read_b128 a[180:183], v240 offset:50176
v_exp_f32 v233, v69
v_mfma_f32_16x16x32_bf16 v[84:87], a[144:147], v[108:111], v[204:207]
s_waitcnt lgkmcnt(2)
v_bitop3_b32 v176, v176, v252, s58 bitop3:0xe0
v_cvt_pk_bf16_f32 v177, v230, v231
v_bitop3_b32 v177, v177, v253, s58 bitop3:0xe0
v_mfma_f32_16x16x32_bf16 v[84:87], a[148:151], v[124:127], v[84:87]
ds_read_b128 a[184:187], v240 offset:51200
v_exp_f32 v234, v70
v_mfma_f32_16x16x32_bf16 v[84:87], a[152:155], v[140:143], v[84:87]
buffer_load_dwordx4 a[4:7], v16, s[16:19], s29 offen offset:1024 sc1
v_cvt_pk_bf16_f32 v180, v232, v233
v_mfma_f32_16x16x32_bf16 v[84:87], a[156:159], v[156:159], v[84:87]
ds_read_b128 a[188:191], v240 offset:52224
v_exp_f32 v235, v71
v_mfma_f32_16x16x32_bf16 v[88:91], a[160:163], v[104:107], v[200:203]
v_and_b32 v180, s59, v180
v_or3_b32 v236, v176, v177, v180
v_cvt_pk_bf16_f32 v181, v234, v235
v_mfma_f32_16x16x32_bf16 v[88:91], a[164:167], v[120:123], v[88:91]
ds_read_b128 a[192:195], v240 offset:53248
v_exp_f32 v228, v72
v_mfma_f32_16x16x32_bf16 v[88:91], a[168:171], v[136:139], v[88:91]
buffer_load_dwordx4 a[8:11], v16, s[16:19], s29 offen offset:2048 sc1
v_and_b32 v181, s59, v181
v_mfma_f32_16x16x32_bf16 v[88:91], a[172:175], v[152:155], v[88:91]
ds_read_b128 a[196:199], v240 offset:54272
v_exp_f32 v229, v73
v_mfma_f32_16x16x32_bf16 v[92:95], a[160:163], v[108:111], v[204:207]
v_cvt_pk_bf16_f32 v178, v228, v229
v_exp_f32 v230, v74
v_mfma_f32_16x16x32_bf16 v[92:95], a[164:167], v[124:127], v[92:95]
ds_read_b128 a[200:203], v240 offset:55296
v_and_b32 v178, s58, v178
v_or3_b32 v236, v236, v181, v178
v_mfma_f32_16x16x32_bf16 v[92:95], a[168:171], v[140:143], v[92:95]
buffer_load_dwordx4 a[12:15], v16, s[16:19], s29 offen offset:3072 sc1
v_mfma_f32_16x16x32_bf16 v[92:95], a[172:175], v[156:159], v[92:95]
ds_read_b128 a[204:207], v240 offset:56320
v_exp_f32 v231, v75
v_mfma_f32_16x16x32_bf16 a[136:139], v[224:227], v[184:187], a[136:139]
s_waitcnt lgkmcnt(3)
v_exp_f32 v232, v76
v_mfma_f32_16x16x32_bf16 a[140:143], v[224:227], v[188:191], a[140:143]
buffer_load_dwordx4 a[16:19], v6, s[16:19], s29 offen offset:0 sc1
v_cvt_pk_bf16_f32 v179, v230, v231
v_mfma_f32_16x16x32_bf16 a[64:67], a[176:179], v[184:187], a[64:67]
s_add_u32 s29, s29, 5120
v_and_b32 v179, s58, v179
v_mfma_f32_16x16x32_bf16 a[68:71], a[176:179], v[188:191], a[68:71]
v_exp_f32 v233, v77
v_mfma_f32_16x16x32_bf16 a[72:75], a[180:183], v[184:187], a[72:75]
buffer_load_dwordx4 a[20:23], v16, s[16:19], s29 offen offset:0 sc1
v_cvt_pk_bf16_f32 v182, v232, v233
v_mfma_f32_16x16x32_bf16 a[76:79], a[180:183], v[188:191], a[76:79]
v_exp_f32 v234, v78
v_mfma_f32_16x16x32_bf16 a[80:83], a[184:187], v[184:187], a[80:83]
v_bitop3_b32 v182, v182, v252, s58 bitop3:0xe0
v_exp_f32 v235, v79
v_mfma_f32_16x16x32_bf16 a[84:87], a[184:187], v[188:191], a[84:87]
buffer_load_dwordx4 a[24:27], v16, s[16:19], s29 offen offset:1024 sc1
v_mfma_f32_16x16x32_bf16 a[88:91], a[188:191], v[184:187], a[88:91]
v_or3_b32 v236, v236, v179, v182
v_cvt_pk_bf16_f32 v183, v234, v235
v_mfma_f32_16x16x32_bf16 a[92:95], a[188:191], v[188:191], a[92:95]
v_bitop3_b32 v183, v183, v253, s58 bitop3:0xe0
v_exp_f32 v228, v80
v_mfma_f32_16x16x32_bf16 a[96:99], a[192:195], v[184:187], a[96:99]
buffer_load_dwordx4 a[28:31], v16, s[16:19], s29 offen offset:2048 sc1
v_bitop3_b32 v236, v236, v183, v241 bitop3:0xa8
v_mfma_f32_16x16x32_bf16 a[100:103], a[192:195], v[188:191], a[100:103]
s_waitcnt lgkmcnt(0)
v_exp_f32 v229, v81
v_mfma_f32_16x16x32_bf16 a[104:107], a[196:199], v[184:187], a[104:107]
v_cmp_ne_u32 vcc, 0, v236
v_and_b32 v252, s58, v252
v_and_b32 v253, s58, v253
v_mfma_f32_16x16x32_bf16 a[108:111], a[196:199], v[188:191], a[108:111]
buffer_load_dwordx4 a[32:35], v16, s[16:19], s29 offen offset:3072 sc1
v_mfma_f32_16x16x32_bf16 a[112:115], a[200:203], v[184:187], a[112:115]
v_exp_f32 v230, v82
v_mfma_f32_16x16x32_bf16 a[116:119], a[200:203], v[188:191], a[116:119]
v_exp_f32 v231, v83
v_mfma_f32_16x16x32_bf16 a[120:123], a[204:207], v[184:187], a[120:123]
buffer_load_dwordx4 a[36:39], v6, s[16:19], s29 offen offset:0 sc1
v_mfma_f32_16x16x32_bf16 a[124:127], a[204:207], v[188:191], a[124:127]
s_cbranch_vccnz fb_concat_50
fbret_concat_51:
s_add_u32 s29, s29, 5120
s_cmp_lg_u32 s3, 0
s_cbranch_scc1 w0_concat_52
v_mov_b32 v31, 0
buffer_load_dword v21, v31, s[16:19], s63 offen sc1
w0_concat_52:
s_sub_u32 s37, s37, 1
s_cmp_gt_i32 s37, 0
s_cselect_b32 s58, -1, 0
s_cmp_ge_i32 s37, 0
s_cselect_b32 s59, -1, 0
v_mfma_f32_16x16x32_bf16 a[136:139], v[224:227], v[176:179], a[136:139]
ds_read_b128 a[176:179], v240 offset:57344
v_cvt_pk_bf16_f32 v184, v228, v229
v_bitop3_b32 v184, v184, v252, s58 bitop3:0xe0
v_exp_f32 v232, v84
v_mfma_f32_16x16x32_bf16 a[140:143], v[224:227], v[180:183], a[140:143]
s_waitcnt lgkmcnt(0)
ds_read_b128 a[180:183], v240 offset:58368
v_cvt_pk_bf16_f32 v185, v230, v231
v_bitop3_b32 v185, v185, v253, s58 bitop3:0xe0
v_exp_f32 v233, v85
v_mfma_f32_16x16x32_bf16 a[64:67], a[176:179], v[176:179], a[64:67]
ds_read_b128 a[184:187], v240 offset:59392
v_cvt_pk_bf16_f32 v188, v232, v233
v_and_b32 v188, s59, v188
v_exp_f32 v234, v86
v_mfma_f32_16x16x32_bf16 a[68:71], a[176:179], v[180:183], a[68:71]
s_waitcnt lgkmcnt(1)
ds_read_b128 a[188:191], v240 offset:60416
v_or3_b32 v236, v184, v185, v188
v_exp_f32 v235, v87
v_mfma_f32_16x16x32_bf16 a[72:75], a[180:183], v[176:179], a[72:75]
ds_read_b128 a[192:195], v240 offset:61440
v_cvt_pk_bf16_f32 v189, v234, v235
v_and_b32 v189, s59, v189
v_exp_f32 v228, v88
v_mfma_f32_16x16x32_bf16 a[76:79], a[180:183], v[180:183], a[76:79]
s_waitcnt lgkmcnt(2)
ds_read_b128 a[196:199], v240 offset:62464
v_exp_f32 v229, v89
v_mfma_f32_16x16x32_bf16 a[80:83], a[184:187], v[176:179], a[80:83]
ds_read_b128 a[200:203], v240 offset:63488
v_cvt_pk_bf16_f32 v186, v228, v229
v_and_b32 v186, s58, v186
v_or3_b32 v236, v236, v189, v186
v_mfma_f32_16x16x32_bf16 a[84:87], a[184:187], v[180:183], a[84:87]
s_waitcnt lgkmcnt(3)
ds_read_b128 a[204:207], v240 offset:64512
v_exp_f32 v230, v90
v_xor_b32 v240, 0x10000, v240
v_mfma_f32_16x16x32_bf16 a[88:91], a[188:191], v[176:179], a[88:91]
buffer_load_dwordx4 a[40:43], v16, s[16:19], s29 offen offset:0 sc1
v_mfma_f32_16x16x32_bf16 a[92:95], a[188:191], v[180:183], a[92:95]
s_waitcnt lgkmcnt(3)
v_exp_f32 v231, v91
v_mfma_f32_16x16x32_bf16 a[96:99], a[192:195], v[176:179], a[96:99]
buffer_load_dwordx4 a[44:47], v16, s[16:19], s29 offen offset:1024 sc1
v_exp_f32 v232, v92
v_mfma_f32_16x16x32_bf16 a[100:103], a[192:195], v[180:183], a[100:103]
s_waitcnt lgkmcnt(2)
v_cvt_pk_bf16_f32 v187, v230, v231
v_and_b32 v187, s58, v187
v_exp_f32 v233, v93
v_mfma_f32_16x16x32_bf16 a[104:107], a[196:199], v[176:179], a[104:107]
buffer_load_dwordx4 a[48:51], v16, s[16:19], s29 offen offset:2048 sc1
v_cvt_pk_bf16_f32 v190, v232, v233
v_mfma_f32_16x16x32_bf16 a[108:111], a[196:199], v[180:183], a[108:111]
s_waitcnt lgkmcnt(0)
v_bitop3_b32 v190, v190, v252, s58 bitop3:0xe0
v_or3_b32 v236, v236, v187, v190
v_and_b32 v252, s58, v252
v_mfma_f32_16x16x32_bf16 a[112:115], a[200:203], v[176:179], a[112:115]
buffer_load_dwordx4 a[52:55], v16, s[16:19], s29 offen offset:3072 sc1
v_exp_f32 v234, v94
v_mfma_f32_16x16x32_bf16 a[116:119], a[200:203], v[180:183], a[116:119]
v_exp_f32 v235, v95
v_mfma_f32_16x16x32_bf16 a[120:123], a[204:207], v[176:179], a[120:123]
buffer_load_dwordx4 a[56:59], v6, s[16:19], s29 offen offset:0 sc1
v_cvt_pk_bf16_f32 v191, v234, v235
v_mfma_f32_16x16x32_bf16 a[124:127], a[204:207], v[180:183], a[124:127]
s_add_u32 s29, s29, 5120
v_bitop3_b32 v191, v191, v253, s58 bitop3:0xe0
v_bitop3_b32 v236, v236, v191, v241 bitop3:0xa8
v_cmp_ne_u32 vcc, 0, v236
v_and_b32 v253, s58, v253
s_cbranch_vccnz fb_concat_53
fbret_concat_54:
s_waitcnt vmcnt(5)
s_barrier
ds_read_b128 a[176:179], v240 offset:16384
ds_read_b128 a[180:183], v240 offset:17408
ds_read_b128 a[184:187], v240 offset:18432
ds_read_b128 a[188:191], v240 offset:19456
ds_read_b128 a[192:195], v240 offset:20480
ds_read_b128 a[196:199], v240 offset:21504
ds_read_b128 a[200:203], v240 offset:22528
ds_read_b128 a[204:207], v240 offset:23552
s_cmp_lg_u32 s3, 0
s_cbranch_scc1 w0_concat_55
v_mov_b32 v31, 0
v_mov_b32 v29, 1
s_mov_b64 exec, 1
s_mov_b32 s60, s5
s_lshl_b32 s60, s60, 2
s_lshr_b32 s61, s4, 3
s_add_u32 s60, s60, s61
s_lshl_b32 s60, s60, 8
s_add_u32 s60, s60, 64176128
buffer_atomic_add v29, v31, s[16:19], s60 offen sc1
s_lshr_b32 s60, s2, 2
s_lshl_b32 s60, s60, 8
s_add_u32 s60, s60, 64192512
buffer_atomic_add v29, v31, s[16:19], s60 offen sc1
s_mov_b64 exec, -1
w0_concat_55:
s_and_b32 s46, s2, 3
s_bfe_u32 s44, s2, 0x10002
s_lshl_b32 s44, s44, 3
s_bfe_u32 s45, s2, 0x30003
s_add_u32 s44, s44, s45
s_lshr_b32 s45, s2, 6
s_lshr_b32 s49, s2, 2
s_lshl_b32 s50, s46, 5
s_lshl_b32 s47, s46, 6
s_add_u32 s47, s47, s3
s_mul_i32 s47, s47, 20480
s_mul_i32 s48, s45, 320
s_add_u32 s47, s47, s48
s_lshl_b32 s48, s44, 2
s_add_u32 s48, s48, s3
s_lshl_b32 s48, s48, 8
s_add_u32 s48, s48, s50
s_lshl_b32 s48, s48, 10
s_add_u32 s48, s48, 33554432
s_mul_i32 s50, s3, 5120
s_lshl_b32 s62, s44, 2
s_add_u32 s62, s62, s46
s_lshl_b32 s62, s62, 8
s_add_u32 s62, s62, 64176128
v_mfma_f32_16x16x32_bf16 a[136:139], v[224:227], v[184:187], a[136:139]
buffer_load_dwordx4 a[60:63], v16, s[16:19], s29 offen offset:0 sc1
v_mfma_f32_16x16x32_bf16 a[140:143], v[224:227], v[188:191], a[140:143]
s_waitcnt lgkmcnt(7)
buffer_load_dwordx4 a[228:231], v16, s[16:19], s29 offen offset:1024 sc1
v_mfma_f32_16x16x32_bf16 a[64:67], a[176:179], v[184:187], a[64:67]
buffer_load_dwordx4 a[232:235], v16, s[16:19], s29 offen offset:2048 sc1
v_mfma_f32_16x16x32_bf16 a[68:71], a[176:179], v[188:191], a[68:71]
s_waitcnt lgkmcnt(6)
buffer_load_dwordx4 a[236:239], v16, s[16:19], s29 offen offset:3072 sc1
v_mfma_f32_16x16x32_bf16 a[72:75], a[180:183], v[184:187], a[72:75]
buffer_load_dwordx4 a[240:243], v6, s[16:19], s29 offen offset:0 sc1
v_mfma_f32_16x16x32_bf16 a[76:79], a[180:183], v[188:191], a[76:79]
s_waitcnt lgkmcnt(5)
s_add_u32 s29, s29, 5120
v_mfma_f32_16x16x32_bf16 a[80:83], a[184:187], v[184:187], a[80:83]
buffer_load_dwordx4 a[244:247], v16, s[16:19], s29 offen offset:0 sc1
v_mfma_f32_16x16x32_bf16 a[84:87], a[184:187], v[188:191], a[84:87]
s_waitcnt lgkmcnt(4)
buffer_load_dwordx4 a[248:251], v16, s[16:19], s29 offen offset:1024 sc1
v_mfma_f32_16x16x32_bf16 a[88:91], a[188:191], v[184:187], a[88:91]
buffer_load_dwordx4 a[252:255], v16, s[16:19], s29 offen offset:2048 sc1
v_mfma_f32_16x16x32_bf16 a[92:95], a[188:191], v[188:191], a[92:95]
s_waitcnt lgkmcnt(3)
buffer_load_dwordx4 v[192:195], v16, s[16:19], s29 offen offset:3072 sc1
v_mfma_f32_16x16x32_bf16 a[96:99], a[192:195], v[184:187], a[96:99]
buffer_load_dwordx4 v[196:199], v6, s[16:19], s29 offen offset:0 sc1
v_mfma_f32_16x16x32_bf16 a[100:103], a[192:195], v[188:191], a[100:103]
s_waitcnt lgkmcnt(2)
s_add_u32 s29, s29, 5120
v_mfma_f32_16x16x32_bf16 a[104:107], a[196:199], v[184:187], a[104:107]
v_mfma_f32_16x16x32_bf16 a[108:111], a[196:199], v[188:191], a[108:111]
s_waitcnt lgkmcnt(1)
v_mfma_f32_16x16x32_bf16 a[112:115], a[200:203], v[184:187], a[112:115]
v_mfma_f32_16x16x32_bf16 a[116:119], a[200:203], v[188:191], a[116:119]
s_waitcnt lgkmcnt(0)
v_mfma_f32_16x16x32_bf16 a[120:123], a[204:207], v[184:187], a[120:123]
v_mfma_f32_16x16x32_bf16 a[124:127], a[204:207], v[188:191], a[124:127]
s_cmp_lg_u32 s3, 0
s_cbranch_scc1 spinret_concat_57
v_readfirstlane_b32 s60, v21
s_cmp_lt_u32 s60, 16
s_cbranch_scc1 spin_concat_56
spinret_concat_57:
s_barrier
s_mul_i32 s32, s88, 12288
s_lshl_b32 s33, s3, 10
s_add_u32 s32, s32, s33
s_add_u32 s32, s32, 63963136
buffer_load_dwordx4 v[244:247], v16, s[16:19], s32 offen sc1
s_add_u32 s32, s32, 4096
buffer_load_dwordx4 v[248:251], v16, s[16:19], s32 offen sc1
s_add_u32 s32, s32, 4096
buffer_load_dwordx4 v[252:255], v16, s[16:19], s32 offen sc1
s_sub_u32 s32, 15, s5
s_lshl_b32 s32, s32, 3
s_lshl_b32 s33, s3, 1
s_add_u32 s32, s32, s33
s_lshl_b32 s32, s32, 17
s_lshl_b32 s33, s4, 12
s_add_u32 s32, s32, s33
s_add_u32 s32, s32, 33554432
.p2align 3
s_nop 7
v_accvgpr_read_b32 v232, a136
v_accvgpr_read_b32 v234, a140
v_rcp_f32 v232, v232
v_rcp_f32 v234, v234
v_accvgpr_read_b32 v212, a72
v_accvgpr_read_b32 v213, a73
v_accvgpr_read_b32 v214, a74
v_accvgpr_read_b32 v215, a75
v_accvgpr_read_b32 v208, a64
v_accvgpr_read_b32 v209, a65
v_accvgpr_read_b32 v210, a66
v_accvgpr_read_b32 v211, a67
v_pk_mul_f32 v[208:209], v[208:209], v[232:233] op_sel_hi:[1,0]
v_pk_mul_f32 v[210:211], v[210:211], v[232:233] op_sel_hi:[1,0]
v_pk_mul_f32 v[212:213], v[212:213], v[232:233] op_sel_hi:[1,0]
v_pk_mul_f32 v[214:215], v[214:215], v[232:233] op_sel_hi:[1,0]
v_cvt_pk_bf16_f32 v208, v208, v209
v_cvt_pk_bf16_f32 v209, v210, v211
v_cvt_pk_bf16_f32 v210, v212, v213
v_cvt_pk_bf16_f32 v211, v214, v215
buffer_store_dwordx4 v[208:211], v16, s[16:19], s32 offen offset:0 sc1
v_accvgpr_read_b32 v220, a88
v_accvgpr_read_b32 v221, a89
v_accvgpr_read_b32 v222, a90
v_accvgpr_read_b32 v223, a91
v_accvgpr_read_b32 v216, a80
v_accvgpr_read_b32 v217, a81
v_accvgpr_read_b32 v218, a82
v_accvgpr_read_b32 v219, a83
v_pk_mul_f32 v[216:217], v[216:217], v[232:233] op_sel_hi:[1,0]
v_pk_mul_f32 v[218:219], v[218:219], v[232:233] op_sel_hi:[1,0]
v_pk_mul_f32 v[220:221], v[220:221], v[232:233] op_sel_hi:[1,0]
v_pk_mul_f32 v[222:223], v[222:223], v[232:233] op_sel_hi:[1,0]
v_cvt_pk_bf16_f32 v216, v216, v217
v_cvt_pk_bf16_f32 v217, v218, v219
v_cvt_pk_bf16_f32 v218, v220, v221
v_cvt_pk_bf16_f32 v219, v222, v223
buffer_store_dwordx4 v[216:219], v16, s[16:19], s32 offen offset:1024 sc1
v_accvgpr_read_b32 v212, a104
v_accvgpr_read_b32 v213, a105
v_accvgpr_read_b32 v214, a106
v_accvgpr_read_b32 v215, a107
v_accvgpr_read_b32 v208, a96
v_accvgpr_read_b32 v209, a97
v_accvgpr_read_b32 v210, a98
v_accvgpr_read_b32 v211, a99
v_pk_mul_f32 v[208:209], v[208:209], v[232:233] op_sel_hi:[1,0]
v_pk_mul_f32 v[210:211], v[210:211], v[232:233] op_sel_hi:[1,0]
v_pk_mul_f32 v[212:213], v[212:213], v[232:233] op_sel_hi:[1,0]
v_pk_mul_f32 v[214:215], v[214:215], v[232:233] op_sel_hi:[1,0]
v_cvt_pk_bf16_f32 v208, v208, v209
v_cvt_pk_bf16_f32 v209, v210, v211
v_cvt_pk_bf16_f32 v210, v212, v213
v_cvt_pk_bf16_f32 v211, v214, v215
buffer_store_dwordx4 v[208:211], v16, s[16:19], s32 offen offset:2048 sc1
v_accvgpr_read_b32 v220, a120
v_accvgpr_read_b32 v221, a121
v_accvgpr_read_b32 v222, a122
v_accvgpr_read_b32 v223, a123
v_accvgpr_read_b32 v216, a112
v_accvgpr_read_b32 v217, a113
v_accvgpr_read_b32 v218, a114
v_accvgpr_read_b32 v219, a115
v_pk_mul_f32 v[216:217], v[216:217], v[232:233] op_sel_hi:[1,0]
v_pk_mul_f32 v[218:219], v[218:219], v[232:233] op_sel_hi:[1,0]
v_pk_mul_f32 v[220:221], v[220:221], v[232:233] op_sel_hi:[1,0]
v_pk_mul_f32 v[222:223], v[222:223], v[232:233] op_sel_hi:[1,0]
v_cvt_pk_bf16_f32 v216, v216, v217
v_cvt_pk_bf16_f32 v217, v218, v219
v_cvt_pk_bf16_f32 v218, v220, v221
v_cvt_pk_bf16_f32 v219, v222, v223
buffer_store_dwordx4 v[216:219], v16, s[16:19], s32 offen offset:3072 sc1
s_add_u32 s32, s32, 131072
v_accvgpr_read_b32 v212, a76
v_accvgpr_read_b32 v213, a77
v_accvgpr_read_b32 v214, a78
v_accvgpr_read_b32 v215, a79
v_accvgpr_read_b32 v208, a68
v_accvgpr_read_b32 v209, a69
v_accvgpr_read_b32 v210, a70
v_accvgpr_read_b32 v211, a71
v_pk_mul_f32 v[208:209], v[208:209], v[234:235] op_sel_hi:[1,0]
v_pk_mul_f32 v[210:211], v[210:211], v[234:235] op_sel_hi:[1,0]
v_pk_mul_f32 v[212:213], v[212:213], v[234:235] op_sel_hi:[1,0]
v_pk_mul_f32 v[214:215], v[214:215], v[234:235] op_sel_hi:[1,0]
v_cvt_pk_bf16_f32 v208, v208, v209
v_cvt_pk_bf16_f32 v209, v210, v211
v_cvt_pk_bf16_f32 v210, v212, v213
v_cvt_pk_bf16_f32 v211, v214, v215
buffer_store_dwordx4 v[208:211], v16, s[16:19], s32 offen offset:0 sc1
v_accvgpr_read_b32 v220, a92
v_accvgpr_read_b32 v221, a93
v_accvgpr_read_b32 v222, a94
v_accvgpr_read_b32 v223, a95
v_accvgpr_read_b32 v216, a84
v_accvgpr_read_b32 v217, a85
v_accvgpr_read_b32 v218, a86
v_accvgpr_read_b32 v219, a87
v_pk_mul_f32 v[216:217], v[216:217], v[234:235] op_sel_hi:[1,0]
v_pk_mul_f32 v[218:219], v[218:219], v[234:235] op_sel_hi:[1,0]
v_pk_mul_f32 v[220:221], v[220:221], v[234:235] op_sel_hi:[1,0]
v_pk_mul_f32 v[222:223], v[222:223], v[234:235] op_sel_hi:[1,0]
v_cvt_pk_bf16_f32 v216, v216, v217
v_cvt_pk_bf16_f32 v217, v218, v219
v_cvt_pk_bf16_f32 v218, v220, v221
v_cvt_pk_bf16_f32 v219, v222, v223
buffer_store_dwordx4 v[216:219], v16, s[16:19], s32 offen offset:1024 sc1
v_accvgpr_read_b32 v212, a108
v_accvgpr_read_b32 v213, a109
v_accvgpr_read_b32 v214, a110
v_accvgpr_read_b32 v215, a111
v_accvgpr_read_b32 v208, a100
v_accvgpr_read_b32 v209, a101
v_accvgpr_read_b32 v210, a102
v_accvgpr_read_b32 v211, a103
v_pk_mul_f32 v[208:209], v[208:209], v[234:235] op_sel_hi:[1,0]
v_pk_mul_f32 v[210:211], v[210:211], v[234:235] op_sel_hi:[1,0]
v_pk_mul_f32 v[212:213], v[212:213], v[234:235] op_sel_hi:[1,0]
v_pk_mul_f32 v[214:215], v[214:215], v[234:235] op_sel_hi:[1,0]
v_cvt_pk_bf16_f32 v208, v208, v209
v_cvt_pk_bf16_f32 v209, v210, v211
v_cvt_pk_bf16_f32 v210, v212, v213
v_cvt_pk_bf16_f32 v211, v214, v215
buffer_store_dwordx4 v[208:211], v16, s[16:19], s32 offen offset:2048 sc1
v_accvgpr_read_b32 v220, a124
v_accvgpr_read_b32 v221, a125
v_accvgpr_read_b32 v222, a126
v_accvgpr_read_b32 v223, a127
v_accvgpr_read_b32 v216, a116
v_accvgpr_read_b32 v217, a117
v_accvgpr_read_b32 v218, a118
v_accvgpr_read_b32 v219, a119
v_pk_mul_f32 v[216:217], v[216:217], v[234:235] op_sel_hi:[1,0]
v_pk_mul_f32 v[218:219], v[218:219], v[234:235] op_sel_hi:[1,0]
v_pk_mul_f32 v[220:221], v[220:221], v[234:235] op_sel_hi:[1,0]
v_pk_mul_f32 v[222:223], v[222:223], v[234:235] op_sel_hi:[1,0]
v_cvt_pk_bf16_f32 v216, v216, v217
v_cvt_pk_bf16_f32 v217, v218, v219
v_cvt_pk_bf16_f32 v218, v220, v221
v_cvt_pk_bf16_f32 v219, v222, v223
buffer_store_dwordx4 v[216:219], v16, s[16:19], s32 offen offset:3072 sc1
v_add_u32 v17, 0, v1
v_mul_u32_u24 v18, 3277, v17
v_lshrrev_b32 v18, 16, v18
v_bfe_u32 v19, v18, 2, 1
v_lshlrev_b32 v19, 1, v19
v_xor_b32 v17, v17, v19
v_mul_u32_u24 v18, 960, v18
v_lshl_add_u32 v200, v17, 4, v18
v_add_u32 v17, 64, v1
v_mul_u32_u24 v18, 3277, v17
v_lshrrev_b32 v18, 16, v18
v_bfe_u32 v19, v18, 2, 1
v_lshlrev_b32 v19, 1, v19
v_xor_b32 v17, v17, v19
v_mul_u32_u24 v18, 960, v18
v_lshl_add_u32 v201, v17, 4, v18
v_subrev_u32 v201, 1024, v201
v_add_u32 v17, 128, v1
v_mul_u32_u24 v18, 3277, v17
v_lshrrev_b32 v18, 16, v18
v_bfe_u32 v19, v18, 2, 1
v_lshlrev_b32 v19, 1, v19
v_xor_b32 v17, v17, v19
v_mul_u32_u24 v18, 960, v18
v_lshl_add_u32 v202, v17, 4, v18
v_subrev_u32 v202, 2048, v202
v_add_u32 v17, 192, v1
v_mul_u32_u24 v18, 3277, v17
v_lshrrev_b32 v18, 16, v18
v_bfe_u32 v19, v18, 2, 1
v_lshlrev_b32 v19, 1, v19
v_xor_b32 v17, v17, v19
v_mul_u32_u24 v18, 960, v18
v_lshl_add_u32 v203, v17, 4, v18
v_subrev_u32 v203, 3072, v203
v_add_u32 v17, 256, v1
v_mul_u32_u24 v18, 3277, v17
v_lshrrev_b32 v18, 16, v18
v_bfe_u32 v19, v18, 2, 1
v_lshlrev_b32 v19, 1, v19
v_xor_b32 v17, v17, v19
v_mul_u32_u24 v18, 960, v18
v_lshl_add_u32 v204, v17, 4, v18
v_add_u32 v10, 129024, v16
v_lshrrev_b32 v17, 2, v1
v_mul_u32_u24 v17, 320, v17
v_and_b32 v18, 3, v1
v_lshl_add_u32 v17, v18, 3, v17
v_bfe_u32 v18, v1, 4, 1
s_lshr_b32 s32, s3, 1
s_mul_i32 s32, s32, 5
v_xor_b32 v19, s32, v18
v_lshl_add_u32 v11, v19, 5, v17
v_add_u32 v8, 40960, v11
s_add_u32 s32, s32, 1
v_xor_b32 v19, s32, v18
v_lshl_add_u32 v205, v19, 5, v17
v_add_u32 v206, 40960, v205
s_and_b32 s32, s3, 1
s_lshl_b32 s32, s32, 13
s_add_u32 s32, s32, 81920
s_add_u32 s33, s46, 0
s_and_b32 s33, s33, 3
s_lshl_b32 s33, s33, 11
s_add_u32 s33, s33, s32
v_add_u32 v12, s33, v16
s_add_u32 s33, s46, 1
s_and_b32 s33, s33, 3
s_lshl_b32 s33, s33, 11
s_add_u32 s33, s33, s32
v_add_u32 v13, s33, v16
s_add_u32 s33, s46, 2
s_and_b32 s33, s33, 3
s_lshl_b32 s33, s33, 11
s_add_u32 s33, s33, s32
v_add_u32 v14, s33, v16
s_add_u32 s33, s46, 3
s_and_b32 s33, s33, 3
s_lshl_b32 s33, s33, 11
s_add_u32 s33, s33, s32
v_add_u32 v15, s33, v16
v_bfe_u32 v17, v1, 2, 2
v_lshlrev_b32 v17, 2, v17
v_lshrrev_b32 v18, 4, v1
v_add_u32 v17, v17, v18
v_lshlrev_b32 v17, 6, v17
v_and_b32 v19, 3, v1
v_lshl_add_u32 v17, v19, 3, v17
s_lshr_b32 s32, s3, 1
s_lshl_b32 s32, s32, 10
s_and_b32 s33, s3, 1
s_lshl_b32 s33, s33, 5
s_add_u32 s32, s32, s33
s_add_u32 s32, s32, 147456
v_add_u32 v17, s32, v17
v_mov_b32 v96, 0
v_mov_b32 v97, 0
v_mov_b32 v98, 0
v_mov_b32 v99, 0
s_lshl_b32 s33, s3, 10
s_add_u32 s33, s33, 153600
v_add_u32 v20, s33, v16
ds_write_b128 v20, v[96:99]
s_waitcnt vmcnt(8)
v_cvt_pk_bf16_f32 v244, v244, v245
v_cvt_pk_bf16_f32 v245, v246, v247
ds_write_b64 v17, v[244:245] offset:0
v_cvt_pk_bf16_f32 v248, v248, v249
v_cvt_pk_bf16_f32 v249, v250, v251
ds_write_b64 v17, v[248:249] offset:2048
v_cvt_pk_bf16_f32 v252, v252, v253
v_cvt_pk_bf16_f32 v253, v254, v255
ds_write_b64 v17, v[252:253] offset:4096
v_and_b32 v20, 2, v19
v_cmp_eq_u32 vcc, v18, v20
v_lshrrev_b32 v18, 1, v18
v_mul_u32_u24 v18, 3072, v18
v_bfe_u32 v20, v1, 2, 2
v_lshl_add_u32 v18, v20, 6, v18
v_and_b32 v20, 1, v19
v_lshl_add_u32 v25, v20, 4, v18
v_lshl_add_u32 v26, v19, 3, v18
v_add_u32 v26, 32, v26
v_mov_b32 v20, 6144
v_cndmask_b32 v25, v20, v25, vcc
v_cndmask_b32 v26, v20, v26, vcc
v_add_u32 v25, 147456, v25
v_add_u32 v26, 147456, v26
v_bfe_u32 v20, v1, 4, 1
v_cmp_eq_u32 s[52:53], 1, v20
s_add_u32 m0, s50, 0
s_nop 0
buffer_load_dwordx4 v200, s[80:83], s47 offen offset:0 lds
buffer_load_dwordx4 v201, s[80:83], s47 offen offset:1024 lds
buffer_load_dwordx4 v202, s[80:83], s47 offen offset:2048 lds
buffer_load_dwordx4 v203, s[80:83], s47 offen offset:3072 lds
s_add_u32 m0, s50, 4096
s_nop 0
buffer_load_dwordx4 v204, s[80:83], s47 offen lds
s_add_u32 s47, s47, 81920
s_waitcnt vmcnt(5) lgkmcnt(0)
s_barrier
s_cmp_lg_u32 s3, 0
s_cbranch_scc1 w0_concat_58
v_mov_b32 v31, 0
v_mov_b32 v29, 1
s_mov_b64 exec, 1
s_sub_u32 s60, 15, s5
s_lshl_b32 s60, s60, 2
s_lshr_b32 s61, s4, 3
s_add_u32 s60, s60, s61
s_lshl_b32 s60, s60, 8
s_add_u32 s60, s60, 64176128
buffer_atomic_add v29, v31, s[16:19], s60 offen sc1
s_mov_b64 exec, -1
w0_concat_58:
s_add_u32 m0, s50, 20480
s_nop 0
buffer_load_dwordx4 v200, s[80:83], s47 offen offset:0 lds
buffer_load_dwordx4 v201, s[80:83], s47 offen offset:1024 lds
buffer_load_dwordx4 v202, s[80:83], s47 offen offset:2048 lds
buffer_load_dwordx4 v203, s[80:83], s47 offen offset:3072 lds
s_add_u32 m0, s50, 24576
s_nop 0
buffer_load_dwordx4 v204, s[80:83], s47 offen lds
s_add_u32 s47, s47, 81920
s_add_u32 m0, s50, 40960
s_nop 0
buffer_load_dwordx4 v200, s[80:83], s47 offen offset:0 lds
buffer_load_dwordx4 v201, s[80:83], s47 offen offset:1024 lds
buffer_load_dwordx4 v202, s[80:83], s47 offen offset:2048 lds
buffer_load_dwordx4 v203, s[80:83], s47 offen offset:3072 lds
s_add_u32 m0, s50, 45056
s_nop 0
buffer_load_dwordx4 v204, s[80:83], s47 offen lds
s_add_u32 s47, s47, 81920
s_add_u32 m0, s50, 61440
s_nop 0
buffer_load_dwordx4 v200, s[80:83], s47 offen offset:0 lds
buffer_load_dwordx4 v201, s[80:83], s47 offen offset:1024 lds
buffer_load_dwordx4 v202, s[80:83], s47 offen offset:2048 lds
buffer_load_dwordx4 v203, s[80:83], s47 offen offset:3072 lds
s_add_u32 m0, s50, 65536
s_nop 0
buffer_load_dwordx4 v204, s[80:83], s47 offen lds
s_add_u32 s47, s47, 81920
s_cmp_lg_u32 s3, 0
s_cbranch_scc1 w0_concat_59
v_mov_b32 v31, 0
buffer_load_dword v21, v31, s[16:19], s62 offen sc1
w0_concat_59:
ds_read_b64_tr_b16 v[32:33], v25 offset:0
ds_read_b64_tr_b16 v[34:35], v25 offset:256
ds_read_b64_tr_b16 v[36:37], v25 offset:512
ds_read_b64_tr_b16 v[38:39], v25 offset:768
ds_read_b64_tr_b16 v[40:41], v25 offset:1024
ds_read_b64_tr_b16 v[42:43], v25 offset:1280
ds_read_b64_tr_b16 v[44:45], v25 offset:1536
ds_read_b64_tr_b16 v[46:47], v25 offset:1792
ds_read_b64_tr_b16 v[48:49], v25 offset:2048
ds_read_b64_tr_b16 v[50:51], v25 offset:2304
ds_read_b64_tr_b16 v[52:53], v25 offset:8
ds_read_b64_tr_b16 v[54:55], v25 offset:264
ds_read_b64_tr_b16 v[56:57], v25 offset:520
ds_read_b64_tr_b16 v[58:59], v25 offset:776
ds_read_b64_tr_b16 v[60:61], v25 offset:1032
ds_read_b64_tr_b16 v[62:63], v25 offset:1288
ds_read_b64_tr_b16 v[64:65], v25 offset:1544
ds_read_b64_tr_b16 v[66:67], v25 offset:1800
ds_read_b64_tr_b16 v[68:69], v25 offset:2056
ds_read_b64_tr_b16 v[70:71], v25 offset:2312
ds_read_b64_tr_b16 v[72:73], v26 offset:0
ds_read_b64_tr_b16 v[74:75], v26 offset:256
ds_read_b64_tr_b16 v[76:77], v26 offset:512
ds_read_b64_tr_b16 v[78:79], v26 offset:768
ds_read_b64_tr_b16 v[80:81], v26 offset:1024
ds_read_b64_tr_b16 v[82:83], v26 offset:1280
ds_read_b64_tr_b16 v[84:85], v26 offset:1536
ds_read_b64_tr_b16 v[86:87], v26 offset:1792
ds_read_b64_tr_b16 v[88:89], v26 offset:2048
ds_read_b64_tr_b16 v[90:91], v26 offset:2304
v_accvgpr_read_b32 v252, a208
v_accvgpr_read_b32 v253, a209
v_accvgpr_read_b32 v254, a210
v_accvgpr_read_b32 v255, a211
v_accvgpr_read_b32 v128, a208
v_accvgpr_read_b32 v129, a209
v_accvgpr_read_b32 v130, a210
v_accvgpr_read_b32 v131, a211
v_permlane16_swap_b32 v252, v128
v_permlane16_swap_b32 v253, v129
v_permlane16_swap_b32 v254, v130
v_permlane16_swap_b32 v255, v131
v_accvgpr_read_b32 v252, a212
v_accvgpr_read_b32 v253, a213
v_accvgpr_read_b32 v254, a214
v_accvgpr_read_b32 v255, a215
v_accvgpr_read_b32 v132, a212
v_accvgpr_read_b32 v133, a213
v_accvgpr_read_b32 v134, a214
v_accvgpr_read_b32 v135, a215
v_permlane16_swap_b32 v252, v132
v_permlane16_swap_b32 v253, v133
v_permlane16_swap_b32 v254, v134
v_permlane16_swap_b32 v255, v135
v_accvgpr_read_b32 v252, a216
v_accvgpr_read_b32 v253, a217
v_accvgpr_read_b32 v254, a218
v_accvgpr_read_b32 v255, a219
v_accvgpr_read_b32 v136, a216
v_accvgpr_read_b32 v137, a217
v_accvgpr_read_b32 v138, a218
v_accvgpr_read_b32 v139, a219
v_permlane16_swap_b32 v252, v136
v_permlane16_swap_b32 v253, v137
v_permlane16_swap_b32 v254, v138
v_permlane16_swap_b32 v255, v139
v_accvgpr_read_b32 v252, a220
v_accvgpr_read_b32 v253, a221
v_accvgpr_read_b32 v254, a222
v_accvgpr_read_b32 v255, a223
v_accvgpr_read_b32 v140, a220
v_accvgpr_read_b32 v141, a221
v_accvgpr_read_b32 v142, a222
v_accvgpr_read_b32 v143, a223
v_permlane16_swap_b32 v252, v140
v_permlane16_swap_b32 v253, v141
v_permlane16_swap_b32 v254, v142
v_permlane16_swap_b32 v255, v143
v_accvgpr_read_b32 v252, a224
v_accvgpr_read_b32 v253, a225
v_accvgpr_read_b32 v254, a226
v_accvgpr_read_b32 v255, a227
v_accvgpr_read_b32 v144, a224
v_accvgpr_read_b32 v145, a225
v_accvgpr_read_b32 v146, a226
v_accvgpr_read_b32 v147, a227
v_permlane16_swap_b32 v252, v144
v_permlane16_swap_b32 v253, v145
v_permlane16_swap_b32 v254, v146
v_permlane16_swap_b32 v255, v147
s_waitcnt lgkmcnt(15)
v_mfma_f32_16x16x32_bf16 v[96:99], v[32:35], a[208:211], 0
s_waitcnt lgkmcnt(15)
v_mfma_f32_16x16x32_bf16 v[96:99], v[36:39], a[212:215], v[96:99]
s_waitcnt lgkmcnt(15)
v_mfma_f32_16x16x32_bf16 v[96:99], v[40:43], a[216:219], v[96:99]
s_waitcnt lgkmcnt(15)
v_mfma_f32_16x16x32_bf16 v[96:99], v[44:47], a[220:223], v[96:99]
s_waitcnt lgkmcnt(15)
v_mfma_f32_16x16x32_bf16 v[96:99], v[48:51], a[224:227], v[96:99]
s_waitcnt lgkmcnt(15)
v_mfma_f32_16x16x32_bf16 v[100:103], v[52:55], a[208:211], 0
s_waitcnt lgkmcnt(15)
v_mfma_f32_16x16x32_bf16 v[100:103], v[56:59], a[212:215], v[100:103]
s_waitcnt lgkmcnt(14)
v_mfma_f32_16x16x32_bf16 v[100:103], v[60:63], a[216:219], v[100:103]
s_waitcnt lgkmcnt(12)
v_mfma_f32_16x16x32_bf16 v[100:103], v[64:67], a[220:223], v[100:103]
s_waitcnt lgkmcnt(10)
v_mfma_f32_16x16x32_bf16 v[100:103], v[68:71], a[224:227], v[100:103]
s_waitcnt lgkmcnt(8)
v_mfma_f32_16x16x32_bf16 v[104:107], v[72:75], a[208:211], 0
s_waitcnt lgkmcnt(6)
v_mfma_f32_16x16x32_bf16 v[104:107], v[76:79], a[212:215], v[104:107]
s_waitcnt lgkmcnt(4)
v_mfma_f32_16x16x32_bf16 v[104:107], v[80:83], a[216:219], v[104:107]
s_waitcnt lgkmcnt(2)
v_mfma_f32_16x16x32_bf16 v[104:107], v[84:87], a[220:223], v[104:107]
s_waitcnt lgkmcnt(0)
v_mfma_f32_16x16x32_bf16 v[104:107], v[88:91], a[224:227], v[104:107]
v_mfma_f32_16x16x32_bf16 v[112:115], v[32:35], v[128:131], 0
v_mfma_f32_16x16x32_bf16 v[112:115], v[36:39], v[132:135], v[112:115]
v_mfma_f32_16x16x32_bf16 v[112:115], v[40:43], v[136:139], v[112:115]
v_mfma_f32_16x16x32_bf16 v[112:115], v[44:47], v[140:143], v[112:115]
v_mfma_f32_16x16x32_bf16 v[112:115], v[48:51], v[144:147], v[112:115]
v_mfma_f32_16x16x32_bf16 v[116:119], v[52:55], v[128:131], 0
v_mfma_f32_16x16x32_bf16 v[116:119], v[56:59], v[132:135], v[116:119]
v_mfma_f32_16x16x32_bf16 v[116:119], v[60:63], v[136:139], v[116:119]
v_mfma_f32_16x16x32_bf16 v[116:119], v[64:67], v[140:143], v[116:119]
v_mfma_f32_16x16x32_bf16 v[116:119], v[68:71], v[144:147], v[116:119]
v_mfma_f32_16x16x32_bf16 v[120:123], v[72:75], v[128:131], 0
v_mfma_f32_16x16x32_bf16 v[120:123], v[76:79], v[132:135], v[120:123]
v_mfma_f32_16x16x32_bf16 v[120:123], v[80:83], v[136:139], v[120:123]
v_mfma_f32_16x16x32_bf16 v[120:123], v[84:87], v[140:143], v[120:123]
v_mfma_f32_16x16x32_bf16 v[120:123], v[88:91], v[144:147], v[120:123]
s_waitcnt vmcnt(0)
s_cmp_lg_u32 s3, 0
s_cbranch_scc1 spinret_concat_61
v_readfirstlane_b32 s60, v21
s_cmp_lt_u32 s60, 8
s_cbranch_scc1 spin_concat_60
spinret_concat_61:
s_barrier
s_add_u32 m0, s35, 81920
s_nop 0
buffer_load_dwordx4 v16, s[16:19], s48 offen offset:0 sc1 lds
buffer_load_dwordx4 v16, s[16:19], s48 offen offset:1024 sc1 lds
buffer_load_dwordx4 v10, s[16:19], s48 offen offset:2048 sc1 lds
buffer_load_dwordx4 v10, s[16:19], s48 offen offset:3072 sc1 lds
s_add_u32 s48, s48, 2048
s_add_u32 m0, s35, 98304
s_nop 0
buffer_load_dwordx4 v16, s[16:19], s48 offen offset:0 sc1 lds
buffer_load_dwordx4 v16, s[16:19], s48 offen offset:1024 sc1 lds
buffer_load_dwordx4 v10, s[16:19], s48 offen offset:2048 sc1 lds
buffer_load_dwordx4 v10, s[16:19], s48 offen offset:3072 sc1 lds
s_add_u32 s48, s48, 2048
s_add_u32 m0, s35, 114688
s_nop 0
buffer_load_dwordx4 v16, s[16:19], s48 offen offset:0 sc1 lds
buffer_load_dwordx4 v16, s[16:19], s48 offen offset:1024 sc1 lds
buffer_load_dwordx4 v10, s[16:19], s48 offen offset:2048 sc1 lds
buffer_load_dwordx4 v10, s[16:19], s48 offen offset:3072 sc1 lds
s_add_u32 s48, s48, 2048
s_add_u32 m0, s35, 131072
s_nop 0
buffer_load_dwordx4 v16, s[16:19], s48 offen offset:0 sc1 lds
buffer_load_dwordx4 v16, s[16:19], s48 offen offset:1024 sc1 lds
buffer_load_dwordx4 v10, s[16:19], s48 offen offset:2048 sc1 lds
buffer_load_dwordx4 v10, s[16:19], s48 offen offset:3072 sc1 lds
s_add_u32 s48, s48, 2048
s_lshl_b32 s54, s89, 3
s_lshl_b32 s33, s3, 1
s_add_u32 s54, s54, s33
s_mul_i32 s54, s54, 20480
s_add_u32 s54, s54, 60817408
s_lshr_b32 s33, s88, 2
s_mul_i32 s33, s33, 5120
s_add_u32 s54, s54, s33
s_and_b32 s34, s88, 3
s_lshl_b32 s33, s34, 8
s_add_u32 s55, s54, s33
s_add_u32 s55, s55, 4096
s_lshl_b32 s34, s34, 10
s_add_u32 s54, s54, s34
v_lshlrev_b32 v17, 2, v1
v_cndmask_b32 v108, v106, v105, s[52:53]
v_cndmask_b32 v104, v104, v106, s[52:53]
v_cndmask_b32 v105, v105, v107, s[52:53]
v_add_f32 v108, 0x358637bd, v108
v_rcp_f32 v108, v108
s_nop 0
v_mul_f32 v96, v96, v108
v_mul_f32 v97, v97, v108
v_mul_f32 v98, v98, v108
v_mul_f32 v99, v99, v108
v_mul_f32 v100, v100, v108
v_mul_f32 v101, v101, v108
v_mul_f32 v102, v102, v108
v_mul_f32 v103, v103, v108
v_mul_f32 v104, v104, v108
v_mul_f32 v105, v105, v108
v_cvt_pk_bf16_f32 v96, v96, v97
v_cvt_pk_bf16_f32 v97, v98, v99
v_cvt_pk_bf16_f32 v98, v100, v101
v_cvt_pk_bf16_f32 v99, v102, v103
v_cvt_pk_bf16_f32 v100, v104, v105
v_cndmask_b32 v124, v122, v121, s[52:53]
v_cndmask_b32 v120, v120, v122, s[52:53]
v_cndmask_b32 v121, v121, v123, s[52:53]
v_add_f32 v124, 0x358637bd, v124
v_rcp_f32 v124, v124
s_nop 0
v_mul_f32 v112, v112, v124
v_mul_f32 v113, v113, v124
v_mul_f32 v114, v114, v124
v_mul_f32 v115, v115, v124
v_mul_f32 v116, v116, v124
v_mul_f32 v117, v117, v124
v_mul_f32 v118, v118, v124
v_mul_f32 v119, v119, v124
v_mul_f32 v120, v120, v124
v_mul_f32 v121, v121, v124
v_cvt_pk_bf16_f32 v112, v112, v113
v_cvt_pk_bf16_f32 v113, v114, v115
v_cvt_pk_bf16_f32 v114, v116, v117
v_cvt_pk_bf16_f32 v115, v118, v119
v_cvt_pk_bf16_f32 v116, v120, v121
buffer_store_dwordx4 v[96:99], v16, s[16:19], s54 offen sc1
buffer_store_dword v100, v17, s[16:19], s55 offen sc1
s_add_u32 s54, s54, 20480
s_add_u32 s55, s55, 20480
buffer_store_dwordx4 v[112:115], v16, s[16:19], s54 offen sc1
buffer_store_dword v116, v17, s[16:19], s55 offen sc1
s_lshr_b32 s61, s6, 1
s_lshl_b32 s63, s61, 8
s_add_u32 s63, s63, 64172032
s_lshl_b32 s62, s49, 8
s_add_u32 s62, s62, 64192512
s_waitcnt vmcnt(16)
s_barrier
ds_read_b64_tr_b16 a[64:65], v11 offset:0
ds_read_b64_tr_b16 a[66:67], v11 offset:5120
ds_read_b64_tr_b16 a[68:69], v11 offset:10240
ds_read_b64_tr_b16 a[70:71], v11 offset:15360
ds_read_b128 a[104:107], v12 offset:0
ds_read_b128 a[112:115], v13 offset:0
ds_read_b128 a[120:123], v14 offset:0
ds_read_b128 a[128:131], v15 offset:0
ds_read_b128 a[108:111], v12 offset:1024
ds_read_b128 a[116:119], v13 offset:1024
ds_read_b128 a[124:127], v14 offset:1024
ds_read_b128 a[132:135], v15 offset:1024
ds_read_b64_tr_b16 a[72:73], v205 offset:0
ds_read_b64_tr_b16 a[74:75], v205 offset:5120
ds_read_b64_tr_b16 a[76:77], v205 offset:10240
ds_read_b64_tr_b16 a[78:79], v205 offset:15360
ds_read_b64_tr_b16 a[80:81], v11 offset:64
ds_read_b64_tr_b16 a[82:83], v11 offset:5184
ds_read_b64_tr_b16 a[84:85], v11 offset:10304
ds_read_b64_tr_b16 a[86:87], v11 offset:15424
ds_read_b64_tr_b16 a[88:89], v205 offset:64
ds_read_b64_tr_b16 a[90:91], v205 offset:5184
ds_read_b64_tr_b16 a[92:93], v205 offset:10304
ds_read_b64_tr_b16 a[94:95], v205 offset:15424
ds_read_b64_tr_b16 a[96:97], v11 offset:128
ds_read_b64_tr_b16 a[98:99], v11 offset:5248
ds_read_b64_tr_b16 a[100:101], v11 offset:10368
ds_read_b64_tr_b16 a[102:103], v11 offset:15488
s_waitcnt lgkmcnt(0)
v_mfma_f32_16x16x32_bf16 v[32:35], a[64:67], a[104:107], 0
s_waitcnt vmcnt(12)
s_barrier
v_mfma_f32_16x16x32_bf16 v[32:35], a[68:71], a[108:111], v[32:35]
s_add_u32 m0, s35, 81920
ds_read_b64_tr_b16 a[136:137], v11 offset:20480
v_mfma_f32_16x16x32_bf16 v[52:55], a[64:67], a[112:115], 0
buffer_load_dwordx4 v16, s[16:19], s48 offen offset:0 sc1 lds
v_mfma_f32_16x16x32_bf16 v[52:55], a[68:71], a[116:119], v[52:55]
ds_read_b64_tr_b16 a[138:139], v11 offset:25600
v_mfma_f32_16x16x32_bf16 v[72:75], a[64:67], a[120:123], 0
ds_read_b64_tr_b16 a[140:141], v11 offset:30720
v_mfma_f32_16x16x32_bf16 v[72:75], a[68:71], a[124:127], v[72:75]
ds_read_b64_tr_b16 a[142:143], v11 offset:35840
v_mfma_f32_16x16x32_bf16 v[92:95], a[64:67], a[128:131], 0
buffer_load_dwordx4 v16, s[16:19], s48 offen offset:1024 sc1 lds
v_mfma_f32_16x16x32_bf16 v[92:95], a[68:71], a[132:135], v[92:95]
ds_read_b128 a[176:179], v12 offset:16384
v_mfma_f32_16x16x32_bf16 v[36:39], a[72:75], a[104:107], 0
ds_read_b128 a[184:187], v13 offset:16384
v_mfma_f32_16x16x32_bf16 v[36:39], a[76:79], a[108:111], v[36:39]
ds_read_b128 a[192:195], v14 offset:16384
v_mfma_f32_16x16x32_bf16 v[56:59], a[72:75], a[112:115], 0
buffer_load_dwordx4 v10, s[16:19], s48 offen offset:2048 sc1 lds
v_mfma_f32_16x16x32_bf16 v[56:59], a[76:79], a[116:119], v[56:59]
ds_read_b128 a[200:203], v15 offset:16384
v_mfma_f32_16x16x32_bf16 v[76:79], a[72:75], a[120:123], 0
ds_read_b128 a[180:183], v12 offset:17408
v_mfma_f32_16x16x32_bf16 v[76:79], a[76:79], a[124:127], v[76:79]
ds_read_b128 a[188:191], v13 offset:17408
v_mfma_f32_16x16x32_bf16 v[96:99], a[72:75], a[128:131], 0
buffer_load_dwordx4 v10, s[16:19], s48 offen offset:3072 sc1 lds
v_mfma_f32_16x16x32_bf16 v[96:99], a[76:79], a[132:135], v[96:99]
s_add_u32 s48, s48, 2048
s_add_u32 m0, s50, 0
v_mfma_f32_16x16x32_bf16 v[40:43], a[80:83], a[104:107], 0
ds_read_b128 a[196:199], v14 offset:17408
v_mfma_f32_16x16x32_bf16 v[40:43], a[84:87], a[108:111], v[40:43]
ds_read_b128 a[204:207], v15 offset:17408
v_mfma_f32_16x16x32_bf16 v[60:63], a[80:83], a[112:115], 0
buffer_load_dwordx4 v200, s[80:83], s47 offen offset:0 lds
v_mfma_f32_16x16x32_bf16 v[60:63], a[84:87], a[116:119], v[60:63]
ds_read_b64_tr_b16 a[144:145], v205 offset:20480
v_mfma_f32_16x16x32_bf16 v[80:83], a[80:83], a[120:123], 0
ds_read_b64_tr_b16 a[146:147], v205 offset:25600
v_mfma_f32_16x16x32_bf16 v[80:83], a[84:87], a[124:127], v[80:83]
ds_read_b64_tr_b16 a[148:149], v205 offset:30720
v_mfma_f32_16x16x32_bf16 v[100:103], a[80:83], a[128:131], 0
buffer_load_dwordx4 v201, s[80:83], s47 offen offset:1024 lds
v_mfma_f32_16x16x32_bf16 v[100:103], a[84:87], a[132:135], v[100:103]
s_waitcnt lgkmcnt(3)
ds_read_b64_tr_b16 a[150:151], v205 offset:35840
v_mfma_f32_16x16x32_bf16 v[44:47], a[88:91], a[104:107], 0
ds_read_b64_tr_b16 a[152:153], v11 offset:20544
v_mfma_f32_16x16x32_bf16 v[44:47], a[92:95], a[108:111], v[44:47]
ds_read_b64_tr_b16 a[154:155], v11 offset:25664
v_mfma_f32_16x16x32_bf16 v[64:67], a[88:91], a[112:115], 0
buffer_load_dwordx4 v202, s[80:83], s47 offen offset:2048 lds
v_mfma_f32_16x16x32_bf16 v[64:67], a[92:95], a[116:119], v[64:67]
ds_read_b64_tr_b16 a[156:157], v11 offset:30784
v_mfma_f32_16x16x32_bf16 v[84:87], a[88:91], a[120:123], 0
ds_read_b64_tr_b16 a[158:159], v11 offset:35904
v_mfma_f32_16x16x32_bf16 v[84:87], a[92:95], a[124:127], v[84:87]
ds_read_b64_tr_b16 a[160:161], v205 offset:20544
v_mfma_f32_16x16x32_bf16 v[104:107], a[88:91], a[128:131], 0
buffer_load_dwordx4 v203, s[80:83], s47 offen offset:3072 lds
v_mfma_f32_16x16x32_bf16 v[104:107], a[92:95], a[132:135], v[104:107]
s_add_u32 m0, s50, 4096
ds_read_b64_tr_b16 a[162:163], v205 offset:25664
v_mfma_f32_16x16x32_bf16 v[48:51], a[96:99], a[104:107], 0
ds_read_b64_tr_b16 a[164:165], v205 offset:30784
v_mfma_f32_16x16x32_bf16 v[48:51], a[100:103], a[108:111], v[48:51]
ds_read_b64_tr_b16 a[166:167], v205 offset:35904
v_mfma_f32_16x16x32_bf16 v[68:71], a[96:99], a[112:115], 0
buffer_load_dwordx4 v204, s[80:83], s47 offen lds
v_mfma_f32_16x16x32_bf16 v[68:71], a[100:103], a[116:119], v[68:71]
s_add_u32 s47, s47, 81920
ds_read_b64_tr_b16 a[168:169], v11 offset:20608
v_mfma_f32_16x16x32_bf16 v[88:91], a[96:99], a[120:123], 0
ds_read_b64_tr_b16 a[170:171], v11 offset:25728
v_mfma_f32_16x16x32_bf16 v[88:91], a[100:103], a[124:127], v[88:91]
ds_read_b64_tr_b16 a[172:173], v11 offset:30848
v_mfma_f32_16x16x32_bf16 v[108:111], a[96:99], a[128:131], 0
ds_read_b64_tr_b16 a[174:175], v11 offset:35968
v_mfma_f32_16x16x32_bf16 v[108:111], a[100:103], a[132:135], v[108:111]
s_waitcnt lgkmcnt(8)
v_mfma_f32_16x16x32_bf16 v[32:35], a[136:139], a[176:179], v[32:35]
s_waitcnt vmcnt(17)
s_barrier
v_mfma_f32_16x16x32_bf16 v[32:35], a[140:143], a[180:183], v[32:35]
s_add_u32 m0, s35, 98304
ds_read_b64_tr_b16 a[64:65], v8 offset:0
v_mfma_f32_16x16x32_bf16 v[52:55], a[136:139], a[184:187], v[52:55]
buffer_load_dwordx4 v16, s[16:19], s48 offen offset:0 sc1 lds
v_mfma_f32_16x16x32_bf16 v[52:55], a[140:143], a[188:191], v[52:55]
ds_read_b64_tr_b16 a[66:67], v8 offset:5120
v_mfma_f32_16x16x32_bf16 v[72:75], a[136:139], a[192:195], v[72:75]
ds_read_b64_tr_b16 a[68:69], v8 offset:10240
v_mfma_f32_16x16x32_bf16 v[72:75], a[140:143], a[196:199], v[72:75]
ds_read_b64_tr_b16 a[70:71], v8 offset:15360
v_mfma_f32_16x16x32_bf16 v[92:95], a[136:139], a[200:203], v[92:95]
buffer_load_dwordx4 v16, s[16:19], s48 offen offset:1024 sc1 lds
v_mfma_f32_16x16x32_bf16 v[92:95], a[140:143], a[204:207], v[92:95]
ds_read_b128 a[104:107], v12 offset:32768
v_mfma_f32_16x16x32_bf16 v[36:39], a[144:147], a[176:179], v[36:39]
ds_read_b128 a[112:115], v13 offset:32768
v_mfma_f32_16x16x32_bf16 v[36:39], a[148:151], a[180:183], v[36:39]
ds_read_b128 a[120:123], v14 offset:32768
v_mfma_f32_16x16x32_bf16 v[56:59], a[144:147], a[184:187], v[56:59]
buffer_load_dwordx4 v10, s[16:19], s48 offen offset:2048 sc1 lds
v_mfma_f32_16x16x32_bf16 v[56:59], a[148:151], a[188:191], v[56:59]
ds_read_b128 a[128:131], v15 offset:32768
v_mfma_f32_16x16x32_bf16 v[76:79], a[144:147], a[192:195], v[76:79]
ds_read_b128 a[108:111], v12 offset:33792
v_mfma_f32_16x16x32_bf16 v[76:79], a[148:151], a[196:199], v[76:79]
ds_read_b128 a[116:119], v13 offset:33792
v_mfma_f32_16x16x32_bf16 v[96:99], a[144:147], a[200:203], v[96:99]
buffer_load_dwordx4 v10, s[16:19], s48 offen offset:3072 sc1 lds
v_mfma_f32_16x16x32_bf16 v[96:99], a[148:151], a[204:207], v[96:99]
s_add_u32 s48, s48, 2048
s_add_u32 m0, s50, 20480
v_mfma_f32_16x16x32_bf16 v[40:43], a[152:155], a[176:179], v[40:43]
ds_read_b128 a[124:127], v14 offset:33792
v_mfma_f32_16x16x32_bf16 v[40:43], a[156:159], a[180:183], v[40:43]
ds_read_b128 a[132:135], v15 offset:33792
v_mfma_f32_16x16x32_bf16 v[60:63], a[152:155], a[184:187], v[60:63]
buffer_load_dwordx4 v200, s[80:83], s47 offen offset:0 lds
v_mfma_f32_16x16x32_bf16 v[60:63], a[156:159], a[188:191], v[60:63]
ds_read_b64_tr_b16 a[72:73], v206 offset:0
v_mfma_f32_16x16x32_bf16 v[80:83], a[152:155], a[192:195], v[80:83]
ds_read_b64_tr_b16 a[74:75], v206 offset:5120
v_mfma_f32_16x16x32_bf16 v[80:83], a[156:159], a[196:199], v[80:83]
ds_read_b64_tr_b16 a[76:77], v206 offset:10240
v_mfma_f32_16x16x32_bf16 v[100:103], a[152:155], a[200:203], v[100:103]
buffer_load_dwordx4 v201, s[80:83], s47 offen offset:1024 lds
v_mfma_f32_16x16x32_bf16 v[100:103], a[156:159], a[204:207], v[100:103]
s_waitcnt lgkmcnt(3)
ds_read_b64_tr_b16 a[78:79], v206 offset:15360
v_mfma_f32_16x16x32_bf16 v[44:47], a[160:163], a[176:179], v[44:47]
ds_read_b64_tr_b16 a[80:81], v8 offset:64
v_mfma_f32_16x16x32_bf16 v[44:47], a[164:167], a[180:183], v[44:47]
ds_read_b64_tr_b16 a[82:83], v8 offset:5184
v_mfma_f32_16x16x32_bf16 v[64:67], a[160:163], a[184:187], v[64:67]
buffer_load_dwordx4 v202, s[80:83], s47 offen offset:2048 lds
v_mfma_f32_16x16x32_bf16 v[64:67], a[164:167], a[188:191], v[64:67]
ds_read_b64_tr_b16 a[84:85], v8 offset:10304
v_mfma_f32_16x16x32_bf16 v[84:87], a[160:163], a[192:195], v[84:87]
ds_read_b64_tr_b16 a[86:87], v8 offset:15424
v_mfma_f32_16x16x32_bf16 v[84:87], a[164:167], a[196:199], v[84:87]
ds_read_b64_tr_b16 a[88:89], v206 offset:64
v_mfma_f32_16x16x32_bf16 v[104:107], a[160:163], a[200:203], v[104:107]
buffer_load_dwordx4 v203, s[80:83], s47 offen offset:3072 lds
v_mfma_f32_16x16x32_bf16 v[104:107], a[164:167], a[204:207], v[104:107]
s_add_u32 m0, s50, 24576
ds_read_b64_tr_b16 a[90:91], v206 offset:5184
v_mfma_f32_16x16x32_bf16 v[48:51], a[168:171], a[176:179], v[48:51]
ds_read_b64_tr_b16 a[92:93], v206 offset:10304
v_mfma_f32_16x16x32_bf16 v[48:51], a[172:175], a[180:183], v[48:51]
ds_read_b64_tr_b16 a[94:95], v206 offset:15424
v_mfma_f32_16x16x32_bf16 v[68:71], a[168:171], a[184:187], v[68:71]
buffer_load_dwordx4 v204, s[80:83], s47 offen lds
v_mfma_f32_16x16x32_bf16 v[68:71], a[172:175], a[188:191], v[68:71]
s_add_u32 s47, s47, 81920
ds_read_b64_tr_b16 a[96:97], v8 offset:128
v_mfma_f32_16x16x32_bf16 v[88:91], a[168:171], a[192:195], v[88:91]
ds_read_b64_tr_b16 a[98:99], v8 offset:5248
v_mfma_f32_16x16x32_bf16 v[88:91], a[172:175], a[196:199], v[88:91]
ds_read_b64_tr_b16 a[100:101], v8 offset:10368
v_mfma_f32_16x16x32_bf16 v[108:111], a[168:171], a[200:203], v[108:111]
ds_read_b64_tr_b16 a[102:103], v8 offset:15488
v_mfma_f32_16x16x32_bf16 v[108:111], a[172:175], a[204:207], v[108:111]
s_waitcnt lgkmcnt(8)
v_mfma_f32_16x16x32_bf16 v[32:35], a[64:67], a[104:107], v[32:35]
s_waitcnt vmcnt(22)
s_barrier
v_mfma_f32_16x16x32_bf16 v[32:35], a[68:71], a[108:111], v[32:35]
s_add_u32 m0, s35, 114688
ds_read_b64_tr_b16 a[136:137], v8 offset:20480
v_mfma_f32_16x16x32_bf16 v[52:55], a[64:67], a[112:115], v[52:55]
buffer_load_dwordx4 v16, s[16:19], s48 offen offset:0 sc1 lds
v_mfma_f32_16x16x32_bf16 v[52:55], a[68:71], a[116:119], v[52:55]
ds_read_b64_tr_b16 a[138:139], v8 offset:25600
v_mfma_f32_16x16x32_bf16 v[72:75], a[64:67], a[120:123], v[72:75]
ds_read_b64_tr_b16 a[140:141], v8 offset:30720
v_mfma_f32_16x16x32_bf16 v[72:75], a[68:71], a[124:127], v[72:75]
ds_read_b64_tr_b16 a[142:143], v8 offset:35840
v_mfma_f32_16x16x32_bf16 v[92:95], a[64:67], a[128:131], v[92:95]
buffer_load_dwordx4 v16, s[16:19], s48 offen offset:1024 sc1 lds
v_mfma_f32_16x16x32_bf16 v[92:95], a[68:71], a[132:135], v[92:95]
ds_read_b128 a[176:179], v12 offset:49152
v_mfma_f32_16x16x32_bf16 v[36:39], a[72:75], a[104:107], v[36:39]
ds_read_b128 a[184:187], v13 offset:49152
v_mfma_f32_16x16x32_bf16 v[36:39], a[76:79], a[108:111], v[36:39]
ds_read_b128 a[192:195], v14 offset:49152
v_mfma_f32_16x16x32_bf16 v[56:59], a[72:75], a[112:115], v[56:59]
buffer_load_dwordx4 v10, s[16:19], s48 offen offset:2048 sc1 lds
v_mfma_f32_16x16x32_bf16 v[56:59], a[76:79], a[116:119], v[56:59]
ds_read_b128 a[200:203], v15 offset:49152
v_mfma_f32_16x16x32_bf16 v[76:79], a[72:75], a[120:123], v[76:79]
ds_read_b128 a[180:183], v12 offset:50176
v_mfma_f32_16x16x32_bf16 v[76:79], a[76:79], a[124:127], v[76:79]
ds_read_b128 a[188:191], v13 offset:50176
v_mfma_f32_16x16x32_bf16 v[96:99], a[72:75], a[128:131], v[96:99]
buffer_load_dwordx4 v10, s[16:19], s48 offen offset:3072 sc1 lds
v_mfma_f32_16x16x32_bf16 v[96:99], a[76:79], a[132:135], v[96:99]
s_add_u32 s48, s48, 2048
s_add_u32 m0, s50, 40960
v_mfma_f32_16x16x32_bf16 v[40:43], a[80:83], a[104:107], v[40:43]
ds_read_b128 a[196:199], v14 offset:50176
v_mfma_f32_16x16x32_bf16 v[40:43], a[84:87], a[108:111], v[40:43]
ds_read_b128 a[204:207], v15 offset:50176
v_mfma_f32_16x16x32_bf16 v[60:63], a[80:83], a[112:115], v[60:63]
buffer_load_dwordx4 v200, s[80:83], s47 offen offset:0 lds
v_mfma_f32_16x16x32_bf16 v[60:63], a[84:87], a[116:119], v[60:63]
ds_read_b64_tr_b16 a[144:145], v206 offset:20480
v_mfma_f32_16x16x32_bf16 v[80:83], a[80:83], a[120:123], v[80:83]
ds_read_b64_tr_b16 a[146:147], v206 offset:25600
v_mfma_f32_16x16x32_bf16 v[80:83], a[84:87], a[124:127], v[80:83]
ds_read_b64_tr_b16 a[148:149], v206 offset:30720
v_mfma_f32_16x16x32_bf16 v[100:103], a[80:83], a[128:131], v[100:103]
buffer_load_dwordx4 v201, s[80:83], s47 offen offset:1024 lds
v_mfma_f32_16x16x32_bf16 v[100:103], a[84:87], a[132:135], v[100:103]
s_waitcnt lgkmcnt(3)
ds_read_b64_tr_b16 a[150:151], v206 offset:35840
v_mfma_f32_16x16x32_bf16 v[44:47], a[88:91], a[104:107], v[44:47]
ds_read_b64_tr_b16 a[152:153], v8 offset:20544
v_mfma_f32_16x16x32_bf16 v[44:47], a[92:95], a[108:111], v[44:47]
ds_read_b64_tr_b16 a[154:155], v8 offset:25664
v_mfma_f32_16x16x32_bf16 v[64:67], a[88:91], a[112:115], v[64:67]
buffer_load_dwordx4 v202, s[80:83], s47 offen offset:2048 lds
v_mfma_f32_16x16x32_bf16 v[64:67], a[92:95], a[116:119], v[64:67]
ds_read_b64_tr_b16 a[156:157], v8 offset:30784
v_mfma_f32_16x16x32_bf16 v[84:87], a[88:91], a[120:123], v[84:87]
ds_read_b64_tr_b16 a[158:159], v8 offset:35904
v_mfma_f32_16x16x32_bf16 v[84:87], a[92:95], a[124:127], v[84:87]
ds_read_b64_tr_b16 a[160:161], v206 offset:20544
v_mfma_f32_16x16x32_bf16 v[104:107], a[88:91], a[128:131], v[104:107]
buffer_load_dwordx4 v203, s[80:83], s47 offen offset:3072 lds
v_mfma_f32_16x16x32_bf16 v[104:107], a[92:95], a[132:135], v[104:107]
s_add_u32 m0, s50, 45056
ds_read_b64_tr_b16 a[162:163], v206 offset:25664
v_mfma_f32_16x16x32_bf16 v[48:51], a[96:99], a[104:107], v[48:51]
ds_read_b64_tr_b16 a[164:165], v206 offset:30784
v_mfma_f32_16x16x32_bf16 v[48:51], a[100:103], a[108:111], v[48:51]
ds_read_b64_tr_b16 a[166:167], v206 offset:35904
v_mfma_f32_16x16x32_bf16 v[68:71], a[96:99], a[112:115], v[68:71]
buffer_load_dwordx4 v204, s[80:83], s47 offen lds
v_mfma_f32_16x16x32_bf16 v[68:71], a[100:103], a[116:119], v[68:71]
s_add_u32 s47, s47, 81920
ds_read_b64_tr_b16 a[168:169], v8 offset:20608
v_mfma_f32_16x16x32_bf16 v[88:91], a[96:99], a[120:123], v[88:91]
ds_read_b64_tr_b16 a[170:171], v8 offset:25728
v_mfma_f32_16x16x32_bf16 v[88:91], a[100:103], a[124:127], v[88:91]
ds_read_b64_tr_b16 a[172:173], v8 offset:30848
v_mfma_f32_16x16x32_bf16 v[108:111], a[96:99], a[128:131], v[108:111]
ds_read_b64_tr_b16 a[174:175], v8 offset:35968
v_mfma_f32_16x16x32_bf16 v[108:111], a[100:103], a[132:135], v[108:111]
s_waitcnt lgkmcnt(8)
v_mfma_f32_16x16x32_bf16 v[32:35], a[136:139], a[176:179], v[32:35]
s_waitcnt vmcnt(18)
s_barrier
s_cmp_lg_u32 s3, 0
s_cbranch_scc1 w0_concat_62
v_mov_b32 v31, 0
v_mov_b32 v29, 1
s_mov_b64 exec, 1
s_lshl_b32 s60, s89, 8
s_add_u32 s60, s60, 64172032
buffer_atomic_add v29, v31, s[16:19], s60 offen sc1
s_mov_b64 exec, -1
w0_concat_62:
v_mfma_f32_16x16x32_bf16 v[32:35], a[140:143], a[180:183], v[32:35]
s_add_u32 m0, s35, 131072
ds_read_b64_tr_b16 a[64:65], v11 offset:0
v_mfma_f32_16x16x32_bf16 v[52:55], a[136:139], a[184:187], v[52:55]
buffer_load_dwordx4 v16, s[16:19], s48 offen offset:0 sc1 lds
v_mfma_f32_16x16x32_bf16 v[52:55], a[140:143], a[188:191], v[52:55]
ds_read_b64_tr_b16 a[66:67], v11 offset:5120
v_mfma_f32_16x16x32_bf16 v[72:75], a[136:139], a[192:195], v[72:75]
ds_read_b64_tr_b16 a[68:69], v11 offset:10240
v_mfma_f32_16x16x32_bf16 v[72:75], a[140:143], a[196:199], v[72:75]
ds_read_b64_tr_b16 a[70:71], v11 offset:15360
v_mfma_f32_16x16x32_bf16 v[92:95], a[136:139], a[200:203], v[92:95]
buffer_load_dwordx4 v16, s[16:19], s48 offen offset:1024 sc1 lds
v_mfma_f32_16x16x32_bf16 v[92:95], a[140:143], a[204:207], v[92:95]
ds_read_b128 a[104:107], v12 offset:0
v_mfma_f32_16x16x32_bf16 v[36:39], a[144:147], a[176:179], v[36:39]
ds_read_b128 a[112:115], v13 offset:0
v_mfma_f32_16x16x32_bf16 v[36:39], a[148:151], a[180:183], v[36:39]
ds_read_b128 a[120:123], v14 offset:0
v_mfma_f32_16x16x32_bf16 v[56:59], a[144:147], a[184:187], v[56:59]
buffer_load_dwordx4 v10, s[16:19], s48 offen offset:2048 sc1 lds
v_mfma_f32_16x16x32_bf16 v[56:59], a[148:151], a[188:191], v[56:59]
ds_read_b128 a[128:131], v15 offset:0
v_mfma_f32_16x16x32_bf16 v[76:79], a[144:147], a[192:195], v[76:79]
ds_read_b128 a[108:111], v12 offset:1024
v_mfma_f32_16x16x32_bf16 v[76:79], a[148:151], a[196:199], v[76:79]
ds_read_b128 a[116:119], v13 offset:1024
v_mfma_f32_16x16x32_bf16 v[96:99], a[144:147], a[200:203], v[96:99]
buffer_load_dwordx4 v10, s[16:19], s48 offen offset:3072 sc1 lds
v_mfma_f32_16x16x32_bf16 v[96:99], a[148:151], a[204:207], v[96:99]
s_add_u32 s48, s48, 2048
s_add_u32 m0, s50, 61440
v_mfma_f32_16x16x32_bf16 v[40:43], a[152:155], a[176:179], v[40:43]
ds_read_b128 a[124:127], v14 offset:1024
v_mfma_f32_16x16x32_bf16 v[40:43], a[156:159], a[180:183], v[40:43]
ds_read_b128 a[132:135], v15 offset:1024
v_mfma_f32_16x16x32_bf16 v[60:63], a[152:155], a[184:187], v[60:63]
buffer_load_dwordx4 v200, s[80:83], s47 offen offset:0 lds
v_mfma_f32_16x16x32_bf16 v[60:63], a[156:159], a[188:191], v[60:63]
ds_read_b64_tr_b16 a[72:73], v205 offset:0
v_mfma_f32_16x16x32_bf16 v[80:83], a[152:155], a[192:195], v[80:83]
ds_read_b64_tr_b16 a[74:75], v205 offset:5120
v_mfma_f32_16x16x32_bf16 v[80:83], a[156:159], a[196:199], v[80:83]
ds_read_b64_tr_b16 a[76:77], v205 offset:10240
v_mfma_f32_16x16x32_bf16 v[100:103], a[152:155], a[200:203], v[100:103]
buffer_load_dwordx4 v201, s[80:83], s47 offen offset:1024 lds
v_mfma_f32_16x16x32_bf16 v[100:103], a[156:159], a[204:207], v[100:103]
s_waitcnt lgkmcnt(3)
ds_read_b64_tr_b16 a[78:79], v205 offset:15360
v_mfma_f32_16x16x32_bf16 v[44:47], a[160:163], a[176:179], v[44:47]
ds_read_b64_tr_b16 a[80:81], v11 offset:64
v_mfma_f32_16x16x32_bf16 v[44:47], a[164:167], a[180:183], v[44:47]
ds_read_b64_tr_b16 a[82:83], v11 offset:5184
v_mfma_f32_16x16x32_bf16 v[64:67], a[160:163], a[184:187], v[64:67]
buffer_load_dwordx4 v202, s[80:83], s47 offen offset:2048 lds
v_mfma_f32_16x16x32_bf16 v[64:67], a[164:167], a[188:191], v[64:67]
ds_read_b64_tr_b16 a[84:85], v11 offset:10304
v_mfma_f32_16x16x32_bf16 v[84:87], a[160:163], a[192:195], v[84:87]
ds_read_b64_tr_b16 a[86:87], v11 offset:15424
v_mfma_f32_16x16x32_bf16 v[84:87], a[164:167], a[196:199], v[84:87]
ds_read_b64_tr_b16 a[88:89], v205 offset:64
v_mfma_f32_16x16x32_bf16 v[104:107], a[160:163], a[200:203], v[104:107]
buffer_load_dwordx4 v203, s[80:83], s47 offen offset:3072 lds
v_mfma_f32_16x16x32_bf16 v[104:107], a[164:167], a[204:207], v[104:107]
s_add_u32 m0, s50, 65536
ds_read_b64_tr_b16 a[90:91], v205 offset:5184
v_mfma_f32_16x16x32_bf16 v[48:51], a[168:171], a[176:179], v[48:51]
ds_read_b64_tr_b16 a[92:93], v205 offset:10304
v_mfma_f32_16x16x32_bf16 v[48:51], a[172:175], a[180:183], v[48:51]
ds_read_b64_tr_b16 a[94:95], v205 offset:15424
v_mfma_f32_16x16x32_bf16 v[68:71], a[168:171], a[184:187], v[68:71]
buffer_load_dwordx4 v204, s[80:83], s47 offen lds
v_mfma_f32_16x16x32_bf16 v[68:71], a[172:175], a[188:191], v[68:71]
s_add_u32 s47, s47, 81920
ds_read_b64_tr_b16 a[96:97], v11 offset:128
v_mfma_f32_16x16x32_bf16 v[88:91], a[168:171], a[192:195], v[88:91]
ds_read_b64_tr_b16 a[98:99], v11 offset:5248
v_mfma_f32_16x16x32_bf16 v[88:91], a[172:175], a[196:199], v[88:91]
ds_read_b64_tr_b16 a[100:101], v11 offset:10368
v_mfma_f32_16x16x32_bf16 v[108:111], a[168:171], a[200:203], v[108:111]
ds_read_b64_tr_b16 a[102:103], v11 offset:15488
v_mfma_f32_16x16x32_bf16 v[108:111], a[172:175], a[204:207], v[108:111]
s_waitcnt lgkmcnt(8)
v_mfma_f32_16x16x32_bf16 v[32:35], a[64:67], a[104:107], v[32:35]
s_waitcnt vmcnt(18)
s_barrier
v_mfma_f32_16x16x32_bf16 v[32:35], a[68:71], a[108:111], v[32:35]
s_add_u32 m0, s35, 81920
ds_read_b64_tr_b16 a[136:137], v11 offset:20480
v_mfma_f32_16x16x32_bf16 v[52:55], a[64:67], a[112:115], v[52:55]
buffer_load_dwordx4 v16, s[16:19], s48 offen offset:0 sc1 lds
v_mfma_f32_16x16x32_bf16 v[52:55], a[68:71], a[116:119], v[52:55]
ds_read_b64_tr_b16 a[138:139], v11 offset:25600
v_mfma_f32_16x16x32_bf16 v[72:75], a[64:67], a[120:123], v[72:75]
ds_read_b64_tr_b16 a[140:141], v11 offset:30720
v_mfma_f32_16x16x32_bf16 v[72:75], a[68:71], a[124:127], v[72:75]
ds_read_b64_tr_b16 a[142:143], v11 offset:35840
v_mfma_f32_16x16x32_bf16 v[92:95], a[64:67], a[128:131], v[92:95]
buffer_load_dwordx4 v16, s[16:19], s48 offen offset:1024 sc1 lds
v_mfma_f32_16x16x32_bf16 v[92:95], a[68:71], a[132:135], v[92:95]
ds_read_b128 a[176:179], v12 offset:16384
v_mfma_f32_16x16x32_bf16 v[36:39], a[72:75], a[104:107], v[36:39]
ds_read_b128 a[184:187], v13 offset:16384
v_mfma_f32_16x16x32_bf16 v[36:39], a[76:79], a[108:111], v[36:39]
ds_read_b128 a[192:195], v14 offset:16384
v_mfma_f32_16x16x32_bf16 v[56:59], a[72:75], a[112:115], v[56:59]
buffer_load_dwordx4 v10, s[16:19], s48 offen offset:2048 sc1 lds
v_mfma_f32_16x16x32_bf16 v[56:59], a[76:79], a[116:119], v[56:59]
ds_read_b128 a[200:203], v15 offset:16384
v_mfma_f32_16x16x32_bf16 v[76:79], a[72:75], a[120:123], v[76:79]
ds_read_b128 a[180:183], v12 offset:17408
v_mfma_f32_16x16x32_bf16 v[76:79], a[76:79], a[124:127], v[76:79]
ds_read_b128 a[188:191], v13 offset:17408
v_mfma_f32_16x16x32_bf16 v[96:99], a[72:75], a[128:131], v[96:99]
buffer_load_dwordx4 v10, s[16:19], s48 offen offset:3072 sc1 lds
v_mfma_f32_16x16x32_bf16 v[96:99], a[76:79], a[132:135], v[96:99]
s_add_u32 s48, s48, 2048
s_add_u32 m0, s50, 0
v_mfma_f32_16x16x32_bf16 v[40:43], a[80:83], a[104:107], v[40:43]
ds_read_b128 a[196:199], v14 offset:17408
v_mfma_f32_16x16x32_bf16 v[40:43], a[84:87], a[108:111], v[40:43]
ds_read_b128 a[204:207], v15 offset:17408
v_mfma_f32_16x16x32_bf16 v[60:63], a[80:83], a[112:115], v[60:63]
buffer_load_dwordx4 v200, s[80:83], s47 offen offset:0 lds
v_mfma_f32_16x16x32_bf16 v[60:63], a[84:87], a[116:119], v[60:63]
ds_read_b64_tr_b16 a[144:145], v205 offset:20480
v_mfma_f32_16x16x32_bf16 v[80:83], a[80:83], a[120:123], v[80:83]
ds_read_b64_tr_b16 a[146:147], v205 offset:25600
v_mfma_f32_16x16x32_bf16 v[80:83], a[84:87], a[124:127], v[80:83]
ds_read_b64_tr_b16 a[148:149], v205 offset:30720
v_mfma_f32_16x16x32_bf16 v[100:103], a[80:83], a[128:131], v[100:103]
buffer_load_dwordx4 v201, s[80:83], s47 offen offset:1024 lds
v_mfma_f32_16x16x32_bf16 v[100:103], a[84:87], a[132:135], v[100:103]
s_waitcnt lgkmcnt(3)
ds_read_b64_tr_b16 a[150:151], v205 offset:35840
v_mfma_f32_16x16x32_bf16 v[44:47], a[88:91], a[104:107], v[44:47]
ds_read_b64_tr_b16 a[152:153], v11 offset:20544
v_mfma_f32_16x16x32_bf16 v[44:47], a[92:95], a[108:111], v[44:47]
ds_read_b64_tr_b16 a[154:155], v11 offset:25664
v_mfma_f32_16x16x32_bf16 v[64:67], a[88:91], a[112:115], v[64:67]
buffer_load_dwordx4 v202, s[80:83], s47 offen offset:2048 lds
v_mfma_f32_16x16x32_bf16 v[64:67], a[92:95], a[116:119], v[64:67]
ds_read_b64_tr_b16 a[156:157], v11 offset:30784
v_mfma_f32_16x16x32_bf16 v[84:87], a[88:91], a[120:123], v[84:87]
ds_read_b64_tr_b16 a[158:159], v11 offset:35904
v_mfma_f32_16x16x32_bf16 v[84:87], a[92:95], a[124:127], v[84:87]
ds_read_b64_tr_b16 a[160:161], v205 offset:20544
v_mfma_f32_16x16x32_bf16 v[104:107], a[88:91], a[128:131], v[104:107]
buffer_load_dwordx4 v203, s[80:83], s47 offen offset:3072 lds
v_mfma_f32_16x16x32_bf16 v[104:107], a[92:95], a[132:135], v[104:107]
s_add_u32 m0, s50, 4096
ds_read_b64_tr_b16 a[162:163], v205 offset:25664
v_mfma_f32_16x16x32_bf16 v[48:51], a[96:99], a[104:107], v[48:51]
ds_read_b64_tr_b16 a[164:165], v205 offset:30784
v_mfma_f32_16x16x32_bf16 v[48:51], a[100:103], a[108:111], v[48:51]
ds_read_b64_tr_b16 a[166:167], v205 offset:35904
v_mfma_f32_16x16x32_bf16 v[68:71], a[96:99], a[112:115], v[68:71]
buffer_load_dwordx4 v204, s[80:83], s47 offen lds
v_mfma_f32_16x16x32_bf16 v[68:71], a[100:103], a[116:119], v[68:71]
s_add_u32 s47, s47, 81920
ds_read_b64_tr_b16 a[168:169], v11 offset:20608
v_mfma_f32_16x16x32_bf16 v[88:91], a[96:99], a[120:123], v[88:91]
ds_read_b64_tr_b16 a[170:171], v11 offset:25728
v_mfma_f32_16x16x32_bf16 v[88:91], a[100:103], a[124:127], v[88:91]
ds_read_b64_tr_b16 a[172:173], v11 offset:30848
v_mfma_f32_16x16x32_bf16 v[108:111], a[96:99], a[128:131], v[108:111]
ds_read_b64_tr_b16 a[174:175], v11 offset:35968
v_mfma_f32_16x16x32_bf16 v[108:111], a[100:103], a[132:135], v[108:111]
s_waitcnt lgkmcnt(8)
v_mfma_f32_16x16x32_bf16 v[32:35], a[136:139], a[176:179], v[32:35]
s_waitcnt vmcnt(18)
s_barrier
v_mfma_f32_16x16x32_bf16 v[32:35], a[140:143], a[180:183], v[32:35]
s_add_u32 m0, s35, 98304
ds_read_b64_tr_b16 a[64:65], v8 offset:0
v_mfma_f32_16x16x32_bf16 v[52:55], a[136:139], a[184:187], v[52:55]
buffer_load_dwordx4 v16, s[16:19], s48 offen offset:0 sc1 lds
v_mfma_f32_16x16x32_bf16 v[52:55], a[140:143], a[188:191], v[52:55]
ds_read_b64_tr_b16 a[66:67], v8 offset:5120
v_mfma_f32_16x16x32_bf16 v[72:75], a[136:139], a[192:195], v[72:75]
ds_read_b64_tr_b16 a[68:69], v8 offset:10240
v_mfma_f32_16x16x32_bf16 v[72:75], a[140:143], a[196:199], v[72:75]
ds_read_b64_tr_b16 a[70:71], v8 offset:15360
v_mfma_f32_16x16x32_bf16 v[92:95], a[136:139], a[200:203], v[92:95]
buffer_load_dwordx4 v16, s[16:19], s48 offen offset:1024 sc1 lds
v_mfma_f32_16x16x32_bf16 v[92:95], a[140:143], a[204:207], v[92:95]
ds_read_b128 a[104:107], v12 offset:32768
v_mfma_f32_16x16x32_bf16 v[36:39], a[144:147], a[176:179], v[36:39]
ds_read_b128 a[112:115], v13 offset:32768
v_mfma_f32_16x16x32_bf16 v[36:39], a[148:151], a[180:183], v[36:39]
ds_read_b128 a[120:123], v14 offset:32768
v_mfma_f32_16x16x32_bf16 v[56:59], a[144:147], a[184:187], v[56:59]
buffer_load_dwordx4 v10, s[16:19], s48 offen offset:2048 sc1 lds
v_mfma_f32_16x16x32_bf16 v[56:59], a[148:151], a[188:191], v[56:59]
ds_read_b128 a[128:131], v15 offset:32768
v_mfma_f32_16x16x32_bf16 v[76:79], a[144:147], a[192:195], v[76:79]
ds_read_b128 a[108:111], v12 offset:33792
v_mfma_f32_16x16x32_bf16 v[76:79], a[148:151], a[196:199], v[76:79]
ds_read_b128 a[116:119], v13 offset:33792
v_mfma_f32_16x16x32_bf16 v[96:99], a[144:147], a[200:203], v[96:99]
buffer_load_dwordx4 v10, s[16:19], s48 offen offset:3072 sc1 lds
v_mfma_f32_16x16x32_bf16 v[96:99], a[148:151], a[204:207], v[96:99]
s_add_u32 s48, s48, 2048
s_add_u32 m0, s50, 20480
v_mfma_f32_16x16x32_bf16 v[40:43], a[152:155], a[176:179], v[40:43]
ds_read_b128 a[124:127], v14 offset:33792
v_mfma_f32_16x16x32_bf16 v[40:43], a[156:159], a[180:183], v[40:43]
ds_read_b128 a[132:135], v15 offset:33792
v_mfma_f32_16x16x32_bf16 v[60:63], a[152:155], a[184:187], v[60:63]
buffer_load_dwordx4 v200, s[80:83], s47 offen offset:0 lds
v_mfma_f32_16x16x32_bf16 v[60:63], a[156:159], a[188:191], v[60:63]
ds_read_b64_tr_b16 a[72:73], v206 offset:0
v_mfma_f32_16x16x32_bf16 v[80:83], a[152:155], a[192:195], v[80:83]
ds_read_b64_tr_b16 a[74:75], v206 offset:5120
v_mfma_f32_16x16x32_bf16 v[80:83], a[156:159], a[196:199], v[80:83]
ds_read_b64_tr_b16 a[76:77], v206 offset:10240
v_mfma_f32_16x16x32_bf16 v[100:103], a[152:155], a[200:203], v[100:103]
buffer_load_dwordx4 v201, s[80:83], s47 offen offset:1024 lds
v_mfma_f32_16x16x32_bf16 v[100:103], a[156:159], a[204:207], v[100:103]
s_waitcnt lgkmcnt(3)
ds_read_b64_tr_b16 a[78:79], v206 offset:15360
v_mfma_f32_16x16x32_bf16 v[44:47], a[160:163], a[176:179], v[44:47]
ds_read_b64_tr_b16 a[80:81], v8 offset:64
v_mfma_f32_16x16x32_bf16 v[44:47], a[164:167], a[180:183], v[44:47]
ds_read_b64_tr_b16 a[82:83], v8 offset:5184
v_mfma_f32_16x16x32_bf16 v[64:67], a[160:163], a[184:187], v[64:67]
buffer_load_dwordx4 v202, s[80:83], s47 offen offset:2048 lds
v_mfma_f32_16x16x32_bf16 v[64:67], a[164:167], a[188:191], v[64:67]
ds_read_b64_tr_b16 a[84:85], v8 offset:10304
v_mfma_f32_16x16x32_bf16 v[84:87], a[160:163], a[192:195], v[84:87]
ds_read_b64_tr_b16 a[86:87], v8 offset:15424
v_mfma_f32_16x16x32_bf16 v[84:87], a[164:167], a[196:199], v[84:87]
ds_read_b64_tr_b16 a[88:89], v206 offset:64
v_mfma_f32_16x16x32_bf16 v[104:107], a[160:163], a[200:203], v[104:107]
buffer_load_dwordx4 v203, s[80:83], s47 offen offset:3072 lds
v_mfma_f32_16x16x32_bf16 v[104:107], a[164:167], a[204:207], v[104:107]
s_add_u32 m0, s50, 24576
ds_read_b64_tr_b16 a[90:91], v206 offset:5184
v_mfma_f32_16x16x32_bf16 v[48:51], a[168:171], a[176:179], v[48:51]
ds_read_b64_tr_b16 a[92:93], v206 offset:10304
v_mfma_f32_16x16x32_bf16 v[48:51], a[172:175], a[180:183], v[48:51]
ds_read_b64_tr_b16 a[94:95], v206 offset:15424
v_mfma_f32_16x16x32_bf16 v[68:71], a[168:171], a[184:187], v[68:71]
buffer_load_dwordx4 v204, s[80:83], s47 offen lds
v_mfma_f32_16x16x32_bf16 v[68:71], a[172:175], a[188:191], v[68:71]
s_add_u32 s47, s47, 81920
ds_read_b64_tr_b16 a[96:97], v8 offset:128
v_mfma_f32_16x16x32_bf16 v[88:91], a[168:171], a[192:195], v[88:91]
ds_read_b64_tr_b16 a[98:99], v8 offset:5248
v_mfma_f32_16x16x32_bf16 v[88:91], a[172:175], a[196:199], v[88:91]
ds_read_b64_tr_b16 a[100:101], v8 offset:10368
v_mfma_f32_16x16x32_bf16 v[108:111], a[168:171], a[200:203], v[108:111]
ds_read_b64_tr_b16 a[102:103], v8 offset:15488
v_mfma_f32_16x16x32_bf16 v[108:111], a[172:175], a[204:207], v[108:111]
s_waitcnt lgkmcnt(8)
v_mfma_f32_16x16x32_bf16 v[32:35], a[64:67], a[104:107], v[32:35]
s_waitcnt vmcnt(18)
s_barrier
v_mfma_f32_16x16x32_bf16 v[32:35], a[68:71], a[108:111], v[32:35]
s_add_u32 m0, s35, 114688
ds_read_b64_tr_b16 a[136:137], v8 offset:20480
v_mfma_f32_16x16x32_bf16 v[52:55], a[64:67], a[112:115], v[52:55]
buffer_load_dwordx4 v16, s[16:19], s48 offen offset:0 sc1 lds
v_mfma_f32_16x16x32_bf16 v[52:55], a[68:71], a[116:119], v[52:55]
ds_read_b64_tr_b16 a[138:139], v8 offset:25600
v_mfma_f32_16x16x32_bf16 v[72:75], a[64:67], a[120:123], v[72:75]
ds_read_b64_tr_b16 a[140:141], v8 offset:30720
v_mfma_f32_16x16x32_bf16 v[72:75], a[68:71], a[124:127], v[72:75]
ds_read_b64_tr_b16 a[142:143], v8 offset:35840
v_mfma_f32_16x16x32_bf16 v[92:95], a[64:67], a[128:131], v[92:95]
buffer_load_dwordx4 v16, s[16:19], s48 offen offset:1024 sc1 lds
v_mfma_f32_16x16x32_bf16 v[92:95], a[68:71], a[132:135], v[92:95]
ds_read_b128 a[176:179], v12 offset:49152
v_mfma_f32_16x16x32_bf16 v[36:39], a[72:75], a[104:107], v[36:39]
ds_read_b128 a[184:187], v13 offset:49152
v_mfma_f32_16x16x32_bf16 v[36:39], a[76:79], a[108:111], v[36:39]
ds_read_b128 a[192:195], v14 offset:49152
v_mfma_f32_16x16x32_bf16 v[56:59], a[72:75], a[112:115], v[56:59]
buffer_load_dwordx4 v10, s[16:19], s48 offen offset:2048 sc1 lds
v_mfma_f32_16x16x32_bf16 v[56:59], a[76:79], a[116:119], v[56:59]
ds_read_b128 a[200:203], v15 offset:49152
v_mfma_f32_16x16x32_bf16 v[76:79], a[72:75], a[120:123], v[76:79]
ds_read_b128 a[180:183], v12 offset:50176
v_mfma_f32_16x16x32_bf16 v[76:79], a[76:79], a[124:127], v[76:79]
ds_read_b128 a[188:191], v13 offset:50176
v_mfma_f32_16x16x32_bf16 v[96:99], a[72:75], a[128:131], v[96:99]
buffer_load_dwordx4 v10, s[16:19], s48 offen offset:3072 sc1 lds
v_mfma_f32_16x16x32_bf16 v[96:99], a[76:79], a[132:135], v[96:99]
s_add_u32 s48, s48, 2048
s_add_u32 m0, s50, 40960
v_mfma_f32_16x16x32_bf16 v[40:43], a[80:83], a[104:107], v[40:43]
ds_read_b128 a[196:199], v14 offset:50176
v_mfma_f32_16x16x32_bf16 v[40:43], a[84:87], a[108:111], v[40:43]
ds_read_b128 a[204:207], v15 offset:50176
v_mfma_f32_16x16x32_bf16 v[60:63], a[80:83], a[112:115], v[60:63]
buffer_load_dwordx4 v200, s[80:83], s47 offen offset:0 lds
v_mfma_f32_16x16x32_bf16 v[60:63], a[84:87], a[116:119], v[60:63]
ds_read_b64_tr_b16 a[144:145], v206 offset:20480
v_mfma_f32_16x16x32_bf16 v[80:83], a[80:83], a[120:123], v[80:83]
ds_read_b64_tr_b16 a[146:147], v206 offset:25600
v_mfma_f32_16x16x32_bf16 v[80:83], a[84:87], a[124:127], v[80:83]
ds_read_b64_tr_b16 a[148:149], v206 offset:30720
v_mfma_f32_16x16x32_bf16 v[100:103], a[80:83], a[128:131], v[100:103]
buffer_load_dwordx4 v201, s[80:83], s47 offen offset:1024 lds
v_mfma_f32_16x16x32_bf16 v[100:103], a[84:87], a[132:135], v[100:103]
s_waitcnt lgkmcnt(3)
ds_read_b64_tr_b16 a[150:151], v206 offset:35840
v_mfma_f32_16x16x32_bf16 v[44:47], a[88:91], a[104:107], v[44:47]
ds_read_b64_tr_b16 a[152:153], v8 offset:20544
v_mfma_f32_16x16x32_bf16 v[44:47], a[92:95], a[108:111], v[44:47]
ds_read_b64_tr_b16 a[154:155], v8 offset:25664
v_mfma_f32_16x16x32_bf16 v[64:67], a[88:91], a[112:115], v[64:67]
buffer_load_dwordx4 v202, s[80:83], s47 offen offset:2048 lds
v_mfma_f32_16x16x32_bf16 v[64:67], a[92:95], a[116:119], v[64:67]
ds_read_b64_tr_b16 a[156:157], v8 offset:30784
v_mfma_f32_16x16x32_bf16 v[84:87], a[88:91], a[120:123], v[84:87]
ds_read_b64_tr_b16 a[158:159], v8 offset:35904
v_mfma_f32_16x16x32_bf16 v[84:87], a[92:95], a[124:127], v[84:87]
ds_read_b64_tr_b16 a[160:161], v206 offset:20544
v_mfma_f32_16x16x32_bf16 v[104:107], a[88:91], a[128:131], v[104:107]
buffer_load_dwordx4 v203, s[80:83], s47 offen offset:3072 lds
v_mfma_f32_16x16x32_bf16 v[104:107], a[92:95], a[132:135], v[104:107]
s_add_u32 m0, s50, 45056
ds_read_b64_tr_b16 a[162:163], v206 offset:25664
v_mfma_f32_16x16x32_bf16 v[48:51], a[96:99], a[104:107], v[48:51]
ds_read_b64_tr_b16 a[164:165], v206 offset:30784
v_mfma_f32_16x16x32_bf16 v[48:51], a[100:103], a[108:111], v[48:51]
ds_read_b64_tr_b16 a[166:167], v206 offset:35904
v_mfma_f32_16x16x32_bf16 v[68:71], a[96:99], a[112:115], v[68:71]
buffer_load_dwordx4 v204, s[80:83], s47 offen lds
v_mfma_f32_16x16x32_bf16 v[68:71], a[100:103], a[116:119], v[68:71]
s_add_u32 s47, s47, 81920
ds_read_b64_tr_b16 a[168:169], v8 offset:20608
v_mfma_f32_16x16x32_bf16 v[88:91], a[96:99], a[120:123], v[88:91]
ds_read_b64_tr_b16 a[170:171], v8 offset:25728
v_mfma_f32_16x16x32_bf16 v[88:91], a[100:103], a[124:127], v[88:91]
ds_read_b64_tr_b16 a[172:173], v8 offset:30848
v_mfma_f32_16x16x32_bf16 v[108:111], a[96:99], a[128:131], v[108:111]
ds_read_b64_tr_b16 a[174:175], v8 offset:35968
v_mfma_f32_16x16x32_bf16 v[108:111], a[100:103], a[132:135], v[108:111]
s_waitcnt lgkmcnt(8)
v_mfma_f32_16x16x32_bf16 v[32:35], a[136:139], a[176:179], v[32:35]
s_waitcnt vmcnt(18)
s_barrier
v_mfma_f32_16x16x32_bf16 v[32:35], a[140:143], a[180:183], v[32:35]
s_add_u32 m0, s35, 131072
ds_read_b64_tr_b16 a[64:65], v11 offset:0
v_mfma_f32_16x16x32_bf16 v[52:55], a[136:139], a[184:187], v[52:55]
buffer_load_dwordx4 v16, s[16:19], s48 offen offset:0 sc1 lds
v_mfma_f32_16x16x32_bf16 v[52:55], a[140:143], a[188:191], v[52:55]
ds_read_b64_tr_b16 a[66:67], v11 offset:5120
v_mfma_f32_16x16x32_bf16 v[72:75], a[136:139], a[192:195], v[72:75]
ds_read_b64_tr_b16 a[68:69], v11 offset:10240
v_mfma_f32_16x16x32_bf16 v[72:75], a[140:143], a[196:199], v[72:75]
ds_read_b64_tr_b16 a[70:71], v11 offset:15360
v_mfma_f32_16x16x32_bf16 v[92:95], a[136:139], a[200:203], v[92:95]
buffer_load_dwordx4 v16, s[16:19], s48 offen offset:1024 sc1 lds
v_mfma_f32_16x16x32_bf16 v[92:95], a[140:143], a[204:207], v[92:95]
ds_read_b128 a[104:107], v12 offset:0
v_mfma_f32_16x16x32_bf16 v[36:39], a[144:147], a[176:179], v[36:39]
ds_read_b128 a[112:115], v13 offset:0
v_mfma_f32_16x16x32_bf16 v[36:39], a[148:151], a[180:183], v[36:39]
ds_read_b128 a[120:123], v14 offset:0
v_mfma_f32_16x16x32_bf16 v[56:59], a[144:147], a[184:187], v[56:59]
buffer_load_dwordx4 v10, s[16:19], s48 offen offset:2048 sc1 lds
v_mfma_f32_16x16x32_bf16 v[56:59], a[148:151], a[188:191], v[56:59]
ds_read_b128 a[128:131], v15 offset:0
v_mfma_f32_16x16x32_bf16 v[76:79], a[144:147], a[192:195], v[76:79]
ds_read_b128 a[108:111], v12 offset:1024
v_mfma_f32_16x16x32_bf16 v[76:79], a[148:151], a[196:199], v[76:79]
ds_read_b128 a[116:119], v13 offset:1024
v_mfma_f32_16x16x32_bf16 v[96:99], a[144:147], a[200:203], v[96:99]
buffer_load_dwordx4 v10, s[16:19], s48 offen offset:3072 sc1 lds
v_mfma_f32_16x16x32_bf16 v[96:99], a[148:151], a[204:207], v[96:99]
s_add_u32 s48, s48, 2048
s_add_u32 m0, s50, 61440
v_mfma_f32_16x16x32_bf16 v[40:43], a[152:155], a[176:179], v[40:43]
ds_read_b128 a[124:127], v14 offset:1024
v_mfma_f32_16x16x32_bf16 v[40:43], a[156:159], a[180:183], v[40:43]
ds_read_b128 a[132:135], v15 offset:1024
v_mfma_f32_16x16x32_bf16 v[60:63], a[152:155], a[184:187], v[60:63]
buffer_load_dwordx4 v200, s[80:83], s47 offen offset:0 lds
v_mfma_f32_16x16x32_bf16 v[60:63], a[156:159], a[188:191], v[60:63]
ds_read_b64_tr_b16 a[72:73], v205 offset:0
v_mfma_f32_16x16x32_bf16 v[80:83], a[152:155], a[192:195], v[80:83]
ds_read_b64_tr_b16 a[74:75], v205 offset:5120
v_mfma_f32_16x16x32_bf16 v[80:83], a[156:159], a[196:199], v[80:83]
ds_read_b64_tr_b16 a[76:77], v205 offset:10240
v_mfma_f32_16x16x32_bf16 v[100:103], a[152:155], a[200:203], v[100:103]
buffer_load_dwordx4 v201, s[80:83], s47 offen offset:1024 lds
v_mfma_f32_16x16x32_bf16 v[100:103], a[156:159], a[204:207], v[100:103]
s_waitcnt lgkmcnt(3)
ds_read_b64_tr_b16 a[78:79], v205 offset:15360
v_mfma_f32_16x16x32_bf16 v[44:47], a[160:163], a[176:179], v[44:47]
ds_read_b64_tr_b16 a[80:81], v11 offset:64
v_mfma_f32_16x16x32_bf16 v[44:47], a[164:167], a[180:183], v[44:47]
ds_read_b64_tr_b16 a[82:83], v11 offset:5184
v_mfma_f32_16x16x32_bf16 v[64:67], a[160:163], a[184:187], v[64:67]
buffer_load_dwordx4 v202, s[80:83], s47 offen offset:2048 lds
v_mfma_f32_16x16x32_bf16 v[64:67], a[164:167], a[188:191], v[64:67]
ds_read_b64_tr_b16 a[84:85], v11 offset:10304
v_mfma_f32_16x16x32_bf16 v[84:87], a[160:163], a[192:195], v[84:87]
ds_read_b64_tr_b16 a[86:87], v11 offset:15424
v_mfma_f32_16x16x32_bf16 v[84:87], a[164:167], a[196:199], v[84:87]
ds_read_b64_tr_b16 a[88:89], v205 offset:64
v_mfma_f32_16x16x32_bf16 v[104:107], a[160:163], a[200:203], v[104:107]
buffer_load_dwordx4 v203, s[80:83], s47 offen offset:3072 lds
v_mfma_f32_16x16x32_bf16 v[104:107], a[164:167], a[204:207], v[104:107]
s_add_u32 m0, s50, 65536
ds_read_b64_tr_b16 a[90:91], v205 offset:5184
v_mfma_f32_16x16x32_bf16 v[48:51], a[168:171], a[176:179], v[48:51]
ds_read_b64_tr_b16 a[92:93], v205 offset:10304
v_mfma_f32_16x16x32_bf16 v[48:51], a[172:175], a[180:183], v[48:51]
ds_read_b64_tr_b16 a[94:95], v205 offset:15424
v_mfma_f32_16x16x32_bf16 v[68:71], a[168:171], a[184:187], v[68:71]
buffer_load_dwordx4 v204, s[80:83], s47 offen lds
v_mfma_f32_16x16x32_bf16 v[68:71], a[172:175], a[188:191], v[68:71]
s_add_u32 s47, s47, 81920
ds_read_b64_tr_b16 a[96:97], v11 offset:128
v_mfma_f32_16x16x32_bf16 v[88:91], a[168:171], a[192:195], v[88:91]
ds_read_b64_tr_b16 a[98:99], v11 offset:5248
v_mfma_f32_16x16x32_bf16 v[88:91], a[172:175], a[196:199], v[88:91]
ds_read_b64_tr_b16 a[100:101], v11 offset:10368
v_mfma_f32_16x16x32_bf16 v[108:111], a[168:171], a[200:203], v[108:111]
ds_read_b64_tr_b16 a[102:103], v11 offset:15488
v_mfma_f32_16x16x32_bf16 v[108:111], a[172:175], a[204:207], v[108:111]
s_waitcnt lgkmcnt(8)
v_mfma_f32_16x16x32_bf16 v[32:35], a[64:67], a[104:107], v[32:35]
s_waitcnt vmcnt(18)
s_barrier
s_cmp_lg_u32 s3, 0
s_cbranch_scc1 w0_concat_63
v_mov_b32 v31, 0
buffer_load_dword v21, v31, s[16:19], s63 offen sc1
buffer_load_dword v20, v31, s[16:19], s62 offen sc1
w0_concat_63:
v_mfma_f32_16x16x32_bf16 v[32:35], a[68:71], a[108:111], v[32:35]
s_add_u32 m0, s35, 81920
ds_read_b64_tr_b16 a[136:137], v11 offset:20480
v_mfma_f32_16x16x32_bf16 v[52:55], a[64:67], a[112:115], v[52:55]
buffer_load_dwordx4 v16, s[16:19], s48 offen offset:0 sc1 lds
v_mfma_f32_16x16x32_bf16 v[52:55], a[68:71], a[116:119], v[52:55]
ds_read_b64_tr_b16 a[138:139], v11 offset:25600
v_mfma_f32_16x16x32_bf16 v[72:75], a[64:67], a[120:123], v[72:75]
ds_read_b64_tr_b16 a[140:141], v11 offset:30720
v_mfma_f32_16x16x32_bf16 v[72:75], a[68:71], a[124:127], v[72:75]
ds_read_b64_tr_b16 a[142:143], v11 offset:35840
v_mfma_f32_16x16x32_bf16 v[92:95], a[64:67], a[128:131], v[92:95]
buffer_load_dwordx4 v16, s[16:19], s48 offen offset:1024 sc1 lds
v_mfma_f32_16x16x32_bf16 v[92:95], a[68:71], a[132:135], v[92:95]
ds_read_b128 a[176:179], v12 offset:16384
v_mfma_f32_16x16x32_bf16 v[36:39], a[72:75], a[104:107], v[36:39]
ds_read_b128 a[184:187], v13 offset:16384
v_mfma_f32_16x16x32_bf16 v[36:39], a[76:79], a[108:111], v[36:39]
ds_read_b128 a[192:195], v14 offset:16384
v_mfma_f32_16x16x32_bf16 v[56:59], a[72:75], a[112:115], v[56:59]
buffer_load_dwordx4 v10, s[16:19], s48 offen offset:2048 sc1 lds
v_mfma_f32_16x16x32_bf16 v[56:59], a[76:79], a[116:119], v[56:59]
ds_read_b128 a[200:203], v15 offset:16384
v_mfma_f32_16x16x32_bf16 v[76:79], a[72:75], a[120:123], v[76:79]
ds_read_b128 a[180:183], v12 offset:17408
v_mfma_f32_16x16x32_bf16 v[76:79], a[76:79], a[124:127], v[76:79]
ds_read_b128 a[188:191], v13 offset:17408
v_mfma_f32_16x16x32_bf16 v[96:99], a[72:75], a[128:131], v[96:99]
buffer_load_dwordx4 v10, s[16:19], s48 offen offset:3072 sc1 lds
v_mfma_f32_16x16x32_bf16 v[96:99], a[76:79], a[132:135], v[96:99]
s_add_u32 s48, s48, 2048
s_add_u32 m0, s50, 0
v_mfma_f32_16x16x32_bf16 v[40:43], a[80:83], a[104:107], v[40:43]
ds_read_b128 a[196:199], v14 offset:17408
v_mfma_f32_16x16x32_bf16 v[40:43], a[84:87], a[108:111], v[40:43]
ds_read_b128 a[204:207], v15 offset:17408
v_mfma_f32_16x16x32_bf16 v[60:63], a[80:83], a[112:115], v[60:63]
buffer_load_dwordx4 v200, s[80:83], s47 offen offset:0 lds
v_mfma_f32_16x16x32_bf16 v[60:63], a[84:87], a[116:119], v[60:63]
ds_read_b64_tr_b16 a[144:145], v205 offset:20480
v_mfma_f32_16x16x32_bf16 v[80:83], a[80:83], a[120:123], v[80:83]
ds_read_b64_tr_b16 a[146:147], v205 offset:25600
v_mfma_f32_16x16x32_bf16 v[80:83], a[84:87], a[124:127], v[80:83]
ds_read_b64_tr_b16 a[148:149], v205 offset:30720
v_mfma_f32_16x16x32_bf16 v[100:103], a[80:83], a[128:131], v[100:103]
buffer_load_dwordx4 v201, s[80:83], s47 offen offset:1024 lds
v_mfma_f32_16x16x32_bf16 v[100:103], a[84:87], a[132:135], v[100:103]
s_waitcnt lgkmcnt(3)
ds_read_b64_tr_b16 a[150:151], v205 offset:35840
v_mfma_f32_16x16x32_bf16 v[44:47], a[88:91], a[104:107], v[44:47]
ds_read_b64_tr_b16 a[152:153], v11 offset:20544
v_mfma_f32_16x16x32_bf16 v[44:47], a[92:95], a[108:111], v[44:47]
ds_read_b64_tr_b16 a[154:155], v11 offset:25664
v_mfma_f32_16x16x32_bf16 v[64:67], a[88:91], a[112:115], v[64:67]
buffer_load_dwordx4 v202, s[80:83], s47 offen offset:2048 lds
v_mfma_f32_16x16x32_bf16 v[64:67], a[92:95], a[116:119], v[64:67]
ds_read_b64_tr_b16 a[156:157], v11 offset:30784
v_mfma_f32_16x16x32_bf16 v[84:87], a[88:91], a[120:123], v[84:87]
ds_read_b64_tr_b16 a[158:159], v11 offset:35904
v_mfma_f32_16x16x32_bf16 v[84:87], a[92:95], a[124:127], v[84:87]
ds_read_b64_tr_b16 a[160:161], v205 offset:20544
v_mfma_f32_16x16x32_bf16 v[104:107], a[88:91], a[128:131], v[104:107]
buffer_load_dwordx4 v203, s[80:83], s47 offen offset:3072 lds
v_mfma_f32_16x16x32_bf16 v[104:107], a[92:95], a[132:135], v[104:107]
s_add_u32 m0, s50, 4096
ds_read_b64_tr_b16 a[162:163], v205 offset:25664
v_mfma_f32_16x16x32_bf16 v[48:51], a[96:99], a[104:107], v[48:51]
ds_read_b64_tr_b16 a[164:165], v205 offset:30784
v_mfma_f32_16x16x32_bf16 v[48:51], a[100:103], a[108:111], v[48:51]
ds_read_b64_tr_b16 a[166:167], v205 offset:35904
v_mfma_f32_16x16x32_bf16 v[68:71], a[96:99], a[112:115], v[68:71]
buffer_load_dwordx4 v204, s[80:83], s47 offen lds
v_mfma_f32_16x16x32_bf16 v[68:71], a[100:103], a[116:119], v[68:71]
s_add_u32 s47, s47, 81920
ds_read_b64_tr_b16 a[168:169], v11 offset:20608
v_mfma_f32_16x16x32_bf16 v[88:91], a[96:99], a[120:123], v[88:91]
ds_read_b64_tr_b16 a[170:171], v11 offset:25728
v_mfma_f32_16x16x32_bf16 v[88:91], a[100:103], a[124:127], v[88:91]
ds_read_b64_tr_b16 a[172:173], v11 offset:30848
v_mfma_f32_16x16x32_bf16 v[108:111], a[96:99], a[128:131], v[108:111]
ds_read_b64_tr_b16 a[174:175], v11 offset:35968
v_mfma_f32_16x16x32_bf16 v[108:111], a[100:103], a[132:135], v[108:111]
s_waitcnt lgkmcnt(8)
v_mfma_f32_16x16x32_bf16 v[32:35], a[136:139], a[176:179], v[32:35]
s_waitcnt vmcnt(18)
s_barrier
v_mfma_f32_16x16x32_bf16 v[32:35], a[140:143], a[180:183], v[32:35]
s_add_u32 m0, s35, 98304
ds_read_b64_tr_b16 a[64:65], v8 offset:0
v_mfma_f32_16x16x32_bf16 v[52:55], a[136:139], a[184:187], v[52:55]
buffer_load_dwordx4 v16, s[16:19], s48 offen offset:0 sc1 lds
v_mfma_f32_16x16x32_bf16 v[52:55], a[140:143], a[188:191], v[52:55]
ds_read_b64_tr_b16 a[66:67], v8 offset:5120
v_mfma_f32_16x16x32_bf16 v[72:75], a[136:139], a[192:195], v[72:75]
ds_read_b64_tr_b16 a[68:69], v8 offset:10240
v_mfma_f32_16x16x32_bf16 v[72:75], a[140:143], a[196:199], v[72:75]
ds_read_b64_tr_b16 a[70:71], v8 offset:15360
v_mfma_f32_16x16x32_bf16 v[92:95], a[136:139], a[200:203], v[92:95]
buffer_load_dwordx4 v16, s[16:19], s48 offen offset:1024 sc1 lds
v_mfma_f32_16x16x32_bf16 v[92:95], a[140:143], a[204:207], v[92:95]
ds_read_b128 a[104:107], v12 offset:32768
v_mfma_f32_16x16x32_bf16 v[36:39], a[144:147], a[176:179], v[36:39]
ds_read_b128 a[112:115], v13 offset:32768
v_mfma_f32_16x16x32_bf16 v[36:39], a[148:151], a[180:183], v[36:39]
ds_read_b128 a[120:123], v14 offset:32768
v_mfma_f32_16x16x32_bf16 v[56:59], a[144:147], a[184:187], v[56:59]
buffer_load_dwordx4 v10, s[16:19], s48 offen offset:2048 sc1 lds
v_mfma_f32_16x16x32_bf16 v[56:59], a[148:151], a[188:191], v[56:59]
ds_read_b128 a[128:131], v15 offset:32768
v_mfma_f32_16x16x32_bf16 v[76:79], a[144:147], a[192:195], v[76:79]
ds_read_b128 a[108:111], v12 offset:33792
v_mfma_f32_16x16x32_bf16 v[76:79], a[148:151], a[196:199], v[76:79]
ds_read_b128 a[116:119], v13 offset:33792
v_mfma_f32_16x16x32_bf16 v[96:99], a[144:147], a[200:203], v[96:99]
buffer_load_dwordx4 v10, s[16:19], s48 offen offset:3072 sc1 lds
v_mfma_f32_16x16x32_bf16 v[96:99], a[148:151], a[204:207], v[96:99]
s_add_u32 s48, s48, 2048
s_add_u32 m0, s50, 20480
v_mfma_f32_16x16x32_bf16 v[40:43], a[152:155], a[176:179], v[40:43]
ds_read_b128 a[124:127], v14 offset:33792
v_mfma_f32_16x16x32_bf16 v[40:43], a[156:159], a[180:183], v[40:43]
ds_read_b128 a[132:135], v15 offset:33792
v_mfma_f32_16x16x32_bf16 v[60:63], a[152:155], a[184:187], v[60:63]
buffer_load_dwordx4 v200, s[80:83], s47 offen offset:0 lds
v_mfma_f32_16x16x32_bf16 v[60:63], a[156:159], a[188:191], v[60:63]
ds_read_b64_tr_b16 a[72:73], v206 offset:0
v_mfma_f32_16x16x32_bf16 v[80:83], a[152:155], a[192:195], v[80:83]
ds_read_b64_tr_b16 a[74:75], v206 offset:5120
v_mfma_f32_16x16x32_bf16 v[80:83], a[156:159], a[196:199], v[80:83]
ds_read_b64_tr_b16 a[76:77], v206 offset:10240
v_mfma_f32_16x16x32_bf16 v[100:103], a[152:155], a[200:203], v[100:103]
buffer_load_dwordx4 v201, s[80:83], s47 offen offset:1024 lds
v_mfma_f32_16x16x32_bf16 v[100:103], a[156:159], a[204:207], v[100:103]
s_waitcnt lgkmcnt(3)
ds_read_b64_tr_b16 a[78:79], v206 offset:15360
v_mfma_f32_16x16x32_bf16 v[44:47], a[160:163], a[176:179], v[44:47]
ds_read_b64_tr_b16 a[80:81], v8 offset:64
v_mfma_f32_16x16x32_bf16 v[44:47], a[164:167], a[180:183], v[44:47]
ds_read_b64_tr_b16 a[82:83], v8 offset:5184
v_mfma_f32_16x16x32_bf16 v[64:67], a[160:163], a[184:187], v[64:67]
buffer_load_dwordx4 v202, s[80:83], s47 offen offset:2048 lds
v_mfma_f32_16x16x32_bf16 v[64:67], a[164:167], a[188:191], v[64:67]
ds_read_b64_tr_b16 a[84:85], v8 offset:10304
v_mfma_f32_16x16x32_bf16 v[84:87], a[160:163], a[192:195], v[84:87]
ds_read_b64_tr_b16 a[86:87], v8 offset:15424
v_mfma_f32_16x16x32_bf16 v[84:87], a[164:167], a[196:199], v[84:87]
ds_read_b64_tr_b16 a[88:89], v206 offset:64
v_mfma_f32_16x16x32_bf16 v[104:107], a[160:163], a[200:203], v[104:107]
buffer_load_dwordx4 v203, s[80:83], s47 offen offset:3072 lds
v_mfma_f32_16x16x32_bf16 v[104:107], a[164:167], a[204:207], v[104:107]
s_add_u32 m0, s50, 24576
ds_read_b64_tr_b16 a[90:91], v206 offset:5184
v_mfma_f32_16x16x32_bf16 v[48:51], a[168:171], a[176:179], v[48:51]
ds_read_b64_tr_b16 a[92:93], v206 offset:10304
v_mfma_f32_16x16x32_bf16 v[48:51], a[172:175], a[180:183], v[48:51]
ds_read_b64_tr_b16 a[94:95], v206 offset:15424
v_mfma_f32_16x16x32_bf16 v[68:71], a[168:171], a[184:187], v[68:71]
buffer_load_dwordx4 v204, s[80:83], s47 offen lds
v_mfma_f32_16x16x32_bf16 v[68:71], a[172:175], a[188:191], v[68:71]
s_add_u32 s47, s47, 81920
ds_read_b64_tr_b16 a[96:97], v8 offset:128
v_mfma_f32_16x16x32_bf16 v[88:91], a[168:171], a[192:195], v[88:91]
ds_read_b64_tr_b16 a[98:99], v8 offset:5248
v_mfma_f32_16x16x32_bf16 v[88:91], a[172:175], a[196:199], v[88:91]
ds_read_b64_tr_b16 a[100:101], v8 offset:10368
v_mfma_f32_16x16x32_bf16 v[108:111], a[168:171], a[200:203], v[108:111]
ds_read_b64_tr_b16 a[102:103], v8 offset:15488
v_mfma_f32_16x16x32_bf16 v[108:111], a[172:175], a[204:207], v[108:111]
s_waitcnt lgkmcnt(8)
v_mfma_f32_16x16x32_bf16 v[32:35], a[64:67], a[104:107], v[32:35]
s_waitcnt vmcnt(18)
s_barrier
v_mfma_f32_16x16x32_bf16 v[32:35], a[68:71], a[108:111], v[32:35]
s_add_u32 m0, s35, 114688
ds_read_b64_tr_b16 a[136:137], v8 offset:20480
v_mfma_f32_16x16x32_bf16 v[52:55], a[64:67], a[112:115], v[52:55]
buffer_load_dwordx4 v16, s[16:19], s48 offen offset:0 sc1 lds
v_mfma_f32_16x16x32_bf16 v[52:55], a[68:71], a[116:119], v[52:55]
ds_read_b64_tr_b16 a[138:139], v8 offset:25600
v_mfma_f32_16x16x32_bf16 v[72:75], a[64:67], a[120:123], v[72:75]
ds_read_b64_tr_b16 a[140:141], v8 offset:30720
v_mfma_f32_16x16x32_bf16 v[72:75], a[68:71], a[124:127], v[72:75]
ds_read_b64_tr_b16 a[142:143], v8 offset:35840
v_mfma_f32_16x16x32_bf16 v[92:95], a[64:67], a[128:131], v[92:95]
buffer_load_dwordx4 v16, s[16:19], s48 offen offset:1024 sc1 lds
v_mfma_f32_16x16x32_bf16 v[92:95], a[68:71], a[132:135], v[92:95]
ds_read_b128 a[176:179], v12 offset:49152
v_mfma_f32_16x16x32_bf16 v[36:39], a[72:75], a[104:107], v[36:39]
ds_read_b128 a[184:187], v13 offset:49152
v_mfma_f32_16x16x32_bf16 v[36:39], a[76:79], a[108:111], v[36:39]
ds_read_b128 a[192:195], v14 offset:49152
v_mfma_f32_16x16x32_bf16 v[56:59], a[72:75], a[112:115], v[56:59]
buffer_load_dwordx4 v10, s[16:19], s48 offen offset:2048 sc1 lds
v_mfma_f32_16x16x32_bf16 v[56:59], a[76:79], a[116:119], v[56:59]
ds_read_b128 a[200:203], v15 offset:49152
v_mfma_f32_16x16x32_bf16 v[76:79], a[72:75], a[120:123], v[76:79]
ds_read_b128 a[180:183], v12 offset:50176
v_mfma_f32_16x16x32_bf16 v[76:79], a[76:79], a[124:127], v[76:79]
ds_read_b128 a[188:191], v13 offset:50176
v_mfma_f32_16x16x32_bf16 v[96:99], a[72:75], a[128:131], v[96:99]
buffer_load_dwordx4 v10, s[16:19], s48 offen offset:3072 sc1 lds
v_mfma_f32_16x16x32_bf16 v[96:99], a[76:79], a[132:135], v[96:99]
s_add_u32 s48, s48, 2048
s_add_u32 m0, s50, 40960
v_mfma_f32_16x16x32_bf16 v[40:43], a[80:83], a[104:107], v[40:43]
ds_read_b128 a[196:199], v14 offset:50176
v_mfma_f32_16x16x32_bf16 v[40:43], a[84:87], a[108:111], v[40:43]
ds_read_b128 a[204:207], v15 offset:50176
v_mfma_f32_16x16x32_bf16 v[60:63], a[80:83], a[112:115], v[60:63]
buffer_load_dwordx4 v200, s[80:83], s47 offen offset:0 lds
v_mfma_f32_16x16x32_bf16 v[60:63], a[84:87], a[116:119], v[60:63]
ds_read_b64_tr_b16 a[144:145], v206 offset:20480
v_mfma_f32_16x16x32_bf16 v[80:83], a[80:83], a[120:123], v[80:83]
ds_read_b64_tr_b16 a[146:147], v206 offset:25600
v_mfma_f32_16x16x32_bf16 v[80:83], a[84:87], a[124:127], v[80:83]
ds_read_b64_tr_b16 a[148:149], v206 offset:30720
v_mfma_f32_16x16x32_bf16 v[100:103], a[80:83], a[128:131], v[100:103]
buffer_load_dwordx4 v201, s[80:83], s47 offen offset:1024 lds
v_mfma_f32_16x16x32_bf16 v[100:103], a[84:87], a[132:135], v[100:103]
s_waitcnt lgkmcnt(3)
ds_read_b64_tr_b16 a[150:151], v206 offset:35840
v_mfma_f32_16x16x32_bf16 v[44:47], a[88:91], a[104:107], v[44:47]
ds_read_b64_tr_b16 a[152:153], v8 offset:20544
v_mfma_f32_16x16x32_bf16 v[44:47], a[92:95], a[108:111], v[44:47]
ds_read_b64_tr_b16 a[154:155], v8 offset:25664
v_mfma_f32_16x16x32_bf16 v[64:67], a[88:91], a[112:115], v[64:67]
buffer_load_dwordx4 v202, s[80:83], s47 offen offset:2048 lds
v_mfma_f32_16x16x32_bf16 v[64:67], a[92:95], a[116:119], v[64:67]
ds_read_b64_tr_b16 a[156:157], v8 offset:30784
v_mfma_f32_16x16x32_bf16 v[84:87], a[88:91], a[120:123], v[84:87]
ds_read_b64_tr_b16 a[158:159], v8 offset:35904
v_mfma_f32_16x16x32_bf16 v[84:87], a[92:95], a[124:127], v[84:87]
ds_read_b64_tr_b16 a[160:161], v206 offset:20544
v_mfma_f32_16x16x32_bf16 v[104:107], a[88:91], a[128:131], v[104:107]
buffer_load_dwordx4 v203, s[80:83], s47 offen offset:3072 lds
v_mfma_f32_16x16x32_bf16 v[104:107], a[92:95], a[132:135], v[104:107]
s_add_u32 m0, s50, 45056
ds_read_b64_tr_b16 a[162:163], v206 offset:25664
v_mfma_f32_16x16x32_bf16 v[48:51], a[96:99], a[104:107], v[48:51]
ds_read_b64_tr_b16 a[164:165], v206 offset:30784
v_mfma_f32_16x16x32_bf16 v[48:51], a[100:103], a[108:111], v[48:51]
ds_read_b64_tr_b16 a[166:167], v206 offset:35904
v_mfma_f32_16x16x32_bf16 v[68:71], a[96:99], a[112:115], v[68:71]
buffer_load_dwordx4 v204, s[80:83], s47 offen lds
v_mfma_f32_16x16x32_bf16 v[68:71], a[100:103], a[116:119], v[68:71]
s_add_u32 s47, s47, 81920
ds_read_b64_tr_b16 a[168:169], v8 offset:20608
v_mfma_f32_16x16x32_bf16 v[88:91], a[96:99], a[120:123], v[88:91]
ds_read_b64_tr_b16 a[170:171], v8 offset:25728
v_mfma_f32_16x16x32_bf16 v[88:91], a[100:103], a[124:127], v[88:91]
ds_read_b64_tr_b16 a[172:173], v8 offset:30848
v_mfma_f32_16x16x32_bf16 v[108:111], a[96:99], a[128:131], v[108:111]
ds_read_b64_tr_b16 a[174:175], v8 offset:35968
v_mfma_f32_16x16x32_bf16 v[108:111], a[100:103], a[132:135], v[108:111]
s_waitcnt lgkmcnt(8)
v_mfma_f32_16x16x32_bf16 v[32:35], a[136:139], a[176:179], v[32:35]
s_waitcnt vmcnt(18)
s_cmp_lg_u32 s3, 0
s_cbranch_scc1 spinret_concat_65
v_readfirstlane_b32 s60, v21
s_cmp_lt_u32 s60, 16
s_cbranch_scc1 spin_concat_64
v_readfirstlane_b32 s60, v20
s_cmp_lt_u32 s60, 4
s_cbranch_scc1 spin_concat_64
spinret_concat_65:
s_barrier
v_mfma_f32_16x16x32_bf16 v[32:35], a[140:143], a[180:183], v[32:35]
s_add_u32 m0, s35, 131072
ds_read_b64_tr_b16 a[64:65], v11 offset:0
v_mfma_f32_16x16x32_bf16 v[52:55], a[136:139], a[184:187], v[52:55]
buffer_load_dwordx4 v16, s[16:19], s48 offen offset:0 sc1 lds
v_mfma_f32_16x16x32_bf16 v[52:55], a[140:143], a[188:191], v[52:55]
ds_read_b64_tr_b16 a[66:67], v11 offset:5120
v_mfma_f32_16x16x32_bf16 v[72:75], a[136:139], a[192:195], v[72:75]
ds_read_b64_tr_b16 a[68:69], v11 offset:10240
v_mfma_f32_16x16x32_bf16 v[72:75], a[140:143], a[196:199], v[72:75]
ds_read_b64_tr_b16 a[70:71], v11 offset:15360
v_mfma_f32_16x16x32_bf16 v[92:95], a[136:139], a[200:203], v[92:95]
buffer_load_dwordx4 v16, s[16:19], s48 offen offset:1024 sc1 lds
v_mfma_f32_16x16x32_bf16 v[92:95], a[140:143], a[204:207], v[92:95]
ds_read_b128 a[104:107], v12 offset:0
v_mfma_f32_16x16x32_bf16 v[36:39], a[144:147], a[176:179], v[36:39]
ds_read_b128 a[112:115], v13 offset:0
v_mfma_f32_16x16x32_bf16 v[36:39], a[148:151], a[180:183], v[36:39]
ds_read_b128 a[120:123], v14 offset:0
v_mfma_f32_16x16x32_bf16 v[56:59], a[144:147], a[184:187], v[56:59]
buffer_load_dwordx4 v10, s[16:19], s48 offen offset:2048 sc1 lds
v_mfma_f32_16x16x32_bf16 v[56:59], a[148:151], a[188:191], v[56:59]
ds_read_b128 a[128:131], v15 offset:0
v_mfma_f32_16x16x32_bf16 v[76:79], a[144:147], a[192:195], v[76:79]
ds_read_b128 a[108:111], v12 offset:1024
v_mfma_f32_16x16x32_bf16 v[76:79], a[148:151], a[196:199], v[76:79]
ds_read_b128 a[116:119], v13 offset:1024
v_mfma_f32_16x16x32_bf16 v[96:99], a[144:147], a[200:203], v[96:99]
buffer_load_dwordx4 v10, s[16:19], s48 offen offset:3072 sc1 lds
v_mfma_f32_16x16x32_bf16 v[96:99], a[148:151], a[204:207], v[96:99]
s_add_u32 s48, s48, 2048
s_add_u32 m0, s50, 61440
v_mfma_f32_16x16x32_bf16 v[40:43], a[152:155], a[176:179], v[40:43]
ds_read_b128 a[124:127], v14 offset:1024
v_mfma_f32_16x16x32_bf16 v[40:43], a[156:159], a[180:183], v[40:43]
ds_read_b128 a[132:135], v15 offset:1024
v_mfma_f32_16x16x32_bf16 v[60:63], a[152:155], a[184:187], v[60:63]
buffer_load_dwordx4 v200, s[80:83], s47 offen offset:0 lds
v_mfma_f32_16x16x32_bf16 v[60:63], a[156:159], a[188:191], v[60:63]
ds_read_b64_tr_b16 a[72:73], v205 offset:0
v_mfma_f32_16x16x32_bf16 v[80:83], a[152:155], a[192:195], v[80:83]
ds_read_b64_tr_b16 a[74:75], v205 offset:5120
v_mfma_f32_16x16x32_bf16 v[80:83], a[156:159], a[196:199], v[80:83]
ds_read_b64_tr_b16 a[76:77], v205 offset:10240
v_mfma_f32_16x16x32_bf16 v[100:103], a[152:155], a[200:203], v[100:103]
buffer_load_dwordx4 v201, s[80:83], s47 offen offset:1024 lds
v_mfma_f32_16x16x32_bf16 v[100:103], a[156:159], a[204:207], v[100:103]
s_waitcnt lgkmcnt(3)
ds_read_b64_tr_b16 a[78:79], v205 offset:15360
v_mfma_f32_16x16x32_bf16 v[44:47], a[160:163], a[176:179], v[44:47]
ds_read_b64_tr_b16 a[80:81], v11 offset:64
v_mfma_f32_16x16x32_bf16 v[44:47], a[164:167], a[180:183], v[44:47]
ds_read_b64_tr_b16 a[82:83], v11 offset:5184
v_mfma_f32_16x16x32_bf16 v[64:67], a[160:163], a[184:187], v[64:67]
buffer_load_dwordx4 v202, s[80:83], s47 offen offset:2048 lds
v_mfma_f32_16x16x32_bf16 v[64:67], a[164:167], a[188:191], v[64:67]
ds_read_b64_tr_b16 a[84:85], v11 offset:10304
v_mfma_f32_16x16x32_bf16 v[84:87], a[160:163], a[192:195], v[84:87]
ds_read_b64_tr_b16 a[86:87], v11 offset:15424
v_mfma_f32_16x16x32_bf16 v[84:87], a[164:167], a[196:199], v[84:87]
ds_read_b64_tr_b16 a[88:89], v205 offset:64
v_mfma_f32_16x16x32_bf16 v[104:107], a[160:163], a[200:203], v[104:107]
buffer_load_dwordx4 v203, s[80:83], s47 offen offset:3072 lds
v_mfma_f32_16x16x32_bf16 v[104:107], a[164:167], a[204:207], v[104:107]
s_add_u32 m0, s50, 65536
ds_read_b64_tr_b16 a[90:91], v205 offset:5184
v_mfma_f32_16x16x32_bf16 v[48:51], a[168:171], a[176:179], v[48:51]
ds_read_b64_tr_b16 a[92:93], v205 offset:10304
v_mfma_f32_16x16x32_bf16 v[48:51], a[172:175], a[180:183], v[48:51]
ds_read_b64_tr_b16 a[94:95], v205 offset:15424
v_mfma_f32_16x16x32_bf16 v[68:71], a[168:171], a[184:187], v[68:71]
buffer_load_dwordx4 v204, s[80:83], s47 offen lds
v_mfma_f32_16x16x32_bf16 v[68:71], a[172:175], a[188:191], v[68:71]
s_add_u32 s47, s47, 81920
ds_read_b64_tr_b16 a[96:97], v11 offset:128
v_mfma_f32_16x16x32_bf16 v[88:91], a[168:171], a[192:195], v[88:91]
ds_read_b64_tr_b16 a[98:99], v11 offset:5248
v_mfma_f32_16x16x32_bf16 v[88:91], a[172:175], a[196:199], v[88:91]
ds_read_b64_tr_b16 a[100:101], v11 offset:10368
v_mfma_f32_16x16x32_bf16 v[108:111], a[168:171], a[200:203], v[108:111]
ds_read_b64_tr_b16 a[102:103], v11 offset:15488
v_mfma_f32_16x16x32_bf16 v[108:111], a[172:175], a[204:207], v[108:111]
s_waitcnt lgkmcnt(8)
v_mfma_f32_16x16x32_bf16 v[32:35], a[64:67], a[104:107], v[32:35]
s_waitcnt vmcnt(18)
s_barrier
v_mfma_f32_16x16x32_bf16 v[32:35], a[68:71], a[108:111], v[32:35]
buffer_load_dwordx4 v[112:115], v2, s[16:19], s28 offen offset:0 sc1
v_mfma_f32_16x16x32_bf16 v[52:55], a[64:67], a[112:115], v[52:55]
ds_read_b64_tr_b16 a[136:137], v11 offset:20480
v_mfma_f32_16x16x32_bf16 v[52:55], a[68:71], a[116:119], v[52:55]
ds_read_b64_tr_b16 a[138:139], v11 offset:25600
v_mfma_f32_16x16x32_bf16 v[72:75], a[64:67], a[120:123], v[72:75]
ds_read_b64_tr_b16 a[140:141], v11 offset:30720
v_mfma_f32_16x16x32_bf16 v[72:75], a[68:71], a[124:127], v[72:75]
buffer_load_dwordx4 v[116:119], v3, s[16:19], s28 offen offset:0 sc1
v_mfma_f32_16x16x32_bf16 v[92:95], a[64:67], a[128:131], v[92:95]
ds_read_b64_tr_b16 a[142:143], v11 offset:35840
v_mfma_f32_16x16x32_bf16 v[92:95], a[68:71], a[132:135], v[92:95]
ds_read_b128 a[176:179], v12 offset:16384
v_mfma_f32_16x16x32_bf16 v[36:39], a[72:75], a[104:107], v[36:39]
ds_read_b128 a[184:187], v13 offset:16384
v_mfma_f32_16x16x32_bf16 v[36:39], a[76:79], a[108:111], v[36:39]
buffer_load_dwordx4 v[120:123], v4, s[16:19], s28 offen offset:0 sc1
v_mfma_f32_16x16x32_bf16 v[56:59], a[72:75], a[112:115], v[56:59]
ds_read_b128 a[192:195], v14 offset:16384
v_mfma_f32_16x16x32_bf16 v[56:59], a[76:79], a[116:119], v[56:59]
ds_read_b128 a[200:203], v15 offset:16384
v_mfma_f32_16x16x32_bf16 v[76:79], a[72:75], a[120:123], v[76:79]
ds_read_b128 a[180:183], v12 offset:17408
v_mfma_f32_16x16x32_bf16 v[76:79], a[76:79], a[124:127], v[76:79]
buffer_load_dwordx4 v[124:127], v5, s[16:19], s28 offen offset:0 sc1
v_mfma_f32_16x16x32_bf16 v[96:99], a[72:75], a[128:131], v[96:99]
ds_read_b128 a[188:191], v13 offset:17408
v_mfma_f32_16x16x32_bf16 v[96:99], a[76:79], a[132:135], v[96:99]
ds_read_b128 a[196:199], v14 offset:17408
v_mfma_f32_16x16x32_bf16 v[40:43], a[80:83], a[104:107], v[40:43]
ds_read_b128 a[204:207], v15 offset:17408
v_mfma_f32_16x16x32_bf16 v[40:43], a[84:87], a[108:111], v[40:43]
buffer_load_dwordx4 v[128:131], v2, s[16:19], s28 offen offset:1024 sc1
v_mfma_f32_16x16x32_bf16 v[60:63], a[80:83], a[112:115], v[60:63]
ds_read_b64_tr_b16 a[144:145], v205 offset:20480
v_mfma_f32_16x16x32_bf16 v[60:63], a[84:87], a[116:119], v[60:63]
ds_read_b64_tr_b16 a[146:147], v205 offset:25600
v_mfma_f32_16x16x32_bf16 v[80:83], a[80:83], a[120:123], v[80:83]
ds_read_b64_tr_b16 a[148:149], v205 offset:30720
v_mfma_f32_16x16x32_bf16 v[80:83], a[84:87], a[124:127], v[80:83]
buffer_load_dwordx4 v[132:135], v3, s[16:19], s28 offen offset:1024 sc1
v_mfma_f32_16x16x32_bf16 v[100:103], a[80:83], a[128:131], v[100:103]
ds_read_b64_tr_b16 a[150:151], v205 offset:35840
v_mfma_f32_16x16x32_bf16 v[100:103], a[84:87], a[132:135], v[100:103]
s_waitcnt lgkmcnt(4)
ds_read_b64_tr_b16 a[152:153], v11 offset:20544
v_mfma_f32_16x16x32_bf16 v[44:47], a[88:91], a[104:107], v[44:47]
ds_read_b64_tr_b16 a[154:155], v11 offset:25664
v_mfma_f32_16x16x32_bf16 v[44:47], a[92:95], a[108:111], v[44:47]
buffer_load_dwordx4 v[136:139], v4, s[16:19], s28 offen offset:1024 sc1
v_mfma_f32_16x16x32_bf16 v[64:67], a[88:91], a[112:115], v[64:67]
ds_read_b64_tr_b16 a[156:157], v11 offset:30784
v_mfma_f32_16x16x32_bf16 v[64:67], a[92:95], a[116:119], v[64:67]
ds_read_b64_tr_b16 a[158:159], v11 offset:35904
v_mfma_f32_16x16x32_bf16 v[84:87], a[88:91], a[120:123], v[84:87]
ds_read_b64_tr_b16 a[160:161], v205 offset:20544
v_mfma_f32_16x16x32_bf16 v[84:87], a[92:95], a[124:127], v[84:87]
buffer_load_dwordx4 v[140:143], v5, s[16:19], s28 offen offset:1024 sc1
v_mfma_f32_16x16x32_bf16 v[104:107], a[88:91], a[128:131], v[104:107]
ds_read_b64_tr_b16 a[162:163], v205 offset:25664
v_mfma_f32_16x16x32_bf16 v[104:107], a[92:95], a[132:135], v[104:107]
ds_read_b64_tr_b16 a[164:165], v205 offset:30784
v_mfma_f32_16x16x32_bf16 v[48:51], a[96:99], a[104:107], v[48:51]
ds_read_b64_tr_b16 a[166:167], v205 offset:35904
v_mfma_f32_16x16x32_bf16 v[48:51], a[100:103], a[108:111], v[48:51]
ds_read_b64_tr_b16 a[168:169], v11 offset:20608
v_mfma_f32_16x16x32_bf16 v[68:71], a[96:99], a[112:115], v[68:71]
ds_read_b64_tr_b16 a[170:171], v11 offset:25728
v_mfma_f32_16x16x32_bf16 v[68:71], a[100:103], a[116:119], v[68:71]
ds_read_b64_tr_b16 a[172:173], v11 offset:30848
v_mfma_f32_16x16x32_bf16 v[88:91], a[96:99], a[120:123], v[88:91]
ds_read_b64_tr_b16 a[174:175], v11 offset:35968
v_mfma_f32_16x16x32_bf16 v[88:91], a[100:103], a[124:127], v[88:91]
v_mfma_f32_16x16x32_bf16 v[108:111], a[96:99], a[128:131], v[108:111]
v_mfma_f32_16x16x32_bf16 v[108:111], a[100:103], a[132:135], v[108:111]
s_waitcnt lgkmcnt(8)
v_mfma_f32_16x16x32_bf16 v[32:35], a[136:139], a[176:179], v[32:35]
s_waitcnt vmcnt(17)
s_barrier
v_mfma_f32_16x16x32_bf16 v[32:35], a[140:143], a[180:183], v[32:35]
buffer_load_dwordx4 v[144:147], v2, s[16:19], s28 offen offset:2048 sc1
v_mfma_f32_16x16x32_bf16 v[52:55], a[136:139], a[184:187], v[52:55]
ds_read_b64_tr_b16 a[64:65], v8 offset:0
v_mfma_f32_16x16x32_bf16 v[52:55], a[140:143], a[188:191], v[52:55]
ds_read_b64_tr_b16 a[66:67], v8 offset:5120
v_mfma_f32_16x16x32_bf16 v[72:75], a[136:139], a[192:195], v[72:75]
ds_read_b64_tr_b16 a[68:69], v8 offset:10240
v_mfma_f32_16x16x32_bf16 v[72:75], a[140:143], a[196:199], v[72:75]
buffer_load_dwordx4 v[148:151], v3, s[16:19], s28 offen offset:2048 sc1
v_mfma_f32_16x16x32_bf16 v[92:95], a[136:139], a[200:203], v[92:95]
ds_read_b64_tr_b16 a[70:71], v8 offset:15360
v_mfma_f32_16x16x32_bf16 v[92:95], a[140:143], a[204:207], v[92:95]
ds_read_b128 a[104:107], v12 offset:32768
v_mfma_f32_16x16x32_bf16 v[36:39], a[144:147], a[176:179], v[36:39]
ds_read_b128 a[112:115], v13 offset:32768
v_mfma_f32_16x16x32_bf16 v[36:39], a[148:151], a[180:183], v[36:39]
buffer_load_dwordx4 v[152:155], v4, s[16:19], s28 offen offset:2048 sc1
v_mfma_f32_16x16x32_bf16 v[56:59], a[144:147], a[184:187], v[56:59]
ds_read_b128 a[120:123], v14 offset:32768
v_mfma_f32_16x16x32_bf16 v[56:59], a[148:151], a[188:191], v[56:59]
ds_read_b128 a[128:131], v15 offset:32768
v_mfma_f32_16x16x32_bf16 v[76:79], a[144:147], a[192:195], v[76:79]
ds_read_b128 a[108:111], v12 offset:33792
v_mfma_f32_16x16x32_bf16 v[76:79], a[148:151], a[196:199], v[76:79]
buffer_load_dwordx4 v[156:159], v5, s[16:19], s28 offen offset:2048 sc1
v_mfma_f32_16x16x32_bf16 v[96:99], a[144:147], a[200:203], v[96:99]
ds_read_b128 a[116:119], v13 offset:33792
v_mfma_f32_16x16x32_bf16 v[96:99], a[148:151], a[204:207], v[96:99]
ds_read_b128 a[124:127], v14 offset:33792
v_mfma_f32_16x16x32_bf16 v[40:43], a[152:155], a[176:179], v[40:43]
ds_read_b128 a[132:135], v15 offset:33792
v_mfma_f32_16x16x32_bf16 v[40:43], a[156:159], a[180:183], v[40:43]
buffer_load_dwordx4 v[160:163], v2, s[16:19], s28 offen offset:3072 sc1
v_mfma_f32_16x16x32_bf16 v[60:63], a[152:155], a[184:187], v[60:63]
ds_read_b64_tr_b16 a[72:73], v206 offset:0
v_mfma_f32_16x16x32_bf16 v[60:63], a[156:159], a[188:191], v[60:63]
ds_read_b64_tr_b16 a[74:75], v206 offset:5120
v_mfma_f32_16x16x32_bf16 v[80:83], a[152:155], a[192:195], v[80:83]
ds_read_b64_tr_b16 a[76:77], v206 offset:10240
v_mfma_f32_16x16x32_bf16 v[80:83], a[156:159], a[196:199], v[80:83]
buffer_load_dwordx4 v[164:167], v3, s[16:19], s28 offen offset:3072 sc1
v_mfma_f32_16x16x32_bf16 v[100:103], a[152:155], a[200:203], v[100:103]
ds_read_b64_tr_b16 a[78:79], v206 offset:15360
v_mfma_f32_16x16x32_bf16 v[100:103], a[156:159], a[204:207], v[100:103]
s_waitcnt lgkmcnt(4)
ds_read_b64_tr_b16 a[80:81], v8 offset:64
v_mfma_f32_16x16x32_bf16 v[44:47], a[160:163], a[176:179], v[44:47]
ds_read_b64_tr_b16 a[82:83], v8 offset:5184
v_mfma_f32_16x16x32_bf16 v[44:47], a[164:167], a[180:183], v[44:47]
buffer_load_dwordx4 v[168:171], v4, s[16:19], s28 offen offset:3072 sc1
v_mfma_f32_16x16x32_bf16 v[64:67], a[160:163], a[184:187], v[64:67]
ds_read_b64_tr_b16 a[84:85], v8 offset:10304
v_mfma_f32_16x16x32_bf16 v[64:67], a[164:167], a[188:191], v[64:67]
ds_read_b64_tr_b16 a[86:87], v8 offset:15424
v_mfma_f32_16x16x32_bf16 v[84:87], a[160:163], a[192:195], v[84:87]
ds_read_b64_tr_b16 a[88:89], v206 offset:64
v_mfma_f32_16x16x32_bf16 v[84:87], a[164:167], a[196:199], v[84:87]
buffer_load_dwordx4 v[172:175], v5, s[16:19], s28 offen offset:3072 sc1
v_mfma_f32_16x16x32_bf16 v[104:107], a[160:163], a[200:203], v[104:107]
ds_read_b64_tr_b16 a[90:91], v206 offset:5184
v_mfma_f32_16x16x32_bf16 v[104:107], a[164:167], a[204:207], v[104:107]
ds_read_b64_tr_b16 a[92:93], v206 offset:10304
v_mfma_f32_16x16x32_bf16 v[48:51], a[168:171], a[176:179], v[48:51]
ds_read_b64_tr_b16 a[94:95], v206 offset:15424
v_mfma_f32_16x16x32_bf16 v[48:51], a[172:175], a[180:183], v[48:51]
ds_read_b64_tr_b16 a[96:97], v8 offset:128
v_mfma_f32_16x16x32_bf16 v[68:71], a[168:171], a[184:187], v[68:71]
ds_read_b64_tr_b16 a[98:99], v8 offset:5248
v_mfma_f32_16x16x32_bf16 v[68:71], a[172:175], a[188:191], v[68:71]
ds_read_b64_tr_b16 a[100:101], v8 offset:10368
v_mfma_f32_16x16x32_bf16 v[88:91], a[168:171], a[192:195], v[88:91]
ds_read_b64_tr_b16 a[102:103], v8 offset:15488
v_mfma_f32_16x16x32_bf16 v[88:91], a[172:175], a[196:199], v[88:91]
v_mfma_f32_16x16x32_bf16 v[108:111], a[168:171], a[200:203], v[108:111]
v_mfma_f32_16x16x32_bf16 v[108:111], a[172:175], a[204:207], v[108:111]
s_waitcnt lgkmcnt(8)
v_mfma_f32_16x16x32_bf16 v[32:35], a[64:67], a[104:107], v[32:35]
s_waitcnt vmcnt(16)
s_barrier
v_mfma_f32_16x16x32_bf16 v[32:35], a[68:71], a[108:111], v[32:35]
s_add_u32 s28, s28, 4096
v_lshlrev_b32 v9, 2, v1
v_mfma_f32_16x16x32_bf16 v[52:55], a[64:67], a[112:115], v[52:55]
buffer_load_dword v176, v9, s[16:19], s28 offen offset:0 sc1
v_mfma_f32_16x16x32_bf16 v[52:55], a[68:71], a[116:119], v[52:55]
ds_read_b64_tr_b16 a[136:137], v8 offset:20480
v_mfma_f32_16x16x32_bf16 v[72:75], a[64:67], a[120:123], v[72:75]
ds_read_b64_tr_b16 a[138:139], v8 offset:25600
v_mfma_f32_16x16x32_bf16 v[72:75], a[68:71], a[124:127], v[72:75]
ds_read_b64_tr_b16 a[140:141], v8 offset:30720
v_mfma_f32_16x16x32_bf16 v[92:95], a[64:67], a[128:131], v[92:95]
buffer_load_dword v177, v9, s[16:19], s28 offen offset:256 sc1
v_mfma_f32_16x16x32_bf16 v[92:95], a[68:71], a[132:135], v[92:95]
ds_read_b64_tr_b16 a[142:143], v8 offset:35840
v_mfma_f32_16x16x32_bf16 v[36:39], a[72:75], a[104:107], v[36:39]
ds_read_b128 a[176:179], v12 offset:49152
v_mfma_f32_16x16x32_bf16 v[36:39], a[76:79], a[108:111], v[36:39]
ds_read_b128 a[184:187], v13 offset:49152
v_mfma_f32_16x16x32_bf16 v[56:59], a[72:75], a[112:115], v[56:59]
buffer_load_dword v178, v9, s[16:19], s28 offen offset:512 sc1
v_mfma_f32_16x16x32_bf16 v[56:59], a[76:79], a[116:119], v[56:59]
ds_read_b128 a[192:195], v14 offset:49152
v_mfma_f32_16x16x32_bf16 v[76:79], a[72:75], a[120:123], v[76:79]
ds_read_b128 a[200:203], v15 offset:49152
v_mfma_f32_16x16x32_bf16 v[76:79], a[76:79], a[124:127], v[76:79]
ds_read_b128 a[180:183], v12 offset:50176
v_mfma_f32_16x16x32_bf16 v[96:99], a[72:75], a[128:131], v[96:99]
buffer_load_dword v179, v9, s[16:19], s28 offen offset:768 sc1
v_mfma_f32_16x16x32_bf16 v[96:99], a[76:79], a[132:135], v[96:99]
s_add_u32 s28, s28, 20480
ds_read_b128 a[188:191], v13 offset:50176
v_mfma_f32_16x16x32_bf16 v[40:43], a[80:83], a[104:107], v[40:43]
ds_read_b128 a[196:199], v14 offset:50176
v_mfma_f32_16x16x32_bf16 v[40:43], a[84:87], a[108:111], v[40:43]
ds_read_b128 a[204:207], v15 offset:50176
v_mfma_f32_16x16x32_bf16 v[60:63], a[80:83], a[112:115], v[60:63]
buffer_load_dword v180, v9, s[16:19], s28 offen offset:0 sc1
v_mfma_f32_16x16x32_bf16 v[60:63], a[84:87], a[116:119], v[60:63]
ds_read_b64_tr_b16 a[144:145], v206 offset:20480
v_mfma_f32_16x16x32_bf16 v[80:83], a[80:83], a[120:123], v[80:83]
ds_read_b64_tr_b16 a[146:147], v206 offset:25600
v_mfma_f32_16x16x32_bf16 v[80:83], a[84:87], a[124:127], v[80:83]
ds_read_b64_tr_b16 a[148:149], v206 offset:30720
v_mfma_f32_16x16x32_bf16 v[100:103], a[80:83], a[128:131], v[100:103]
buffer_load_dword v181, v9, s[16:19], s28 offen offset:256 sc1
v_mfma_f32_16x16x32_bf16 v[100:103], a[84:87], a[132:135], v[100:103]
s_waitcnt lgkmcnt(3)
ds_read_b64_tr_b16 a[150:151], v206 offset:35840
v_mfma_f32_16x16x32_bf16 v[44:47], a[88:91], a[104:107], v[44:47]
ds_read_b64_tr_b16 a[152:153], v8 offset:20544
v_mfma_f32_16x16x32_bf16 v[44:47], a[92:95], a[108:111], v[44:47]
ds_read_b64_tr_b16 a[154:155], v8 offset:25664
v_mfma_f32_16x16x32_bf16 v[64:67], a[88:91], a[112:115], v[64:67]
buffer_load_dword v182, v9, s[16:19], s28 offen offset:512 sc1
v_mfma_f32_16x16x32_bf16 v[64:67], a[92:95], a[116:119], v[64:67]
ds_read_b64_tr_b16 a[156:157], v8 offset:30784
v_mfma_f32_16x16x32_bf16 v[84:87], a[88:91], a[120:123], v[84:87]
ds_read_b64_tr_b16 a[158:159], v8 offset:35904
v_mfma_f32_16x16x32_bf16 v[84:87], a[92:95], a[124:127], v[84:87]
ds_read_b64_tr_b16 a[160:161], v206 offset:20544
v_mfma_f32_16x16x32_bf16 v[104:107], a[88:91], a[128:131], v[104:107]
buffer_load_dword v183, v9, s[16:19], s28 offen offset:768 sc1
v_mfma_f32_16x16x32_bf16 v[104:107], a[92:95], a[132:135], v[104:107]
ds_read_b64_tr_b16 a[162:163], v206 offset:25664
v_mfma_f32_16x16x32_bf16 v[48:51], a[96:99], a[104:107], v[48:51]
ds_read_b64_tr_b16 a[164:165], v206 offset:30784
v_mfma_f32_16x16x32_bf16 v[48:51], a[100:103], a[108:111], v[48:51]
ds_read_b64_tr_b16 a[166:167], v206 offset:35904
v_mfma_f32_16x16x32_bf16 v[68:71], a[96:99], a[112:115], v[68:71]
ds_read_b64_tr_b16 a[168:169], v8 offset:20608
v_mfma_f32_16x16x32_bf16 v[68:71], a[100:103], a[116:119], v[68:71]
ds_read_b64_tr_b16 a[170:171], v8 offset:25728
v_mfma_f32_16x16x32_bf16 v[88:91], a[96:99], a[120:123], v[88:91]
ds_read_b64_tr_b16 a[172:173], v8 offset:30848
v_mfma_f32_16x16x32_bf16 v[88:91], a[100:103], a[124:127], v[88:91]
ds_read_b64_tr_b16 a[174:175], v8 offset:35968
v_mfma_f32_16x16x32_bf16 v[108:111], a[96:99], a[128:131], v[108:111]
v_mfma_f32_16x16x32_bf16 v[108:111], a[100:103], a[132:135], v[108:111]
s_waitcnt lgkmcnt(8)
v_mfma_f32_16x16x32_bf16 v[32:35], a[136:139], a[176:179], v[32:35]
v_mfma_f32_16x16x32_bf16 v[32:35], a[140:143], a[180:183], v[32:35]
s_add_u32 s28, s28, 20480
v_mfma_f32_16x16x32_bf16 v[52:55], a[136:139], a[184:187], v[52:55]
buffer_load_dword v184, v9, s[16:19], s28 offen offset:0 sc1
v_mfma_f32_16x16x32_bf16 v[52:55], a[140:143], a[188:191], v[52:55]
v_mfma_f32_16x16x32_bf16 v[72:75], a[136:139], a[192:195], v[72:75]
v_mfma_f32_16x16x32_bf16 v[72:75], a[140:143], a[196:199], v[72:75]
v_mfma_f32_16x16x32_bf16 v[92:95], a[136:139], a[200:203], v[92:95]
buffer_load_dword v185, v9, s[16:19], s28 offen offset:256 sc1
v_mfma_f32_16x16x32_bf16 v[92:95], a[140:143], a[204:207], v[92:95]
v_mfma_f32_16x16x32_bf16 v[36:39], a[144:147], a[176:179], v[36:39]
v_mfma_f32_16x16x32_bf16 v[36:39], a[148:151], a[180:183], v[36:39]
v_mfma_f32_16x16x32_bf16 v[56:59], a[144:147], a[184:187], v[56:59]
buffer_load_dword v186, v9, s[16:19], s28 offen offset:512 sc1
v_mfma_f32_16x16x32_bf16 v[56:59], a[148:151], a[188:191], v[56:59]
v_mfma_f32_16x16x32_bf16 v[76:79], a[144:147], a[192:195], v[76:79]
v_mfma_f32_16x16x32_bf16 v[76:79], a[148:151], a[196:199], v[76:79]
v_mfma_f32_16x16x32_bf16 v[96:99], a[144:147], a[200:203], v[96:99]
buffer_load_dword v187, v9, s[16:19], s28 offen offset:768 sc1
v_mfma_f32_16x16x32_bf16 v[96:99], a[148:151], a[204:207], v[96:99]
s_add_u32 s28, s28, 20480
v_mfma_f32_16x16x32_bf16 v[40:43], a[152:155], a[176:179], v[40:43]
v_mfma_f32_16x16x32_bf16 v[40:43], a[156:159], a[180:183], v[40:43]
v_mfma_f32_16x16x32_bf16 v[60:63], a[152:155], a[184:187], v[60:63]
buffer_load_dword v188, v9, s[16:19], s28 offen offset:0 sc1
v_mfma_f32_16x16x32_bf16 v[60:63], a[156:159], a[188:191], v[60:63]
v_mfma_f32_16x16x32_bf16 v[80:83], a[152:155], a[192:195], v[80:83]
v_mfma_f32_16x16x32_bf16 v[80:83], a[156:159], a[196:199], v[80:83]
v_mfma_f32_16x16x32_bf16 v[100:103], a[152:155], a[200:203], v[100:103]
buffer_load_dword v189, v9, s[16:19], s28 offen offset:256 sc1
v_mfma_f32_16x16x32_bf16 v[100:103], a[156:159], a[204:207], v[100:103]
s_waitcnt lgkmcnt(0)
v_mfma_f32_16x16x32_bf16 v[44:47], a[160:163], a[176:179], v[44:47]
v_mfma_f32_16x16x32_bf16 v[44:47], a[164:167], a[180:183], v[44:47]
v_mfma_f32_16x16x32_bf16 v[64:67], a[160:163], a[184:187], v[64:67]
buffer_load_dword v190, v9, s[16:19], s28 offen offset:512 sc1
v_mfma_f32_16x16x32_bf16 v[64:67], a[164:167], a[188:191], v[64:67]
v_mfma_f32_16x16x32_bf16 v[84:87], a[160:163], a[192:195], v[84:87]
v_mfma_f32_16x16x32_bf16 v[84:87], a[164:167], a[196:199], v[84:87]
v_mfma_f32_16x16x32_bf16 v[104:107], a[160:163], a[200:203], v[104:107]
buffer_load_dword v191, v9, s[16:19], s28 offen offset:768 sc1
v_mfma_f32_16x16x32_bf16 v[104:107], a[164:167], a[204:207], v[104:107]
v_mfma_f32_16x16x32_bf16 v[48:51], a[168:171], a[176:179], v[48:51]
v_mfma_f32_16x16x32_bf16 v[48:51], a[172:175], a[180:183], v[48:51]
v_mfma_f32_16x16x32_bf16 v[68:71], a[168:171], a[184:187], v[68:71]
v_mfma_f32_16x16x32_bf16 v[68:71], a[172:175], a[188:191], v[68:71]
v_mfma_f32_16x16x32_bf16 v[88:91], a[168:171], a[192:195], v[88:91]
v_mfma_f32_16x16x32_bf16 v[88:91], a[172:175], a[196:199], v[88:91]
v_mfma_f32_16x16x32_bf16 v[108:111], a[168:171], a[200:203], v[108:111]
v_mfma_f32_16x16x32_bf16 v[108:111], a[172:175], a[204:207], v[108:111]
s_mul_i32 s32, s49, 122880
s_mul_i32 s33, s3, 2560
s_add_u32 s32, s32, s33
s_add_u32 s32, s32, 65011712
v_lshlrev_b32 v10, 3, v1
s_add_u32 s33, s46, 1
s_and_b32 s33, s33, 3
s_mul_i32 s33, s33, 30720
s_add_u32 s33, s33, s32
v_cvt_pk_bf16_f32 v52, v52, v53
v_cvt_pk_bf16_f32 v53, v54, v55
v_cvt_pk_bf16_f32 v54, v56, v57
v_cvt_pk_bf16_f32 v55, v58, v59
v_cvt_pk_bf16_f32 v56, v60, v61
v_cvt_pk_bf16_f32 v57, v62, v63
v_cvt_pk_bf16_f32 v58, v64, v65
v_cvt_pk_bf16_f32 v59, v66, v67
v_cvt_pk_bf16_f32 v60, v68, v69
v_cvt_pk_bf16_f32 v61, v70, v71
buffer_store_dwordx4 v[52:55], v16, s[16:19], s33 offen sc1
buffer_store_dwordx4 v[56:59], v16, s[16:19], s33 offen offset:1024 sc1
buffer_store_dwordx2 v[60:61], v10, s[16:19], s33 offen offset:2048 sc1
s_add_u32 s33, s46, 2
s_and_b32 s33, s33, 3
s_mul_i32 s33, s33, 30720
s_add_u32 s33, s33, s32
s_add_u32 s33, s33, 10240
v_cvt_pk_bf16_f32 v72, v72, v73
v_cvt_pk_bf16_f32 v73, v74, v75
v_cvt_pk_bf16_f32 v74, v76, v77
v_cvt_pk_bf16_f32 v75, v78, v79
v_cvt_pk_bf16_f32 v76, v80, v81
v_cvt_pk_bf16_f32 v77, v82, v83
v_cvt_pk_bf16_f32 v78, v84, v85
v_cvt_pk_bf16_f32 v79, v86, v87
v_cvt_pk_bf16_f32 v80, v88, v89
v_cvt_pk_bf16_f32 v81, v90, v91
buffer_store_dwordx4 v[72:75], v16, s[16:19], s33 offen sc1
buffer_store_dwordx4 v[76:79], v16, s[16:19], s33 offen offset:1024 sc1
buffer_store_dwordx2 v[80:81], v10, s[16:19], s33 offen offset:2048 sc1
s_add_u32 s33, s46, 3
s_and_b32 s33, s33, 3
s_mul_i32 s33, s33, 30720
s_add_u32 s33, s33, s32
s_add_u32 s33, s33, 20480
v_cvt_pk_bf16_f32 v92, v92, v93
v_cvt_pk_bf16_f32 v93, v94, v95
v_cvt_pk_bf16_f32 v94, v96, v97
v_cvt_pk_bf16_f32 v95, v98, v99
v_cvt_pk_bf16_f32 v96, v100, v101
v_cvt_pk_bf16_f32 v97, v102, v103
v_cvt_pk_bf16_f32 v98, v104, v105
v_cvt_pk_bf16_f32 v99, v106, v107
v_cvt_pk_bf16_f32 v100, v108, v109
v_cvt_pk_bf16_f32 v101, v110, v111
buffer_store_dwordx4 v[92:95], v16, s[16:19], s33 offen sc1
buffer_store_dwordx4 v[96:99], v16, s[16:19], s33 offen offset:1024 sc1
buffer_store_dwordx2 v[100:101], v10, s[16:19], s33 offen offset:2048 sc1
s_mul_i32 s47, s46, 30720
s_add_u32 s47, s47, s32
s_waitcnt vmcnt(9)
v_mfma_f32_16x16x32_bf16 a[64:67], a[0:3], v[112:115], 0
s_mul_i32 s32, s3, 5120
v_add_u32 v17, s32, v16
v_add_u32 v19, 40960, v17
v_mfma_f32_16x16x32_bf16 a[64:67], a[20:23], v[128:131], a[64:67]
s_mul_i32 s32, s3, 20480
v_add_u32 v18, s32, v16
v_and_b32 v7, 15, v1
v_mfma_f32_16x16x32_bf16 a[64:67], a[40:43], v[144:147], a[64:67]
v_mul_u32_u24 v7, 2560, v7
v_lshrrev_b32 v24, 4, v1
v_mfma_f32_16x16x32_bf16 a[64:67], a[60:63], v[160:163], a[64:67]
v_lshl_add_u32 v7, v24, 3, v7
v_mfma_f32_16x16x32_bf16 a[64:67], a[244:247], v[176:179], a[64:67]
s_lshl_b32 s34, s6, 2
s_add_u32 s34, s34, s3
s_mul_i32 s34, s34, 40960
v_mfma_f32_16x16x32_bf16 a[68:71], a[0:3], v[116:119], 0
s_mul_i32 s33, s7, 160
s_add_u32 s34, s34, s33
s_lshl_b32 s48, s44, 3
v_mfma_f32_16x16x32_bf16 a[68:71], a[20:23], v[132:135], a[68:71]
s_and_b32 s33, s3, 1
s_lshl_b32 s33, s33, 2
s_add_u32 s48, s48, s33
v_mfma_f32_16x16x32_bf16 a[68:71], a[40:43], v[148:151], a[68:71]
s_add_u32 s48, s48, s46
s_mul_i32 s48, s48, 40960
s_lshl_b32 s33, s45, 1
v_mfma_f32_16x16x32_bf16 a[68:71], a[60:63], v[164:167], a[68:71]
s_lshr_b32 s32, s3, 1
s_add_u32 s33, s33, s32
s_mul_i32 s33, s33, 160
v_mfma_f32_16x16x32_bf16 a[68:71], a[244:247], v[180:183], a[68:71]
s_add_u32 s48, s48, s33
v_mfma_f32_16x16x32_bf16 a[72:75], a[0:3], v[120:123], 0
v_mfma_f32_16x16x32_bf16 a[72:75], a[20:23], v[136:139], a[72:75]
v_mfma_f32_16x16x32_bf16 a[72:75], a[40:43], v[152:155], a[72:75]
v_mfma_f32_16x16x32_bf16 a[72:75], a[60:63], v[168:171], a[72:75]
v_mfma_f32_16x16x32_bf16 a[72:75], a[244:247], v[184:187], a[72:75]
v_mfma_f32_16x16x32_bf16 a[76:79], a[0:3], v[124:127], 0
v_mfma_f32_16x16x32_bf16 a[76:79], a[20:23], v[140:143], a[76:79]
v_mfma_f32_16x16x32_bf16 a[76:79], a[40:43], v[156:159], a[76:79]
v_mfma_f32_16x16x32_bf16 a[76:79], a[60:63], v[172:175], a[76:79]
v_mfma_f32_16x16x32_bf16 a[76:79], a[244:247], v[188:191], a[76:79]
v_mfma_f32_16x16x32_bf16 a[80:83], a[4:7], v[112:115], 0
s_barrier
v_mfma_f32_16x16x32_bf16 a[80:83], a[24:27], v[128:131], a[80:83]
ds_write_b128 v17, a[64:67] offset:0
v_mfma_f32_16x16x32_bf16 a[80:83], a[44:47], v[144:147], a[80:83]
ds_write_b128 v17, a[68:71] offset:20480
v_mfma_f32_16x16x32_bf16 a[80:83], a[228:231], v[160:163], a[80:83]
ds_write_b128 v19, a[72:75] offset:0
v_mfma_f32_16x16x32_bf16 a[80:83], a[248:251], v[176:179], a[80:83]
v_mfma_f32_16x16x32_bf16 a[84:87], a[4:7], v[116:119], 0
v_mfma_f32_16x16x32_bf16 a[84:87], a[24:27], v[132:135], a[84:87]
v_mfma_f32_16x16x32_bf16 a[84:87], a[44:47], v[148:151], a[84:87]
ds_write_b128 v19, a[76:79] offset:20480
v_mfma_f32_16x16x32_bf16 a[84:87], a[228:231], v[164:167], a[84:87]
v_mfma_f32_16x16x32_bf16 a[84:87], a[248:251], v[180:183], a[84:87]
v_mfma_f32_16x16x32_bf16 a[88:91], a[4:7], v[120:123], 0
v_mfma_f32_16x16x32_bf16 a[88:91], a[24:27], v[136:139], a[88:91]
v_mfma_f32_16x16x32_bf16 a[88:91], a[44:47], v[152:155], a[88:91]
ds_write_b128 v17, a[80:83] offset:1024
v_mfma_f32_16x16x32_bf16 a[88:91], a[228:231], v[168:171], a[88:91]
v_mfma_f32_16x16x32_bf16 a[88:91], a[248:251], v[184:187], a[88:91]
v_mfma_f32_16x16x32_bf16 a[92:95], a[4:7], v[124:127], 0
v_mfma_f32_16x16x32_bf16 a[92:95], a[24:27], v[140:143], a[92:95]
v_mfma_f32_16x16x32_bf16 a[92:95], a[44:47], v[156:159], a[92:95]
ds_write_b128 v17, a[84:87] offset:21504
v_mfma_f32_16x16x32_bf16 a[92:95], a[228:231], v[172:175], a[92:95]
v_mfma_f32_16x16x32_bf16 a[92:95], a[248:251], v[188:191], a[92:95]
v_mfma_f32_16x16x32_bf16 a[96:99], a[8:11], v[112:115], 0
v_mfma_f32_16x16x32_bf16 a[96:99], a[28:31], v[128:131], a[96:99]
v_mfma_f32_16x16x32_bf16 a[96:99], a[48:51], v[144:147], a[96:99]
ds_write_b128 v19, a[88:91] offset:1024
v_mfma_f32_16x16x32_bf16 a[96:99], a[232:235], v[160:163], a[96:99]
v_mfma_f32_16x16x32_bf16 a[96:99], a[252:255], v[176:179], a[96:99]
v_mfma_f32_16x16x32_bf16 a[100:103], a[8:11], v[116:119], 0
v_mfma_f32_16x16x32_bf16 a[100:103], a[28:31], v[132:135], a[100:103]
v_mfma_f32_16x16x32_bf16 a[100:103], a[48:51], v[148:151], a[100:103]
ds_write_b128 v19, a[92:95] offset:21504
v_mfma_f32_16x16x32_bf16 a[100:103], a[232:235], v[164:167], a[100:103]
v_mfma_f32_16x16x32_bf16 a[100:103], a[252:255], v[180:183], a[100:103]
v_mfma_f32_16x16x32_bf16 a[104:107], a[8:11], v[120:123], 0
v_mfma_f32_16x16x32_bf16 a[104:107], a[28:31], v[136:139], a[104:107]
v_mfma_f32_16x16x32_bf16 a[104:107], a[48:51], v[152:155], a[104:107]
ds_write_b128 v17, a[96:99] offset:2048
v_mfma_f32_16x16x32_bf16 a[104:107], a[232:235], v[168:171], a[104:107]
v_mfma_f32_16x16x32_bf16 a[104:107], a[252:255], v[184:187], a[104:107]
v_mfma_f32_16x16x32_bf16 a[108:111], a[8:11], v[124:127], 0
v_mfma_f32_16x16x32_bf16 a[108:111], a[28:31], v[140:143], a[108:111]
v_mfma_f32_16x16x32_bf16 a[108:111], a[48:51], v[156:159], a[108:111]
ds_write_b128 v17, a[100:103] offset:22528
v_mfma_f32_16x16x32_bf16 a[108:111], a[232:235], v[172:175], a[108:111]
v_mfma_f32_16x16x32_bf16 a[108:111], a[252:255], v[188:191], a[108:111]
v_mfma_f32_16x16x32_bf16 a[112:115], a[12:15], v[112:115], 0
v_mfma_f32_16x16x32_bf16 a[112:115], a[32:35], v[128:131], a[112:115]
v_mfma_f32_16x16x32_bf16 a[112:115], a[52:55], v[144:147], a[112:115]
ds_write_b128 v19, a[104:107] offset:2048
v_mfma_f32_16x16x32_bf16 a[112:115], a[236:239], v[160:163], a[112:115]
v_mfma_f32_16x16x32_bf16 a[112:115], v[192:195], v[176:179], a[112:115]
v_mfma_f32_16x16x32_bf16 a[116:119], a[12:15], v[116:119], 0
v_mfma_f32_16x16x32_bf16 a[116:119], a[32:35], v[132:135], a[116:119]
v_mfma_f32_16x16x32_bf16 a[116:119], a[52:55], v[148:151], a[116:119]
ds_write_b128 v19, a[108:111] offset:22528
v_mfma_f32_16x16x32_bf16 a[116:119], a[236:239], v[164:167], a[116:119]
v_mfma_f32_16x16x32_bf16 a[116:119], v[192:195], v[180:183], a[116:119]
v_mfma_f32_16x16x32_bf16 a[120:123], a[12:15], v[120:123], 0
v_mfma_f32_16x16x32_bf16 a[120:123], a[32:35], v[136:139], a[120:123]
v_mfma_f32_16x16x32_bf16 a[120:123], a[52:55], v[152:155], a[120:123]
ds_write_b128 v17, a[112:115] offset:3072
v_mfma_f32_16x16x32_bf16 a[120:123], a[236:239], v[168:171], a[120:123]
v_mfma_f32_16x16x32_bf16 a[120:123], v[192:195], v[184:187], a[120:123]
v_mfma_f32_16x16x32_bf16 a[124:127], a[12:15], v[124:127], 0
v_mfma_f32_16x16x32_bf16 a[124:127], a[32:35], v[140:143], a[124:127]
v_mfma_f32_16x16x32_bf16 a[124:127], a[52:55], v[156:159], a[124:127]
ds_write_b128 v17, a[116:119] offset:23552
v_mfma_f32_16x16x32_bf16 a[124:127], a[236:239], v[172:175], a[124:127]
v_mfma_f32_16x16x32_bf16 a[124:127], v[192:195], v[188:191], a[124:127]
v_mfma_f32_16x16x32_bf16 a[128:131], a[16:19], v[112:115], 0
v_mfma_f32_16x16x32_bf16 a[128:131], a[36:39], v[128:131], a[128:131]
v_mfma_f32_16x16x32_bf16 a[128:131], a[56:59], v[144:147], a[128:131]
ds_write_b128 v19, a[120:123] offset:3072
v_mfma_f32_16x16x32_bf16 a[128:131], a[240:243], v[160:163], a[128:131]
v_mfma_f32_16x16x32_bf16 a[128:131], v[196:199], v[176:179], a[128:131]
v_mfma_f32_16x16x32_bf16 a[132:135], a[16:19], v[116:119], 0
v_mfma_f32_16x16x32_bf16 a[132:135], a[36:39], v[132:135], a[132:135]
v_mfma_f32_16x16x32_bf16 a[132:135], a[56:59], v[148:151], a[132:135]
ds_write_b128 v19, a[124:127] offset:23552
v_mfma_f32_16x16x32_bf16 a[132:135], a[240:243], v[164:167], a[132:135]
v_mfma_f32_16x16x32_bf16 a[132:135], v[196:199], v[180:183], a[132:135]
v_mfma_f32_16x16x32_bf16 a[136:139], a[16:19], v[120:123], 0
v_mfma_f32_16x16x32_bf16 a[136:139], a[36:39], v[136:139], a[136:139]
v_mfma_f32_16x16x32_bf16 a[136:139], a[56:59], v[152:155], a[136:139]
ds_write_b128 v17, a[128:131] offset:4096
v_mfma_f32_16x16x32_bf16 a[136:139], a[240:243], v[168:171], a[136:139]
v_mfma_f32_16x16x32_bf16 a[136:139], v[196:199], v[184:187], a[136:139]
v_mfma_f32_16x16x32_bf16 a[140:143], a[16:19], v[124:127], 0
v_mfma_f32_16x16x32_bf16 a[140:143], a[36:39], v[140:143], a[140:143]
v_mfma_f32_16x16x32_bf16 a[140:143], a[56:59], v[156:159], a[140:143]
ds_write_b128 v17, a[132:135] offset:24576
v_mfma_f32_16x16x32_bf16 a[140:143], a[240:243], v[172:175], a[140:143]
v_mfma_f32_16x16x32_bf16 a[140:143], v[196:199], v[188:191], a[140:143]
s_nop 7
ds_write_b128 v19, a[136:139] offset:4096
ds_write_b128 v19, a[140:143] offset:24576
s_waitcnt lgkmcnt(0)
s_barrier
s_add_u32 s46, s47, 10240
s_add_u32 s50, s47, 20480
buffer_load_dwordx4 v[52:55], v16, s[16:19], s47 offen sc1
buffer_load_dwordx4 v[56:59], v16, s[16:19], s47 offen offset:1024 sc1
buffer_load_dwordx2 v[60:61], v10, s[16:19], s47 offen offset:2048 sc1
buffer_load_dwordx4 v[64:67], v16, s[16:19], s46 offen sc1
buffer_load_dwordx4 v[68:71], v16, s[16:19], s46 offen offset:1024 sc1
buffer_load_dwordx2 v[72:73], v10, s[16:19], s46 offen offset:2048 sc1
buffer_load_dwordx4 v[74:77], v16, s[16:19], s50 offen sc1
buffer_load_dwordx4 v[78:81], v16, s[16:19], s50 offen offset:1024 sc1
buffer_load_dwordx2 v[82:83], v10, s[16:19], s50 offen offset:2048 sc1
ds_read_b128 v[112:115], v18 offset:0
ds_read_b128 v[116:119], v18 offset:5120
ds_read_b128 v[120:123], v18 offset:10240
ds_read_b128 v[124:127], v18 offset:15360
ds_read_b128 v[128:131], v18 offset:1024
ds_read_b128 v[132:135], v18 offset:6144
ds_read_b128 v[136:139], v18 offset:11264
ds_read_b128 v[140:143], v18 offset:16384
ds_read_b128 v[144:147], v18 offset:2048
ds_read_b128 v[148:151], v18 offset:7168
ds_read_b128 v[152:155], v18 offset:12288
ds_read_b128 v[156:159], v18 offset:17408
ds_read_b128 v[160:163], v18 offset:3072
ds_read_b128 v[164:167], v18 offset:8192
ds_read_b128 v[168:171], v18 offset:13312
ds_read_b128 v[172:175], v18 offset:18432
ds_read_b128 v[176:179], v18 offset:4096
ds_read_b128 v[180:183], v18 offset:9216
ds_read_b128 v[184:187], v18 offset:14336
ds_read_b128 v[188:191], v18 offset:19456
s_waitcnt lgkmcnt(15)
v_pk_add_f32 v[112:113], v[112:113], v[116:117]
v_pk_add_f32 v[114:115], v[114:115], v[118:119]
s_waitcnt lgkmcnt(15)
v_pk_add_f32 v[120:121], v[120:121], v[124:125]
v_pk_add_f32 v[122:123], v[122:123], v[126:127]
v_pk_add_f32 v[112:113], v[112:113], v[120:121]
v_pk_add_f32 v[114:115], v[114:115], v[122:123]
v_cvt_pk_bf16_f32 v112, v112, v113
v_cvt_pk_bf16_f32 v113, v114, v115
buffer_store_dwordx2 v[112:113], v7, s[20:23], s34 offen offset:1280
s_waitcnt lgkmcnt(14)
v_pk_add_f32 v[128:129], v[128:129], v[132:133]
v_pk_add_f32 v[130:131], v[130:131], v[134:135]
s_waitcnt lgkmcnt(12)
v_pk_add_f32 v[136:137], v[136:137], v[140:141]
v_pk_add_f32 v[138:139], v[138:139], v[142:143]
v_pk_add_f32 v[128:129], v[128:129], v[136:137]
v_pk_add_f32 v[130:131], v[130:131], v[138:139]
v_cvt_pk_bf16_f32 v128, v128, v129
v_cvt_pk_bf16_f32 v129, v130, v131
buffer_store_dwordx2 v[128:129], v7, s[20:23], s34 offen offset:1312
s_waitcnt lgkmcnt(10)
v_pk_add_f32 v[144:145], v[144:145], v[148:149]
v_pk_add_f32 v[146:147], v[146:147], v[150:151]
s_waitcnt lgkmcnt(8)
v_pk_add_f32 v[152:153], v[152:153], v[156:157]
v_pk_add_f32 v[154:155], v[154:155], v[158:159]
v_pk_add_f32 v[144:145], v[144:145], v[152:153]
v_pk_add_f32 v[146:147], v[146:147], v[154:155]
v_cvt_pk_bf16_f32 v144, v144, v145
v_cvt_pk_bf16_f32 v145, v146, v147
buffer_store_dwordx2 v[144:145], v7, s[20:23], s34 offen offset:1344
s_waitcnt lgkmcnt(6)
v_pk_add_f32 v[160:161], v[160:161], v[164:165]
v_pk_add_f32 v[162:163], v[162:163], v[166:167]
s_waitcnt lgkmcnt(4)
v_pk_add_f32 v[168:169], v[168:169], v[172:173]
v_pk_add_f32 v[170:171], v[170:171], v[174:175]
v_pk_add_f32 v[160:161], v[160:161], v[168:169]
v_pk_add_f32 v[162:163], v[162:163], v[170:171]
v_cvt_pk_bf16_f32 v160, v160, v161
v_cvt_pk_bf16_f32 v161, v162, v163
buffer_store_dwordx2 v[160:161], v7, s[20:23], s34 offen offset:1376
s_waitcnt lgkmcnt(2)
v_pk_add_f32 v[176:177], v[176:177], v[180:181]
v_pk_add_f32 v[178:179], v[178:179], v[182:183]
s_waitcnt lgkmcnt(0)
v_pk_add_f32 v[184:185], v[184:185], v[188:189]
v_pk_add_f32 v[186:187], v[186:187], v[190:191]
v_pk_add_f32 v[176:177], v[176:177], v[184:185]
v_pk_add_f32 v[178:179], v[178:179], v[186:187]
v_cvt_pk_bf16_f32 v176, v176, v177
v_cvt_pk_bf16_f32 v177, v178, v179
buffer_store_dwordx2 v[176:177], v7, s[20:23], s34 offen offset:1408
s_movk_i32 s61, 0x2000
s_mov_b32 s33, 0xffff0000
s_waitcnt vmcnt(5)
L_inchk:
v_max3_u32 v24, v52, v53, v54
v_max3_u32 v24, v24, v55, v56
v_max3_u32 v24, v24, v57, v58
v_max3_u32 v24, v24, v59, v60
v_max3_u32 v24, v24, v61, v64
v_max3_u32 v24, v24, v65, v66
v_max3_u32 v24, v24, v67, v68
v_max3_u32 v24, v24, v69, v70
v_max3_u32 v24, v24, v71, v72
v_max3_u32 v24, v24, v73, v74
v_max3_u32 v24, v24, v75, v76
v_max3_u32 v24, v24, v77, v78
v_max3_u32 v24, v24, v79, v80
v_max3_u32 v24, v24, v81, v82
v_max_u32 v24, v24, v83
v_cmp_eq_u32 vcc, -1, v24
s_cbranch_vccnz L_inretry
L_indone:
v_lshlrev_b32 v88, 16, v52
v_and_b32 v89, s33, v52
v_pk_add_f32 v[32:33], v[32:33], v[88:89]
v_lshlrev_b32 v90, 16, v53
v_and_b32 v91, s33, v53
v_pk_add_f32 v[34:35], v[34:35], v[90:91]
v_lshlrev_b32 v88, 16, v54
v_and_b32 v89, s33, v54
v_pk_add_f32 v[36:37], v[36:37], v[88:89]
v_lshlrev_b32 v90, 16, v55
v_and_b32 v91, s33, v55
v_pk_add_f32 v[38:39], v[38:39], v[90:91]
v_lshlrev_b32 v88, 16, v56
v_and_b32 v89, s33, v56
v_pk_add_f32 v[40:41], v[40:41], v[88:89]
v_lshlrev_b32 v90, 16, v57
v_and_b32 v91, s33, v57
v_pk_add_f32 v[42:43], v[42:43], v[90:91]
v_lshlrev_b32 v88, 16, v58
v_and_b32 v89, s33, v58
v_pk_add_f32 v[44:45], v[44:45], v[88:89]
v_lshlrev_b32 v90, 16, v59
v_and_b32 v91, s33, v59
v_pk_add_f32 v[46:47], v[46:47], v[90:91]
v_lshlrev_b32 v88, 16, v60
v_and_b32 v89, s33, v60
v_pk_add_f32 v[48:49], v[48:49], v[88:89]
v_lshlrev_b32 v90, 16, v61
v_and_b32 v91, s33, v61
v_pk_add_f32 v[50:51], v[50:51], v[90:91]
v_lshlrev_b32 v88, 16, v64
v_and_b32 v89, s33, v64
v_pk_add_f32 v[32:33], v[32:33], v[88:89]
v_lshlrev_b32 v90, 16, v65
v_and_b32 v91, s33, v65
v_pk_add_f32 v[34:35], v[34:35], v[90:91]
v_lshlrev_b32 v88, 16, v66
v_and_b32 v89, s33, v66
v_pk_add_f32 v[36:37], v[36:37], v[88:89]
v_lshlrev_b32 v90, 16, v67
v_and_b32 v91, s33, v67
v_pk_add_f32 v[38:39], v[38:39], v[90:91]
v_lshlrev_b32 v88, 16, v68
v_and_b32 v89, s33, v68
v_pk_add_f32 v[40:41], v[40:41], v[88:89]
v_lshlrev_b32 v90, 16, v69
v_and_b32 v91, s33, v69
v_pk_add_f32 v[42:43], v[42:43], v[90:91]
v_lshlrev_b32 v88, 16, v70
v_and_b32 v89, s33, v70
v_pk_add_f32 v[44:45], v[44:45], v[88:89]
v_lshlrev_b32 v90, 16, v71
v_and_b32 v91, s33, v71
v_pk_add_f32 v[46:47], v[46:47], v[90:91]
v_lshlrev_b32 v88, 16, v72
v_and_b32 v89, s33, v72
v_pk_add_f32 v[48:49], v[48:49], v[88:89]
v_lshlrev_b32 v90, 16, v73
v_and_b32 v91, s33, v73
v_pk_add_f32 v[50:51], v[50:51], v[90:91]
v_lshlrev_b32 v88, 16, v74
v_and_b32 v89, s33, v74
v_pk_add_f32 v[32:33], v[32:33], v[88:89]
v_lshlrev_b32 v90, 16, v75
v_and_b32 v91, s33, v75
v_pk_add_f32 v[34:35], v[34:35], v[90:91]
v_lshlrev_b32 v88, 16, v76
v_and_b32 v89, s33, v76
v_pk_add_f32 v[36:37], v[36:37], v[88:89]
v_lshlrev_b32 v90, 16, v77
v_and_b32 v91, s33, v77
v_pk_add_f32 v[38:39], v[38:39], v[90:91]
v_lshlrev_b32 v88, 16, v78
v_and_b32 v89, s33, v78
v_pk_add_f32 v[40:41], v[40:41], v[88:89]
v_lshlrev_b32 v90, 16, v79
v_and_b32 v91, s33, v79
v_pk_add_f32 v[42:43], v[42:43], v[90:91]
v_lshlrev_b32 v88, 16, v80
v_and_b32 v89, s33, v80
v_pk_add_f32 v[44:45], v[44:45], v[88:89]
v_lshlrev_b32 v90, 16, v81
v_and_b32 v91, s33, v81
v_pk_add_f32 v[46:47], v[46:47], v[90:91]
v_lshlrev_b32 v88, 16, v82
v_and_b32 v89, s33, v82
v_pk_add_f32 v[48:49], v[48:49], v[88:89]
v_lshlrev_b32 v90, 16, v83
v_and_b32 v91, s33, v83
v_pk_add_f32 v[50:51], v[50:51], v[90:91]
v_cvt_pk_bf16_f32 v32, v32, v33
v_cvt_pk_bf16_f32 v33, v34, v35
buffer_store_dwordx2 v[32:33], v7, s[20:23], s48 offen offset:0
v_cvt_pk_bf16_f32 v36, v36, v37
v_cvt_pk_bf16_f32 v37, v38, v39
buffer_store_dwordx2 v[36:37], v7, s[20:23], s48 offen offset:32
v_cvt_pk_bf16_f32 v40, v40, v41
v_cvt_pk_bf16_f32 v41, v42, v43
buffer_store_dwordx2 v[40:41], v7, s[20:23], s48 offen offset:64
v_cvt_pk_bf16_f32 v44, v44, v45
v_cvt_pk_bf16_f32 v45, v46, v47
buffer_store_dwordx2 v[44:45], v7, s[20:23], s48 offen offset:96
v_cvt_pk_bf16_f32 v48, v48, v49
v_cvt_pk_bf16_f32 v49, v50, v51
buffer_store_dwordx2 v[48:49], v7, s[20:23], s48 offen offset:128
L_end:
s_endpgm
LC_1:
s_cmp_lg_u32 s3, 0
s_cbranch_scc1 w0_concat_66
v_mov_b32 v31, 0
buffer_load_dword v21, v31, s[16:19], s62 offen sc1
s_waitcnt vmcnt(0)
w0_concat_66:
s_cmp_lg_u32 s3, 0
s_cbranch_scc1 spinret_concat_68
v_readfirstlane_b32 s60, v21
s_cmp_lt_u32 s60, 16
s_cbranch_scc1 spin_concat_67
spinret_concat_68:
v_mul_u32_u24 v3, 24576, v0
s_sub_u32 s34, s2, 64
s_lshl_b32 s34, s34, 7
buffer_load_dword v28, v3, s[80:83], s34 offen
s_branch LCR_1
LC_2:
s_waitcnt vmcnt(8)
s_cmp_lg_u32 s3, 0
s_cbranch_scc1 spinret_concat_70
v_readfirstlane_b32 s60, v21
s_cmp_lt_u32 s60, 16
s_cbranch_scc1 spin_concat_69
spinret_concat_70:
s_branch LCR_2
L_inretry:
s_sub_u32 s61, s61, 1
s_cmp_eq_u32 s61, 0
s_cbranch_scc1 L_indone
s_sleep 2
buffer_load_dwordx4 v[52:55], v16, s[16:19], s47 offen sc1
buffer_load_dwordx4 v[56:59], v16, s[16:19], s47 offen offset:1024 sc1
buffer_load_dwordx2 v[60:61], v10, s[16:19], s47 offen offset:2048 sc1
buffer_load_dwordx4 v[64:67], v16, s[16:19], s46 offen sc1
buffer_load_dwordx4 v[68:71], v16, s[16:19], s46 offen offset:1024 sc1
buffer_load_dwordx2 v[72:73], v10, s[16:19], s46 offen offset:2048 sc1
buffer_load_dwordx4 v[74:77], v16, s[16:19], s50 offen sc1
buffer_load_dwordx4 v[78:81], v16, s[16:19], s50 offen offset:1024 sc1
buffer_load_dwordx2 v[82:83], v10, s[16:19], s50 offen offset:2048 sc1
s_waitcnt vmcnt(0)
s_branch L_inchk
fb_concat_12:
s_call_b64 s[42:43], MK_0_1
s_call_b64 s[42:43], FB_0_1
s_call_b64 s[42:43], FB_1_1
s_branch fbret_concat_13
fb_concat_15:
s_call_b64 s[42:43], FB_0_0
s_call_b64 s[42:43], FB_1_0
s_branch fbret_concat_16
fb_concat_17:
s_call_b64 s[42:43], FB_0_1
s_call_b64 s[42:43], FB_1_1
s_branch fbret_concat_18
fb_concat_19:
s_call_b64 s[42:43], FB_0_0
s_call_b64 s[42:43], FB_1_0
s_branch fbret_concat_20
fb_concat_21:
s_call_b64 s[42:43], FB_0_1
s_call_b64 s[42:43], FB_1_1
s_branch fbret_concat_22
fb_concat_23:
s_call_b64 s[42:43], MK_0_0
s_call_b64 s[42:43], FB_0_0
s_call_b64 s[42:43], FB_1_0
s_branch fbret_concat_24
fb_concat_25:
s_call_b64 s[42:43], MK_0_1
s_call_b64 s[42:43], FB_0_1
s_call_b64 s[42:43], FB_1_1
s_branch fbret_concat_26
fb_concat_27:
s_call_b64 s[42:43], MK_0_0
s_call_b64 s[42:43], FB_0_0
s_call_b64 s[42:43], FB_1_0
s_branch fbret_concat_28
fb_concat_30:
s_call_b64 s[42:43], MK_0_1
s_call_b64 s[42:43], FB_0_1
s_call_b64 s[42:43], FB_1_1
s_branch fbret_concat_31
fb_concat_35:
s_call_b64 s[42:43], MK_1_0
s_call_b64 s[42:43], FB_1_0
s_branch fbret_concat_36
fb_concat_38:
s_call_b64 s[42:43], FB_1_0
s_branch fbret_concat_39
fb_concat_40:
s_call_b64 s[42:43], FB_1_1
s_branch fbret_concat_41
fb_concat_42:
s_call_b64 s[42:43], FB_1_0
s_branch fbret_concat_43
fb_concat_44:
s_call_b64 s[42:43], FB_1_1
s_branch fbret_concat_45
fb_concat_46:
s_call_b64 s[42:43], MK_1_0
s_call_b64 s[42:43], FB_1_0
s_branch fbret_concat_47
fb_concat_48:
s_call_b64 s[42:43], MK_1_1
s_call_b64 s[42:43], FB_1_1
s_branch fbret_concat_49
fb_concat_50:
s_call_b64 s[42:43], MK_1_0
s_call_b64 s[42:43], FB_1_0
s_branch fbret_concat_51
fb_concat_53:
s_call_b64 s[42:43], MK_1_1
s_call_b64 s[42:43], FB_1_1
s_branch fbret_concat_54
FB_0_0:
s_nop 7
v_max3_f32 v208, v32, v33, v34
v_max3_f32 v208, v208, v35, v40
v_max3_f32 v208, v208, v41, v42
v_max_f32 v208, v208, v43
v_mov_b32 v209, v208
s_nop 1
v_permlane32_swap_b32 v209, v208
v_max_f32 v208, v208, v209
v_mov_b32 v209, v208
s_nop 1
v_permlane16_swap_b32 v209, v208
v_max_f32 v208, v208, v209
v_add_f32 v208, 0x42c80000, v208
v_max_f32 v208, 0, v208
v_exp_f32 v210, -v208
v_sub_f32 v192, v192, v208
v_sub_f32 v193, v193, v208
v_sub_f32 v194, v194, v208
v_sub_f32 v195, v195, v208
v_sub_f32 v32, v32, v208
v_sub_f32 v33, v33, v208
v_sub_f32 v34, v34, v208
v_sub_f32 v35, v35, v208
v_sub_f32 v40, v40, v208
v_sub_f32 v41, v41, v208
v_sub_f32 v42, v42, v208
v_sub_f32 v43, v43, v208
v_sub_f32 v48, v48, v208
v_sub_f32 v49, v49, v208
v_sub_f32 v50, v50, v208
v_sub_f32 v51, v51, v208
v_sub_f32 v56, v56, v208
v_sub_f32 v57, v57, v208
v_sub_f32 v58, v58, v208
v_sub_f32 v59, v59, v208
v_accvgpr_read_b32 v212, a0
v_accvgpr_read_b32 v213, a1
v_accvgpr_read_b32 v214, a2
v_accvgpr_read_b32 v215, a3
v_mul_f32 v212, v212, v210
v_mul_f32 v213, v213, v210
v_mul_f32 v214, v214, v210
v_mul_f32 v215, v215, v210
v_accvgpr_write_b32 a0, v212
v_accvgpr_write_b32 a1, v213
v_accvgpr_write_b32 a2, v214
v_accvgpr_write_b32 a3, v215
v_accvgpr_read_b32 v212, a8
v_accvgpr_read_b32 v213, a9
v_accvgpr_read_b32 v214, a10
v_accvgpr_read_b32 v215, a11
v_mul_f32 v212, v212, v210
v_mul_f32 v213, v213, v210
v_mul_f32 v214, v214, v210
v_mul_f32 v215, v215, v210
v_accvgpr_write_b32 a8, v212
v_accvgpr_write_b32 a9, v213
v_accvgpr_write_b32 a10, v214
v_accvgpr_write_b32 a11, v215
v_accvgpr_read_b32 v212, a16
v_accvgpr_read_b32 v213, a17
v_accvgpr_read_b32 v214, a18
v_accvgpr_read_b32 v215, a19
v_mul_f32 v212, v212, v210
v_mul_f32 v213, v213, v210
v_mul_f32 v214, v214, v210
v_mul_f32 v215, v215, v210
v_accvgpr_write_b32 a16, v212
v_accvgpr_write_b32 a17, v213
v_accvgpr_write_b32 a18, v214
v_accvgpr_write_b32 a19, v215
v_accvgpr_read_b32 v212, a24
v_accvgpr_read_b32 v213, a25
v_accvgpr_read_b32 v214, a26
v_accvgpr_read_b32 v215, a27
v_mul_f32 v212, v212, v210
v_mul_f32 v213, v213, v210
v_mul_f32 v214, v214, v210
v_mul_f32 v215, v215, v210
v_accvgpr_write_b32 a24, v212
v_accvgpr_write_b32 a25, v213
v_accvgpr_write_b32 a26, v214
v_accvgpr_write_b32 a27, v215
v_accvgpr_read_b32 v212, a32
v_accvgpr_read_b32 v213, a33
v_accvgpr_read_b32 v214, a34
v_accvgpr_read_b32 v215, a35
v_mul_f32 v212, v212, v210
v_mul_f32 v213, v213, v210
v_mul_f32 v214, v214, v210
v_mul_f32 v215, v215, v210
v_accvgpr_write_b32 a32, v212
v_accvgpr_write_b32 a33, v213
v_accvgpr_write_b32 a34, v214
v_accvgpr_write_b32 a35, v215
v_accvgpr_read_b32 v212, a40
v_accvgpr_read_b32 v213, a41
v_accvgpr_read_b32 v214, a42
v_accvgpr_read_b32 v215, a43
v_mul_f32 v212, v212, v210
v_mul_f32 v213, v213, v210
v_mul_f32 v214, v214, v210
v_mul_f32 v215, v215, v210
v_accvgpr_write_b32 a40, v212
v_accvgpr_write_b32 a41, v213
v_accvgpr_write_b32 a42, v214
v_accvgpr_write_b32 a43, v215
v_accvgpr_read_b32 v212, a48
v_accvgpr_read_b32 v213, a49
v_accvgpr_read_b32 v214, a50
v_accvgpr_read_b32 v215, a51
v_mul_f32 v212, v212, v210
v_mul_f32 v213, v213, v210
v_mul_f32 v214, v214, v210
v_mul_f32 v215, v215, v210
v_accvgpr_write_b32 a48, v212
v_accvgpr_write_b32 a49, v213
v_accvgpr_write_b32 a50, v214
v_accvgpr_write_b32 a51, v215
v_accvgpr_read_b32 v212, a56
v_accvgpr_read_b32 v213, a57
v_accvgpr_read_b32 v214, a58
v_accvgpr_read_b32 v215, a59
v_mul_f32 v212, v212, v210
v_mul_f32 v213, v213, v210
v_mul_f32 v214, v214, v210
v_mul_f32 v215, v215, v210
v_accvgpr_write_b32 a56, v212
v_accvgpr_write_b32 a57, v213
v_accvgpr_write_b32 a58, v214
v_accvgpr_write_b32 a59, v215
v_accvgpr_read_b32 v212, a128
v_accvgpr_read_b32 v213, a129
v_accvgpr_read_b32 v214, a130
v_accvgpr_read_b32 v215, a131
v_mul_f32 v212, v212, v210
v_mul_f32 v213, v213, v210
v_mul_f32 v214, v214, v210
v_mul_f32 v215, v215, v210
v_accvgpr_write_b32 a128, v212
v_accvgpr_write_b32 a129, v213
v_accvgpr_write_b32 a130, v214
v_accvgpr_write_b32 a131, v215
v_max3_f32 v208, v36, v37, v38
v_max3_f32 v208, v208, v39, v44
v_max3_f32 v208, v208, v45, v46
v_max_f32 v208, v208, v47
v_mov_b32 v209, v208
s_nop 1
v_permlane32_swap_b32 v209, v208
v_max_f32 v208, v208, v209
v_mov_b32 v209, v208
s_nop 1
v_permlane16_swap_b32 v209, v208
v_max_f32 v208, v208, v209
v_add_f32 v208, 0x42c80000, v208
v_max_f32 v208, 0, v208
v_exp_f32 v210, -v208
v_sub_f32 v196, v196, v208
v_sub_f32 v197, v197, v208
v_sub_f32 v198, v198, v208
v_sub_f32 v199, v199, v208
v_sub_f32 v36, v36, v208
v_sub_f32 v37, v37, v208
v_sub_f32 v38, v38, v208
v_sub_f32 v39, v39, v208
v_sub_f32 v44, v44, v208
v_sub_f32 v45, v45, v208
v_sub_f32 v46, v46, v208
v_sub_f32 v47, v47, v208
v_sub_f32 v52, v52, v208
v_sub_f32 v53, v53, v208
v_sub_f32 v54, v54, v208
v_sub_f32 v55, v55, v208
v_sub_f32 v60, v60, v208
v_sub_f32 v61, v61, v208
v_sub_f32 v62, v62, v208
v_sub_f32 v63, v63, v208
v_accvgpr_read_b32 v212, a4
v_accvgpr_read_b32 v213, a5
v_accvgpr_read_b32 v214, a6
v_accvgpr_read_b32 v215, a7
v_mul_f32 v212, v212, v210
v_mul_f32 v213, v213, v210
v_mul_f32 v214, v214, v210
v_mul_f32 v215, v215, v210
v_accvgpr_write_b32 a4, v212
v_accvgpr_write_b32 a5, v213
v_accvgpr_write_b32 a6, v214
v_accvgpr_write_b32 a7, v215
v_accvgpr_read_b32 v212, a12
v_accvgpr_read_b32 v213, a13
v_accvgpr_read_b32 v214, a14
v_accvgpr_read_b32 v215, a15
v_mul_f32 v212, v212, v210
v_mul_f32 v213, v213, v210
v_mul_f32 v214, v214, v210
v_mul_f32 v215, v215, v210
v_accvgpr_write_b32 a12, v212
v_accvgpr_write_b32 a13, v213
v_accvgpr_write_b32 a14, v214
v_accvgpr_write_b32 a15, v215
v_accvgpr_read_b32 v212, a20
v_accvgpr_read_b32 v213, a21
v_accvgpr_read_b32 v214, a22
v_accvgpr_read_b32 v215, a23
v_mul_f32 v212, v212, v210
v_mul_f32 v213, v213, v210
v_mul_f32 v214, v214, v210
v_mul_f32 v215, v215, v210
v_accvgpr_write_b32 a20, v212
v_accvgpr_write_b32 a21, v213
v_accvgpr_write_b32 a22, v214
v_accvgpr_write_b32 a23, v215
v_accvgpr_read_b32 v212, a28
v_accvgpr_read_b32 v213, a29
v_accvgpr_read_b32 v214, a30
v_accvgpr_read_b32 v215, a31
v_mul_f32 v212, v212, v210
v_mul_f32 v213, v213, v210
v_mul_f32 v214, v214, v210
v_mul_f32 v215, v215, v210
v_accvgpr_write_b32 a28, v212
v_accvgpr_write_b32 a29, v213
v_accvgpr_write_b32 a30, v214
v_accvgpr_write_b32 a31, v215
v_accvgpr_read_b32 v212, a36
v_accvgpr_read_b32 v213, a37
v_accvgpr_read_b32 v214, a38
v_accvgpr_read_b32 v215, a39
v_mul_f32 v212, v212, v210
v_mul_f32 v213, v213, v210
v_mul_f32 v214, v214, v210
v_mul_f32 v215, v215, v210
v_accvgpr_write_b32 a36, v212
v_accvgpr_write_b32 a37, v213
v_accvgpr_write_b32 a38, v214
v_accvgpr_write_b32 a39, v215
v_accvgpr_read_b32 v212, a44
v_accvgpr_read_b32 v213, a45
v_accvgpr_read_b32 v214, a46
v_accvgpr_read_b32 v215, a47
v_mul_f32 v212, v212, v210
v_mul_f32 v213, v213, v210
v_mul_f32 v214, v214, v210
v_mul_f32 v215, v215, v210
v_accvgpr_write_b32 a44, v212
v_accvgpr_write_b32 a45, v213
v_accvgpr_write_b32 a46, v214
v_accvgpr_write_b32 a47, v215
v_accvgpr_read_b32 v212, a52
v_accvgpr_read_b32 v213, a53
v_accvgpr_read_b32 v214, a54
v_accvgpr_read_b32 v215, a55
v_mul_f32 v212, v212, v210
v_mul_f32 v213, v213, v210
v_mul_f32 v214, v214, v210
v_mul_f32 v215, v215, v210
v_accvgpr_write_b32 a52, v212
v_accvgpr_write_b32 a53, v213
v_accvgpr_write_b32 a54, v214
v_accvgpr_write_b32 a55, v215
v_accvgpr_read_b32 v212, a60
v_accvgpr_read_b32 v213, a61
v_accvgpr_read_b32 v214, a62
v_accvgpr_read_b32 v215, a63
v_mul_f32 v212, v212, v210
v_mul_f32 v213, v213, v210
v_mul_f32 v214, v214, v210
v_mul_f32 v215, v215, v210
v_accvgpr_write_b32 a60, v212
v_accvgpr_write_b32 a61, v213
v_accvgpr_write_b32 a62, v214
v_accvgpr_write_b32 a63, v215
v_accvgpr_read_b32 v212, a132
v_accvgpr_read_b32 v213, a133
v_accvgpr_read_b32 v214, a134
v_accvgpr_read_b32 v215, a135
v_mul_f32 v212, v212, v210
v_mul_f32 v213, v213, v210
v_mul_f32 v214, v214, v210
v_mul_f32 v215, v215, v210
v_accvgpr_write_b32 a132, v212
v_accvgpr_write_b32 a133, v213
v_accvgpr_write_b32 a134, v214
v_accvgpr_write_b32 a135, v215
v_exp_f32 v228, v32
v_exp_f32 v229, v33
s_nop 0
v_cvt_pk_bf16_f32 v160, v228, v229
v_exp_f32 v230, v34
v_exp_f32 v231, v35
s_nop 0
v_cvt_pk_bf16_f32 v161, v230, v231
v_exp_f32 v232, v36
v_exp_f32 v233, v37
s_nop 0
v_cvt_pk_bf16_f32 v164, v232, v233
v_exp_f32 v234, v38
v_exp_f32 v235, v39
s_nop 0
v_cvt_pk_bf16_f32 v165, v234, v235
v_exp_f32 v228, v40
v_exp_f32 v229, v41
s_nop 0
v_cvt_pk_bf16_f32 v162, v228, v229
v_exp_f32 v230, v42
v_exp_f32 v231, v43
s_nop 0
v_cvt_pk_bf16_f32 v163, v230, v231
v_exp_f32 v232, v44
v_exp_f32 v233, v45
s_nop 0
v_cvt_pk_bf16_f32 v166, v232, v233
v_exp_f32 v234, v46
v_exp_f32 v235, v47
s_nop 0
v_cvt_pk_bf16_f32 v167, v234, v235
s_nop 1
s_setpc_b64 s[42:43]
MK_0_0:
s_lshl_b32 s60, s37, 5
v_add_u32 v238, s60, v237
v_cmp_le_i32 s[44:45], 0, v238
v_cmp_le_i32 s[46:47], 1, v238
v_cmp_le_i32 s[48:49], 2, v238
v_cmp_le_i32 s[50:51], 3, v238
v_cndmask_b32 v32, v239, v32, s[44:45]
v_cndmask_b32 v33, v239, v33, s[46:47]
v_cndmask_b32 v34, v239, v34, s[48:49]
v_cndmask_b32 v35, v239, v35, s[50:51]
v_cndmask_b32 v44, v239, v44, s[44:45]
v_cndmask_b32 v45, v239, v45, s[46:47]
v_cndmask_b32 v46, v239, v46, s[48:49]
v_cndmask_b32 v47, v239, v47, s[50:51]
v_cmp_le_i32 s[44:45], -16, v238
v_cmp_le_i32 s[46:47], -15, v238
v_cmp_le_i32 s[48:49], -14, v238
v_cmp_le_i32 s[50:51], -13, v238
v_cndmask_b32 v36, v239, v36, s[44:45]
v_cndmask_b32 v37, v239, v37, s[46:47]
v_cndmask_b32 v38, v239, v38, s[48:49]
v_cndmask_b32 v39, v239, v39, s[50:51]
v_cmp_le_i32 s[44:45], 16, v238
v_cmp_le_i32 s[46:47], 17, v238
v_cmp_le_i32 s[48:49], 18, v238
v_cmp_le_i32 s[50:51], 19, v238
v_cndmask_b32 v40, v239, v40, s[44:45]
v_cndmask_b32 v41, v239, v41, s[46:47]
v_cndmask_b32 v42, v239, v42, s[48:49]
v_cndmask_b32 v43, v239, v43, s[50:51]
s_setpc_b64 s[42:43]
FB_0_1:
s_nop 7
v_max3_f32 v208, v48, v49, v50
v_max3_f32 v208, v208, v51, v56
v_max3_f32 v208, v208, v57, v58
v_max_f32 v208, v208, v59
v_mov_b32 v209, v208
s_nop 1
v_permlane32_swap_b32 v209, v208
v_max_f32 v208, v208, v209
v_mov_b32 v209, v208
s_nop 1
v_permlane16_swap_b32 v209, v208
v_max_f32 v208, v208, v209
v_add_f32 v208, 0x42c80000, v208
v_max_f32 v208, 0, v208
v_exp_f32 v210, -v208
v_sub_f32 v192, v192, v208
v_sub_f32 v193, v193, v208
v_sub_f32 v194, v194, v208
v_sub_f32 v195, v195, v208
v_sub_f32 v32, v32, v208
v_sub_f32 v33, v33, v208
v_sub_f32 v34, v34, v208
v_sub_f32 v35, v35, v208
v_sub_f32 v40, v40, v208
v_sub_f32 v41, v41, v208
v_sub_f32 v42, v42, v208
v_sub_f32 v43, v43, v208
v_sub_f32 v48, v48, v208
v_sub_f32 v49, v49, v208
v_sub_f32 v50, v50, v208
v_sub_f32 v51, v51, v208
v_sub_f32 v56, v56, v208
v_sub_f32 v57, v57, v208
v_sub_f32 v58, v58, v208
v_sub_f32 v59, v59, v208
v_accvgpr_read_b32 v212, a0
v_accvgpr_read_b32 v213, a1
v_accvgpr_read_b32 v214, a2
v_accvgpr_read_b32 v215, a3
v_mul_f32 v212, v212, v210
v_mul_f32 v213, v213, v210
v_mul_f32 v214, v214, v210
v_mul_f32 v215, v215, v210
v_accvgpr_write_b32 a0, v212
v_accvgpr_write_b32 a1, v213
v_accvgpr_write_b32 a2, v214
v_accvgpr_write_b32 a3, v215
v_accvgpr_read_b32 v212, a8
v_accvgpr_read_b32 v213, a9
v_accvgpr_read_b32 v214, a10
v_accvgpr_read_b32 v215, a11
v_mul_f32 v212, v212, v210
v_mul_f32 v213, v213, v210
v_mul_f32 v214, v214, v210
v_mul_f32 v215, v215, v210
v_accvgpr_write_b32 a8, v212
v_accvgpr_write_b32 a9, v213
v_accvgpr_write_b32 a10, v214
v_accvgpr_write_b32 a11, v215
v_accvgpr_read_b32 v212, a16
v_accvgpr_read_b32 v213, a17
v_accvgpr_read_b32 v214, a18
v_accvgpr_read_b32 v215, a19
v_mul_f32 v212, v212, v210
v_mul_f32 v213, v213, v210
v_mul_f32 v214, v214, v210
v_mul_f32 v215, v215, v210
v_accvgpr_write_b32 a16, v212
v_accvgpr_write_b32 a17, v213
v_accvgpr_write_b32 a18, v214
v_accvgpr_write_b32 a19, v215
v_accvgpr_read_b32 v212, a24
v_accvgpr_read_b32 v213, a25
v_accvgpr_read_b32 v214, a26
v_accvgpr_read_b32 v215, a27
v_mul_f32 v212, v212, v210
v_mul_f32 v213, v213, v210
v_mul_f32 v214, v214, v210
v_mul_f32 v215, v215, v210
v_accvgpr_write_b32 a24, v212
v_accvgpr_write_b32 a25, v213
v_accvgpr_write_b32 a26, v214
v_accvgpr_write_b32 a27, v215
v_accvgpr_read_b32 v212, a32
v_accvgpr_read_b32 v213, a33
v_accvgpr_read_b32 v214, a34
v_accvgpr_read_b32 v215, a35
v_mul_f32 v212, v212, v210
v_mul_f32 v213, v213, v210
v_mul_f32 v214, v214, v210
v_mul_f32 v215, v215, v210
v_accvgpr_write_b32 a32, v212
v_accvgpr_write_b32 a33, v213
v_accvgpr_write_b32 a34, v214
v_accvgpr_write_b32 a35, v215
v_accvgpr_read_b32 v212, a40
v_accvgpr_read_b32 v213, a41
v_accvgpr_read_b32 v214, a42
v_accvgpr_read_b32 v215, a43
v_mul_f32 v212, v212, v210
v_mul_f32 v213, v213, v210
v_mul_f32 v214, v214, v210
v_mul_f32 v215, v215, v210
v_accvgpr_write_b32 a40, v212
v_accvgpr_write_b32 a41, v213
v_accvgpr_write_b32 a42, v214
v_accvgpr_write_b32 a43, v215
v_accvgpr_read_b32 v212, a48
v_accvgpr_read_b32 v213, a49
v_accvgpr_read_b32 v214, a50
v_accvgpr_read_b32 v215, a51
v_mul_f32 v212, v212, v210
v_mul_f32 v213, v213, v210
v_mul_f32 v214, v214, v210
v_mul_f32 v215, v215, v210
v_accvgpr_write_b32 a48, v212
v_accvgpr_write_b32 a49, v213
v_accvgpr_write_b32 a50, v214
v_accvgpr_write_b32 a51, v215
v_accvgpr_read_b32 v212, a56
v_accvgpr_read_b32 v213, a57
v_accvgpr_read_b32 v214, a58
v_accvgpr_read_b32 v215, a59
v_mul_f32 v212, v212, v210
v_mul_f32 v213, v213, v210
v_mul_f32 v214, v214, v210
v_mul_f32 v215, v215, v210
v_accvgpr_write_b32 a56, v212
v_accvgpr_write_b32 a57, v213
v_accvgpr_write_b32 a58, v214
v_accvgpr_write_b32 a59, v215
v_accvgpr_read_b32 v212, a128
v_accvgpr_read_b32 v213, a129
v_accvgpr_read_b32 v214, a130
v_accvgpr_read_b32 v215, a131
v_mul_f32 v212, v212, v210
v_mul_f32 v213, v213, v210
v_mul_f32 v214, v214, v210
v_mul_f32 v215, v215, v210
v_accvgpr_write_b32 a128, v212
v_accvgpr_write_b32 a129, v213
v_accvgpr_write_b32 a130, v214
v_accvgpr_write_b32 a131, v215
v_max3_f32 v208, v52, v53, v54
v_max3_f32 v208, v208, v55, v60
v_max3_f32 v208, v208, v61, v62
v_max_f32 v208, v208, v63
v_mov_b32 v209, v208
s_nop 1
v_permlane32_swap_b32 v209, v208
v_max_f32 v208, v208, v209
v_mov_b32 v209, v208
s_nop 1
v_permlane16_swap_b32 v209, v208
v_max_f32 v208, v208, v209
v_add_f32 v208, 0x42c80000, v208
v_max_f32 v208, 0, v208
v_exp_f32 v210, -v208
v_sub_f32 v196, v196, v208
v_sub_f32 v197, v197, v208
v_sub_f32 v198, v198, v208
v_sub_f32 v199, v199, v208
v_sub_f32 v36, v36, v208
v_sub_f32 v37, v37, v208
v_sub_f32 v38, v38, v208
v_sub_f32 v39, v39, v208
v_sub_f32 v44, v44, v208
v_sub_f32 v45, v45, v208
v_sub_f32 v46, v46, v208
v_sub_f32 v47, v47, v208
v_sub_f32 v52, v52, v208
v_sub_f32 v53, v53, v208
v_sub_f32 v54, v54, v208
v_sub_f32 v55, v55, v208
v_sub_f32 v60, v60, v208
v_sub_f32 v61, v61, v208
v_sub_f32 v62, v62, v208
v_sub_f32 v63, v63, v208
v_accvgpr_read_b32 v212, a4
v_accvgpr_read_b32 v213, a5
v_accvgpr_read_b32 v214, a6
v_accvgpr_read_b32 v215, a7
v_mul_f32 v212, v212, v210
v_mul_f32 v213, v213, v210
v_mul_f32 v214, v214, v210
v_mul_f32 v215, v215, v210
v_accvgpr_write_b32 a4, v212
v_accvgpr_write_b32 a5, v213
v_accvgpr_write_b32 a6, v214
v_accvgpr_write_b32 a7, v215
v_accvgpr_read_b32 v212, a12
v_accvgpr_read_b32 v213, a13
v_accvgpr_read_b32 v214, a14
v_accvgpr_read_b32 v215, a15
v_mul_f32 v212, v212, v210
v_mul_f32 v213, v213, v210
v_mul_f32 v214, v214, v210
v_mul_f32 v215, v215, v210
v_accvgpr_write_b32 a12, v212
v_accvgpr_write_b32 a13, v213
v_accvgpr_write_b32 a14, v214
v_accvgpr_write_b32 a15, v215
v_accvgpr_read_b32 v212, a20
v_accvgpr_read_b32 v213, a21
v_accvgpr_read_b32 v214, a22
v_accvgpr_read_b32 v215, a23
v_mul_f32 v212, v212, v210
v_mul_f32 v213, v213, v210
v_mul_f32 v214, v214, v210
v_mul_f32 v215, v215, v210
v_accvgpr_write_b32 a20, v212
v_accvgpr_write_b32 a21, v213
v_accvgpr_write_b32 a22, v214
v_accvgpr_write_b32 a23, v215
v_accvgpr_read_b32 v212, a28
v_accvgpr_read_b32 v213, a29
v_accvgpr_read_b32 v214, a30
v_accvgpr_read_b32 v215, a31
v_mul_f32 v212, v212, v210
v_mul_f32 v213, v213, v210
v_mul_f32 v214, v214, v210
v_mul_f32 v215, v215, v210
v_accvgpr_write_b32 a28, v212
v_accvgpr_write_b32 a29, v213
v_accvgpr_write_b32 a30, v214
v_accvgpr_write_b32 a31, v215
v_accvgpr_read_b32 v212, a36
v_accvgpr_read_b32 v213, a37
v_accvgpr_read_b32 v214, a38
v_accvgpr_read_b32 v215, a39
v_mul_f32 v212, v212, v210
v_mul_f32 v213, v213, v210
v_mul_f32 v214, v214, v210
v_mul_f32 v215, v215, v210
v_accvgpr_write_b32 a36, v212
v_accvgpr_write_b32 a37, v213
v_accvgpr_write_b32 a38, v214
v_accvgpr_write_b32 a39, v215
v_accvgpr_read_b32 v212, a44
v_accvgpr_read_b32 v213, a45
v_accvgpr_read_b32 v214, a46
v_accvgpr_read_b32 v215, a47
v_mul_f32 v212, v212, v210
v_mul_f32 v213, v213, v210
v_mul_f32 v214, v214, v210
v_mul_f32 v215, v215, v210
v_accvgpr_write_b32 a44, v212
v_accvgpr_write_b32 a45, v213
v_accvgpr_write_b32 a46, v214
v_accvgpr_write_b32 a47, v215
v_accvgpr_read_b32 v212, a52
v_accvgpr_read_b32 v213, a53
v_accvgpr_read_b32 v214, a54
v_accvgpr_read_b32 v215, a55
v_mul_f32 v212, v212, v210
v_mul_f32 v213, v213, v210
v_mul_f32 v214, v214, v210
v_mul_f32 v215, v215, v210
v_accvgpr_write_b32 a52, v212
v_accvgpr_write_b32 a53, v213
v_accvgpr_write_b32 a54, v214
v_accvgpr_write_b32 a55, v215
v_accvgpr_read_b32 v212, a60
v_accvgpr_read_b32 v213, a61
v_accvgpr_read_b32 v214, a62
v_accvgpr_read_b32 v215, a63
v_mul_f32 v212, v212, v210
v_mul_f32 v213, v213, v210
v_mul_f32 v214, v214, v210
v_mul_f32 v215, v215, v210
v_accvgpr_write_b32 a60, v212
v_accvgpr_write_b32 a61, v213
v_accvgpr_write_b32 a62, v214
v_accvgpr_write_b32 a63, v215
v_accvgpr_read_b32 v212, a132
v_accvgpr_read_b32 v213, a133
v_accvgpr_read_b32 v214, a134
v_accvgpr_read_b32 v215, a135
v_mul_f32 v212, v212, v210
v_mul_f32 v213, v213, v210
v_mul_f32 v214, v214, v210
v_mul_f32 v215, v215, v210
v_accvgpr_write_b32 a132, v212
v_accvgpr_write_b32 a133, v213
v_accvgpr_write_b32 a134, v214
v_accvgpr_write_b32 a135, v215
v_exp_f32 v228, v48
v_exp_f32 v229, v49
s_nop 0
v_cvt_pk_bf16_f32 v168, v228, v229
v_exp_f32 v230, v50
v_exp_f32 v231, v51
s_nop 0
v_cvt_pk_bf16_f32 v169, v230, v231
v_exp_f32 v232, v52
v_exp_f32 v233, v53
s_nop 0
v_cvt_pk_bf16_f32 v172, v232, v233
v_exp_f32 v234, v54
v_exp_f32 v235, v55
s_nop 0
v_cvt_pk_bf16_f32 v173, v234, v235
v_exp_f32 v228, v56
v_exp_f32 v229, v57
s_nop 0
v_cvt_pk_bf16_f32 v170, v228, v229
v_exp_f32 v230, v58
v_exp_f32 v231, v59
s_nop 0
v_cvt_pk_bf16_f32 v171, v230, v231
v_exp_f32 v232, v60
v_exp_f32 v233, v61
s_nop 0
v_cvt_pk_bf16_f32 v174, v232, v233
v_exp_f32 v234, v62
v_exp_f32 v235, v63
s_nop 0
v_cvt_pk_bf16_f32 v175, v234, v235
s_nop 1
s_setpc_b64 s[42:43]
MK_0_1:
s_lshl_b32 s60, s37, 5
v_add_u32 v238, s60, v237
v_cmp_le_i32 s[44:45], 0, v238
v_cmp_le_i32 s[46:47], 1, v238
v_cmp_le_i32 s[48:49], 2, v238
v_cmp_le_i32 s[50:51], 3, v238
v_cndmask_b32 v48, v239, v48, s[44:45]
v_cndmask_b32 v49, v239, v49, s[46:47]
v_cndmask_b32 v50, v239, v50, s[48:49]
v_cndmask_b32 v51, v239, v51, s[50:51]
v_cndmask_b32 v60, v239, v60, s[44:45]
v_cndmask_b32 v61, v239, v61, s[46:47]
v_cndmask_b32 v62, v239, v62, s[48:49]
v_cndmask_b32 v63, v239, v63, s[50:51]
v_cmp_le_i32 s[44:45], -16, v238
v_cmp_le_i32 s[46:47], -15, v238
v_cmp_le_i32 s[48:49], -14, v238
v_cmp_le_i32 s[50:51], -13, v238
v_cndmask_b32 v52, v239, v52, s[44:45]
v_cndmask_b32 v53, v239, v53, s[46:47]
v_cndmask_b32 v54, v239, v54, s[48:49]
v_cndmask_b32 v55, v239, v55, s[50:51]
v_cmp_le_i32 s[44:45], 16, v238
v_cmp_le_i32 s[46:47], 17, v238
v_cmp_le_i32 s[48:49], 18, v238
v_cmp_le_i32 s[50:51], 19, v238
v_cndmask_b32 v56, v239, v56, s[44:45]
v_cndmask_b32 v57, v239, v57, s[46:47]
v_cndmask_b32 v58, v239, v58, s[48:49]
v_cndmask_b32 v59, v239, v59, s[50:51]
s_setpc_b64 s[42:43]
FB_1_0:
s_nop 7
v_max3_f32 v208, v64, v65, v66
v_max3_f32 v208, v208, v67, v72
v_max3_f32 v208, v208, v73, v74
v_max_f32 v208, v208, v75
v_mov_b32 v209, v208
s_nop 1
v_permlane32_swap_b32 v209, v208
v_max_f32 v208, v208, v209
v_mov_b32 v209, v208
s_nop 1
v_permlane16_swap_b32 v209, v208
v_max_f32 v208, v208, v209
v_add_f32 v208, 0x42c80000, v208
v_max_f32 v208, 0, v208
v_exp_f32 v210, -v208
v_sub_f32 v200, v200, v208
v_sub_f32 v201, v201, v208
v_sub_f32 v202, v202, v208
v_sub_f32 v203, v203, v208
v_sub_f32 v64, v64, v208
v_sub_f32 v65, v65, v208
v_sub_f32 v66, v66, v208
v_sub_f32 v67, v67, v208
v_sub_f32 v72, v72, v208
v_sub_f32 v73, v73, v208
v_sub_f32 v74, v74, v208
v_sub_f32 v75, v75, v208
v_sub_f32 v80, v80, v208
v_sub_f32 v81, v81, v208
v_sub_f32 v82, v82, v208
v_sub_f32 v83, v83, v208
v_sub_f32 v88, v88, v208
v_sub_f32 v89, v89, v208
v_sub_f32 v90, v90, v208
v_sub_f32 v91, v91, v208
v_accvgpr_read_b32 v212, a64
v_accvgpr_read_b32 v213, a65
v_accvgpr_read_b32 v214, a66
v_accvgpr_read_b32 v215, a67
v_mul_f32 v212, v212, v210
v_mul_f32 v213, v213, v210
v_mul_f32 v214, v214, v210
v_mul_f32 v215, v215, v210
v_accvgpr_write_b32 a64, v212
v_accvgpr_write_b32 a65, v213
v_accvgpr_write_b32 a66, v214
v_accvgpr_write_b32 a67, v215
v_accvgpr_read_b32 v212, a72
v_accvgpr_read_b32 v213, a73
v_accvgpr_read_b32 v214, a74
v_accvgpr_read_b32 v215, a75
v_mul_f32 v212, v212, v210
v_mul_f32 v213, v213, v210
v_mul_f32 v214, v214, v210
v_mul_f32 v215, v215, v210
v_accvgpr_write_b32 a72, v212
v_accvgpr_write_b32 a73, v213
v_accvgpr_write_b32 a74, v214
v_accvgpr_write_b32 a75, v215
v_accvgpr_read_b32 v212, a80
v_accvgpr_read_b32 v213, a81
v_accvgpr_read_b32 v214, a82
v_accvgpr_read_b32 v215, a83
v_mul_f32 v212, v212, v210
v_mul_f32 v213, v213, v210
v_mul_f32 v214, v214, v210
v_mul_f32 v215, v215, v210
v_accvgpr_write_b32 a80, v212
v_accvgpr_write_b32 a81, v213
v_accvgpr_write_b32 a82, v214
v_accvgpr_write_b32 a83, v215
v_accvgpr_read_b32 v212, a88
v_accvgpr_read_b32 v213, a89
v_accvgpr_read_b32 v214, a90
v_accvgpr_read_b32 v215, a91
v_mul_f32 v212, v212, v210
v_mul_f32 v213, v213, v210
v_mul_f32 v214, v214, v210
v_mul_f32 v215, v215, v210
v_accvgpr_write_b32 a88, v212
v_accvgpr_write_b32 a89, v213
v_accvgpr_write_b32 a90, v214
v_accvgpr_write_b32 a91, v215
v_accvgpr_read_b32 v212, a96
v_accvgpr_read_b32 v213, a97
v_accvgpr_read_b32 v214, a98
v_accvgpr_read_b32 v215, a99
v_mul_f32 v212, v212, v210
v_mul_f32 v213, v213, v210
v_mul_f32 v214, v214, v210
v_mul_f32 v215, v215, v210
v_accvgpr_write_b32 a96, v212
v_accvgpr_write_b32 a97, v213
v_accvgpr_write_b32 a98, v214
v_accvgpr_write_b32 a99, v215
v_accvgpr_read_b32 v212, a104
v_accvgpr_read_b32 v213, a105
v_accvgpr_read_b32 v214, a106
v_accvgpr_read_b32 v215, a107
v_mul_f32 v212, v212, v210
v_mul_f32 v213, v213, v210
v_mul_f32 v214, v214, v210
v_mul_f32 v215, v215, v210
v_accvgpr_write_b32 a104, v212
v_accvgpr_write_b32 a105, v213
v_accvgpr_write_b32 a106, v214
v_accvgpr_write_b32 a107, v215
v_accvgpr_read_b32 v212, a112
v_accvgpr_read_b32 v213, a113
v_accvgpr_read_b32 v214, a114
v_accvgpr_read_b32 v215, a115
v_mul_f32 v212, v212, v210
v_mul_f32 v213, v213, v210
v_mul_f32 v214, v214, v210
v_mul_f32 v215, v215, v210
v_accvgpr_write_b32 a112, v212
v_accvgpr_write_b32 a113, v213
v_accvgpr_write_b32 a114, v214
v_accvgpr_write_b32 a115, v215
v_accvgpr_read_b32 v212, a120
v_accvgpr_read_b32 v213, a121
v_accvgpr_read_b32 v214, a122
v_accvgpr_read_b32 v215, a123
v_mul_f32 v212, v212, v210
v_mul_f32 v213, v213, v210
v_mul_f32 v214, v214, v210
v_mul_f32 v215, v215, v210
v_accvgpr_write_b32 a120, v212
v_accvgpr_write_b32 a121, v213
v_accvgpr_write_b32 a122, v214
v_accvgpr_write_b32 a123, v215
v_accvgpr_read_b32 v212, a136
v_accvgpr_read_b32 v213, a137
v_accvgpr_read_b32 v214, a138
v_accvgpr_read_b32 v215, a139
v_mul_f32 v212, v212, v210
v_mul_f32 v213, v213, v210
v_mul_f32 v214, v214, v210
v_mul_f32 v215, v215, v210
v_accvgpr_write_b32 a136, v212
v_accvgpr_write_b32 a137, v213
v_accvgpr_write_b32 a138, v214
v_accvgpr_write_b32 a139, v215
v_max3_f32 v208, v68, v69, v70
v_max3_f32 v208, v208, v71, v76
v_max3_f32 v208, v208, v77, v78
v_max_f32 v208, v208, v79
v_mov_b32 v209, v208
s_nop 1
v_permlane32_swap_b32 v209, v208
v_max_f32 v208, v208, v209
v_mov_b32 v209, v208
s_nop 1
v_permlane16_swap_b32 v209, v208
v_max_f32 v208, v208, v209
v_add_f32 v208, 0x42c80000, v208
v_max_f32 v208, 0, v208
v_exp_f32 v210, -v208
v_sub_f32 v204, v204, v208
v_sub_f32 v205, v205, v208
v_sub_f32 v206, v206, v208
v_sub_f32 v207, v207, v208
v_sub_f32 v68, v68, v208
v_sub_f32 v69, v69, v208
v_sub_f32 v70, v70, v208
v_sub_f32 v71, v71, v208
v_sub_f32 v76, v76, v208
v_sub_f32 v77, v77, v208
v_sub_f32 v78, v78, v208
v_sub_f32 v79, v79, v208
v_sub_f32 v84, v84, v208
v_sub_f32 v85, v85, v208
v_sub_f32 v86, v86, v208
v_sub_f32 v87, v87, v208
v_sub_f32 v92, v92, v208
v_sub_f32 v93, v93, v208
v_sub_f32 v94, v94, v208
v_sub_f32 v95, v95, v208
v_accvgpr_read_b32 v212, a68
v_accvgpr_read_b32 v213, a69
v_accvgpr_read_b32 v214, a70
v_accvgpr_read_b32 v215, a71
v_mul_f32 v212, v212, v210
v_mul_f32 v213, v213, v210
v_mul_f32 v214, v214, v210
v_mul_f32 v215, v215, v210
v_accvgpr_write_b32 a68, v212
v_accvgpr_write_b32 a69, v213
v_accvgpr_write_b32 a70, v214
v_accvgpr_write_b32 a71, v215
v_accvgpr_read_b32 v212, a76
v_accvgpr_read_b32 v213, a77
v_accvgpr_read_b32 v214, a78
v_accvgpr_read_b32 v215, a79
v_mul_f32 v212, v212, v210
v_mul_f32 v213, v213, v210
v_mul_f32 v214, v214, v210
v_mul_f32 v215, v215, v210
v_accvgpr_write_b32 a76, v212
v_accvgpr_write_b32 a77, v213
v_accvgpr_write_b32 a78, v214
v_accvgpr_write_b32 a79, v215
v_accvgpr_read_b32 v212, a84
v_accvgpr_read_b32 v213, a85
v_accvgpr_read_b32 v214, a86
v_accvgpr_read_b32 v215, a87
v_mul_f32 v212, v212, v210
v_mul_f32 v213, v213, v210
v_mul_f32 v214, v214, v210
v_mul_f32 v215, v215, v210
v_accvgpr_write_b32 a84, v212
v_accvgpr_write_b32 a85, v213
v_accvgpr_write_b32 a86, v214
v_accvgpr_write_b32 a87, v215
v_accvgpr_read_b32 v212, a92
v_accvgpr_read_b32 v213, a93
v_accvgpr_read_b32 v214, a94
v_accvgpr_read_b32 v215, a95
v_mul_f32 v212, v212, v210
v_mul_f32 v213, v213, v210
v_mul_f32 v214, v214, v210
v_mul_f32 v215, v215, v210
v_accvgpr_write_b32 a92, v212
v_accvgpr_write_b32 a93, v213
v_accvgpr_write_b32 a94, v214
v_accvgpr_write_b32 a95, v215
v_accvgpr_read_b32 v212, a100
v_accvgpr_read_b32 v213, a101
v_accvgpr_read_b32 v214, a102
v_accvgpr_read_b32 v215, a103
v_mul_f32 v212, v212, v210
v_mul_f32 v213, v213, v210
v_mul_f32 v214, v214, v210
v_mul_f32 v215, v215, v210
v_accvgpr_write_b32 a100, v212
v_accvgpr_write_b32 a101, v213
v_accvgpr_write_b32 a102, v214
v_accvgpr_write_b32 a103, v215
v_accvgpr_read_b32 v212, a108
v_accvgpr_read_b32 v213, a109
v_accvgpr_read_b32 v214, a110
v_accvgpr_read_b32 v215, a111
v_mul_f32 v212, v212, v210
v_mul_f32 v213, v213, v210
v_mul_f32 v214, v214, v210
v_mul_f32 v215, v215, v210
v_accvgpr_write_b32 a108, v212
v_accvgpr_write_b32 a109, v213
v_accvgpr_write_b32 a110, v214
v_accvgpr_write_b32 a111, v215
v_accvgpr_read_b32 v212, a116
v_accvgpr_read_b32 v213, a117
v_accvgpr_read_b32 v214, a118
v_accvgpr_read_b32 v215, a119
v_mul_f32 v212, v212, v210
v_mul_f32 v213, v213, v210
v_mul_f32 v214, v214, v210
v_mul_f32 v215, v215, v210
v_accvgpr_write_b32 a116, v212
v_accvgpr_write_b32 a117, v213
v_accvgpr_write_b32 a118, v214
v_accvgpr_write_b32 a119, v215
v_accvgpr_read_b32 v212, a124
v_accvgpr_read_b32 v213, a125
v_accvgpr_read_b32 v214, a126
v_accvgpr_read_b32 v215, a127
v_mul_f32 v212, v212, v210
v_mul_f32 v213, v213, v210
v_mul_f32 v214, v214, v210
v_mul_f32 v215, v215, v210
v_accvgpr_write_b32 a124, v212
v_accvgpr_write_b32 a125, v213
v_accvgpr_write_b32 a126, v214
v_accvgpr_write_b32 a127, v215
v_accvgpr_read_b32 v212, a140
v_accvgpr_read_b32 v213, a141
v_accvgpr_read_b32 v214, a142
v_accvgpr_read_b32 v215, a143
v_mul_f32 v212, v212, v210
v_mul_f32 v213, v213, v210
v_mul_f32 v214, v214, v210
v_mul_f32 v215, v215, v210
v_accvgpr_write_b32 a140, v212
v_accvgpr_write_b32 a141, v213
v_accvgpr_write_b32 a142, v214
v_accvgpr_write_b32 a143, v215
v_exp_f32 v228, v64
v_exp_f32 v229, v65
s_nop 0
v_cvt_pk_bf16_f32 v176, v228, v229
v_exp_f32 v230, v66
v_exp_f32 v231, v67
s_nop 0
v_cvt_pk_bf16_f32 v177, v230, v231
v_exp_f32 v232, v68
v_exp_f32 v233, v69
s_nop 0
v_cvt_pk_bf16_f32 v180, v232, v233
v_exp_f32 v234, v70
v_exp_f32 v235, v71
s_nop 0
v_cvt_pk_bf16_f32 v181, v234, v235
v_exp_f32 v228, v72
v_exp_f32 v229, v73
s_nop 0
v_cvt_pk_bf16_f32 v178, v228, v229
v_exp_f32 v230, v74
v_exp_f32 v231, v75
s_nop 0
v_cvt_pk_bf16_f32 v179, v230, v231
v_exp_f32 v232, v76
v_exp_f32 v233, v77
s_nop 0
v_cvt_pk_bf16_f32 v182, v232, v233
v_exp_f32 v234, v78
v_exp_f32 v235, v79
s_nop 0
v_cvt_pk_bf16_f32 v183, v234, v235
v_exp_f32 v228, v80
v_exp_f32 v229, v81
v_exp_f32 v230, v82
v_exp_f32 v231, v83
s_nop 1
s_setpc_b64 s[42:43]
MK_1_0:
s_lshl_b32 s60, s37, 5
v_add_u32 v238, s60, v237
v_cmp_le_i32 s[44:45], 0, v238
v_cmp_le_i32 s[46:47], 1, v238
v_cmp_le_i32 s[48:49], 2, v238
v_cmp_le_i32 s[50:51], 3, v238
v_cndmask_b32 v64, v239, v64, s[44:45]
v_cndmask_b32 v65, v239, v65, s[46:47]
v_cndmask_b32 v66, v239, v66, s[48:49]
v_cndmask_b32 v67, v239, v67, s[50:51]
v_cndmask_b32 v76, v239, v76, s[44:45]
v_cndmask_b32 v77, v239, v77, s[46:47]
v_cndmask_b32 v78, v239, v78, s[48:49]
v_cndmask_b32 v79, v239, v79, s[50:51]
v_cmp_le_i32 s[44:45], -16, v238
v_cmp_le_i32 s[46:47], -15, v238
v_cmp_le_i32 s[48:49], -14, v238
v_cmp_le_i32 s[50:51], -13, v238
v_cndmask_b32 v68, v239, v68, s[44:45]
v_cndmask_b32 v69, v239, v69, s[46:47]
v_cndmask_b32 v70, v239, v70, s[48:49]
v_cndmask_b32 v71, v239, v71, s[50:51]
v_cmp_le_i32 s[44:45], 16, v238
v_cmp_le_i32 s[46:47], 17, v238
v_cmp_le_i32 s[48:49], 18, v238
v_cmp_le_i32 s[50:51], 19, v238
v_cndmask_b32 v72, v239, v72, s[44:45]
v_cndmask_b32 v73, v239, v73, s[46:47]
v_cndmask_b32 v74, v239, v74, s[48:49]
v_cndmask_b32 v75, v239, v75, s[50:51]
s_setpc_b64 s[42:43]
FB_1_1:
s_nop 7
v_max3_f32 v208, v80, v81, v82
v_max3_f32 v208, v208, v83, v88
v_max3_f32 v208, v208, v89, v90
v_max_f32 v208, v208, v91
v_mov_b32 v209, v208
s_nop 1
v_permlane32_swap_b32 v209, v208
v_max_f32 v208, v208, v209
v_mov_b32 v209, v208
s_nop 1
v_permlane16_swap_b32 v209, v208
v_max_f32 v208, v208, v209
v_add_f32 v208, 0x42c80000, v208
v_max_f32 v208, 0, v208
v_exp_f32 v210, -v208
v_sub_f32 v200, v200, v208
v_sub_f32 v201, v201, v208
v_sub_f32 v202, v202, v208
v_sub_f32 v203, v203, v208
v_sub_f32 v64, v64, v208
v_sub_f32 v65, v65, v208
v_sub_f32 v66, v66, v208
v_sub_f32 v67, v67, v208
v_sub_f32 v72, v72, v208
v_sub_f32 v73, v73, v208
v_sub_f32 v74, v74, v208
v_sub_f32 v75, v75, v208
v_sub_f32 v80, v80, v208
v_sub_f32 v81, v81, v208
v_sub_f32 v82, v82, v208
v_sub_f32 v83, v83, v208
v_sub_f32 v88, v88, v208
v_sub_f32 v89, v89, v208
v_sub_f32 v90, v90, v208
v_sub_f32 v91, v91, v208
v_accvgpr_read_b32 v212, a64
v_accvgpr_read_b32 v213, a65
v_accvgpr_read_b32 v214, a66
v_accvgpr_read_b32 v215, a67
v_mul_f32 v212, v212, v210
v_mul_f32 v213, v213, v210
v_mul_f32 v214, v214, v210
v_mul_f32 v215, v215, v210
v_accvgpr_write_b32 a64, v212
v_accvgpr_write_b32 a65, v213
v_accvgpr_write_b32 a66, v214
v_accvgpr_write_b32 a67, v215
v_accvgpr_read_b32 v212, a72
v_accvgpr_read_b32 v213, a73
v_accvgpr_read_b32 v214, a74
v_accvgpr_read_b32 v215, a75
v_mul_f32 v212, v212, v210
v_mul_f32 v213, v213, v210
v_mul_f32 v214, v214, v210
v_mul_f32 v215, v215, v210
v_accvgpr_write_b32 a72, v212
v_accvgpr_write_b32 a73, v213
v_accvgpr_write_b32 a74, v214
v_accvgpr_write_b32 a75, v215
v_accvgpr_read_b32 v212, a80
v_accvgpr_read_b32 v213, a81
v_accvgpr_read_b32 v214, a82
v_accvgpr_read_b32 v215, a83
v_mul_f32 v212, v212, v210
v_mul_f32 v213, v213, v210
v_mul_f32 v214, v214, v210
v_mul_f32 v215, v215, v210
v_accvgpr_write_b32 a80, v212
v_accvgpr_write_b32 a81, v213
v_accvgpr_write_b32 a82, v214
v_accvgpr_write_b32 a83, v215
v_accvgpr_read_b32 v212, a88
v_accvgpr_read_b32 v213, a89
v_accvgpr_read_b32 v214, a90
v_accvgpr_read_b32 v215, a91
v_mul_f32 v212, v212, v210
v_mul_f32 v213, v213, v210
v_mul_f32 v214, v214, v210
v_mul_f32 v215, v215, v210
v_accvgpr_write_b32 a88, v212
v_accvgpr_write_b32 a89, v213
v_accvgpr_write_b32 a90, v214
v_accvgpr_write_b32 a91, v215
v_accvgpr_read_b32 v212, a96
v_accvgpr_read_b32 v213, a97
v_accvgpr_read_b32 v214, a98
v_accvgpr_read_b32 v215, a99
v_mul_f32 v212, v212, v210
v_mul_f32 v213, v213, v210
v_mul_f32 v214, v214, v210
v_mul_f32 v215, v215, v210
v_accvgpr_write_b32 a96, v212
v_accvgpr_write_b32 a97, v213
v_accvgpr_write_b32 a98, v214
v_accvgpr_write_b32 a99, v215
v_accvgpr_read_b32 v212, a104
v_accvgpr_read_b32 v213, a105
v_accvgpr_read_b32 v214, a106
v_accvgpr_read_b32 v215, a107
v_mul_f32 v212, v212, v210
v_mul_f32 v213, v213, v210
v_mul_f32 v214, v214, v210
v_mul_f32 v215, v215, v210
v_accvgpr_write_b32 a104, v212
v_accvgpr_write_b32 a105, v213
v_accvgpr_write_b32 a106, v214
v_accvgpr_write_b32 a107, v215
v_accvgpr_read_b32 v212, a112
v_accvgpr_read_b32 v213, a113
v_accvgpr_read_b32 v214, a114
v_accvgpr_read_b32 v215, a115
v_mul_f32 v212, v212, v210
v_mul_f32 v213, v213, v210
v_mul_f32 v214, v214, v210
v_mul_f32 v215, v215, v210
v_accvgpr_write_b32 a112, v212
v_accvgpr_write_b32 a113, v213
v_accvgpr_write_b32 a114, v214
v_accvgpr_write_b32 a115, v215
v_accvgpr_read_b32 v212, a120
v_accvgpr_read_b32 v213, a121
v_accvgpr_read_b32 v214, a122
v_accvgpr_read_b32 v215, a123
v_mul_f32 v212, v212, v210
v_mul_f32 v213, v213, v210
v_mul_f32 v214, v214, v210
v_mul_f32 v215, v215, v210
v_accvgpr_write_b32 a120, v212
v_accvgpr_write_b32 a121, v213
v_accvgpr_write_b32 a122, v214
v_accvgpr_write_b32 a123, v215
v_accvgpr_read_b32 v212, a136
v_accvgpr_read_b32 v213, a137
v_accvgpr_read_b32 v214, a138
v_accvgpr_read_b32 v215, a139
v_mul_f32 v212, v212, v210
v_mul_f32 v213, v213, v210
v_mul_f32 v214, v214, v210
v_mul_f32 v215, v215, v210
v_accvgpr_write_b32 a136, v212
v_accvgpr_write_b32 a137, v213
v_accvgpr_write_b32 a138, v214
v_accvgpr_write_b32 a139, v215
v_max3_f32 v208, v84, v85, v86
v_max3_f32 v208, v208, v87, v92
v_max3_f32 v208, v208, v93, v94
v_max_f32 v208, v208, v95
v_mov_b32 v209, v208
s_nop 1
v_permlane32_swap_b32 v209, v208
v_max_f32 v208, v208, v209
v_mov_b32 v209, v208
s_nop 1
v_permlane16_swap_b32 v209, v208
v_max_f32 v208, v208, v209
v_add_f32 v208, 0x42c80000, v208
v_max_f32 v208, 0, v208
v_exp_f32 v210, -v208
v_sub_f32 v204, v204, v208
v_sub_f32 v205, v205, v208
v_sub_f32 v206, v206, v208
v_sub_f32 v207, v207, v208
v_sub_f32 v68, v68, v208
v_sub_f32 v69, v69, v208
v_sub_f32 v70, v70, v208
v_sub_f32 v71, v71, v208
v_sub_f32 v76, v76, v208
v_sub_f32 v77, v77, v208
v_sub_f32 v78, v78, v208
v_sub_f32 v79, v79, v208
v_sub_f32 v84, v84, v208
v_sub_f32 v85, v85, v208
v_sub_f32 v86, v86, v208
v_sub_f32 v87, v87, v208
v_sub_f32 v92, v92, v208
v_sub_f32 v93, v93, v208
v_sub_f32 v94, v94, v208
v_sub_f32 v95, v95, v208
v_accvgpr_read_b32 v212, a68
v_accvgpr_read_b32 v213, a69
v_accvgpr_read_b32 v214, a70
v_accvgpr_read_b32 v215, a71
v_mul_f32 v212, v212, v210
v_mul_f32 v213, v213, v210
v_mul_f32 v214, v214, v210
v_mul_f32 v215, v215, v210
v_accvgpr_write_b32 a68, v212
v_accvgpr_write_b32 a69, v213
v_accvgpr_write_b32 a70, v214
v_accvgpr_write_b32 a71, v215
v_accvgpr_read_b32 v212, a76
v_accvgpr_read_b32 v213, a77
v_accvgpr_read_b32 v214, a78
v_accvgpr_read_b32 v215, a79
v_mul_f32 v212, v212, v210
v_mul_f32 v213, v213, v210
v_mul_f32 v214, v214, v210
v_mul_f32 v215, v215, v210
v_accvgpr_write_b32 a76, v212
v_accvgpr_write_b32 a77, v213
v_accvgpr_write_b32 a78, v214
v_accvgpr_write_b32 a79, v215
v_accvgpr_read_b32 v212, a84
v_accvgpr_read_b32 v213, a85
v_accvgpr_read_b32 v214, a86
v_accvgpr_read_b32 v215, a87
v_mul_f32 v212, v212, v210
v_mul_f32 v213, v213, v210
v_mul_f32 v214, v214, v210
v_mul_f32 v215, v215, v210
v_accvgpr_write_b32 a84, v212
v_accvgpr_write_b32 a85, v213
v_accvgpr_write_b32 a86, v214
v_accvgpr_write_b32 a87, v215
v_accvgpr_read_b32 v212, a92
v_accvgpr_read_b32 v213, a93
v_accvgpr_read_b32 v214, a94
v_accvgpr_read_b32 v215, a95
v_mul_f32 v212, v212, v210
v_mul_f32 v213, v213, v210
v_mul_f32 v214, v214, v210
v_mul_f32 v215, v215, v210
v_accvgpr_write_b32 a92, v212
v_accvgpr_write_b32 a93, v213
v_accvgpr_write_b32 a94, v214
v_accvgpr_write_b32 a95, v215
v_accvgpr_read_b32 v212, a100
v_accvgpr_read_b32 v213, a101
v_accvgpr_read_b32 v214, a102
v_accvgpr_read_b32 v215, a103
v_mul_f32 v212, v212, v210
v_mul_f32 v213, v213, v210
v_mul_f32 v214, v214, v210
v_mul_f32 v215, v215, v210
v_accvgpr_write_b32 a100, v212
v_accvgpr_write_b32 a101, v213
v_accvgpr_write_b32 a102, v214
v_accvgpr_write_b32 a103, v215
v_accvgpr_read_b32 v212, a108
v_accvgpr_read_b32 v213, a109
v_accvgpr_read_b32 v214, a110
v_accvgpr_read_b32 v215, a111
v_mul_f32 v212, v212, v210
v_mul_f32 v213, v213, v210
v_mul_f32 v214, v214, v210
v_mul_f32 v215, v215, v210
v_accvgpr_write_b32 a108, v212
v_accvgpr_write_b32 a109, v213
v_accvgpr_write_b32 a110, v214
v_accvgpr_write_b32 a111, v215
v_accvgpr_read_b32 v212, a116
v_accvgpr_read_b32 v213, a117
v_accvgpr_read_b32 v214, a118
v_accvgpr_read_b32 v215, a119
v_mul_f32 v212, v212, v210
v_mul_f32 v213, v213, v210
v_mul_f32 v214, v214, v210
v_mul_f32 v215, v215, v210
v_accvgpr_write_b32 a116, v212
v_accvgpr_write_b32 a117, v213
v_accvgpr_write_b32 a118, v214
v_accvgpr_write_b32 a119, v215
v_accvgpr_read_b32 v212, a124
v_accvgpr_read_b32 v213, a125
v_accvgpr_read_b32 v214, a126
v_accvgpr_read_b32 v215, a127
v_mul_f32 v212, v212, v210
v_mul_f32 v213, v213, v210
v_mul_f32 v214, v214, v210
v_mul_f32 v215, v215, v210
v_accvgpr_write_b32 a124, v212
v_accvgpr_write_b32 a125, v213
v_accvgpr_write_b32 a126, v214
v_accvgpr_write_b32 a127, v215
v_accvgpr_read_b32 v212, a140
v_accvgpr_read_b32 v213, a141
v_accvgpr_read_b32 v214, a142
v_accvgpr_read_b32 v215, a143
v_mul_f32 v212, v212, v210
v_mul_f32 v213, v213, v210
v_mul_f32 v214, v214, v210
v_mul_f32 v215, v215, v210
v_accvgpr_write_b32 a140, v212
v_accvgpr_write_b32 a141, v213
v_accvgpr_write_b32 a142, v214
v_accvgpr_write_b32 a143, v215
v_exp_f32 v228, v80
v_exp_f32 v229, v81
s_nop 0
v_cvt_pk_bf16_f32 v184, v228, v229
v_exp_f32 v230, v82
v_exp_f32 v231, v83
s_nop 0
v_cvt_pk_bf16_f32 v185, v230, v231
v_exp_f32 v232, v84
v_exp_f32 v233, v85
s_nop 0
v_cvt_pk_bf16_f32 v188, v232, v233
v_exp_f32 v234, v86
v_exp_f32 v235, v87
s_nop 0
v_cvt_pk_bf16_f32 v189, v234, v235
v_exp_f32 v228, v88
v_exp_f32 v229, v89
s_nop 0
v_cvt_pk_bf16_f32 v186, v228, v229
v_exp_f32 v230, v90
v_exp_f32 v231, v91
s_nop 0
v_cvt_pk_bf16_f32 v187, v230, v231
v_exp_f32 v232, v92
v_exp_f32 v233, v93
s_nop 0
v_cvt_pk_bf16_f32 v190, v232, v233
v_exp_f32 v234, v94
v_exp_f32 v235, v95
s_nop 0
v_cvt_pk_bf16_f32 v191, v234, v235
v_exp_f32 v228, v64
v_exp_f32 v229, v65
v_exp_f32 v230, v66
v_exp_f32 v231, v67
s_nop 1
s_setpc_b64 s[42:43]
MK_1_1:
s_lshl_b32 s60, s37, 5
v_add_u32 v238, s60, v237
v_cmp_le_i32 s[44:45], 0, v238
v_cmp_le_i32 s[46:47], 1, v238
v_cmp_le_i32 s[48:49], 2, v238
v_cmp_le_i32 s[50:51], 3, v238
v_cndmask_b32 v80, v239, v80, s[44:45]
v_cndmask_b32 v81, v239, v81, s[46:47]
v_cndmask_b32 v82, v239, v82, s[48:49]
v_cndmask_b32 v83, v239, v83, s[50:51]
v_cndmask_b32 v92, v239, v92, s[44:45]
v_cndmask_b32 v93, v239, v93, s[46:47]
v_cndmask_b32 v94, v239, v94, s[48:49]
v_cndmask_b32 v95, v239, v95, s[50:51]
v_cmp_le_i32 s[44:45], -16, v238
v_cmp_le_i32 s[46:47], -15, v238
v_cmp_le_i32 s[48:49], -14, v238
v_cmp_le_i32 s[50:51], -13, v238
v_cndmask_b32 v84, v239, v84, s[44:45]
v_cndmask_b32 v85, v239, v85, s[46:47]
v_cndmask_b32 v86, v239, v86, s[48:49]
v_cndmask_b32 v87, v239, v87, s[50:51]
v_cmp_le_i32 s[44:45], 16, v238
v_cmp_le_i32 s[46:47], 17, v238
v_cmp_le_i32 s[48:49], 18, v238
v_cmp_le_i32 s[50:51], 19, v238
v_cndmask_b32 v88, v239, v88, s[44:45]
v_cndmask_b32 v89, v239, v89, s[46:47]
v_cndmask_b32 v90, v239, v90, s[48:49]
v_cndmask_b32 v91, v239, v91, s[50:51]
s_setpc_b64 s[42:43]
spin_concat_2:
s_mov_b32 s61, 0x20000
sl_concat_71:
v_mov_b32 v31, 0
buffer_load_dword v21, v31, s[24:27], 0 offen sc1
s_sub_u32 s61, s61, 1
s_cmp_eq_u32 s61, 0
s_waitcnt vmcnt(0)
s_cbranch_scc1 spinret_concat_3
v_readfirstlane_b32 s60, v21
s_cmp_lt_u32 s60, 1
s_cbranch_scc1 sn_concat_72
s_branch spinret_concat_3
sn_concat_72:
s_sleep 3
s_branch sl_concat_71
spin_concat_6:
s_mov_b32 s61, 0x20000
sl_concat_73:
v_mov_b32 v31, 0
buffer_load_dword v21, v31, s[16:19], s62 offen sc1
buffer_load_dword v20, v31, s[16:19], s63 offen sc1
s_sub_u32 s61, s61, 1
s_cmp_eq_u32 s61, 0
s_waitcnt vmcnt(0)
s_cbranch_scc1 spinret_concat_7
v_readfirstlane_b32 s60, v21
s_cmp_lt_u32 s60, 10
s_cbranch_scc1 sn_concat_74
v_readfirstlane_b32 s60, v20
s_cmp_lt_u32 s60, 40
s_cbranch_scc1 sn_concat_74
s_branch spinret_concat_7
sn_concat_74:
s_sleep 3
s_branch sl_concat_73
spin_concat_10:
s_mov_b32 s61, 0x20000
sl_concat_75:
v_mov_b32 v31, 0
buffer_load_dword v21, v31, s[16:19], s62 offen sc1
s_sub_u32 s61, s61, 1
s_cmp_eq_u32 s61, 0
s_waitcnt vmcnt(0)
s_cbranch_scc1 spinret_concat_11
v_readfirstlane_b32 s60, v21
s_cmp_lt_u32 s60, 8
s_cbranch_scc1 sn_concat_76
s_branch spinret_concat_11
sn_concat_76:
s_sleep 3
s_branch sl_concat_75
spin_concat_32:
s_mov_b32 s61, 0x20000
sl_concat_77:
v_mov_b32 v31, 0
buffer_load_dword v21, v31, s[16:19], s62 offen sc1
s_sub_u32 s61, s61, 1
s_cmp_eq_u32 s61, 0
s_waitcnt vmcnt(0)
s_cbranch_scc1 spinret_concat_33
v_readfirstlane_b32 s60, v21
s_cmp_lt_u32 s60, s41
s_cbranch_scc1 sn_concat_78
s_branch spinret_concat_33
sn_concat_78:
s_sleep 3
s_branch sl_concat_77
spin_concat_56:
s_mov_b32 s61, 0x20000
sl_concat_79:
v_mov_b32 v31, 0
buffer_load_dword v21, v31, s[16:19], s63 offen sc1
s_sub_u32 s61, s61, 1
s_cmp_eq_u32 s61, 0
s_waitcnt vmcnt(0)
s_cbranch_scc1 spinret_concat_57
v_readfirstlane_b32 s60, v21
s_cmp_lt_u32 s60, 16
s_cbranch_scc1 sn_concat_80
s_branch spinret_concat_57
sn_concat_80:
s_sleep 3
s_branch sl_concat_79
spin_concat_60:
s_mov_b32 s61, 0x20000
sl_concat_81:
v_mov_b32 v31, 0
buffer_load_dword v21, v31, s[16:19], s62 offen sc1
s_sub_u32 s61, s61, 1
s_cmp_eq_u32 s61, 0
s_waitcnt vmcnt(0)
s_cbranch_scc1 spinret_concat_61
v_readfirstlane_b32 s60, v21
s_cmp_lt_u32 s60, 8
s_cbranch_scc1 sn_concat_82
s_branch spinret_concat_61
sn_concat_82:
s_sleep 3
s_branch sl_concat_81
spin_concat_64:
s_mov_b32 s61, 0x20000
sl_concat_83:
v_mov_b32 v31, 0
buffer_load_dword v21, v31, s[16:19], s63 offen sc1
buffer_load_dword v20, v31, s[16:19], s62 offen sc1
s_sub_u32 s61, s61, 1
s_cmp_eq_u32 s61, 0
s_waitcnt vmcnt(0)
s_cbranch_scc1 spinret_concat_65
v_readfirstlane_b32 s60, v21
s_cmp_lt_u32 s60, 16
s_cbranch_scc1 sn_concat_84
v_readfirstlane_b32 s60, v20
s_cmp_lt_u32 s60, 4
s_cbranch_scc1 sn_concat_84
s_branch spinret_concat_65
sn_concat_84:
s_sleep 3
s_branch sl_concat_83
spin_concat_67:
s_mov_b32 s61, 0x20000
sl_concat_85:
v_mov_b32 v31, 0
buffer_load_dword v21, v31, s[16:19], s62 offen sc1
s_sub_u32 s61, s61, 1
s_cmp_eq_u32 s61, 0
s_waitcnt vmcnt(0)
s_cbranch_scc1 spinret_concat_68
v_readfirstlane_b32 s60, v21
s_cmp_lt_u32 s60, 16
s_cbranch_scc1 sn_concat_86
s_branch spinret_concat_68
sn_concat_86:
s_sleep 3
s_branch sl_concat_85
spin_concat_69:
s_mov_b32 s61, 0x20000
sl_concat_87:
v_mov_b32 v31, 0
buffer_load_dword v21, v31, s[16:19], s62 offen sc1
s_sub_u32 s61, s61, 1
s_cmp_eq_u32 s61, 0
s_waitcnt vmcnt(0)
s_cbranch_scc1 spinret_concat_70
v_readfirstlane_b32 s60, v21
s_cmp_lt_u32 s60, 16
s_cbranch_scc1 sn_concat_88
s_branch spinret_concat_70
sn_concat_88:
s_sleep 3
s_branch sl_concat_87
L_code_end:
.section .rodata,"a"
.p2align 6
.amdhsa_kernel concat_heads__compressed_kv_cla__linear_kernel_hedgehog__prompt_kernel
  .amdhsa_next_free_vgpr 512
  .amdhsa_next_free_sgpr 102
  .amdhsa_accum_offset 256
  .amdhsa_group_segment_fixed_size 0
  .amdhsa_kernarg_size 104
  .amdhsa_user_sgpr_count 2
  .amdhsa_user_sgpr_kernarg_segment_ptr 1
  .amdhsa_system_sgpr_workgroup_id_x 1
.end_amdhsa_kernel
```
